```python
import torch

def _softmax(x, axis=-1):
    return torch.softmax(x, dim=axis)
def _gelu(x):
    return torch.nn.functional.gelu(x, approximate="tanh")
def _silu(x):
    return torch.nn.functional.silu(x)
def _sigmoid(x):
    return torch.sigmoid(x)
def _layernorm(x, axis=-1, eps=1e-5):
    m = x.mean(dim=axis, keepdim=True)
    v = x.var(dim=axis, keepdim=True, unbiased=False)
    return (x - m) / torch.sqrt(v + eps)
def _scatter_add(tgt, idx, src, axis=0):
    return tgt.clone().index_add_(axis, idx, src)
def _segment_sum(src, seg, n):
    out = torch.zeros((n,) + src.shape[1:], dtype=src.dtype)
    return out.index_add_(0, seg, src)
def _pad(x, pw):
    flat = tuple(v for pair in reversed(pw) for v in pair)
    return torch.nn.functional.pad(x, flat)

kernel_name = 'interleave_layers__linear_kernel_hedgehog__linear_kernel_hedgehog__prompt'

def setup_inputs():

    _w = (lambda a: (lambda t: t.to(torch.bfloat16) if t.is_floating_point() else t)(torch.as_tensor(a)))
    def _A_setup():
        B, S, D, H = 1, 2048, 512, 32
        Dh = D // H
        return {
            "x": _w((lambda *s: torch.randn(*s, dtype=torch.bfloat16) * 0.1)(B, S, D)),
            "wqkv": _w((lambda *s: torch.randn(*s, dtype=torch.bfloat16) * 0.4)(D, 3 * D)),
            "w_phi": _w((lambda *s: torch.randn(*s, dtype=torch.bfloat16) * 0.4)(H, Dh, Dh) * (Dh ** -0.5)),
            "wo": _w((lambda *s: torch.randn(*s, dtype=torch.bfloat16) * 0.1)(D, D)),
        }
    _A_in = _A_setup()

    def _B_setup():
        B, S, D, H = 1, 2048, 512, 32
        Dh = D // H
        return {
            "x": _w((lambda *s: torch.randn(*s, dtype=torch.bfloat16) * 0.1)(B, S, D)),
            "wqkv": _w((lambda *s: torch.randn(*s, dtype=torch.bfloat16) * 0.8)(D, 3 * D)),
            "w_phi": _w((lambda *s: torch.randn(*s, dtype=torch.bfloat16) * 0.8)(H, Dh, Dh) * (Dh ** -0.5)),
            "wo": _w((lambda *s: torch.randn(*s, dtype=torch.bfloat16) * 0.1)(D, D)),
        }
    _B_in = _B_setup()

    return {
        "A_x": _A_in["x"],
        "A_wqkv": _A_in["wqkv"],
        "A_w_phi": _A_in["w_phi"],
        "A_wo": _A_in["wo"],
        "B_x": _B_in["x"],
        "B_wqkv": _B_in["wqkv"],
        "B_w_phi": _B_in["w_phi"],
        "B_wo": _B_in["wo"],
    }

def reference(A_x, A_wqkv, A_w_phi, A_wo, B_x, B_wqkv, B_w_phi, B_wo):
    def _A_ref(x, wqkv, w_phi, wo):
        B, S, D = x.shape
        H = 32; Dh = D // H
        qkv = (lambda x, *d: x.permute(*d))((x @ wqkv).reshape(B, S, 3, H, Dh), 2, 0, 3, 1, 4)
        q, k, v = qkv[0], qkv[1], qkv[2]
        pq = torch.einsum("bhsd,hdf->bhsf", q, w_phi)
        pk = torch.einsum("bhsd,hdf->bhsf", k, w_phi)
        phi_q = torch.concatenate([_softmax(pq, axis=-1), _softmax(-pq, axis=-1)], axis=-1)
        phi_k = torch.concatenate([_softmax(pk, axis=-1), _softmax(-pk, axis=-1)], axis=-1)
        kv = torch.einsum("bhsf,bhsd->bhfd", phi_k, v)
        z  = torch.einsum("bhsf->bhf", phi_k)
        num = torch.einsum("bhqf,bhfd->bhqd", phi_q, kv)
        den = torch.einsum("bhqf,bhf->bhq", phi_q, z)[..., None] + 1e-6
        o = num / den
        return (lambda x, *d: x.permute(*d))(o, 0, 2, 1, 3).reshape(B, S, D) @ wo

    def _B_ref(x, wqkv, w_phi, wo):
        B, S, D = x.shape
        H = 32; Dh = D // H
        qkv = (lambda x, *d: x.permute(*d))((x @ wqkv).reshape(B, S, 3, H, Dh), 2, 0, 3, 1, 4)
        q, k, v = qkv[0], qkv[1], qkv[2]
        pq = torch.einsum("bhsd,hdf->bhsf", q, w_phi)
        pk = torch.einsum("bhsd,hdf->bhsf", k, w_phi)
        phi_q = torch.concatenate([_softmax(pq, axis=-1), _softmax(-pq, axis=-1)], axis=-1)
        phi_k = torch.concatenate([_softmax(pk, axis=-1), _softmax(-pk, axis=-1)], axis=-1)
        kv = torch.einsum("bhsf,bhsd->bhfd", phi_k, v)
        z  = torch.einsum("bhsf->bhf", phi_k)
        num = torch.einsum("bhqf,bhfd->bhqd", phi_q, kv)
        den = torch.einsum("bhqf,bhf->bhq", phi_q, z)[..., None] + 1e-6
        o = num / den
        return (lambda x, *d: x.permute(*d))(o, 0, 2, 1, 3).reshape(B, S, D) @ wo

    x = A_x
    x = x + _A_ref(_layernorm(x, axis=-1), A_wqkv, A_w_phi, A_wo)
    x = x + _B_ref(_layernorm(x, axis=-1), B_wqkv, B_w_phi, B_wo)
    x = x + _A_ref(_layernorm(x, axis=-1), A_wqkv, A_w_phi, A_wo)
    x = x + _B_ref(_layernorm(x, axis=-1), B_wqkv, B_w_phi, B_wo)
    return x
```

```asm
; @launch grid=(256,1,1) block=(256,1,1) lds=162944
.amdgcn_target "amdgcn-amd-amdhsa--gfx950"
.text
.globl interleave_layers__linear_kernel_hedgehog__linear_kernel_hedgehog__prompt_kernel
.p2align 8
.type interleave_layers__linear_kernel_hedgehog__linear_kernel_hedgehog__prompt_kernel,@function
interleave_layers__linear_kernel_hedgehog__linear_kernel_hedgehog__prompt_kernel:
    s_load_dwordx16 s[8:23], s[0:1], 0
    s_load_dwordx4 s[24:27], s[0:1], 64
    s_load_dwordx2 s[28:29], s[0:1], 80
    s_cmp_ge_u32 s2, 0x100
    s_cbranch_scc1 L_end
    s_getpc_b64 s[4:5]
L_pc:
    s_lshr_b32 s3, s2, 3
    s_lshl_b32 s6, s3, 5
    v_lshrrev_b32 v1, 3, v0
    v_add_lshl_u32 v1, v1, s6, 6
    v_min_u32 v1, L_end-L_pc, v1
    global_load_dword v255, v1, s[4:5]
    v_lshrrev_b32 v2, 6, v0
    v_and_b32 v0, 63, v0
    v_readfirstlane_b32 s66, v2
    s_and_b32 s6, s2, 7
    s_lshl_b32 s6, s6, 1
    s_lshr_b32 s7, s3, 4
    s_add_u32 s64, s6, s7
    s_and_b32 s65, s3, 15
    v_lshrrev_b32 v224, 2, v0
    v_and_b32 v225, 3, v0
    v_lshlrev_b32 v225, 4, v225
    v_lshl_add_u32 v228, v224, 10, v225
    v_lshlrev_b32 v1, 4, v0
    s_lshl_b32 s84, s64, 17
    s_lshl_b32 s81, s66, 11
    s_mov_b32 s54, 0x200000
    s_mov_b32 s55, 0x20000
    s_mov_b32 s34, 0x180000
    s_mov_b32 s35, 0x20000
    s_mov_b32 s42, 0x2000000
    s_mov_b32 s43, 0x20000
    s_mov_b32 s58, 0x80000
    s_mov_b32 s59, 0x20000
    s_mov_b32 s62, 0x4000
    s_mov_b32 s63, 0x20000
    v_lshlrev_b32 v35, 7, v0
    s_lshl_b32 s85, s65, 13
    s_add_u32 s82, s84, s85
    s_add_u32 s82, s82, s81
    s_lshl2_add_u32 s7, s3, s66
    s_mul_i32 s7, s7, 12288
    s_add_u32 s7, s7, 384
    v_bfe_u32 v224, v0, 2, 2
    v_mov_b32 v226, 0xc00
    v_mad_u32_u24 v226, v224, v226, s7
    s_lshl2_add_u32 s6, s2, s66
    s_lshr_b32 s7, s2, 1
    s_mul_i32 s7, s7, 3072
    s_and_b32 s3, s6, 7
    s_lshl_b32 s3, s3, 7
    s_add_u32 s97, s7, s3
    v_cmp_gt_u32 vcc, 16, v0
    v_mul_u32_u24 v224, 0x60000, v224
    v_add_u32 v224, s97, v224
    v_cndmask_b32 v224, v226, v224, vcc
    v_and_b32 v225, 3, v0
    v_lshl_add_u32 v36, v225, 10, v224
    s_bfe_u32 s7, s6, 0x50004
    s_and_b32 s3, s6, 15
    s_lshl_b32 s30, s7, 14
    s_lshl_b32 s31, s3, 6
    s_add_u32 s30, s30, s31
    s_add_u32 s31, s81, 65536
    s_and_b32 s85, s66, 1
    s_lshl1_add_u32 s85, s65, s85
    s_lshl_b32 s85, s85, 9
    s_mov_b32 m0, s31
    s_lshr_b32 s88, s2, 3
    s_or_b32 s88, s88, s66
    s_cmp_ge_u32 s2, 8
    s_cbranch_scc1 Lback_2
    v_mov_b32 v225, 0
    v_lshlrev_b32 v224, 10, v0
    s_lshl_b32 s84, s2, 7
    s_add_u32 s84, s84, 0x5c0000
    s_cmp_lg_u32 s66, 0
    s_cbranch_scc1 Llead_1
    s_mov_b32 exec_hi, 0
    s_waitcnt lgkmcnt(0)
    s_mov_b64 s[40:41], s[28:29]
    buffer_store_dword v225, v224, s[40:43], s84 offen sc1
    s_mov_b32 exec_hi, -1
Llead_1:
    s_barrier
Lback_2:
    s_waitcnt lgkmcnt(0)
    s_mov_b64 s[32:33], s[10:11]
    s_mov_b64 exec, 0x66666666
    buffer_load_dword v255, v36, s[32:35], 0 offen
    s_mov_b64 s[52:53], s[8:9]
    s_mov_b64 exec, -1
    buffer_load_dwordx4 v[192:195], v1, s[52:55], s82 offen offset:0
    buffer_load_dwordx4 v[196:199], v1, s[52:55], s82 offen offset:1024
    s_cmp_lt_u32 s2, 0x80
    s_cselect_b64 s[56:57], s[14:15], s[22:23]
    buffer_load_dwordx4 v228, s[56:59], s30 offen lds
    s_mov_b64 s[40:41], s[28:29]
    s_add_u32 m0, s31, 1024
    s_cmp_lt_u32 s66, 2
    s_cselect_b64 s[60:61], s[12:13], s[20:21]
    s_mov_b32 exec_hi, 0
    buffer_load_dwordx4 v1, s[60:63], s85 offen lds
    s_mov_b32 exec_hi, -1
    v_lshrrev_b32 v224, 3, v0
    v_lshrrev_b32 v225, 4, v0
    v_xor_b32 v225, v225, v0
    v_and_b32 v225, 7, v225
    v_lshlrev_b32 v225, 4, v225
    v_lshl_add_u32 v122, v224, 10, v225
    v_xor_b32 v123, 64, v122
    v_lshrrev_b32 v224, 2, v0
    v_lshl_add_u32 v5, v224, 11, v228
    s_lshl_b32 s84, s64, 17
    s_lshl_b32 s85, s66, 15
    s_add_u32 s70, s84, s85
    s_mul_i32 s85, s66, 98304
    s_lshl_b32 s87, s65, 6
    s_add_u32 s80, s85, s87
    s_lshl_b32 s96, s66, 12
    s_add_u32 s96, s96, 98304
    s_lshr_b32 s6, s6, 9
    s_lshl_b32 s6, s6, 19
    s_bfe_u32 s84, s3, 0x20002
    s_lshl_b32 s84, s84, 1
    s_xor_b32 s7, s7, s84
    s_lshl_b32 s3, s3, 15
    s_lshl_b32 s7, s7, 10
    s_add_u32 s6, s6, s3
    s_add_u32 s6, s6, s7
    s_add_u32 s6, s6, 0x200000
    s_lshl_b32 s84, s64, 17
    s_lshr_b32 s85, s65, 2
    s_lshl_b32 s85, s85, 15
    s_add_u32 s84, s84, s85
    s_lshl_b32 s85, s66, 13
    s_add_u32 s72, s84, s85
    s_and_b32 s86, s65, 3
    s_lshl_b32 s86, s86, 2
    s_add_u32 s86, s86, s66
    s_lshl_b32 s87, s86, 11
    s_add_u32 s73, s84, s87
    s_lshl_b32 s87, s86, 6
    s_add_u32 s89, s84, s87
    s_mul_i32 s85, s65, 2176
    s_add_u32 s75, s85, 0x300000
    s_mul_i32 s85, s64, 34816
    s_add_u32 s74, s75, s85
    s_lshl_b32 s84, s64, 14
    s_lshl_b32 s85, s65, 10
    s_add_u32 s85, s84, s85
    s_add_u32 s76, s85, 0x540000
    s_lshl_b32 s87, s66, 7
    s_add_u32 s85, s85, s87
    s_add_u32 s85, s85, 0x57fe80
    v_mov_b32 v224, s85
    s_lshl_b32 s87, s66, 8
    s_add_u32 s85, s76, s87
    s_sub_u32 s85, s85, 128
    v_mov_b32 v225, s85
    v_cmp_gt_u32 vcc, 24, v0
    s_mul_i32 s87, s66, 557056
    s_add_u32 s85, s74, s87
    s_add_u32 s85, s85, 2048
    v_cndmask_b32 v224, v224, v225, vcc
    v_cndmask_b32 v244, 0, -1, vcc
    v_mov_b32 v225, s85
    v_cmp_gt_u32 vcc, 8, v0
    v_mov_b32 v240, -1
    v_mov_b32 v241, -1
    v_mov_b32 v242, -1
    v_mov_b32 v243, -1
    v_cndmask_b32 v224, v224, v225, vcc
    v_add_u32 v229, v224, v1
    v_mov_b32 v245, v244
    v_mov_b32 v246, v244
    v_mov_b32 v247, v244
    s_lshl_b32 s87, s66, 9
    s_add_u32 s87, s87, s74
    s_sub_u32 s87, s87, 512
    s_mov_b32 exec_lo, 0
    v_add_u32 v229, s87, v1
    v_mov_b32 v244, -1
    v_mov_b32 v245, -1
    v_mov_b32 v246, -1
    v_mov_b32 v247, -1
    s_mov_b32 exec_lo, -1
    buffer_store_dwordx4 v[244:247], v229, s[40:43], 0 offen sc1
    s_getreg_b32 s69, hwreg(HW_REG_XCC_ID, 0, 4)
    s_mov_b32 s68, 0x40000
    s_mov_b32 s83, 0x3f803f80
    v_lshlrev_b32 v20, 2, v0
    s_lshl_b32 s85, s65, 11
    s_add_u32 s71, s70, s85
    s_and_b32 s84, s65, 3
    s_lshl_b32 s0, s84, 13
    s_mul_i32 s85, s84, 0x60000
    s_add_u32 s20, s80, s85
    s_xor_b32 s85, s84, 1
    s_mul_i32 s85, s85, 0x60000
    s_add_u32 s21, s80, s85
    s_xor_b32 s85, s84, 2
    s_mul_i32 s85, s85, 0x60000
    s_add_u32 s22, s80, s85
    s_xor_b32 s85, s84, 3
    s_mul_i32 s85, s85, 0x60000
    s_add_u32 s23, s80, s85
    s_lshl_b32 s85, s84, 8
    s_add_u32 s97, s70, s85
    s_add_u32 s70, s70, s0
    s_lshl_b32 s84, s64, 14
    s_lshl_b32 s85, s66, 12
    s_add_u32 s85, s84, s85
    s_add_u32 s77, s85, 0x540000
    s_add_u32 s84, s84, 0x580000
    s_add_u32 s85, s84, s81
    s_lshl_b32 s87, s65, 2
    s_add_u32 s78, s85, s87
    v_and_b32 v224, 15, v0
    s_add_u32 s85, s85, 1024
    v_lshl_add_u32 v19, v224, 2, s85
    s_lshr_b32 s85, s65, 2
    s_lshl_b32 s85, s85, 11
    s_add_u32 s85, s84, s85
    s_mov_b32 s61, s85
    s_mov_b32 s60, 0xfffe0000
    s_lshl_b32 s87, s86, 2
    s_add_u32 s79, s85, s87
    s_add_u32 s79, s79, 1024
    s_lshl_b32 s87, s66, 4
    s_add_u32 s85, s85, s87
    v_and_b32 v224, 3, v0
    v_lshl_add_u32 v18, v224, 2, s85
    s_and_b32 s87, s86, 12
    s_add_u32 s16, s85, s87
    s_mov_b32 s36, s18
    s_mov_b32 s37, s19
    s_mov_b32 s38, 0x180000
    s_mov_b32 s39, 0x20000
    s_mov_b32 s44, s24
    s_mov_b32 s45, s25
    s_mov_b32 s46, 0x200000
    s_mov_b32 s47, 0x20000
    s_mov_b32 s48, s26
    s_mov_b32 s49, s27
    s_mov_b32 s50, 0x100
    s_mov_b32 s51, 0x20000
    s_lshl_b32 s85, s66, 13
    s_lshl_b32 s87, s86, 15
    s_add_u32 s87, s87, 0x200000
    s_add_u32 s84, s85, 0
    s_and_b32 s84, s84, 0x6000
    s_add_u32 s8, s87, s84
    s_add_u32 s84, s85, 8192
    s_and_b32 s84, s84, 0x6000
    s_add_u32 s9, s87, s84
    s_add_u32 s84, s85, 16384
    s_and_b32 s84, s84, 0x6000
    s_add_u32 s10, s87, s84
    s_add_u32 s84, s85, 24576
    s_and_b32 s84, s84, 0x6000
    s_add_u32 s11, s87, s84
    v_lshrrev_b32 v232, 4, v0
    v_bfe_u32 v233, v0, 2, 2
    v_and_b32 v234, 3, v0
    v_lshrrev_b32 v224, 5, v0
    v_lshl_add_u32 v224, v224, 3, v233
    v_lshlrev_b32 v3, 6, v224
    v_and_b32 v225, 1, v232
    v_lshl_add_u32 v3, v225, 5, v3
    v_and_b32 v226, 1, v234
    v_lshl_add_u32 v3, v226, 4, v3
    v_lshrrev_b32 v227, 1, v234
    v_lshl_add_u32 v3, v227, 3, v3
    v_add_u32 v4, 0x10000, v3
    v_lshl_add_u32 v235, v225, 1, v227
    v_lshlrev_b32 v235, 3, v235
    v_lshl_add_u32 v235, v224, 5, v235
    v_add_u32 v235, s31, v235
    v_add_u32 v236, s31, v3
    v_lshl_add_u32 v224, v232, 2, v233
    v_xor_b32 v227, v227, v225
    v_lshlrev_b32 v227, 4, v227
    v_lshl_add_u32 v227, v226, 3, v227
    v_lshl_add_u32 v224, v224, 5, v227
    s_lshl_b32 s84, s66, 12
    s_add_u32 s84, s84, 122880
    v_add_u32 v9, s84, v224
    s_lshr_b32 s84, s66, 1
    s_lshl_b32 s84, s84, 12
    s_add_u32 s84, s84, 139264
    v_add_u32 v10, s84, v224
    v_and_b32 v224, 31, v0
    v_lshlrev_b32 v224, 5, v224
    s_lshl_b32 s84, s66, 10
    s_add_u32 s84, s84, 122880
    v_add_u32 v224, s84, v224
    v_lshrrev_b32 v225, 5, v0
    v_and_b32 v226, 1, v233
    v_lshl_add_u32 v6, v225, 12, v224
    v_lshl_add_u32 v6, v226, 4, v6
    v_xor_b32 v7, 16, v6
    v_xor_b32 v226, v226, v225
    v_lshl_add_u32 v8, v226, 4, v224
    v_add_u32 v8, 0x4000, v8
    s_cmp_lg_u32 s88, 0
    s_cbranch_scc1 Lsig_3
    v_mov_b32 v231, 1
    s_lshl_b32 s92, s2, 5
    s_mov_b64 exec, 1
    s_waitcnt vmcnt(6)
    buffer_store_dword v231, off, s[48:51], s92 sc1
    s_mov_b64 exec, -1
Lsig_3:
    v_and_b32 v224, 15, v0
    s_lshl_b32 s84, s66, 9
    s_lshl_b32 s85, s66, 5
    s_add_u32 s85, s85, 2048
    v_cmp_gt_u32 vcc, 32, v0
    v_add_u32 v11, s84, v1
    v_and_or_b32 v225, v0, 16, s85
    v_cndmask_b32 v11, v225, v11, vcc
    v_mul_u32_u24 v225, 0x8800, v232
    v_lshl_add_u32 v13, v224, 4, v225
    v_add_u32 v13, s84, v13
    v_and_b32 v226, 7, v0
    v_lshl_add_u32 v14, v226, 4, v225
    s_mul_i32 s85, s66, 139264
    s_add_u32 s85, s85, 2048
    v_add_u32 v14, s85, v14
    s_lshr_b32 s84, s66, 1
    s_mul_i32 s84, s84, 1600
    s_and_b32 s85, s66, 1
    s_lshl_b32 s85, s85, 5
    s_add_u32 s84, s84, s85
    s_add_u32 s84, s84, 159744
    v_and_b32 v225, 1, v232
    v_mul_u32_u24 v226, 80, v224
    v_lshrrev_b32 v227, 5, v0
    v_lshl_add_u32 v226, v227, 3, v226
    v_and_b32 v224, 16, v0
    v_add3_u32 v15, v226, v224, s84
    s_mul_i32 s84, s66, 80
    s_add_u32 s84, s84, 161024
    v_and_b32 v224, 1, v233
    v_mul_u32_u24 v226, 1600, v224
    v_and_or_b32 v225, v234, 2, v225
    v_lshl_add_u32 v226, v225, 4, v226
    v_and_b32 v225, 1, v234
    v_lshl_add_u32 v226, v225, 3, v226
    v_add_u32 v16, s84, v226
    v_lshlrev_b32 v224, 3, v224
    v_bfe_u32 v225, v0, 3, 1
    v_lshl_add_u32 v224, v225, 2, v224
    v_and_b32 v225, 16, v0
    v_cmp_eq_u32 vcc, 0, v225
    v_add_u32 v2, 0x1c000, v1
    v_add_u32 v22, 0x25800, v20
    v_cndmask_b32 v224, 16, v224, vcc
    v_add_u32 v224, v224, v234
    v_mul_u32_u24 v224, 80, v224
    v_lshl_add_u32 v224, v227, 5, v224
    v_add_u32 v17, 0x27000, v224
    v_and_b32 v224, 31, v0
    v_bfe_u32 v225, v0, 1, 3
    v_xor_b32 v225, v225, v227
    v_lshlrev_b32 v225, 4, v225
    v_lshl_add_u32 v224, v224, 7, v225
    v_add_u32 v124, s96, v224
    v_xor_b32 v125, 32, v124
    v_xor_b32 v126, 64, v124
    v_xor_b32 v127, 96, v124
    s_and_b32 s84, s65, 3
    v_lshl_add_u32 v224, v0, 2, s84
    v_and_b32 v225, 15, v0
    s_and_b32 s3, s2, 0x87
    v_lshl_add_u32 v226, v225, 3, s3
    v_cmp_gt_u32 vcc, 32, v0
    v_and_b32 v227, 1, v0
    v_lshrrev_b32 v225, 1, v225
    v_cndmask_b32 v224, v226, v224, vcc
    v_lshl_add_u32 v225, v227, 7, v225
    v_cmp_gt_u32 vcc, 48, v0
    s_and_b32 s3, s2, 0x78
    v_add_u32 v225, s3, v225
    v_cndmask_b32 v224, v225, v224, vcc
    v_lshlrev_b32 v224, 7, v224
    v_add_u32 v21, 0x5c0000, v224
    s_lshl_b32 s84, s66, 3
    s_lshl_b32 s14, 0xff, s84
    s_lshl_b32 s84, s66, 2
    s_lshl_b32 s15, 983040, s84
    s_or_b32 s15, s15, 0xffff
    s_or_b32 s84, s69, 0x80
    v_mov_b32 v38, s84
    v_and_b32 v224, 1, v0
    v_lshlrev_b32 v224, 4, v224
    v_mov_b32 v225, 0x3f80
    v_lshlrev_b32 v225, v224, v225
    v_bfe_u32 v224, v0, 1, 3
    v_cmp_eq_u32 vcc, 0, v224
    s_nop 1
    v_cndmask_b32 v72, 0, v225, vcc
    v_cmp_eq_u32 vcc, 1, v224
    s_nop 1
    v_cndmask_b32 v73, 0, v225, vcc
    v_cmp_eq_u32 vcc, 2, v224
    s_nop 1
    v_cndmask_b32 v74, 0, v225, vcc
    v_cmp_eq_u32 vcc, 3, v224
    s_nop 1
    v_cndmask_b32 v75, 0, v225, vcc
    v_cmp_eq_u32 vcc, 4, v224
    s_nop 1
    v_cndmask_b32 v76, 0, v225, vcc
    v_cmp_eq_u32 vcc, 5, v224
    s_nop 1
    v_cndmask_b32 v77, 0, v225, vcc
    v_cmp_eq_u32 vcc, 6, v224
    s_nop 1
    v_cndmask_b32 v78, 0, v225, vcc
    v_cmp_eq_u32 vcc, 7, v224
    s_nop 1
    v_cndmask_b32 v79, 0, v225, vcc
    v_lshrrev_b32 v116, 2, v0
    v_lshrrev_b32 v117, 4, v0
    v_xor_b32 v116, v116, v117
    v_and_b32 v116, 1, v116
    v_subrev_u32 v116, 1, v116
    v_and_b32 v116, 0x3f803f80, v116
    v_mov_b32 v117, v116
    v_mov_b32 v118, v116
    v_mov_b32 v119, v116
    v_add_u32 v120, s81, v3
    v_add_u32 v121, s81, v4
    v_mov_b32 v200, 0
    v_mov_b32 v201, 0
    v_mov_b32 v202, 0
    v_mov_b32 v203, 0
    v_and_b32 v224, 24, v0
    v_lshlrev_b32 v224, 4, v224
    v_and_b32 v225, 6, v0
    v_lshrrev_b32 v226, 5, v0
    v_add3_u32 v224, v224, v225, v226
    v_and_b32 v225, 1, v0
    v_lshl_add_u32 v224, v224, 1, v225
    s_and_b32 s3, s2, 0x87
    s_lshl_b32 s84, s66, 5
    s_add_u32 s3, s3, s84
    s_lshl_b32 s3, s3, 7
    s_add_u32 s3, s3, 0x5c0040
    v_lshl_add_u32 v113, v224, 2, s3
    v_lshlrev_b32 v204, 2, v232
    v_bfe_u32 v224, v0, 2, 1
    v_mul_u32_u24 v224, 0x8000, v224
    v_lshl_add_u32 v224, v224, 16, v224
    s_lshl_b32 s84, s66, 10
    v_add_u32 v225, s84, v2
    v_lshlrev_b32 v34, 2, v0
    v_and_b32 v34, 0xe0, v34
    s_branch L_page0
.p2align 12
L_page0:
    s_mov_b64 exec, 0
    s_cmp_eq_u32 s66, 0
    s_cbranch_scc1 L_pg1
    s_cmp_eq_u32 s66, 1
    s_cbranch_scc1 L_pg2
    s_cmp_eq_u32 s66, 2
    s_cbranch_scc1 L_pg3
    s_branch L_pg4
L_pgret0:
    s_mov_b64 exec, -1
    ds_write_b128 v2, v[72:75] offset:36864
    ds_write_b128 v2, v[76:79] offset:37888
    s_add_u32 m0, s96, 16384
    s_xor_b32 s94, s97, 0
    buffer_load_dwordx4 v122, s[52:55], s94 offen offset:0 lds
    s_xor_b32 s94, s97, 7168
    buffer_load_dwordx4 v123, s[52:55], s94 offen offset:1024 lds
    s_xor_b32 s94, s97, 14336
    buffer_load_dwordx4 v122, s[52:55], s94 offen offset:2048 lds
    s_xor_b32 s94, s97, 21504
    buffer_load_dwordx4 v123, s[52:55], s94 offen offset:3072 lds
    s_waitcnt vmcnt(5)
    ds_read_b64_tr_b16 v[24:25], v236
    ds_read_b64_tr_b16 v[26:27], v236 offset:256
    ds_read_b64_tr_b16 v[28:29], v235 offset:1024
    ds_read_b64_tr_b16 v[30:31], v235 offset:1152
    s_add_u32 m0, s81, 0
    s_add_u32 s94, s20, 1024
    buffer_load_dwordx4 v5, s[32:35], s94 offen lds
    s_add_u32 m0, s81, 1024
    s_add_u32 s94, s20, 50176
    buffer_load_dwordx4 v5, s[32:35], s94 offen lds
    s_add_u32 m0, s81, 32768
    s_add_u32 s94, s20, 2048
    buffer_load_dwordx4 v5, s[32:35], s94 offen lds
    s_add_u32 m0, s81, 33792
    s_add_u32 s94, s20, 51200
    buffer_load_dwordx4 v5, s[32:35], s94 offen lds
    s_add_u32 m0, s96, 32768
    s_xor_b32 s94, s97, 128
    buffer_load_dwordx4 v122, s[52:55], s94 offen offset:0 lds
    s_xor_b32 s94, s97, 7296
    buffer_load_dwordx4 v123, s[52:55], s94 offen offset:1024 lds
    s_xor_b32 s94, s97, 14464
    buffer_load_dwordx4 v122, s[52:55], s94 offen offset:2048 lds
    s_xor_b32 s94, s97, 21632
    buffer_load_dwordx4 v123, s[52:55], s94 offen offset:3072 lds
    v_dot2c_f32_bf16 v200, s83, v192
    v_dot2c_f32_bf16 v201, v192, v192
    v_dot2c_f32_bf16 v202, s83, v196
    v_dot2c_f32_bf16 v203, v196, v196
    v_dot2c_f32_bf16 v200, s83, v193
    v_dot2c_f32_bf16 v201, v193, v193
    v_dot2c_f32_bf16 v202, s83, v197
    v_dot2c_f32_bf16 v203, v197, v197
    v_dot2c_f32_bf16 v200, s83, v194
    v_dot2c_f32_bf16 v201, v194, v194
    v_dot2c_f32_bf16 v202, s83, v198
    v_dot2c_f32_bf16 v203, v198, v198
    v_dot2c_f32_bf16 v200, s83, v195
    v_dot2c_f32_bf16 v201, v195, v195
    v_dot2c_f32_bf16 v202, s83, v199
    v_dot2c_f32_bf16 v203, v199, v199
    s_lshl3_add_u32 s84, s2, s66
    s_lshl_b32 s84, s84, 4
    s_add_u32 s84, s84, 0x5c0040
    v_permlane32_swap_b32 v200, v201
    v_permlane32_swap_b32 v202, v203
    v_add_f32 v200, v200, v201
    v_add_f32 v202, v202, v203
    s_nop 1
    v_permlane16_swap_b32 v200, v202
    v_add_f32 v200, v200, v202
    s_nop 1
    v_add_f32_dpp v200, v200, v200 row_ror:8 row_mask:0xf bank_mask:0xf
    s_nop 1
    v_add_f32_dpp v200, v200, v200 row_ror:4 row_mask:0xf bank_mask:0xf
    s_nop 1
    v_add_f32_dpp v200, v200, v200 row_ror:2 row_mask:0xf bank_mask:0xf
    s_nop 1
    v_add_f32_dpp v200, v200, v200 row_ror:1 row_mask:0xf bank_mask:0xf
    s_mov_b32 exec_lo, 0x00010001
    s_mov_b32 exec_hi, 0x00010001
    buffer_store_dword v200, v204, s[40:43], s84 offen sc1
    s_mov_b64 exec, -1
    s_waitcnt lgkmcnt(0)
    buffer_store_dwordx4 v[24:27], v1, s[40:43], s6 offen sc1
    v_xor_b32 v28, v224, v28
    v_xor_b32 v29, v224, v29
    v_xor_b32 v30, v224, v30
    v_xor_b32 v31, v224, v31
    ds_write_b128 v225, v[28:31] offset:32768
    v_and_b32 v226, 15, v0
    v_lshlrev_b32 v227, 6, v226
    v_lshl_add_u32 v227, v232, 4, v227
    s_add_u32 s3, s81, 90112
    v_add_u32 v37, s3, v227
    v_lshrrev_b32 v227, 5, v0
    v_and_b32 v237, 1, v232
    v_and_b32 v226, 11, v0
    v_lshl_add_u32 v226, v237, 5, v226
    v_lshl_add_u32 v226, v227, 6, v226
    v_lshlrev_b32 v226, 4, v226
    v_and_b32 v238, 1, v233
    v_cmp_eq_u32 vcc, v227, v238
    v_add_u32 v32, 0x24800, v226
    v_add_u32 v33, 0x24900, v226
    v_mov_b32 v227, 0x25080
    v_cndmask_b32 v32, v227, v32, vcc
    v_cndmask_b32 v33, v227, v33, vcc
    v_lshl_add_u32 v226, v238, 3, v234
    v_lshrrev_b32 v238, 1, v233
    v_cmp_gt_u32 vcc, 32, v0
    v_lshl_add_u32 v226, v238, 2, v226
    v_lshl_add_u32 v226, v237, 6, v226
    v_lshlrev_b32 v226, 4, v226
    v_add_u32 v226, 0x25000, v226
    s_cmp_eq_u32 s66, 1
    s_cselect_b64 exec, -1, 0
    v_cndmask_b32 v32, v227, v226, vcc
    v_cndmask_b32 v33, v226, v227, vcc
    s_mov_b64 exec, -1
    s_mul_i32 s4, s64, 98304
    s_lshl_b32 s84, s65, 6
    s_add_u32 s4, s4, s84
    s_add_u32 s84, s66, 1
    s_lshl_b32 s84, s84, 10
    s_lshl_b32 s5, s66, 15
    s_cmp_eq_u32 s66, 2
    s_cselect_b32 s84, 0, s84
    s_cselect_b32 s5, 90112, s5
    s_add_u32 s4, s4, s84
    s_mul_i32 s17, s65, 122880
    s_lshl_b32 s84, s64, 11
    s_xor_b32 s84, s84, s0
    s_add_u32 s5, s5, s84
    s_add_u32 s5, s5, s17
    s_lshl_b32 s63, s65, 13
    s_add_u32 s63, s63, 0x5d0000
    s_and_b32 s84, s64, 12
    s_add_u32 s84, s84, s66
    s_and_b32 s7, s64, 3
    s_lshl2_add_u32 s7, s84, s7
    s_lshl_b32 s7, s7, 7
    s_add_u32 s7, s7, s63
    s_add_u32 s63, s63, s81
    s_cmp_eq_u32 s66, 3
    s_cselect_b32 s7, 0x10000000, s7
    s_cselect_b32 s4, 0x10000000, s4
    s_cselect_b32 s5, 0x10000000, s5
    v_and_b32 v226, 8, v0
    v_lshl_add_u32 v226, v232, 1, v226
    s_and_b32 s84, s64, 1
    s_lshl_b32 s84, s84, 10
    s_add_u32 s84, s84, s17
    s_add_u32 s84, s84, s81
    v_lshl_add_u32 v226, v226, 12, s84
    v_and_b32 v227, 0x380, v35
    v_add_u32 v12, v226, v227
    s_waitcnt vmcnt(10)
    ds_read_b128 v[128:131], v124 offset:16384
    ds_read_b128 v[132:135], v125 offset:16384
    ds_read_b128 v[136:139], v126 offset:16384
    ds_read_b128 v[140:143], v127 offset:16384
    s_add_u32 m0, s96, 0
    s_nop 0
    s_xor_b32 s94, s97, 256
    buffer_load_dwordx4 v122, s[52:55], s94 offen offset:0 lds
    s_xor_b32 s94, s97, 7424
    buffer_load_dwordx4 v123, s[52:55], s94 offen offset:1024 lds
    s_xor_b32 s94, s97, 14592
    buffer_load_dwordx4 v122, s[52:55], s94 offen offset:2048 lds
    s_xor_b32 s94, s97, 21760
    buffer_load_dwordx4 v123, s[52:55], s94 offen offset:3072 lds
    s_waitcnt lgkmcnt(0)
    s_waitcnt vmcnt(10)
    ds_read_b64_tr_b16 v[72:73], v120 offset:0
    ds_read_b64_tr_b16 v[74:75], v120 offset:256
    ds_read_b64_tr_b16 v[76:77], v120 offset:1024
    ds_read_b64_tr_b16 v[78:79], v120 offset:1280
    ds_read_b64_tr_b16 v[80:81], v120 offset:32768
    ds_read_b64_tr_b16 v[82:83], v120 offset:33024
    ds_read_b64_tr_b16 v[84:85], v120 offset:33792
    ds_read_b64_tr_b16 v[86:87], v120 offset:34048
    s_add_u32 m0, s81, 8192
    s_add_u32 s94, s21, 1024
    buffer_load_dwordx4 v5, s[32:35], s94 offen lds
    s_add_u32 m0, s81, 9216
    s_add_u32 s94, s21, 50176
    buffer_load_dwordx4 v5, s[32:35], s94 offen lds
    s_add_u32 m0, s81, 40960
    s_add_u32 s94, s21, 2048
    buffer_load_dwordx4 v5, s[32:35], s94 offen lds
    s_cmp_lg_u32 s66, 1
    s_cbranch_scc1 Ldbg_4
    buffer_load_dword v252, v34, s[48:51], 0 offen sc1
Ldbg_4:
    s_add_u32 m0, s81, 41984
    s_add_u32 s94, s21, 51200
    buffer_load_dwordx4 v5, s[32:35], s94 offen lds
    s_waitcnt lgkmcnt(6)
    v_mfma_f32_16x16x32_bf16 v[104:107], v[116:119], v[72:75], 0
    s_waitcnt lgkmcnt(4)
    v_mfma_f32_16x16x32_bf16 v[104:107], v[116:119], v[76:79], v[104:107]
    s_waitcnt lgkmcnt(2)
    v_mfma_f32_16x16x32_bf16 v[108:111], v[116:119], v[80:83], 0
    s_waitcnt lgkmcnt(0)
    v_mfma_f32_16x16x32_bf16 v[108:111], v[116:119], v[84:87], v[108:111]
    s_barrier
    s_nop 0
    ds_read_b64_tr_b16 v[72:73], v3 offset:0
    ds_read_b64_tr_b16 v[74:75], v3 offset:256
    ds_read_b64_tr_b16 v[76:77], v3 offset:32768
    ds_read_b64_tr_b16 v[78:79], v3 offset:33024
    ds_read_b64_tr_b16 v[80:81], v3 offset:1024
    ds_read_b64_tr_b16 v[82:83], v3 offset:1280
    ds_read_b64_tr_b16 v[84:85], v3 offset:33792
    ds_read_b64_tr_b16 v[86:87], v3 offset:34048
    ds_read_b64_tr_b16 v[88:89], v3 offset:2048
    ds_read_b64_tr_b16 v[90:91], v3 offset:2304
    ds_read_b64_tr_b16 v[92:93], v3 offset:34816
    ds_read_b64_tr_b16 v[94:95], v3 offset:35072
    s_waitcnt lgkmcnt(10)
    v_mfma_f32_32x32x16_bf16 v[40:55], v[72:75], v[128:131], 0
    ds_read_b64_tr_b16 v[96:97], v3 offset:3072
    ds_read_b64_tr_b16 v[98:99], v3 offset:3328
    s_add_u32 m0, s96, 16384
    s_xor_b32 s94, s97, 384
    buffer_load_dwordx4 v122, s[52:55], s94 offen offset:0 lds
    s_waitcnt lgkmcnt(10)
    v_mfma_f32_32x32x16_bf16 v[56:71], v[76:79], v[128:131], 0
    ds_read_b64_tr_b16 v[100:101], v3 offset:35840
    ds_read_b64_tr_b16 v[102:103], v3 offset:36096
    s_add_u32 m0, s96, 16384
    s_xor_b32 s94, s97, 7552
    buffer_load_dwordx4 v123, s[52:55], s94 offen offset:1024 lds
    s_waitcnt lgkmcnt(10)
    v_mfma_f32_32x32x16_bf16 v[40:55], v[80:83], v[132:135], v[40:55]
    ds_read_b64_tr_b16 v[72:73], v3 offset:4096
    ds_read_b64_tr_b16 v[74:75], v3 offset:4352
    s_add_u32 m0, s96, 16384
    s_xor_b32 s94, s97, 14720
    buffer_load_dwordx4 v122, s[52:55], s94 offen offset:2048 lds
    s_waitcnt lgkmcnt(10)
    v_mfma_f32_32x32x16_bf16 v[56:71], v[84:87], v[132:135], v[56:71]
    ds_read_b64_tr_b16 v[76:77], v3 offset:36864
    ds_read_b64_tr_b16 v[78:79], v3 offset:37120
    s_add_u32 m0, s96, 16384
    s_xor_b32 s94, s97, 21888
    buffer_load_dwordx4 v123, s[52:55], s94 offen offset:3072 lds
    s_waitcnt vmcnt(14)
    ds_read_b128 v[144:147], v124 offset:32768
    ds_read_b128 v[148:151], v125 offset:32768
    ds_read_b128 v[152:155], v126 offset:32768
    ds_read_b128 v[156:159], v127 offset:32768
    s_waitcnt lgkmcnt(14)
    v_mfma_f32_32x32x16_bf16 v[40:55], v[88:91], v[136:139], v[40:55]
    ds_read_b64_tr_b16 v[80:81], v3 offset:5120
    ds_read_b64_tr_b16 v[82:83], v3 offset:5376
    s_waitcnt lgkmcnt(14)
    v_mfma_f32_32x32x16_bf16 v[56:71], v[92:95], v[136:139], v[56:71]
    ds_read_b64_tr_b16 v[84:85], v3 offset:37888
    ds_read_b64_tr_b16 v[86:87], v3 offset:38144
    s_waitcnt lgkmcnt(14)
    v_mfma_f32_32x32x16_bf16 v[40:55], v[96:99], v[140:143], v[40:55]
    ds_read_b64_tr_b16 v[88:89], v3 offset:6144
    ds_read_b64_tr_b16 v[90:91], v3 offset:6400
    s_waitcnt lgkmcnt(14)
    v_mfma_f32_32x32x16_bf16 v[56:71], v[100:103], v[140:143], v[56:71]
    ds_read_b64_tr_b16 v[92:93], v3 offset:38912
    ds_read_b64_tr_b16 v[94:95], v3 offset:39168
    s_waitcnt lgkmcnt(8)
    v_mfma_f32_32x32x16_bf16 v[40:55], v[72:75], v[144:147], v[40:55]
    ds_read_b64_tr_b16 v[96:97], v3 offset:7168
    ds_read_b64_tr_b16 v[98:99], v3 offset:7424
    s_add_u32 m0, s96, 32768
    s_xor_b32 s94, s97, 512
    buffer_load_dwordx4 v122, s[52:55], s94 offen offset:0 lds
    v_mfma_f32_32x32x16_bf16 v[56:71], v[76:79], v[144:147], v[56:71]
    ds_read_b64_tr_b16 v[100:101], v3 offset:39936
    ds_read_b64_tr_b16 v[102:103], v3 offset:40192
    s_add_u32 m0, s96, 32768
    s_xor_b32 s94, s97, 7680
    buffer_load_dwordx4 v123, s[52:55], s94 offen offset:1024 lds
    s_waitcnt lgkmcnt(10)
    v_mfma_f32_32x32x16_bf16 v[40:55], v[80:83], v[148:151], v[40:55]
    s_add_u32 m0, s96, 32768
    s_xor_b32 s94, s97, 14848
    buffer_load_dwordx4 v122, s[52:55], s94 offen offset:2048 lds
    s_waitcnt lgkmcnt(8)
    v_mfma_f32_32x32x16_bf16 v[56:71], v[84:87], v[148:151], v[56:71]
    s_add_u32 m0, s96, 32768
    s_xor_b32 s94, s97, 22016
    buffer_load_dwordx4 v123, s[52:55], s94 offen offset:3072 lds
    s_waitcnt vmcnt(12)
    ds_read_b128 v[160:163], v124 offset:0
    ds_read_b128 v[164:167], v125 offset:0
    ds_read_b128 v[168:171], v126 offset:0
    ds_read_b128 v[172:175], v127 offset:0
    s_waitcnt lgkmcnt(10)
    v_mfma_f32_32x32x16_bf16 v[40:55], v[88:91], v[152:155], v[40:55]
    s_waitcnt lgkmcnt(8)
    v_mfma_f32_32x32x16_bf16 v[56:71], v[92:95], v[152:155], v[56:71]
    s_waitcnt lgkmcnt(6)
    v_mfma_f32_32x32x16_bf16 v[40:55], v[96:99], v[156:159], v[40:55]
    s_waitcnt lgkmcnt(4)
    v_mfma_f32_32x32x16_bf16 v[56:71], v[100:103], v[156:159], v[56:71]
    s_waitcnt vmcnt(8)
    ds_read_b64_tr_b16 v[72:73], v120 offset:8192
    ds_read_b64_tr_b16 v[74:75], v120 offset:8448
    ds_read_b64_tr_b16 v[76:77], v120 offset:9216
    ds_read_b64_tr_b16 v[78:79], v120 offset:9472
    ds_read_b64_tr_b16 v[80:81], v120 offset:40960
    ds_read_b64_tr_b16 v[82:83], v120 offset:41216
    ds_read_b64_tr_b16 v[84:85], v120 offset:41984
    ds_read_b64_tr_b16 v[86:87], v120 offset:42240
    s_waitcnt lgkmcnt(8)
    s_nop 0
    s_add_u32 m0, s81, 16384
    s_add_u32 s94, s22, 1024
    buffer_load_dwordx4 v5, s[32:35], s94 offen lds
    s_add_u32 m0, s81, 17408
    s_add_u32 s94, s22, 50176
    buffer_load_dwordx4 v5, s[32:35], s94 offen lds
    s_add_u32 m0, s81, 49152
    s_add_u32 s94, s22, 2048
    buffer_load_dwordx4 v5, s[32:35], s94 offen lds
    s_add_u32 m0, s81, 50176
    s_add_u32 s94, s22, 51200
    buffer_load_dwordx4 v5, s[32:35], s94 offen lds
    s_waitcnt lgkmcnt(6)
    v_mfma_f32_16x16x32_bf16 v[104:107], v[116:119], v[72:75], v[104:107]
    s_waitcnt lgkmcnt(4)
    v_mfma_f32_16x16x32_bf16 v[104:107], v[116:119], v[76:79], v[104:107]
    s_waitcnt lgkmcnt(2)
    v_mfma_f32_16x16x32_bf16 v[108:111], v[116:119], v[80:83], v[108:111]
    s_waitcnt lgkmcnt(0)
    v_mfma_f32_16x16x32_bf16 v[108:111], v[116:119], v[84:87], v[108:111]
    s_barrier
    s_cmp_lg_u32 s66, 1
    s_cbranch_scc1 Lrdy_5
Lrdyp_6:
    v_cmp_eq_u32 vcc, 0, v252
    s_cbranch_vccnz Lrdyr_7
    s_or_b32 s84, s69, 0x80
    v_mov_b32 v226, s84
    s_lshl_b32 s84, s2, 7
    s_add_u32 s84, s84, 0x5c0000
    s_mov_b64 exec, 1
    buffer_store_dword v226, off, s[40:43], s84 sc1
    s_mov_b64 exec, -1
Lrdy_5:
    s_nop 0
    ds_read_b64_tr_b16 v[72:73], v3 offset:8192
    ds_read_b64_tr_b16 v[74:75], v3 offset:8448
    ds_read_b64_tr_b16 v[76:77], v3 offset:40960
    ds_read_b64_tr_b16 v[78:79], v3 offset:41216
    ds_read_b64_tr_b16 v[80:81], v3 offset:9216
    ds_read_b64_tr_b16 v[82:83], v3 offset:9472
    ds_read_b64_tr_b16 v[84:85], v3 offset:41984
    ds_read_b64_tr_b16 v[86:87], v3 offset:42240
    ds_read_b64_tr_b16 v[88:89], v3 offset:10240
    ds_read_b64_tr_b16 v[90:91], v3 offset:10496
    ds_read_b64_tr_b16 v[92:93], v3 offset:43008
    ds_read_b64_tr_b16 v[94:95], v3 offset:43264
    s_waitcnt lgkmcnt(10)
    v_mfma_f32_32x32x16_bf16 v[40:55], v[72:75], v[160:163], v[40:55]
    ds_read_b64_tr_b16 v[96:97], v3 offset:11264
    ds_read_b64_tr_b16 v[98:99], v3 offset:11520
    s_add_u32 m0, s96, 0
    s_xor_b32 s94, s97, 640
    buffer_load_dwordx4 v122, s[52:55], s94 offen offset:0 lds
    s_waitcnt lgkmcnt(10)
    v_mfma_f32_32x32x16_bf16 v[56:71], v[76:79], v[160:163], v[56:71]
    ds_read_b64_tr_b16 v[100:101], v3 offset:44032
    ds_read_b64_tr_b16 v[102:103], v3 offset:44288
    s_add_u32 m0, s96, 0
    s_xor_b32 s94, s97, 7808
    buffer_load_dwordx4 v123, s[52:55], s94 offen offset:1024 lds
    s_waitcnt lgkmcnt(10)
    v_mfma_f32_32x32x16_bf16 v[40:55], v[80:83], v[164:167], v[40:55]
    ds_read_b64_tr_b16 v[72:73], v3 offset:12288
    ds_read_b64_tr_b16 v[74:75], v3 offset:12544
    s_add_u32 m0, s96, 0
    s_xor_b32 s94, s97, 14976
    buffer_load_dwordx4 v122, s[52:55], s94 offen offset:2048 lds
    s_waitcnt lgkmcnt(10)
    v_mfma_f32_32x32x16_bf16 v[56:71], v[84:87], v[164:167], v[56:71]
    ds_read_b64_tr_b16 v[76:77], v3 offset:45056
    ds_read_b64_tr_b16 v[78:79], v3 offset:45312
    s_add_u32 m0, s96, 0
    s_xor_b32 s94, s97, 22144
    buffer_load_dwordx4 v123, s[52:55], s94 offen offset:3072 lds
    s_waitcnt vmcnt(12)
    ds_read_b128 v[176:179], v124 offset:16384
    ds_read_b128 v[180:183], v125 offset:16384
    ds_read_b128 v[184:187], v126 offset:16384
    ds_read_b128 v[188:191], v127 offset:16384
    s_waitcnt lgkmcnt(14)
    v_mfma_f32_32x32x16_bf16 v[40:55], v[88:91], v[168:171], v[40:55]
    ds_read_b64_tr_b16 v[80:81], v3 offset:13312
    ds_read_b64_tr_b16 v[82:83], v3 offset:13568
    s_mov_b64 exec, 0x11111111
    buffer_load_dword v39, v36, s[32:35], 0 offen
    s_mov_b64 exec, -1
    s_add_u32 m0, s81, 90112
    s_add_u32 s84, s4, 48128
    buffer_load_dwordx4 v5, s[36:39], s4 offen lds
    buffer_load_dwordx4 v5, s[36:39], s84 offen offset:1024 lds
    s_waitcnt lgkmcnt(14)
    v_mfma_f32_32x32x16_bf16 v[56:71], v[92:95], v[168:171], v[56:71]
    ds_read_b64_tr_b16 v[84:85], v3 offset:46080
    ds_read_b64_tr_b16 v[86:87], v3 offset:46336
    s_waitcnt lgkmcnt(14)
    v_mfma_f32_32x32x16_bf16 v[40:55], v[96:99], v[172:175], v[40:55]
    ds_read_b64_tr_b16 v[88:89], v3 offset:14336
    ds_read_b64_tr_b16 v[90:91], v3 offset:14592
    s_waitcnt lgkmcnt(14)
    v_mfma_f32_32x32x16_bf16 v[56:71], v[100:103], v[172:175], v[56:71]
    ds_read_b64_tr_b16 v[92:93], v3 offset:47104
    ds_read_b64_tr_b16 v[94:95], v3 offset:47360
    s_waitcnt lgkmcnt(8)
    v_mfma_f32_32x32x16_bf16 v[40:55], v[72:75], v[176:179], v[40:55]
    ds_read_b64_tr_b16 v[96:97], v3 offset:15360
    ds_read_b64_tr_b16 v[98:99], v3 offset:15616
    s_add_u32 m0, s96, 16384
    s_xor_b32 s94, s97, 768
    buffer_load_dwordx4 v122, s[52:55], s94 offen offset:0 lds
    v_mfma_f32_32x32x16_bf16 v[56:71], v[76:79], v[176:179], v[56:71]
    ds_read_b64_tr_b16 v[100:101], v3 offset:48128
    ds_read_b64_tr_b16 v[102:103], v3 offset:48384
    s_add_u32 m0, s96, 16384
    s_xor_b32 s94, s97, 7936
    buffer_load_dwordx4 v123, s[52:55], s94 offen offset:1024 lds
    s_waitcnt lgkmcnt(10)
    v_mfma_f32_32x32x16_bf16 v[40:55], v[80:83], v[180:183], v[40:55]
    s_add_u32 m0, s96, 16384
    s_xor_b32 s94, s97, 15104
    buffer_load_dwordx4 v122, s[52:55], s94 offen offset:2048 lds
    s_waitcnt lgkmcnt(8)
    v_mfma_f32_32x32x16_bf16 v[56:71], v[84:87], v[180:183], v[56:71]
    s_add_u32 m0, s96, 16384
    s_xor_b32 s94, s97, 22272
    buffer_load_dwordx4 v123, s[52:55], s94 offen offset:3072 lds
    s_waitcnt vmcnt(15)
    ds_read_b128 v[192:195], v124 offset:32768
    ds_read_b128 v[196:199], v125 offset:32768
    ds_read_b128 v[200:203], v126 offset:32768
    ds_read_b128 v[204:207], v127 offset:32768
    s_waitcnt lgkmcnt(10)
    v_mfma_f32_32x32x16_bf16 v[40:55], v[88:91], v[184:187], v[40:55]
    s_waitcnt lgkmcnt(8)
    v_mfma_f32_32x32x16_bf16 v[56:71], v[92:95], v[184:187], v[56:71]
    s_waitcnt lgkmcnt(6)
    v_mfma_f32_32x32x16_bf16 v[40:55], v[96:99], v[188:191], v[40:55]
    s_waitcnt lgkmcnt(4)
    v_mfma_f32_32x32x16_bf16 v[56:71], v[100:103], v[188:191], v[56:71]
    s_waitcnt vmcnt(11)
    s_nop 0
    ds_read_b64_tr_b16 v[72:73], v120 offset:16384
    ds_read_b64_tr_b16 v[74:75], v120 offset:16640
    ds_read_b64_tr_b16 v[76:77], v120 offset:17408
    ds_read_b64_tr_b16 v[78:79], v120 offset:17664
    ds_read_b64_tr_b16 v[80:81], v120 offset:49152
    ds_read_b64_tr_b16 v[82:83], v120 offset:49408
    ds_read_b64_tr_b16 v[84:85], v120 offset:50176
    ds_read_b64_tr_b16 v[86:87], v120 offset:50432
    s_waitcnt lgkmcnt(8)
    s_nop 0
    s_add_u32 m0, s81, 24576
    s_add_u32 s94, s23, 1024
    buffer_load_dwordx4 v5, s[32:35], s94 offen lds
    s_add_u32 m0, s81, 25600
    s_add_u32 s94, s23, 50176
    buffer_load_dwordx4 v5, s[32:35], s94 offen lds
    s_add_u32 m0, s81, 57344
    s_add_u32 s94, s23, 2048
    buffer_load_dwordx4 v5, s[32:35], s94 offen lds
    s_add_u32 m0, s81, 58368
    s_add_u32 s94, s23, 51200
    buffer_load_dwordx4 v5, s[32:35], s94 offen lds
    s_waitcnt lgkmcnt(6)
    v_mfma_f32_16x16x32_bf16 v[104:107], v[116:119], v[72:75], v[104:107]
    s_waitcnt lgkmcnt(4)
    v_mfma_f32_16x16x32_bf16 v[104:107], v[116:119], v[76:79], v[104:107]
    s_waitcnt lgkmcnt(2)
    v_mfma_f32_16x16x32_bf16 v[108:111], v[116:119], v[80:83], v[108:111]
    s_waitcnt lgkmcnt(0)
    v_mfma_f32_16x16x32_bf16 v[108:111], v[116:119], v[84:87], v[108:111]
    s_barrier
    s_nop 0
    ds_read_b64_tr_b16 v[72:73], v3 offset:16384
    ds_read_b64_tr_b16 v[74:75], v3 offset:16640
    ds_read_b64_tr_b16 v[76:77], v3 offset:49152
    ds_read_b64_tr_b16 v[78:79], v3 offset:49408
    ds_read_b64_tr_b16 v[80:81], v3 offset:17408
    ds_read_b64_tr_b16 v[82:83], v3 offset:17664
    ds_read_b64_tr_b16 v[84:85], v3 offset:50176
    ds_read_b64_tr_b16 v[86:87], v3 offset:50432
    ds_read_b64_tr_b16 v[88:89], v3 offset:18432
    ds_read_b64_tr_b16 v[90:91], v3 offset:18688
    ds_read_b64_tr_b16 v[92:93], v3 offset:51200
    ds_read_b64_tr_b16 v[94:95], v3 offset:51456
    s_waitcnt lgkmcnt(10)
    v_mfma_f32_32x32x16_bf16 v[40:55], v[72:75], v[192:195], v[40:55]
    ds_read_b64_tr_b16 v[96:97], v3 offset:19456
    ds_read_b64_tr_b16 v[98:99], v3 offset:19712
    s_add_u32 m0, s96, 32768
    s_xor_b32 s94, s97, 896
    buffer_load_dwordx4 v122, s[52:55], s94 offen offset:0 lds
    s_waitcnt lgkmcnt(10)
    v_mfma_f32_32x32x16_bf16 v[56:71], v[76:79], v[192:195], v[56:71]
    ds_read_b64_tr_b16 v[100:101], v3 offset:52224
    ds_read_b64_tr_b16 v[102:103], v3 offset:52480
    s_add_u32 m0, s96, 32768
    s_xor_b32 s94, s97, 8064
    buffer_load_dwordx4 v123, s[52:55], s94 offen offset:1024 lds
    s_waitcnt lgkmcnt(10)
    v_mfma_f32_32x32x16_bf16 v[40:55], v[80:83], v[196:199], v[40:55]
    ds_read_b64_tr_b16 v[72:73], v3 offset:20480
    ds_read_b64_tr_b16 v[74:75], v3 offset:20736
    s_add_u32 m0, s96, 32768
    s_xor_b32 s94, s97, 15232
    buffer_load_dwordx4 v122, s[52:55], s94 offen offset:2048 lds
    s_waitcnt lgkmcnt(10)
    v_mfma_f32_32x32x16_bf16 v[56:71], v[84:87], v[196:199], v[56:71]
    ds_read_b64_tr_b16 v[76:77], v3 offset:53248
    ds_read_b64_tr_b16 v[78:79], v3 offset:53504
    s_add_u32 m0, s96, 32768
    s_xor_b32 s94, s97, 22400
    buffer_load_dwordx4 v123, s[52:55], s94 offen offset:3072 lds
    s_waitcnt vmcnt(15)
    ds_read_b128 v[208:211], v124 offset:0
    ds_read_b128 v[212:215], v125 offset:0
    ds_read_b128 v[216:219], v126 offset:0
    ds_read_b128 v[220:223], v127 offset:0
    s_waitcnt lgkmcnt(14)
    v_mfma_f32_32x32x16_bf16 v[40:55], v[88:91], v[200:203], v[40:55]
    ds_read_b64_tr_b16 v[80:81], v3 offset:21504
    ds_read_b64_tr_b16 v[82:83], v3 offset:21760
    s_waitcnt lgkmcnt(14)
    v_mfma_f32_32x32x16_bf16 v[56:71], v[92:95], v[200:203], v[56:71]
    ds_read_b64_tr_b16 v[84:85], v3 offset:54272
    ds_read_b64_tr_b16 v[86:87], v3 offset:54528
    s_waitcnt lgkmcnt(14)
    v_mfma_f32_32x32x16_bf16 v[40:55], v[96:99], v[204:207], v[40:55]
    ds_read_b64_tr_b16 v[88:89], v3 offset:22528
    ds_read_b64_tr_b16 v[90:91], v3 offset:22784
    s_waitcnt vmcnt(12)
    ds_read_b128 v[240:243], v32
    ds_read_b128 v[24:27], v37 offset:0
    ds_read_b128 v[244:247], v33
    ds_read_b128 v[28:31], v37 offset:1024
    s_waitcnt lgkmcnt(15)
    v_mfma_f32_32x32x16_bf16 v[56:71], v[100:103], v[204:207], v[56:71]
    ds_read_b64_tr_b16 v[92:93], v3 offset:55296
    ds_read_b64_tr_b16 v[94:95], v3 offset:55552
    s_waitcnt lgkmcnt(12)
    v_mfma_f32_32x32x16_bf16 v[40:55], v[72:75], v[208:211], v[40:55]
    ds_read_b64_tr_b16 v[96:97], v3 offset:23552
    ds_read_b64_tr_b16 v[98:99], v3 offset:23808
    s_add_u32 m0, s81, 65536
    s_add_u32 s94, s20, 0
    buffer_load_dwordx4 v5, s[32:35], s94 offen lds
    v_mfma_f32_32x32x16_bf16 v[56:71], v[76:79], v[208:211], v[56:71]
    ds_read_b64_tr_b16 v[100:101], v3 offset:56320
    ds_read_b64_tr_b16 v[102:103], v3 offset:56576
    s_mov_b64 exec, s[14:15]
    buffer_load_dword v38, v21, s[40:43], 0 offen sc1
    s_mov_b64 exec, -1
    buffer_load_dword v112, v113, s[40:43], 0 offen sc1
    s_waitcnt lgkmcnt(6)
    v_mfma_f32_16x16x32_bf16 v[248:251], v[24:27], v[240:243], 0
    v_mfma_f32_16x16x32_bf16 v[252:255], v[24:27], v[244:247], 0
    v_mfma_f32_32x32x16_bf16 v[40:55], v[80:83], v[212:215], v[40:55]
    s_add_u32 m0, s81, 66560
    s_add_u32 s94, s20, 49152
    buffer_load_dwordx4 v5, s[32:35], s94 offen lds
    v_mfma_f32_32x32x16_bf16 v[56:71], v[84:87], v[212:215], v[56:71]
    s_waitcnt vmcnt(12)
    ds_read_b128 v[224:227], v124 offset:16384
    ds_read_b128 v[228:231], v125 offset:16384
    ds_read_b128 v[232:235], v126 offset:16384
    ds_read_b128 v[236:239], v127 offset:16384
    v_cvt_pk_bf16_f32 v24, v248, v249
    v_cvt_pk_bf16_f32 v25, v250, v251
    v_cvt_pk_bf16_f32 v26, v252, v253
    v_cvt_pk_bf16_f32 v27, v254, v255
    v_mfma_f32_16x16x32_bf16 v[248:251], v[28:31], v[240:243], 0
    v_mfma_f32_16x16x32_bf16 v[252:255], v[28:31], v[244:247], 0
    v_mfma_f32_32x32x16_bf16 v[40:55], v[88:91], v[216:219], v[40:55]
    v_permlane16_swap_b32 v24, v26
    v_permlane16_swap_b32 v25, v27
    s_waitcnt lgkmcnt(8)
    v_mfma_f32_32x32x16_bf16 v[56:71], v[92:95], v[216:219], v[56:71]
    v_cvt_pk_bf16_f32 v28, v248, v249
    v_cvt_pk_bf16_f32 v29, v250, v251
    v_cvt_pk_bf16_f32 v30, v252, v253
    v_cvt_pk_bf16_f32 v31, v254, v255
    s_waitcnt lgkmcnt(6)
    v_mfma_f32_32x32x16_bf16 v[40:55], v[96:99], v[220:223], v[40:55]
    v_permlane16_swap_b32 v28, v30
    v_permlane16_swap_b32 v29, v31
    s_waitcnt lgkmcnt(4)
    v_mfma_f32_32x32x16_bf16 v[56:71], v[100:103], v[220:223], v[56:71]
    v_mfma_f32_16x16x32_bf16 v[248:251], v[116:119], v[24:27], 0
    v_mfma_f32_16x16x32_bf16 v[248:251], v[116:119], v[28:31], v[248:251]
    buffer_store_dwordx4 v[24:27], v1, s[40:43], s5 offen offset:0 sc1
    buffer_store_dwordx4 v[28:31], v1, s[40:43], s5 offen offset:1024 sc1
    s_nop 5
    v_mov_b32_e64 v36, v248
    s_waitcnt lgkmcnt(0)
    s_waitcnt vmcnt(10)
    ds_read_b64_tr_b16 v[24:25], v120 offset:24576
    ds_read_b64_tr_b16 v[26:27], v120 offset:24832
L_pg1:
    s_cbranch_execz L_pgret0
    ds_read_b64_tr_b16 v[28:29], v120 offset:25600
    ds_read_b64_tr_b16 v[30:31], v120 offset:25856
    ds_read_b64_tr_b16 v[32:33], v120 offset:57344
    ds_read_b64_tr_b16 v[34:35], v120 offset:57600
    s_barrier
    ds_read_b64_tr_b16 v[72:73], v3 offset:24576
    ds_read_b64_tr_b16 v[74:75], v3 offset:24832
    ds_read_b64_tr_b16 v[76:77], v3 offset:57344
    ds_read_b64_tr_b16 v[78:79], v3 offset:57600
    ds_read_b64_tr_b16 v[80:81], v3 offset:25600
    ds_read_b64_tr_b16 v[82:83], v3 offset:25856
    ds_read_b64_tr_b16 v[84:85], v3 offset:58368
    ds_read_b64_tr_b16 v[86:87], v3 offset:58624
    ds_read_b64_tr_b16 v[88:89], v3 offset:26624
    ds_read_b64_tr_b16 v[90:91], v3 offset:26880
    ds_read_b64_tr_b16 v[92:93], v3 offset:59392
    ds_read_b64_tr_b16 v[94:95], v3 offset:59648
    s_waitcnt lgkmcnt(10)
    v_mfma_f32_32x32x16_bf16 v[40:55], v[72:75], v[224:227], v[40:55]
    ds_read_b64_tr_b16 v[96:97], v3 offset:27648
    ds_read_b64_tr_b16 v[98:99], v3 offset:27904
    s_add_u32 m0, s81, 73728
    s_add_u32 s94, s21, 0
    buffer_load_dwordx4 v5, s[32:35], s94 offen lds
    v_mfma_f32_16x16x32_bf16 v[104:107], v[116:119], v[24:27], v[104:107]
    ds_read_b64_tr_b16 v[24:25], v120 offset:58368
    ds_read_b64_tr_b16 v[26:27], v120 offset:58624
    s_waitcnt lgkmcnt(12)
    v_mfma_f32_32x32x16_bf16 v[56:71], v[76:79], v[224:227], v[56:71]
    ds_read_b64_tr_b16 v[100:101], v3 offset:60416
    ds_read_b64_tr_b16 v[102:103], v3 offset:60672
    v_mfma_f32_16x16x32_bf16 v[104:107], v[116:119], v[28:31], v[104:107]
    s_waitcnt lgkmcnt(12)
    v_mfma_f32_32x32x16_bf16 v[40:55], v[80:83], v[228:231], v[40:55]
    ds_read_b64_tr_b16 v[72:73], v3 offset:28672
    ds_read_b64_tr_b16 v[74:75], v3 offset:28928
    s_add_u32 m0, s81, 74752
    s_add_u32 s94, s21, 49152
    buffer_load_dwordx4 v5, s[32:35], s94 offen lds
    s_lshr_b32 s0, s65, 2
    s_cmp_lg_u32 s66, s0
    s_cbranch_scc1 Lres_8
    v_add_u32 v240, 0x18000, v1
    ds_write_b128 v240, v[128:131] offset:0
    ds_write_b128 v240, v[132:135] offset:1024
    ds_write_b128 v240, v[136:139] offset:2048
    ds_write_b128 v240, v[140:143] offset:3072
Lres_8:
    v_mfma_f32_16x16x32_bf16 v[108:111], v[116:119], v[32:35], v[108:111]
    s_waitcnt lgkmcnt(12)
    v_mfma_f32_32x32x16_bf16 v[56:71], v[84:87], v[228:231], v[56:71]
    ds_read_b64_tr_b16 v[76:77], v3 offset:29696
    ds_read_b64_tr_b16 v[78:79], v3 offset:29952
    s_cmp_lg_u32 s66, s0
    s_cbranch_scc1 Lres_9
    ds_write_b128 v240, v[144:147] offset:4096
    ds_write_b128 v240, v[148:151] offset:5120
    ds_write_b128 v240, v[152:155] offset:6144
    ds_write_b128 v240, v[156:159] offset:7168
Lres_9:
    s_waitcnt vmcnt(8)
    ds_read_b128 v[240:243], v124 offset:32768
    ds_read_b128 v[244:247], v125 offset:32768
    ds_read_b128 v[248:251], v126 offset:32768
    ds_read_b128 v[252:255], v127 offset:32768
    s_waitcnt lgkmcnt(15)
    v_mfma_f32_32x32x16_bf16 v[40:55], v[88:91], v[232:235], v[40:55]
    ds_read_b64_tr_b16 v[80:81], v3 offset:30720
    ds_read_b64_tr_b16 v[82:83], v3 offset:30976
    s_add_u32 m0, s81, 81920
    s_add_u32 s94, s22, 0
    buffer_load_dwordx4 v5, s[32:35], s94 offen lds
    s_waitcnt lgkmcnt(12)
    v_mfma_f32_16x16x32_bf16 v[108:111], v[116:119], v[24:27], v[108:111]
    v_mfma_f32_32x32x16_bf16 v[56:71], v[92:95], v[232:235], v[56:71]
    ds_read_b64_tr_b16 v[84:85], v3 offset:61440
    ds_read_b64_tr_b16 v[86:87], v3 offset:61696
    v_mfma_f32_32x32x16_bf16 v[40:55], v[96:99], v[236:239], v[40:55]
    ds_read_b64_tr_b16 v[88:89], v3 offset:31744
    ds_read_b64_tr_b16 v[90:91], v3 offset:32000
    s_add_u32 m0, s81, 82944
    s_add_u32 s94, s22, 49152
    buffer_load_dwordx4 v5, s[32:35], s94 offen lds
    s_lshl_b32 s84, s66, 8
    v_add_u32 v120, s84, v22
    ds_write_b32 v120, v104 offset:0
    ds_write_b32 v120, v108 offset:1024
    s_waitcnt lgkmcnt(15)
    v_mfma_f32_32x32x16_bf16 v[56:71], v[100:103], v[236:239], v[56:71]
    ds_read_b64_tr_b16 v[92:93], v3 offset:62464
    ds_read_b64_tr_b16 v[94:95], v3 offset:62720
    s_or_b32 s84, s69, 0x80
    s_waitcnt vmcnt(7)
    v_cmp_gt_u32 vcc, 0x80, v38
    v_cmp_ne_u32 s[92:93], s84, v38
    s_waitcnt lgkmcnt(10)
    v_mfma_f32_32x32x16_bf16 v[40:55], v[72:75], v[240:243], v[40:55]
    ds_read_b64_tr_b16 v[96:97], v3 offset:63488
    ds_read_b64_tr_b16 v[98:99], v3 offset:63744
    s_add_u32 m0, s81, 114688
    s_add_u32 s94, s23, 0
    buffer_load_dwordx4 v5, s[32:35], s94 offen lds
    s_bfe_u64 s[92:93], s[92:93], 0x100020
    s_or_b64 s[92:93], s[92:93], vcc
    s_cbranch_scc1 L_notrdy
L_switch:
    s_waitcnt lgkmcnt(4)
    s_barrier
    ds_read2st64_b32 v[104:105], v22 offset0:0 offset1:1
    ds_read2st64_b32 v[106:107], v22 offset0:2 offset1:3
    ds_read2st64_b32 v[108:109], v22 offset0:4 offset1:5
    ds_read2st64_b32 v[110:111], v22 offset0:6 offset1:7
    v_mfma_f32_32x32x16_bf16 v[40:55], v[76:79], v[244:247], v[40:55]
    ds_read_b64_tr_b16 v[100:101], v3 offset:64512
    ds_read_b64_tr_b16 v[102:103], v3 offset:64768
    s_mov_b32 exec_hi, 0
    buffer_store_dword v36, v20, s[40:43], s7 offen sc1
    s_mov_b32 exec_hi, -1
    v_mov_b32 v24, -1
    v_mov_b32 v25, -1
    v_mov_b32 v26, -1
    v_mov_b32 v27, -1
    s_add_u32 s87, s74, 557056
    s_mov_b32 exec_hi, 0
    buffer_store_dwordx4 v[24:27], v11, s[40:43], s87 offen sc1
    s_mov_b32 exec_hi, -1
    v_mul_f32 v112, 0x3b000000, v112
    v_mov_b32 v113, v112
    v_cmp_gt_u32 vcc, 32, v0
    v_mfma_f32_32x32x16_bf16 v[40:55], v[80:83], v[248:251], v[40:55]
    s_add_u32 m0, s81, 115712
    s_add_u32 s94, s23, 49152
    buffer_load_dwordx4 v5, s[32:35], s94 offen lds
    v_permlane32_swap_b32 v112, v113
    v_fma_f32 v113, -v112, v112, v113
    v_cndmask_b32 v112, 0, v112, vcc
    v_mfma_f32_32x32x16_bf16 v[56:71], v[84:87], v[240:243], v[56:71]
    v_cvt_pk_bf16_f32 v117, -v112, 0
    v_lshlrev_b32 v114, 16, v117
    v_sub_f32 v114, -v112, v114
    v_cvt_pk_bf16_f32 v116, -v112, v114
    v_mfma_f32_32x32x16_bf16 v[40:55], v[88:91], v[252:255], v[40:55]
    s_waitcnt lgkmcnt(2)
    v_add_f32 v104, v104, v105
    v_add_f32 v106, v106, v107
    v_add_f32 v106, v104, v106
    v_cvt_pk_bf16_f32 v104, v106, v106
    v_and_b32 v107, 0xffff0000, v104
    v_sub_f32 v107, v106, v107
    v_cvt_pk_bf16_f32 v105, v107, 0
    v_add_f32 v108, v108, v109
    v_add_f32 v110, v110, v111
    v_add_f32 v110, v108, v110
    v_mfma_f32_32x32x8_bf16 v[40:55], v[104:105], v[116:117], v[40:55]
    v_cvt_pk_bf16_f32 v108, v110, v110
    v_and_b32 v111, 0xffff0000, v108
    v_sub_f32 v111, v110, v111
    v_cvt_pk_bf16_f32 v109, v111, 0
    v_max_f32 v113, 0, v113
    v_mfma_f32_32x32x16_bf16 v[56:71], v[92:95], v[244:247], v[56:71]
    v_add_f32 v113, 0x3727c5ac, v113
    v_rsq_f32 v120, v113
    v_mfma_f32_32x32x8_bf16 v[56:71], v[108:109], v[116:117], v[56:71]
    v_mul_f32 v118, 0x3fb8aa3b, v120
    ds_read_b128 v[104:107], v2 offset:32768
    ds_read_b128 v[108:111], v2 offset:33792
    v_mfma_f32_32x32x16_bf16 v[56:71], v[96:99], v[248:251], v[56:71]
    v_cvt_pk_bf16_f32 v40, v40, v41
    v_cvt_pk_bf16_f32 v41, v42, v43
    v_cvt_pk_bf16_f32 v42, v44, v45
    v_cvt_pk_bf16_f32 v43, v46, v47
    s_waitcnt lgkmcnt(2)
    v_mfma_f32_32x32x16_bf16 v[56:71], v[100:103], v[252:255], v[56:71]
    v_cvt_pk_bf16_f32 v44, v48, v49
    v_cvt_pk_bf16_f32 v45, v50, v51
    v_cvt_pk_bf16_f32 v46, v52, v53
    v_cvt_pk_bf16_f32 v47, v54, v55
    s_waitcnt lgkmcnt(0)
    v_mfma_f32_32x32x16_bf16 v[72:87], v[104:107], v[40:43], 0
    v_mfma_f32_32x32x16_bf16 v[88:103], v[108:111], v[44:47], 0
    v_mul_f32 v56, v56, v120
    v_mul_f32 v57, v57, v120
    v_mul_f32 v58, v58, v120
    v_mul_f32 v59, v59, v120
    v_mul_f32 v60, v60, v120
    v_mul_f32 v61, v61, v120
    v_mul_f32 v62, v62, v120
    v_mul_f32 v63, v63, v120
    v_cvt_pk_bf16_f32 v56, v56, v57
    v_cvt_pk_bf16_f32 v57, v58, v59
    v_cvt_pk_bf16_f32 v58, v60, v61
    v_cvt_pk_bf16_f32 v59, v62, v63
    ds_write_b128 v8, v[56:59]
    v_pk_mul_f32 v[64:65], v[64:65], v[120:121] op_sel_hi:[1,0]
    v_pk_mul_f32 v[66:67], v[66:67], v[120:121] op_sel_hi:[1,0]
    v_pk_mul_f32 v[68:69], v[68:69], v[120:121] op_sel_hi:[1,0]
    v_pk_mul_f32 v[70:71], v[70:71], v[120:121] op_sel_hi:[1,0]
    s_add_u32 s95, s8, 0
    s_nop 0
    buffer_load_dwordx4 a[0:3], v1, s[40:43], s95 offen offset:0 sc1
    v_cvt_pk_bf16_f32 v60, v64, v65
    v_cvt_pk_bf16_f32 v61, v66, v67
    v_cvt_pk_bf16_f32 v62, v68, v69
    v_cvt_pk_bf16_f32 v63, v70, v71
    v_max3_f32 v122, v72, v73, v74
    v_max3_f32 v123, v75, v76, v77
    v_max3_f32 v122, v122, v78, v79
    v_max3_f32 v123, v123, v80, v81
    v_max3_f32 v122, v122, v82, v83
    v_max3_f32 v123, v123, v84, v85
    ds_write_b128 v8, v[60:63] offset:4096
    v_max3_f32 v122, v122, v86, v87
    v_max_f32_e64 v122, v122, v123
    v_mul_f32 v119, -v122, v118
    v_pk_fma_f32 v[72:73], v[72:73], v[118:119], v[118:119] op_sel:[0,0,1] op_sel_hi:[1,0,1]
    v_pk_fma_f32 v[74:75], v[74:75], v[118:119], v[118:119] op_sel:[0,0,1] op_sel_hi:[1,0,1]
    v_pk_fma_f32 v[76:77], v[76:77], v[118:119], v[118:119] op_sel:[0,0,1] op_sel_hi:[1,0,1]
    buffer_load_dwordx4 a[4:7], v1, s[40:43], s95 offen offset:1024 sc1
    v_pk_fma_f32 v[78:79], v[78:79], v[118:119], v[118:119] op_sel:[0,0,1] op_sel_hi:[1,0,1]
    v_pk_fma_f32 v[80:81], v[80:81], v[118:119], v[118:119] op_sel:[0,0,1] op_sel_hi:[1,0,1]
    v_pk_fma_f32 v[82:83], v[82:83], v[118:119], v[118:119] op_sel:[0,0,1] op_sel_hi:[1,0,1]
    v_pk_fma_f32 v[84:85], v[84:85], v[118:119], v[118:119] op_sel:[0,0,1] op_sel_hi:[1,0,1]
    v_pk_fma_f32 v[86:87], v[86:87], v[118:119], v[118:119] op_sel:[0,0,1] op_sel_hi:[1,0,1]
    v_exp_f32 v72, v72
    v_exp_f32 v73, v73
    v_exp_f32 v74, v74
    v_exp_f32 v75, v75
    v_exp_f32 v76, v76
    v_exp_f32 v77, v77
    buffer_load_dwordx4 a[8:11], v1, s[40:43], s95 offen offset:2048 sc1
    v_exp_f32 v78, v78
    v_exp_f32 v79, v79
    v_exp_f32 v80, v80
    v_exp_f32 v81, v81
    v_exp_f32 v82, v82
    v_exp_f32 v83, v83
    v_exp_f32 v84, v84
    v_exp_f32 v85, v85
    buffer_load_dwordx4 a[12:15], v1, s[40:43], s95 offen offset:3072 sc1
    v_exp_f32 v86, v86
    v_exp_f32 v87, v87
    v_pk_add_f32 v[124:125], v[72:73], v[74:75]
    v_pk_add_f32 v[126:127], v[76:77], v[78:79]
    v_pk_add_f32 v[124:125], v[124:125], v[80:81]
    v_pk_add_f32 v[126:127], v[126:127], v[82:83]
    v_pk_add_f32 v[124:125], v[124:125], v[84:85]
    v_pk_add_f32 v[126:127], v[126:127], v[86:87]
    v_pk_add_f32 v[124:125], v[124:125], v[126:127]
    v_add_f32 v124, v124, v125
    v_rcp_f32_e64 v124, v124
    s_nop 0
    v_pk_mul_f32 v[72:73], v[72:73], v[124:125] op_sel_hi:[1,0]
    v_pk_mul_f32 v[74:75], v[74:75], v[124:125] op_sel_hi:[1,0]
    s_add_u32 s95, s8, 4096
    buffer_load_dwordx4 a[16:19], v1, s[40:43], s95 offen offset:0 sc1
    v_pk_mul_f32 v[76:77], v[76:77], v[124:125] op_sel_hi:[1,0]
    v_pk_mul_f32 v[78:79], v[78:79], v[124:125] op_sel_hi:[1,0]
    v_cvt_pk_bf16_f32 v72, v72, v73
    v_cvt_pk_bf16_f32 v73, v74, v75
    v_cvt_pk_bf16_f32 v74, v76, v77
    v_cvt_pk_bf16_f32 v75, v78, v79
    ds_write_b128 v6, v[72:75]
    v_pk_mul_f32 v[80:81], v[80:81], v[124:125] op_sel_hi:[1,0]
    v_pk_mul_f32 v[82:83], v[82:83], v[124:125] op_sel_hi:[1,0]
    v_pk_mul_f32 v[84:85], v[84:85], v[124:125] op_sel_hi:[1,0]
    v_pk_mul_f32 v[86:87], v[86:87], v[124:125] op_sel_hi:[1,0]
    v_cvt_pk_bf16_f32 v76, v80, v81
    v_cvt_pk_bf16_f32 v77, v82, v83
    v_cvt_pk_bf16_f32 v78, v84, v85
    v_cvt_pk_bf16_f32 v79, v86, v87
    v_max3_f32 v122, v88, v89, v90
    v_max3_f32 v123, v91, v92, v93
    buffer_load_dwordx4 a[20:23], v1, s[40:43], s95 offen offset:1024 sc1
    v_max3_f32 v122, v122, v94, v95
    v_max3_f32 v123, v123, v96, v97
    v_max3_f32 v122, v122, v98, v99
    v_max3_f32 v123, v123, v100, v101
    ds_write_b128 v7, v[76:79]
    v_max3_f32 v122, v122, v102, v103
    v_max_f32_e64 v122, v122, v123
    v_mul_f32 v119, -v122, v118
    v_pk_fma_f32 v[88:89], v[88:89], v[118:119], v[118:119] op_sel:[0,0,1] op_sel_hi:[1,0,1]
    v_pk_fma_f32 v[90:91], v[90:91], v[118:119], v[118:119] op_sel:[0,0,1] op_sel_hi:[1,0,1]
    v_pk_fma_f32 v[92:93], v[92:93], v[118:119], v[118:119] op_sel:[0,0,1] op_sel_hi:[1,0,1]
    v_pk_fma_f32 v[94:95], v[94:95], v[118:119], v[118:119] op_sel:[0,0,1] op_sel_hi:[1,0,1]
    v_pk_fma_f32 v[96:97], v[96:97], v[118:119], v[118:119] op_sel:[0,0,1] op_sel_hi:[1,0,1]
    v_pk_fma_f32 v[98:99], v[98:99], v[118:119], v[118:119] op_sel:[0,0,1] op_sel_hi:[1,0,1]
    v_pk_fma_f32 v[100:101], v[100:101], v[118:119], v[118:119] op_sel:[0,0,1] op_sel_hi:[1,0,1]
    v_pk_fma_f32 v[102:103], v[102:103], v[118:119], v[118:119] op_sel:[0,0,1] op_sel_hi:[1,0,1]
    v_exp_f32 v88, v88
    buffer_load_dwordx4 a[24:27], v1, s[40:43], s95 offen offset:2048 sc1
    v_exp_f32 v89, v89
    v_exp_f32 v90, v90
    v_exp_f32 v91, v91
    v_exp_f32 v92, v92
    v_exp_f32 v93, v93
    v_exp_f32 v94, v94
    v_exp_f32 v95, v95
    v_exp_f32 v96, v96
    buffer_load_dwordx4 a[28:31], v1, s[40:43], s95 offen offset:3072 sc1
    v_exp_f32 v97, v97
    v_exp_f32 v98, v98
    v_exp_f32 v99, v99
    v_exp_f32 v100, v100
    v_exp_f32 v101, v101
    v_exp_f32 v102, v102
    v_exp_f32 v103, v103
    v_pk_add_f32 v[124:125], v[88:89], v[90:91]
    v_pk_add_f32 v[126:127], v[92:93], v[94:95]
    s_add_u32 s95, s9, 0
    s_nop 0
    buffer_load_dwordx4 a[32:35], v1, s[40:43], s95 offen offset:0 sc1
    v_pk_add_f32 v[124:125], v[124:125], v[96:97]
    v_pk_add_f32 v[126:127], v[126:127], v[98:99]
    v_pk_add_f32 v[124:125], v[124:125], v[100:101]
    v_pk_add_f32 v[126:127], v[126:127], v[102:103]
    v_pk_add_f32 v[124:125], v[124:125], v[126:127]
    v_add_f32 v124, v124, v125
    v_rcp_f32_e64 v124, v124
    s_nop 0
    v_pk_mul_f32 v[88:89], v[88:89], v[124:125] op_sel_hi:[1,0]
    v_pk_mul_f32 v[90:91], v[90:91], v[124:125] op_sel_hi:[1,0]
    v_pk_mul_f32 v[92:93], v[92:93], v[124:125] op_sel_hi:[1,0]
    v_pk_mul_f32 v[94:95], v[94:95], v[124:125] op_sel_hi:[1,0]
    v_cvt_pk_bf16_f32 v88, v88, v89
    v_cvt_pk_bf16_f32 v89, v90, v91
    v_cvt_pk_bf16_f32 v90, v92, v93
    v_cvt_pk_bf16_f32 v91, v94, v95
    buffer_load_dwordx4 a[36:39], v1, s[40:43], s95 offen offset:1024 sc1
    ds_write_b128 v6, v[88:91] offset:8192
    v_pk_mul_f32 v[96:97], v[96:97], v[124:125] op_sel_hi:[1,0]
    v_pk_mul_f32 v[98:99], v[98:99], v[124:125] op_sel_hi:[1,0]
    v_pk_mul_f32 v[100:101], v[100:101], v[124:125] op_sel_hi:[1,0]
    v_pk_mul_f32 v[102:103], v[102:103], v[124:125] op_sel_hi:[1,0]
    v_cvt_pk_bf16_f32 v92, v96, v97
    v_cvt_pk_bf16_f32 v93, v98, v99
    v_cvt_pk_bf16_f32 v94, v100, v101
    v_cvt_pk_bf16_f32 v95, v102, v103
    ds_write_b128 v7, v[92:95] offset:8192
    v_mov_b32 v64, 0x3f803f80
    v_mov_b32 v65, 0x3f803f80
    v_mov_b32 v66, 0x3f803f80
    v_mov_b32 v67, 0x3f803f80
    v_lshlrev_b32 v37, 3, v1
    s_mov_b64 exec, 0xffff
    buffer_load_dword v39, v37, s[44:47], s71 offen
    s_mov_b64 exec, -1
    s_waitcnt vmcnt(11)
    s_waitcnt lgkmcnt(0)
    s_barrier
    s_nop 0
    ds_read_b64_tr_b16 v[72:73], v9 offset:0
    ds_read_b64_tr_b16 v[74:75], v9 offset:512
    ds_read_b64_tr_b16 v[76:77], v10 offset:0
    ds_read_b64_tr_b16 v[78:79], v10 offset:512
    ds_read_b64_tr_b16 v[80:81], v9 offset:1024
    ds_read_b64_tr_b16 v[82:83], v9 offset:1536
    ds_read_b64_tr_b16 v[84:85], v10 offset:1024
    ds_read_b64_tr_b16 v[86:87], v10 offset:1536
    ds_read_b64_tr_b16 v[88:89], v9 offset:2048
    ds_read_b64_tr_b16 v[90:91], v9 offset:2560
    ds_read_b64_tr_b16 v[92:93], v10 offset:2048
    ds_read_b64_tr_b16 v[94:95], v10 offset:2560
    ds_read_b64_tr_b16 v[96:97], v9 offset:3072
    ds_read_b64_tr_b16 v[98:99], v9 offset:3584
    ds_read_b64_tr_b16 v[100:101], v10 offset:3072
    ds_read_b64_tr_b16 v[102:103], v10 offset:3584
    buffer_load_dwordx4 a[40:43], v1, s[40:43], s95 offen offset:2048 sc1
    s_waitcnt lgkmcnt(12)
    v_mfma_f32_16x16x32_bf16 v[56:59], v[72:75], v[76:79], 0
    v_mfma_f32_16x16x32_bf16 v[60:63], v[72:75], v[64:67], 0
    s_waitcnt lgkmcnt(8)
    v_mfma_f32_16x16x32_bf16 v[56:59], v[80:83], v[84:87], v[56:59]
    v_mfma_f32_16x16x32_bf16 v[60:63], v[80:83], v[64:67], v[60:63]
    s_waitcnt lgkmcnt(4)
    v_mfma_f32_16x16x32_bf16 v[56:59], v[88:91], v[92:95], v[56:59]
    v_mfma_f32_16x16x32_bf16 v[60:63], v[88:91], v[64:67], v[60:63]
    s_waitcnt lgkmcnt(0)
    v_mfma_f32_16x16x32_bf16 v[56:59], v[96:99], v[100:103], v[56:59]
    v_mfma_f32_16x16x32_bf16 v[60:63], v[96:99], v[64:67], v[60:63]
    s_add_u32 s84, s74, 0
    ds_read_b64_tr_b16 v[72:73], v4 offset:0
    ds_read_b64_tr_b16 v[74:75], v4 offset:256
    ds_read_b64_tr_b16 v[76:77], v4 offset:1024
    ds_read_b64_tr_b16 v[78:79], v4 offset:1280
    v_add_u32 v21, s81, v1
    v_add_u32_e64 v5, s17, v1
    v_cvt_pk_bf16_f32 v56, v56, v57
    v_cvt_pk_bf16_f32 v57, v58, v59
    v_cvt_pk_bf16_f32 v58, v60, v61
    v_cvt_pk_bf16_f32 v59, v62, v63
    s_nop 0
    v_permlane32_swap_b32 v56, v58
    v_permlane32_swap_b32 v57, v59
    s_mov_b32 exec_hi, 0x00010001
    buffer_store_dwordx4 v[56:59], v11, s[40:43], s84 offen sc1
    s_mov_b64 exec, -1
    v_lshrrev_b32 v97, 5, v0
    v_mul_u32_u24 v97, 556544, v97
    s_lshl_b32 s87, s66, 9
    v_add3_u32 v96, v97, v1, s87
    v_mov_b32 v92, -1
    v_mov_b32 v93, -1
    v_mov_b32 v94, -1
    v_mov_b32 v95, -1
    s_add_u32 s84, s74, 1114112
    buffer_store_dwordx4 v[92:95], v96, s[40:43], s84 offen sc1
    ds_read_b64_tr_b16 v[80:81], v4 offset:2048
    ds_read_b64_tr_b16 v[82:83], v4 offset:2304
    ds_read_b64_tr_b16 v[84:85], v4 offset:3072
    ds_read_b64_tr_b16 v[86:87], v4 offset:3328
    ds_read_b64_tr_b16 v[88:89], v4 offset:4096
    ds_read_b64_tr_b16 v[90:91], v4 offset:4352
    s_waitcnt lgkmcnt(8)
    v_mfma_f32_32x32x16_bf16 v[40:55], v[72:75], v[128:131], 0
    ds_read_b64_tr_b16 v[92:93], v4 offset:5120
    ds_read_b64_tr_b16 v[94:95], v4 offset:5376
    v_add_u32 v122, s81, v4
    v_lshrrev_b32 v124, 2, v0
    v_lshrrev_b32 v125, 4, v0
    v_xor_b32 v124, v124, v125
    buffer_load_dwordx4 a[44:47], v1, s[40:43], s95 offen offset:3072 sc1
    s_waitcnt lgkmcnt(8)
    v_mfma_f32_32x32x16_bf16 v[40:55], v[76:79], v[132:135], v[40:55]
    ds_read_b64_tr_b16 v[96:97], v4 offset:6144
    ds_read_b64_tr_b16 v[98:99], v4 offset:6400
    v_and_b32 v124, 1, v124
    v_subrev_u32 v124, 1, v124
    v_and_b32 v124, 0x3f803f80, v124
    ds_read_b64_tr_b16 v[56:57], v122 offset:0
    ds_read_b64_tr_b16 v[58:59], v122 offset:256
    ds_read_b128 a[184:187], v21 offset:0
    s_waitcnt lgkmcnt(11)
    v_mfma_f32_32x32x16_bf16 v[40:55], v[80:83], v[136:139], v[40:55]
    ds_read_b64_tr_b16 v[100:101], v4 offset:7168
    ds_read_b64_tr_b16 v[102:103], v4 offset:7424
    v_mov_b32 v125, v124
    v_mov_b32 v126, v124
    v_mov_b32 v127, v124
    ds_read_b64_tr_b16 v[60:61], v122 offset:1024
    ds_read_b64_tr_b16 v[62:63], v122 offset:1280
    s_add_u32 s95, s9, 4096
    buffer_load_dwordx4 a[48:51], v1, s[40:43], s95 offen offset:0 sc1
    s_waitcnt lgkmcnt(13)
    v_mfma_f32_32x32x16_bf16 v[40:55], v[84:87], v[140:143], v[40:55]
    ds_read_b64_tr_b16 v[72:73], v4 offset:8192
    ds_read_b64_tr_b16 v[74:75], v4 offset:8448
    ds_read_b64_tr_b16 v[64:65], v122 offset:8192
    ds_read_b64_tr_b16 v[66:67], v122 offset:8448
    ds_read_b128 a[188:191], v21 offset:1024
    s_waitcnt lgkmcnt(15)
    v_mfma_f32_32x32x16_bf16 v[40:55], v[88:91], v[144:147], v[40:55]
    ds_read_b64_tr_b16 v[76:77], v4 offset:9216
    ds_read_b64_tr_b16 v[78:79], v4 offset:9472
    s_waitcnt lgkmcnt(12)
    v_mfma_f32_16x16x32_bf16 v[112:115], v[124:127], v[56:59], 0
    ds_read_b64_tr_b16 v[68:69], v122 offset:9216
    ds_read_b64_tr_b16 v[70:71], v122 offset:9472
    buffer_load_dwordx4 a[52:55], v1, s[40:43], s95 offen offset:1024 sc1
    v_mfma_f32_32x32x16_bf16 v[40:55], v[92:95], v[148:151], v[40:55]
    ds_read_b64_tr_b16 v[80:81], v4 offset:10240
    ds_read_b64_tr_b16 v[82:83], v4 offset:10496
    s_waitcnt lgkmcnt(11)
    v_mfma_f32_16x16x32_bf16 v[112:115], v[124:127], v[60:63], v[112:115]
    ds_read_b64_tr_b16 v[56:57], v122 offset:16384
    ds_read_b64_tr_b16 v[58:59], v122 offset:16640
    ds_read_b128 a[192:195], v21 offset:8192
    v_mfma_f32_32x32x16_bf16 v[40:55], v[96:99], v[152:155], v[40:55]
    ds_read_b64_tr_b16 v[84:85], v4 offset:11264
    ds_read_b64_tr_b16 v[86:87], v4 offset:11520
    s_waitcnt lgkmcnt(12)
    v_mfma_f32_16x16x32_bf16 v[112:115], v[124:127], v[64:67], v[112:115]
    ds_read_b64_tr_b16 v[60:61], v122 offset:17408
    ds_read_b64_tr_b16 v[62:63], v122 offset:17664
    buffer_load_dwordx4 a[56:59], v1, s[40:43], s95 offen offset:2048 sc1
    v_mfma_f32_32x32x16_bf16 v[40:55], v[100:103], v[156:159], v[40:55]
    ds_read_b64_tr_b16 v[88:89], v4 offset:12288
    ds_read_b64_tr_b16 v[90:91], v4 offset:12544
    s_waitcnt lgkmcnt(11)
    v_mfma_f32_16x16x32_bf16 v[112:115], v[124:127], v[68:71], v[112:115]
    ds_read_b64_tr_b16 v[64:65], v122 offset:49152
    ds_read_b64_tr_b16 v[66:67], v122 offset:49408
    ds_read_b128 a[196:199], v21 offset:9216
    v_mfma_f32_32x32x16_bf16 v[40:55], v[72:75], v[160:163], v[40:55]
    ds_read_b64_tr_b16 v[92:93], v4 offset:13312
    ds_read_b64_tr_b16 v[94:95], v4 offset:13568
    s_waitcnt lgkmcnt(12)
    v_mfma_f32_16x16x32_bf16 v[112:115], v[124:127], v[56:59], v[112:115]
    ds_read_b64_tr_b16 v[68:69], v122 offset:50176
    ds_read_b64_tr_b16 v[70:71], v122 offset:50432
    buffer_load_dwordx4 a[60:63], v1, s[40:43], s95 offen offset:3072 sc1
    v_mfma_f32_32x32x16_bf16 v[40:55], v[76:79], v[164:167], v[40:55]
    ds_read_b64_tr_b16 v[96:97], v4 offset:14336
    ds_read_b64_tr_b16 v[98:99], v4 offset:14592
    s_waitcnt lgkmcnt(11)
    v_mfma_f32_16x16x32_bf16 v[112:115], v[124:127], v[60:63], v[112:115]
    ds_read_b128 a[200:203], v21 offset:16384
    v_mfma_f32_32x32x16_bf16 v[40:55], v[80:83], v[168:171], v[40:55]
    ds_read_b64_tr_b16 v[100:101], v4 offset:15360
    ds_read_b64_tr_b16 v[102:103], v4 offset:15616
    s_waitcnt lgkmcnt(10)
    v_mfma_f32_16x16x32_bf16 v[112:115], v[124:127], v[64:67], v[112:115]
    s_add_u32 s95, s10, 0
    buffer_load_dwordx4 a[64:67], v1, s[40:43], s95 offen offset:0 sc1
    v_mfma_f32_32x32x16_bf16 v[40:55], v[84:87], v[172:175], v[40:55]
    ds_read_b64_tr_b16 v[72:73], v4 offset:16384
    ds_read_b64_tr_b16 v[74:75], v4 offset:16640
    s_waitcnt lgkmcnt(7)
    v_mfma_f32_16x16x32_bf16 v[112:115], v[124:127], v[68:71], v[112:115]
    ds_read_b128 a[204:207], v21 offset:17408
    v_mfma_f32_32x32x16_bf16 v[40:55], v[88:91], v[176:179], v[40:55]
    ds_read_b64_tr_b16 v[76:77], v4 offset:17408
    ds_read_b64_tr_b16 v[78:79], v4 offset:17664
    buffer_load_dwordx4 a[68:71], v1, s[40:43], s95 offen offset:1024 sc1
    v_mfma_f32_32x32x16_bf16 v[40:55], v[92:95], v[180:183], v[40:55]
    ds_read_b64_tr_b16 v[80:81], v4 offset:18432
    ds_read_b64_tr_b16 v[82:83], v4 offset:18688
    ds_read_b128 a[208:211], v21 offset:24576
    s_waitcnt lgkmcnt(11)
    v_mfma_f32_32x32x16_bf16 v[40:55], v[96:99], v[184:187], v[40:55]
    ds_read_b64_tr_b16 v[84:85], v4 offset:19456
    ds_read_b64_tr_b16 v[86:87], v4 offset:19712
    s_lshl_b32 s84, s66, 8
    v_add_u32 v122, s84, v22
    ds_write_b32 v122, v112 offset:2048
    buffer_load_dwordx4 a[72:75], v1, s[40:43], s95 offen offset:2048 sc1
    s_waitcnt lgkmcnt(11)
    v_mfma_f32_32x32x16_bf16 v[40:55], v[100:103], v[188:191], v[40:55]
    ds_read_b64_tr_b16 v[88:89], v4 offset:20480
    ds_read_b64_tr_b16 v[90:91], v4 offset:20736
    ds_read_b128 a[212:215], v21 offset:25600
    s_waitcnt lgkmcnt(12)
    v_mfma_f32_32x32x16_bf16 v[40:55], v[72:75], v[192:195], v[40:55]
    ds_read_b64_tr_b16 v[92:93], v4 offset:21504
    ds_read_b64_tr_b16 v[94:95], v4 offset:21760
    buffer_load_dwordx4 a[76:79], v1, s[40:43], s95 offen offset:3072 sc1
    s_waitcnt lgkmcnt(11)
    v_mfma_f32_32x32x16_bf16 v[40:55], v[76:79], v[196:199], v[40:55]
    ds_read_b64_tr_b16 v[96:97], v4 offset:22528
    ds_read_b64_tr_b16 v[98:99], v4 offset:22784
    s_waitcnt lgkmcnt(7)
    s_barrier
    ds_read_b128 a[216:219], v21 offset:32768
    v_mfma_f32_32x32x16_bf16 v[40:55], v[80:83], v[200:203], v[40:55]
    ds_read_b64_tr_b16 v[100:101], v4 offset:23552
    ds_read_b64_tr_b16 v[102:103], v4 offset:23808
    ds_read2st64_b32 v[112:113], v22 offset0:8 offset1:9
    ds_read2st64_b32 v[114:115], v22 offset0:10 offset1:11
    s_add_u32 s95, s10, 4096
    buffer_load_dwordx4 a[80:83], v1, s[40:43], s95 offen offset:0 sc1
    v_mfma_f32_32x32x16_bf16 v[40:55], v[84:87], v[204:207], v[40:55]
    ds_read_b64_tr_b16 v[72:73], v4 offset:49152
    ds_read_b64_tr_b16 v[74:75], v4 offset:49408
    ds_read_b128 a[220:223], v21 offset:33792
    s_waitcnt lgkmcnt(13)
    v_mfma_f32_32x32x16_bf16 v[40:55], v[88:91], v[208:211], v[40:55]
    ds_read_b64_tr_b16 v[76:77], v4 offset:50176
    ds_read_b64_tr_b16 v[78:79], v4 offset:50432
    buffer_load_dwordx4 a[84:87], v1, s[40:43], s95 offen offset:1024 sc1
    s_waitcnt lgkmcnt(12)
    v_mfma_f32_32x32x16_bf16 v[40:55], v[92:95], v[212:215], v[40:55]
    ds_read_b64_tr_b16 v[80:81], v4 offset:51200
    ds_read_b64_tr_b16 v[82:83], v4 offset:51456
    s_add_u32 s12, s75, 0
    ds_read_b128 a[224:227], v21 offset:40960
    s_waitcnt lgkmcnt(13)
    v_mfma_f32_32x32x16_bf16 v[40:55], v[96:99], v[216:219], v[40:55]
    ds_read_b64_tr_b16 v[84:85], v4 offset:52224
    ds_read_b64_tr_b16 v[86:87], v4 offset:52480
    s_waitcnt lgkmcnt(10)
    v_add_f32 v112, v112, v113
    v_add_f32 v114, v114, v115
    v_add_f32 v114, v112, v114
    buffer_load_dwordx4 a[88:91], v1, s[40:43], s95 offen offset:2048 sc1
    s_add_u32 s13, s75, 139264
    v_mfma_f32_32x32x16_bf16 v[40:55], v[100:103], v[220:223], v[40:55]
    ds_read_b64_tr_b16 v[88:89], v4 offset:53248
    ds_read_b64_tr_b16 v[90:91], v4 offset:53504
    v_cvt_pk_bf16_f32 v112, v114, v114
    v_and_b32 v115, 0xffff0000, v112
    v_sub_f32 v115, v114, v115
    s_add_u32 s14, s75, 278528
    ds_read_b128 a[228:231], v21 offset:41984
    s_waitcnt lgkmcnt(11)
    v_mfma_f32_32x32x16_bf16 v[40:55], v[72:75], v[224:227], v[40:55]
    ds_read_b64_tr_b16 v[92:93], v4 offset:54272
    ds_read_b64_tr_b16 v[94:95], v4 offset:54528
    v_cvt_pk_bf16_f32 v113, v115, 0
    buffer_load_dwordx4 a[92:95], v1, s[40:43], s95 offen offset:3072 sc1
    s_add_u32 s15, s75, 417792
    s_waitcnt lgkmcnt(10)
    v_mfma_f32_32x32x16_bf16 v[40:55], v[76:79], v[228:231], v[40:55]
    ds_read_b64_tr_b16 v[96:97], v4 offset:55296
    ds_read_b64_tr_b16 v[98:99], v4 offset:55552
    s_mov_b32 s67, 0
    ds_read_b128 a[232:235], v21 offset:49152
    s_waitcnt lgkmcnt(11)
L_pg2:
    s_cbranch_execz L_pgret0
    v_mfma_f32_32x32x16_bf16 v[40:55], v[80:83], v[232:235], v[40:55]
    ds_read_b64_tr_b16 v[100:101], v4 offset:56320
    ds_read_b64_tr_b16 v[102:103], v4 offset:56576
    buffer_load_dwordx4 v[132:135], v13, s[40:43], s12 offen offset:0 sc1
    s_waitcnt lgkmcnt(10)
    v_mfma_f32_32x32x16_bf16 v[40:55], v[84:87], v[236:239], v[40:55]
    v_mfma_f32_32x32x8_bf16 v[40:55], v[112:113], v[116:117], v[40:55]
    buffer_load_dwordx4 v[136:139], v13, s[40:43], s12 offen offset:256 sc1
    ds_read_b128 a[236:239], v21 offset:50176
    s_waitcnt lgkmcnt(9)
    v_mfma_f32_32x32x16_bf16 v[40:55], v[88:91], v[240:243], v[40:55]
    buffer_load_dwordx4 v[140:143], v13, s[40:43], s13 offen offset:0 sc1
    s_waitcnt lgkmcnt(6)
    v_mfma_f32_32x32x16_bf16 v[40:55], v[92:95], v[244:247], v[40:55]
    buffer_load_dwordx4 v[144:147], v13, s[40:43], s13 offen offset:256 sc1
    ds_read_b128 a[240:243], v21 offset:57344
    s_waitcnt lgkmcnt(5)
    v_mfma_f32_32x32x16_bf16 v[40:55], v[96:99], v[248:251], v[40:55]
    v_add_u32 v115, 0x10000, v21
    buffer_load_dwordx4 v[128:131], v14, s[40:43], s12 offen sc1
    s_waitcnt lgkmcnt(2)
    v_mfma_f32_32x32x16_bf16 v[40:55], v[100:103], v[252:255], v[40:55]
    buffer_load_dwordx4 v[148:151], v13, s[40:43], s14 offen offset:0 sc1
    buffer_load_dwordx4 v[152:155], v13, s[40:43], s14 offen offset:256 sc1
    buffer_load_dwordx4 v[156:159], v13, s[40:43], s15 offen offset:0 sc1
    buffer_load_dwordx4 v[160:163], v13, s[40:43], s15 offen offset:256 sc1
    ds_read_b128 a[244:247], v21 offset:58368
    ds_read_b128 v[192:195], v2 offset:36864
    ds_read_b128 v[196:199], v2 offset:37888
    ds_read_b128 a[248:251], v115 offset:49152
    ds_read_b128 a[252:255], v115 offset:50176
    s_nop 2
    s_nop 0
    v_cvt_pk_bf16_f32 v40, v40, v41
    v_cvt_pk_bf16_f32 v41, v42, v43
    v_cvt_pk_bf16_f32 v42, v44, v45
    v_cvt_pk_bf16_f32 v43, v46, v47
    v_cvt_pk_bf16_f32 v44, v48, v49
    v_cvt_pk_bf16_f32 v45, v50, v51
    v_cvt_pk_bf16_f32 v46, v52, v53
    v_cvt_pk_bf16_f32 v47, v54, v55
    v_mfma_f32_32x32x16_bf16 v[72:87], v[104:107], v[40:43], 0
    s_nop 0
    v_mfma_f32_32x32x16_bf16 v[88:103], v[108:111], v[44:47], 0
    s_nop 4
    v_max3_f32 v122, v72, v73, v74
    v_max3_f32 v123, v75, v76, v77
    v_max3_f32 v122, v122, v78, v79
    v_max3_f32 v123, v123, v80, v81
    v_max3_f32 v122, v122, v82, v83
    v_max3_f32 v123, v123, v84, v85
    v_max3_f32 v122, v122, v86, v87
    v_max_f32 v122, v122, v123
    s_add_u32 s95, s11, 0
    buffer_load_dwordx4 a[96:99], v1, s[40:43], s95 offen offset:0 sc1
    v_mul_f32 v119, -v122, v118
    v_pk_fma_f32 v[72:73], v[72:73], v[118:119], v[118:119] op_sel:[0,0,1] op_sel_hi:[1,0,1]
    v_pk_fma_f32 v[74:75], v[74:75], v[118:119], v[118:119] op_sel:[0,0,1] op_sel_hi:[1,0,1]
    v_pk_fma_f32 v[76:77], v[76:77], v[118:119], v[118:119] op_sel:[0,0,1] op_sel_hi:[1,0,1]
    v_pk_fma_f32 v[78:79], v[78:79], v[118:119], v[118:119] op_sel:[0,0,1] op_sel_hi:[1,0,1]
    v_pk_fma_f32 v[80:81], v[80:81], v[118:119], v[118:119] op_sel:[0,0,1] op_sel_hi:[1,0,1]
    v_pk_fma_f32 v[82:83], v[82:83], v[118:119], v[118:119] op_sel:[0,0,1] op_sel_hi:[1,0,1]
    v_pk_fma_f32 v[84:85], v[84:85], v[118:119], v[118:119] op_sel:[0,0,1] op_sel_hi:[1,0,1]
    v_pk_fma_f32 v[86:87], v[86:87], v[118:119], v[118:119] op_sel:[0,0,1] op_sel_hi:[1,0,1]
    v_exp_f32 v72, v72
    v_exp_f32 v73, v73
    v_exp_f32 v74, v74
    v_exp_f32 v75, v75
    buffer_load_dwordx4 a[100:103], v1, s[40:43], s95 offen offset:1024 sc1
    v_exp_f32 v76, v76
    v_exp_f32 v77, v77
    v_exp_f32 v78, v78
    v_exp_f32 v79, v79
    v_exp_f32 v80, v80
    v_exp_f32 v81, v81
    v_exp_f32 v82, v82
    v_exp_f32 v83, v83
    buffer_load_dwordx4 a[104:107], v1, s[40:43], s95 offen offset:2048 sc1
    v_exp_f32 v84, v84
    v_exp_f32 v85, v85
    v_exp_f32 v86, v86
    v_exp_f32 v87, v87
    v_pk_add_f32 v[124:125], v[72:73], v[74:75]
    v_pk_add_f32 v[126:127], v[76:77], v[78:79]
    v_pk_add_f32 v[124:125], v[124:125], v[80:81]
    v_pk_add_f32 v[126:127], v[126:127], v[82:83]
    v_pk_add_f32 v[124:125], v[124:125], v[84:85]
    v_pk_add_f32 v[126:127], v[126:127], v[86:87]
    v_pk_add_f32 v[124:125], v[124:125], v[126:127]
    v_add_f32 v124, v124, v125
    buffer_load_dwordx4 a[108:111], v1, s[40:43], s95 offen offset:3072 sc1
    v_rcp_f32_e64 v124, v124
    s_nop 0
    v_pk_mul_f32 v[72:73], v[72:73], v[124:125] op_sel_hi:[1,0]
    v_pk_mul_f32 v[74:75], v[74:75], v[124:125] op_sel_hi:[1,0]
    v_pk_mul_f32 v[76:77], v[76:77], v[124:125] op_sel_hi:[1,0]
    v_pk_mul_f32 v[78:79], v[78:79], v[124:125] op_sel_hi:[1,0]
    v_pk_mul_f32 v[80:81], v[80:81], v[124:125] op_sel_hi:[1,0]
    v_pk_mul_f32 v[82:83], v[82:83], v[124:125] op_sel_hi:[1,0]
    v_pk_mul_f32 v[84:85], v[84:85], v[124:125] op_sel_hi:[1,0]
    v_pk_mul_f32 v[86:87], v[86:87], v[124:125] op_sel_hi:[1,0]
    v_cvt_pk_bf16_f32 v72, v72, v73
    v_cvt_pk_bf16_f32 v73, v74, v75
    v_cvt_pk_bf16_f32 v74, v76, v77
    v_cvt_pk_bf16_f32 v75, v78, v79
    v_cvt_pk_bf16_f32 v76, v80, v81
    v_cvt_pk_bf16_f32 v77, v82, v83
    s_add_u32 s95, s11, 4096
    buffer_load_dwordx4 a[112:115], v1, s[40:43], s95 offen offset:0 sc1
    v_cvt_pk_bf16_f32 v78, v84, v85
    v_cvt_pk_bf16_f32 v79, v86, v87
    v_max3_f32 v122, v88, v89, v90
    v_max3_f32 v123, v91, v92, v93
    v_max3_f32 v122, v122, v94, v95
    v_max3_f32 v123, v123, v96, v97
    v_max3_f32 v122, v122, v98, v99
    v_max3_f32 v123, v123, v100, v101
    v_max3_f32 v122, v122, v102, v103
    v_max_f32_e64 v122, v122, v123
    v_mul_f32 v119, -v122, v118
    v_pk_fma_f32 v[88:89], v[88:89], v[118:119], v[118:119] op_sel:[0,0,1] op_sel_hi:[1,0,1]
    v_pk_fma_f32 v[90:91], v[90:91], v[118:119], v[118:119] op_sel:[0,0,1] op_sel_hi:[1,0,1]
    v_pk_fma_f32 v[92:93], v[92:93], v[118:119], v[118:119] op_sel:[0,0,1] op_sel_hi:[1,0,1]
    v_pk_fma_f32 v[94:95], v[94:95], v[118:119], v[118:119] op_sel:[0,0,1] op_sel_hi:[1,0,1]
    v_pk_fma_f32 v[96:97], v[96:97], v[118:119], v[118:119] op_sel:[0,0,1] op_sel_hi:[1,0,1]
    buffer_load_dwordx4 a[116:119], v1, s[40:43], s95 offen offset:1024 sc1
    v_pk_fma_f32 v[98:99], v[98:99], v[118:119], v[118:119] op_sel:[0,0,1] op_sel_hi:[1,0,1]
    v_pk_fma_f32 v[100:101], v[100:101], v[118:119], v[118:119] op_sel:[0,0,1] op_sel_hi:[1,0,1]
    v_pk_fma_f32 v[102:103], v[102:103], v[118:119], v[118:119] op_sel:[0,0,1] op_sel_hi:[1,0,1]
    v_exp_f32 v88, v88
    v_exp_f32 v89, v89
    v_exp_f32 v90, v90
    v_exp_f32 v91, v91
    v_exp_f32 v92, v92
    v_exp_f32 v93, v93
    v_exp_f32 v94, v94
    buffer_load_dwordx4 a[120:123], v1, s[40:43], s95 offen offset:2048 sc1
    v_exp_f32 v95, v95
    v_exp_f32 v96, v96
    v_exp_f32 v97, v97
    v_exp_f32 v98, v98
    v_exp_f32 v99, v99
    v_exp_f32 v100, v100
    v_exp_f32 v101, v101
    v_exp_f32 v102, v102
    buffer_load_dwordx4 a[124:127], v1, s[40:43], s95 offen offset:3072 sc1
    v_exp_f32 v103, v103
    v_pk_add_f32 v[124:125], v[88:89], v[90:91]
    v_pk_add_f32 v[126:127], v[92:93], v[94:95]
    v_pk_add_f32 v[124:125], v[124:125], v[96:97]
    v_pk_add_f32 v[126:127], v[126:127], v[98:99]
    v_pk_add_f32 v[124:125], v[124:125], v[100:101]
    v_pk_add_f32 v[126:127], v[126:127], v[102:103]
    v_pk_add_f32 v[124:125], v[124:125], v[126:127]
    v_add_f32 v124, v124, v125
    v_rcp_f32_e64 v124, v124
    s_nop 0
    v_pk_mul_f32 v[88:89], v[88:89], v[124:125] op_sel_hi:[1,0]
    v_pk_mul_f32 v[90:91], v[90:91], v[124:125] op_sel_hi:[1,0]
    v_pk_mul_f32 v[92:93], v[92:93], v[124:125] op_sel_hi:[1,0]
    v_pk_mul_f32 v[94:95], v[94:95], v[124:125] op_sel_hi:[1,0]
    v_lshlrev_b32 v37, 3, v1
    s_mov_b64 exec, 0xff
    buffer_load_dword v39, v37, s[40:43], s76 offen
    s_mov_b64 exec, -1
    v_pk_mul_f32 v[96:97], v[96:97], v[124:125] op_sel_hi:[1,0]
    v_pk_mul_f32 v[98:99], v[98:99], v[124:125] op_sel_hi:[1,0]
    v_pk_mul_f32 v[100:101], v[100:101], v[124:125] op_sel_hi:[1,0]
    v_pk_mul_f32 v[102:103], v[102:103], v[124:125] op_sel_hi:[1,0]
    v_cvt_pk_bf16_f32 v88, v88, v89
    v_cvt_pk_bf16_f32 v89, v90, v91
    v_cvt_pk_bf16_f32 v90, v92, v93
    v_cvt_pk_bf16_f32 v91, v94, v95
    v_cvt_pk_bf16_f32 v92, v96, v97
    v_cvt_pk_bf16_f32 v93, v98, v99
    v_cvt_pk_bf16_f32 v94, v100, v101
    v_cvt_pk_bf16_f32 v95, v102, v103
    s_mov_b64 exec, 0xffff
    buffer_load_dword v206, v12, s[40:43], 0 offen sc1
    s_mov_b64 exec, -1
    s_waitcnt lgkmcnt(2)
L_part0:
    s_waitcnt vmcnt(18)
    v_mfma_f32_16x16x32_bf16 v[56:59], v[192:195], v[132:135], 0
    s_waitcnt vmcnt(17)
    v_mfma_f32_16x16x32_bf16 v[56:59], v[196:199], v[136:139], v[56:59]
    s_waitcnt vmcnt(16)
    v_mfma_f32_16x16x32_bf16 v[56:59], v[192:195], v[140:143], v[56:59]
    s_waitcnt vmcnt(15)
    v_mfma_f32_16x16x32_bf16 v[56:59], v[196:199], v[144:147], v[56:59]
    s_waitcnt vmcnt(14)
    v_mfma_f32_16x16x32_bf16 v[60:63], v[192:195], v[128:131], 0
    s_waitcnt vmcnt(13)
    v_mfma_f32_16x16x32_bf16 v[56:59], v[192:195], v[148:151], v[56:59]
    s_waitcnt vmcnt(12)
    v_mfma_f32_16x16x32_bf16 v[56:59], v[196:199], v[152:155], v[56:59]
    s_waitcnt vmcnt(11)
    v_mfma_f32_16x16x32_bf16 v[56:59], v[192:195], v[156:159], v[56:59]
    v_cvt_pk_bf16_f32 v64, v60, v61
    v_cvt_pk_bf16_f32 v65, v62, v63
    s_waitcnt vmcnt(10)
    v_mfma_f32_16x16x32_bf16 v[56:59], v[196:199], v[160:163], v[56:59]
    s_mov_b64 exec, 0x00ff00ff
    ds_write_b64 v16, v[64:65]
    s_mov_b64 exec, -1
    s_nop 4
    v_cmp_u_f32 vcc, v56, v60
    v_cvt_pk_bf16_f32 v56, v56, v57
    v_cvt_pk_bf16_f32 v57, v58, v59
    ds_write_b64 v15, v[56:57]
    s_cbranch_vccnz L_partre
L_partok0:
    s_waitcnt lgkmcnt(0)
    s_barrier
    ds_read_b128 v[128:131], v17 offset:0
    ds_read_b128 v[132:135], v17 offset:16
    ds_read_b128 v[136:139], v17 offset:1600
    ds_read_b128 v[140:143], v17 offset:1616
    s_waitcnt lgkmcnt(3)
    v_mfma_f32_32x32x16_bf16 v[40:55], v[128:131], v[72:75], 0
    v_mov_b32 v106, 1
    s_waitcnt lgkmcnt(2)
    v_mfma_f32_32x32x16_bf16 v[40:55], v[132:135], v[76:79], v[40:55]
    s_waitcnt lgkmcnt(0)
    v_mfma_f32_32x32x16_bf16 v[56:71], v[136:139], v[88:91], 0
    v_mfma_f32_32x32x16_bf16 v[56:71], v[140:143], v[92:95], v[56:71]
    v_add_f32 v48, v48, v50
    v_add_f32 v49, v49, v51
    v_add_f32 v48, 0x358637bd, v48
    v_add_f32 v48, v48, v49
    v_rcp_f32 v48, v48
    s_nop 0
    v_pk_mul_f32 v[40:41], v[40:41], v[48:49] op_sel_hi:[1,0]
    v_pk_mul_f32 v[42:43], v[42:43], v[48:49] op_sel_hi:[1,0]
    v_pk_mul_f32 v[44:45], v[44:45], v[48:49] op_sel_hi:[1,0]
    v_pk_mul_f32 v[46:47], v[46:47], v[48:49] op_sel_hi:[1,0]
    v_bfi_b32 v40, s60, v40, v4
    v_cvt_pk_bf16_f32 v40, v40, v41
    v_cvt_pk_bf16_f32 v41, v42, v43
    v_cvt_pk_bf16_f32 v42, v44, v45
    v_cvt_pk_bf16_f32 v43, v46, v47
    buffer_store_dwordx4 v[40:43], v1, s[44:47], s71 offen offset:0
    v_add_f32 v64, v64, v66
    v_add_f32 v65, v65, v67
    v_add_f32 v64, 0x358637bd, v64
    v_add_f32 v64, v64, v65
    v_rcp_f32_e64 v64, v64
    s_nop 0
    v_pk_mul_f32 v[56:57], v[56:57], v[64:65] op_sel_hi:[1,0]
    v_pk_mul_f32 v[58:59], v[58:59], v[64:65] op_sel_hi:[1,0]
    v_pk_mul_f32 v[60:61], v[60:61], v[64:65] op_sel_hi:[1,0]
    v_pk_mul_f32 v[62:63], v[62:63], v[64:65] op_sel_hi:[1,0]
    v_bfi_b32 v56, s60, v56, v4
    v_cvt_pk_bf16_f32 v56, v56, v57
    v_cvt_pk_bf16_f32 v57, v58, v59
    v_cvt_pk_bf16_f32 v58, v60, v61
    v_cvt_pk_bf16_f32 v59, v62, v63
    buffer_store_dwordx4 v[56:59], v1, s[44:47], s71 offen offset:1024
    s_mov_b64 exec, 0
    s_cmp_eq_u32 s66, 0
    s_cbranch_scc1 L_pg5
    s_cmp_eq_u32 s66, 1
    s_cbranch_scc1 L_pg6
    s_cmp_eq_u32 s66, 2
    s_cbranch_scc1 L_pg7
    s_branch L_pg8
L_pgret1:
    s_mov_b64 exec, -1
    s_mov_b64 exec, 1
    s_waitcnt vmcnt(0)
    buffer_store_dword v106, off, s[40:43], s78 offset:0
    s_mov_b64 exec, -1
    v_add_u32 v104, 0x18000, v21
    s_and_b32 s84, s8, 0x6000
    v_add_u32 v116, s84, v2
    s_and_b32 s84, s9, 0x6000
    v_add_u32 v117, s84, v2
    s_and_b32 s84, s10, 0x6000
    v_add_u32 v118, s84, v2
    s_and_b32 s84, s11, 0x6000
    v_add_u32 v119, s84, v2
    v_and_or_b32 v141, v20, 60, s61
    s_lshl_b32 s84, s0, 10
    s_lshl_b32 s85, s66, 13
    s_add_u32 s85, s85, s84
    s_add_u32 s1, s85, 4096
    s_add_u32 s82, s85, 8192
    s_cmp_eq_u32 s66, 0
    s_cselect_b32 s1, 47104, s1
    s_cmp_eq_u32 s66, 3
    s_cselect_b32 s82, 46080, s82
    s_and_b32 s84, s65, 3
    s_lshl_b32 s84, s84, 11
    s_add_u32 s72, s72, s84
L_ore0:
    s_lshl2_add_u32 m0, s81, 114688
    buffer_load_dword v127, v18, s[40:43], 0 offen sc1
    s_cmp_eq_u32 s66, s0
    s_cbranch_scc0 Lpchk_11
    ds_write_b128 v116, v[40:43] offset:0
    ds_write_b128 v116, v[56:59] offset:1024
    s_branch L_oown0
L_opoll0:
    buffer_load_dword v127, v18, s[40:43], 0 offen sc1
    s_sub_u32 s68, s68, 1
    s_cbranch_scc1 L_end
L_oown0:
    s_waitcnt vmcnt(0)
    v_cmp_gt_u32 vcc, 1, v127
    s_cbranch_vccnz L_opoll0
    s_branch L_ojoin0
Lpoll_10:
    buffer_load_dword v127, v18, s[40:43], 0 offen sc1
    s_sub_u32 s68, s68, 1
    s_cbranch_scc1 L_end
Lpchk_11:
    s_waitcnt vmcnt(0)
    v_cmp_gt_u32 vcc, 1, v127
    s_cbranch_vccnz Lpoll_10
    buffer_load_dwordx4 v1, s[44:47], s72 offen offset:0 sc1 lds
    buffer_load_dwordx4 v1, s[44:47], s72 offen offset:1024 sc1 lds
L_ojoin0:
    s_lshl2_add_u32 m0, s81, 116736
    s_xor_b32 s84, s72, 2048
    ds_read_b128 v[128:131], v104
    ds_read_b128 v[132:135], v104 offset:1024
    buffer_load_dwordx4 v1, s[44:47], s84 offen offset:0 sc1 lds
    buffer_load_dwordx4 v1, s[44:47], s84 offen offset:1024 sc1 lds
    s_lshl2_add_u32 m0, s81, 118784
    s_xor_b32 s84, s72, 4096
    buffer_load_dwordx4 v1, s[44:47], s84 offen offset:0 sc1 lds
    buffer_load_dwordx4 v1, s[44:47], s84 offen offset:1024 sc1 lds
    s_lshl2_add_u32 m0, s81, 120832
    s_xor_b32 s84, s72, 6144
    buffer_load_dwordx4 v1, s[44:47], s84 offen offset:0 sc1 lds
    s_waitcnt lgkmcnt(0)
    v_lshlrev_b32 v24, 16, v128
    v_and_b32 v25, 0xffff0000, v128
    v_lshlrev_b32 v26, 16, v129
    v_and_b32 v27, 0xffff0000, v129
    v_lshlrev_b32 v28, 16, v130
    v_and_b32 v29, 0xffff0000, v130
    v_lshlrev_b32 v30, 16, v131
    v_and_b32 v31, 0xffff0000, v131
    v_lshlrev_b32 v32, 16, v132
    v_and_b32 v33, 0xffff0000, v132
    v_lshlrev_b32 v34, 16, v133
    v_and_b32 v35, 0xffff0000, v133
    v_lshlrev_b32 v36, 16, v134
    v_and_b32 v37, 0xffff0000, v134
    v_lshlrev_b32 v38, 16, v135
    v_and_b32 v39, 0xffff0000, v135
    s_barrier
    buffer_load_dwordx4 v1, s[44:47], s84 offen offset:1024 sc1 lds
L_oskip0:
    s_waitcnt vmcnt(7)
    ds_read_b128 v[72:75], v116 offset:0
    s_waitcnt vmcnt(6)
    ds_read_b128 v[76:79], v116 offset:1024
    s_waitcnt vmcnt(5)
    ds_read_b128 v[80:83], v116 offset:2048
    s_waitcnt lgkmcnt(2)
    v_mfma_f32_32x32x16_bf16 v[24:39], a[0:3], v[72:75], v[24:39]
    s_waitcnt vmcnt(4)
    ds_read_b128 v[84:87], v116 offset:3072
    s_waitcnt lgkmcnt(2)
    v_mfma_f32_32x32x16_bf16 v[24:39], a[4:7], v[76:79], v[24:39]
    s_waitcnt vmcnt(3)
    ds_read_b128 v[88:91], v116 offset:4096
    s_waitcnt lgkmcnt(2)
    v_mfma_f32_32x32x16_bf16 v[24:39], a[8:11], v[80:83], v[24:39]
    s_waitcnt vmcnt(2)
    ds_read_b128 v[92:95], v116 offset:5120
    s_waitcnt lgkmcnt(2)
    v_mfma_f32_32x32x16_bf16 v[24:39], a[12:15], v[84:87], v[24:39]
    s_waitcnt vmcnt(1)
    ds_read_b128 v[96:99], v116 offset:6144
    s_waitcnt lgkmcnt(2)
    v_mfma_f32_32x32x16_bf16 v[24:39], a[16:19], v[88:91], v[24:39]
    s_waitcnt vmcnt(0)
    ds_read_b128 v[100:103], v116 offset:7168
    s_add_u32 m0, s81, 0
    s_barrier
    buffer_load_dwordx4 v5, s[40:43], m0 offen offset:0 sc1 lds
    s_waitcnt lgkmcnt(2)
    v_mfma_f32_32x32x16_bf16 v[24:39], a[20:23], v[92:95], v[24:39]
    ds_read_b128 v[72:75], v117 offset:0
    ds_read_b128 v[76:79], v117 offset:1024
    s_mov_b64 exec, 1
    buffer_store_dword v106, off, s[40:43], s16 offset:64
    s_mov_b64 exec, -1
    s_waitcnt lgkmcnt(3)
    v_mfma_f32_32x32x16_bf16 v[24:39], a[24:27], v[96:99], v[24:39]
    ds_read_b128 v[80:83], v117 offset:2048
    ds_read_b128 v[84:87], v117 offset:3072
    buffer_load_dwordx4 v5, s[40:43], m0 offen offset:1024 sc1 lds
    s_waitcnt lgkmcnt(4)
    v_mfma_f32_32x32x16_bf16 v[24:39], a[28:31], v[100:103], v[24:39]
    ds_read_b128 v[88:91], v117 offset:4096
    ds_read_b128 v[92:95], v117 offset:5120
    s_waitcnt lgkmcnt(5)
    v_mfma_f32_32x32x16_bf16 v[24:39], a[32:35], v[72:75], v[24:39]
    ds_read_b128 v[96:99], v117 offset:6144
    s_add_u32 m0, s81, 32768
    ds_read_b128 v[100:103], v117 offset:7168
    buffer_load_dwordx4 v5, s[40:43], m0 offen offset:0 sc1 lds
    s_waitcnt lgkmcnt(6)
    v_mfma_f32_32x32x16_bf16 v[24:39], a[36:39], v[76:79], v[24:39]
    ds_read_b128 v[72:75], v118 offset:0
    s_waitcnt lgkmcnt(6)
    v_mfma_f32_32x32x16_bf16 v[24:39], a[40:43], v[80:83], v[24:39]
    ds_read_b128 v[76:79], v118 offset:1024
    buffer_load_dwordx4 v5, s[40:43], m0 offen offset:1024 sc1 lds
    s_waitcnt lgkmcnt(6)
    v_mfma_f32_32x32x16_bf16 v[24:39], a[44:47], v[84:87], v[24:39]
    ds_read_b128 v[80:83], v118 offset:2048
    s_waitcnt lgkmcnt(6)
    v_mfma_f32_32x32x16_bf16 v[24:39], a[48:51], v[88:91], v[24:39]
    s_add_u32 m0, s81, 8192
    ds_read_b128 v[84:87], v118 offset:3072
    buffer_load_dwordx4 v5, s[40:43], m0 offen offset:0 sc1 lds
    s_waitcnt lgkmcnt(6)
    v_mfma_f32_32x32x16_bf16 v[24:39], a[52:55], v[92:95], v[24:39]
    ds_read_b128 v[88:91], v118 offset:4096
    s_waitcnt lgkmcnt(6)
    v_mfma_f32_32x32x16_bf16 v[24:39], a[56:59], v[96:99], v[24:39]
    ds_read_b128 v[92:95], v118 offset:5120
    buffer_load_dwordx4 v5, s[40:43], m0 offen offset:1024 sc1 lds
    s_waitcnt lgkmcnt(6)
    v_mfma_f32_32x32x16_bf16 v[24:39], a[60:63], v[100:103], v[24:39]
    ds_read_b128 v[96:99], v118 offset:6144
    buffer_load_dword v140, v141, s[40:43], 0 offen offset:64 sc1
    buffer_load_dword v144, v20, s[40:43], s63 offen offset:0 sc1
    buffer_load_dword v145, v20, s[40:43], s63 offen offset:256 sc1
    s_waitcnt lgkmcnt(6)
    v_mfma_f32_32x32x16_bf16 v[24:39], a[64:67], v[72:75], v[24:39]
    s_add_u32 m0, s81, 40960
    ds_read_b128 v[100:103], v118 offset:7168
    buffer_load_dwordx4 v5, s[40:43], m0 offen offset:0 sc1 lds
    s_waitcnt lgkmcnt(6)
    v_mfma_f32_32x32x16_bf16 v[24:39], a[68:71], v[76:79], v[24:39]
    ds_read_b128 v[72:75], v119 offset:0
    buffer_load_dword v146, v20, s[40:43], s63 offen offset:512 sc1
    buffer_load_dword v147, v20, s[40:43], s63 offen offset:768 sc1
    s_waitcnt lgkmcnt(6)
    v_mfma_f32_32x32x16_bf16 v[24:39], a[72:75], v[80:83], v[24:39]
    ds_read_b128 v[76:79], v119 offset:1024
    buffer_load_dwordx4 v5, s[40:43], m0 offen offset:1024 sc1 lds
    s_waitcnt lgkmcnt(6)
    v_mfma_f32_32x32x16_bf16 v[24:39], a[76:79], v[84:87], v[24:39]
    ds_read_b128 v[80:83], v119 offset:2048
    buffer_load_dword v148, v20, s[40:43], s63 offen offset:1024 sc1
    buffer_load_dword v149, v20, s[40:43], s63 offen offset:1280 sc1
    s_waitcnt lgkmcnt(6)
    v_mfma_f32_32x32x16_bf16 v[24:39], a[80:83], v[88:91], v[24:39]
    s_add_u32 m0, s81, 16384
    ds_read_b128 v[84:87], v119 offset:3072
    buffer_load_dwordx4 v5, s[40:43], m0 offen offset:0 sc1 lds
    s_waitcnt lgkmcnt(6)
    v_mfma_f32_32x32x16_bf16 v[24:39], a[84:87], v[92:95], v[24:39]
    ds_read_b128 v[88:91], v119 offset:4096
    s_waitcnt lgkmcnt(6)
    v_mfma_f32_32x32x16_bf16 v[24:39], a[88:91], v[96:99], v[24:39]
    ds_read_b128 v[92:95], v119 offset:5120
    buffer_load_dwordx4 v5, s[40:43], m0 offen offset:1024 sc1 lds
    s_waitcnt lgkmcnt(6)
    v_mfma_f32_32x32x16_bf16 v[24:39], a[92:95], v[100:103], v[24:39]
    ds_read_b128 v[96:99], v119 offset:6144
    s_waitcnt lgkmcnt(6)
    v_mfma_f32_32x32x16_bf16 v[24:39], a[96:99], v[72:75], v[24:39]
    s_add_u32 m0, s81, 49152
    ds_read_b128 v[100:103], v119 offset:7168
    buffer_load_dwordx4 v5, s[40:43], m0 offen offset:0 sc1 lds
    s_waitcnt lgkmcnt(6)
    v_mfma_f32_32x32x16_bf16 v[24:39], a[100:103], v[76:79], v[24:39]
    s_waitcnt lgkmcnt(5)
    v_mfma_f32_32x32x16_bf16 v[24:39], a[104:107], v[80:83], v[24:39]
    buffer_load_dwordx4 v5, s[40:43], m0 offen offset:1024 sc1 lds
    s_waitcnt lgkmcnt(4)
    v_mfma_f32_32x32x16_bf16 v[24:39], a[108:111], v[84:87], v[24:39]
    s_waitcnt lgkmcnt(3)
    v_mfma_f32_32x32x16_bf16 v[24:39], a[112:115], v[88:91], v[24:39]
    s_waitcnt lgkmcnt(2)
    v_mfma_f32_32x32x16_bf16 v[24:39], a[116:119], v[92:95], v[24:39]
    s_waitcnt vmcnt(12)
    v_cmp_gt_u32 vcc, 1, v140
    s_waitcnt lgkmcnt(1)
    v_mfma_f32_32x32x16_bf16 v[24:39], a[120:123], v[96:99], v[24:39]
    s_cbranch_vccnz Lrefb_13
Lfc_12:
    s_waitcnt lgkmcnt(0)
    v_mfma_f32_32x32x16_bf16 v[24:39], a[124:127], v[100:103], v[24:39]
    v_mov_b32_e64 v62, 1
    s_nop 10
    v_cvt_pk_bf16_f32 v43, v30, v31
    v_cvt_pk_bf16_f32 v42, v28, v29
    v_cvt_pk_bf16_f32 v41, v26, v27
    v_cvt_pk_bf16_f32 v40, v24, v25
    v_and_b32_e64 v40, -2, v40
    buffer_store_dwordx4 v[40:43], v1, s[44:47], s73 offen offset:0
    v_cvt_pk_bf16_f32 v47, v38, v39
    v_cvt_pk_bf16_f32 v46, v36, v37
    v_cvt_pk_bf16_f32 v45, v34, v35
    v_cvt_pk_bf16_f32 v44, v32, v33
    v_and_b32 v44, -2, v44
    buffer_store_dwordx4 v[44:47], v1, s[44:47], s73 offen offset:1024
    s_mov_b64 exec, 1
    buffer_store_dword v62, off, s[40:43], s79 offset:0
    s_mov_b64 exec, -1
    s_nop 0
    v_pk_add_f32 v[56:57], v[24:25], v[26:27]
    v_pk_mul_f32 v[58:59], v[24:25], v[24:25]
    v_pk_fma_f32 v[58:59], v[26:27], v[26:27], v[58:59]
    v_pk_add_f32 v[56:57], v[56:57], v[28:29]
    v_pk_fma_f32 v[58:59], v[28:29], v[28:29], v[58:59]
    v_pk_add_f32 v[56:57], v[56:57], v[30:31]
    v_pk_fma_f32 v[58:59], v[30:31], v[30:31], v[58:59]
    v_pk_add_f32 v[56:57], v[56:57], v[32:33]
    v_pk_fma_f32 v[58:59], v[32:33], v[32:33], v[58:59]
    v_pk_add_f32 v[56:57], v[56:57], v[34:35]
    v_pk_fma_f32 v[58:59], v[34:35], v[34:35], v[58:59]
    v_pk_add_f32 v[56:57], v[56:57], v[36:37]
    v_pk_fma_f32 v[58:59], v[36:37], v[36:37], v[58:59]
    v_pk_add_f32 v[56:57], v[56:57], v[38:39]
    v_pk_fma_f32 v[58:59], v[38:39], v[38:39], v[58:59]
    v_add_f32 v56, v56, v57
    v_add_f32 v58, v58, v59
    s_lshl_b32 s84, s66, 8
    v_add_u32 v60, s84, v22
    v_permlane32_swap_b32 v56, v58
    v_add_f32 v56, v56, v58
    s_add_u32 m0, s81, 24576
    ds_write_b32 v60, v56 offset:6144
    buffer_load_dwordx4 v5, s[40:43], m0 offen offset:0 sc1 lds
    buffer_load_dwordx4 v5, s[40:43], m0 offen offset:1024 sc1 lds
    s_add_u32 m0, s81, 57344
    s_nop 0
    buffer_load_dwordx4 v5, s[40:43], m0 offen offset:0 sc1 lds
    s_waitcnt lgkmcnt(0)
    s_barrier
    s_cmp_lg_u32 s66, 0
    s_cbranch_scc1 Lst_14
    ds_read2st64_b32 v[56:57], v22 offset0:24 offset1:25
    ds_read2st64_b32 v[58:59], v22 offset0:26 offset1:27
    s_waitcnt lgkmcnt(0)
    v_add_f32 v56, v56, v57
    v_add_f32 v58, v58, v59
    v_add_f32 v56, v56, v58
    buffer_store_dword v56, v20, s[40:43], s76 offen offset:256
Lst_14:
    s_add_u32 m0, s81, 57344
    s_nop 0
    buffer_load_dwordx4 v5, s[40:43], m0 offen offset:1024 sc1 lds
    buffer_load_dword v127, v19, s[40:43], 0 offen sc1
    v_add_u32 v64, s1, v2
    v_add_u32 v65, s82, v2
    ds_write_b128 v64, v[40:43]
    ds_write_b128 v65, v[44:47]
    s_lshl_b32 s84, s66, 10
    v_add_u32 v66, s84, v2
    s_waitcnt vmcnt(12)
    v_add_f32 v104, v144, v145
    v_add_f32 v108, v146, v147
    v_add_f32 v112, v148, v149
    s_lshl_b32 s84, s66, 8
    v_add_u32 v120, s84, v22
    ds_write_b32 v120, v104 offset:3072
    ds_write_b32 v120, v108 offset:4096
    ds_write_b32 v120, v112 offset:5120
    s_cmp_eq_u32 s66, s0
    s_waitcnt lgkmcnt(3)
    s_barrier
    s_cbranch_scc0 Lpchk_16
    ds_read_b128 v[128:131], v2 offset:47104
    ds_read_b128 v[132:135], v66 offset:8192
    ds_read_b128 v[136:139], v66 offset:12288
    ds_read_b128 v[140:143], v66 offset:16384
    ds_read_b128 v[144:147], v66 offset:20480
    ds_read_b128 v[148:151], v66 offset:24576
    ds_read_b128 v[152:155], v66 offset:28672
    ds_read_b128 v[156:159], v2 offset:46080
    s_branch L_xown1
L_xpoll1:
    buffer_load_dword v127, v19, s[40:43], 0 offen sc1
    s_sub_u32 s68, s68, 1
    s_cbranch_scc1 L_end
L_xown1:
    s_waitcnt vmcnt(0)
    v_cmp_gt_u32 vcc, 1, v127
    s_cbranch_vccnz L_xpoll1
    s_xor_b32 s96, s70, 8192
    buffer_load_dwordx4 v[160:163], v1, s[44:47], s96 offen offset:0 sc1
    s_waitcnt lgkmcnt(0)
    s_barrier
    s_branch L_xjoin1
Lpoll_15:
    buffer_load_dword v127, v19, s[40:43], 0 offen sc1
    s_sub_u32 s68, s68, 1
    s_cbranch_scc1 L_end
Lpchk_16:
    s_waitcnt vmcnt(0)
    v_cmp_gt_u32 vcc, 1, v127
    s_cbranch_vccnz Lpoll_15
    s_xor_b32 s96, s70, 0
    s_nop 0
    buffer_load_dwordx4 v[128:131], v1, s[44:47], s96 offen offset:0 sc1
    buffer_load_dwordx4 v[132:135], v1, s[44:47], s96 offen offset:1024 sc1
    buffer_load_dwordx4 v[136:139], v1, s[44:47], s96 offen offset:2048 sc1
    buffer_load_dwordx4 v[140:143], v1, s[44:47], s96 offen offset:3072 sc1
    s_xor_b32 s96, s70, 4096
    buffer_load_dwordx4 v[144:147], v1, s[44:47], s96 offen offset:0 sc1
    s_waitcnt lgkmcnt(0)
    s_barrier
L_xre1:
    buffer_load_dwordx4 v[148:151], v1, s[44:47], s96 offen offset:1024 sc1
    buffer_load_dwordx4 v[152:155], v1, s[44:47], s96 offen offset:2048 sc1
    buffer_load_dwordx4 v[156:159], v1, s[44:47], s96 offen offset:3072 sc1
    s_xor_b32 s96, s70, 8192
    buffer_load_dwordx4 v[160:163], v1, s[44:47], s96 offen offset:0 sc1
L_xjoin1:
    ds_read_b128 v[72:75], v1 offset:0
    ds_read_b128 v[76:79], v1 offset:32768
    ds_read_b128 v[80:83], v1 offset:1024
    ds_read_b128 v[84:87], v1 offset:33792
    ds_read_b128 v[88:91], v1 offset:2048
    ds_read_b128 v[92:95], v1 offset:34816
    s_waitcnt vmcnt(8) lgkmcnt(5)
    v_mfma_f32_32x32x16_bf16 v[40:55], v[72:75], v[128:131], 0
    ds_read_b128 v[96:99], v1 offset:3072
    buffer_load_dwordx4 v[164:167], v1, s[44:47], s96 offen offset:1024 sc1
    s_waitcnt lgkmcnt(5)
    v_mfma_f32_32x32x16_bf16 v[56:71], v[76:79], v[128:131], 0
    ds_read_b128 v[100:103], v1 offset:35840
    s_waitcnt vmcnt(8) lgkmcnt(5)
    v_mfma_f32_32x32x16_bf16 v[40:55], v[80:83], v[132:135], v[40:55]
    ds_read_b128 v[72:75], v1 offset:4096
    buffer_load_dwordx4 v[168:171], v1, s[44:47], s96 offen offset:2048 sc1
    s_waitcnt lgkmcnt(5)
    v_mfma_f32_32x32x16_bf16 v[56:71], v[84:87], v[132:135], v[56:71]
    ds_read_b128 v[76:79], v1 offset:36864
    v_or3_b32 v12, 0, v128, v132
    v_and_b32 v122, 32, v0
    s_waitcnt vmcnt(8) lgkmcnt(5)
    v_mfma_f32_32x32x16_bf16 v[40:55], v[88:91], v[136:139], v[40:55]
    ds_read_b128 v[80:83], v1 offset:5120
    buffer_load_dwordx4 v[172:175], v1, s[44:47], s96 offen offset:3072 sc1
L_pg3:
    s_cbranch_execz L_pgret0
    s_waitcnt lgkmcnt(5)
    v_mfma_f32_32x32x16_bf16 v[56:71], v[92:95], v[136:139], v[56:71]
    ds_read_b128 v[84:87], v1 offset:37888
    ds_read2st64_b32 v[104:105], v22 offset0:12 offset1:13
    ds_read2st64_b32 v[106:107], v22 offset0:14 offset1:15
    v_lshl_add_u32 v126, v122, 7, v6
    v_lshl_add_u32 v127, v122, 7, v7
    s_waitcnt vmcnt(8) lgkmcnt(7)
    v_mfma_f32_32x32x16_bf16 v[40:55], v[96:99], v[140:143], v[40:55]
    ds_read_b128 v[88:91], v1 offset:6144
    s_xor_b32 s96, s70, 12288
    buffer_load_dwordx4 v[176:179], v1, s[44:47], s96 offen offset:0 sc1
    s_waitcnt lgkmcnt(7)
    v_mfma_f32_32x32x16_bf16 v[56:71], v[100:103], v[140:143], v[56:71]
    ds_read_b128 v[92:95], v1 offset:38912
    ds_read2st64_b32 v[108:109], v22 offset0:16 offset1:17
    ds_read2st64_b32 v[110:111], v22 offset0:18 offset1:19
    v_or3_b32 v12, v12, v136, v140
    s_waitcnt vmcnt(8) lgkmcnt(9)
    v_mfma_f32_32x32x16_bf16 v[40:55], v[72:75], v[144:147], v[40:55]
    ds_read_b128 v[96:99], v1 offset:7168
    buffer_load_dwordx4 v[180:183], v1, s[44:47], s96 offen offset:1024 sc1
    s_waitcnt lgkmcnt(9)
    v_mfma_f32_32x32x16_bf16 v[56:71], v[76:79], v[144:147], v[56:71]
    ds_read_b128 v[100:103], v1 offset:39936
    s_waitcnt vmcnt(8) lgkmcnt(9)
    v_mfma_f32_32x32x16_bf16 v[40:55], v[80:83], v[148:151], v[40:55]
    ds_read_b128 v[72:75], v1 offset:8192
    buffer_load_dwordx4 v[184:187], v1, s[44:47], s96 offen offset:2048 sc1
    s_waitcnt lgkmcnt(9)
    v_mfma_f32_32x32x16_bf16 v[56:71], v[84:87], v[148:151], v[56:71]
    ds_read_b128 v[76:79], v1 offset:40960
    v_or3_b32 v12, v12, v144, v148
    s_waitcnt vmcnt(8) lgkmcnt(7)
    v_mfma_f32_32x32x16_bf16 v[40:55], v[88:91], v[152:155], v[40:55]
    ds_read_b128 v[80:83], v1 offset:9216
    buffer_load_dwordx4 v[188:191], v1, s[44:47], s96 offen offset:3072 sc1
    buffer_load_dword v112, v20, s[40:43], s77 offen offset:256 sc1
    buffer_load_dword v113, v20, s[40:43], s77 offen offset:1280 sc1
    buffer_load_dword v114, v20, s[40:43], s77 offen offset:2304 sc1
    buffer_load_dword v115, v20, s[40:43], s77 offen offset:3328 sc1
    s_waitcnt lgkmcnt(7)
    v_mfma_f32_32x32x16_bf16 v[56:71], v[92:95], v[152:155], v[56:71]
    ds_read_b128 v[84:87], v1 offset:41984
    s_waitcnt lgkmcnt(6)
    v_add_f32 v104, v104, v105
    v_add_f32 v106, v106, v107
    s_waitcnt vmcnt(12) lgkmcnt(5)
    v_mfma_f32_32x32x16_bf16 v[40:55], v[96:99], v[156:159], v[40:55]
    ds_read_b128 v[88:91], v1 offset:10240
    s_xor_b32 s96, s70, 16384
    buffer_load_dwordx4 v[192:195], v1, s[44:47], s96 offen offset:0 sc1
    v_add_f32 v106, v104, v106
    s_waitcnt lgkmcnt(5)
    v_mfma_f32_32x32x16_bf16 v[56:71], v[100:103], v[156:159], v[56:71]
    ds_read_b128 v[92:95], v1 offset:43008
    v_cvt_pk_bf16_f32 v104, v106, v106
    v_and_b32 v107, 0xffff0000, v104
    v_or3_b32 v12, v12, v152, v156
    s_waitcnt vmcnt(12) lgkmcnt(5)
    v_mfma_f32_32x32x16_bf16 v[40:55], v[72:75], v[160:163], v[40:55]
    ds_read_b128 v[96:99], v1 offset:11264
    buffer_load_dwordx4 v[196:199], v1, s[44:47], s96 offen offset:1024 sc1
    v_sub_f32 v107, v106, v107
    s_waitcnt lgkmcnt(5)
    v_mfma_f32_32x32x16_bf16 v[56:71], v[76:79], v[160:163], v[56:71]
    ds_read_b128 v[100:103], v1 offset:44032
    v_cvt_pk_bf16_f32 v105, v107, 0
    v_add_f32 v108, v108, v109
    s_waitcnt vmcnt(12) lgkmcnt(5)
    v_mfma_f32_32x32x16_bf16 v[40:55], v[80:83], v[164:167], v[40:55]
    ds_read_b128 v[72:75], v1 offset:12288
    buffer_load_dwordx4 v[200:203], v1, s[44:47], s96 offen offset:2048 sc1
    v_add_f32 v110, v110, v111
    s_waitcnt lgkmcnt(5)
    v_mfma_f32_32x32x16_bf16 v[56:71], v[84:87], v[164:167], v[56:71]
    ds_read_b128 v[76:79], v1 offset:45056
    v_add_f32 v110, v108, v110
    v_cvt_pk_bf16_f32 v108, v110, v110
    v_or3_b32 v12, v12, v160, v164
    s_waitcnt vmcnt(12) lgkmcnt(5)
    v_mfma_f32_32x32x16_bf16 v[40:55], v[88:91], v[168:171], v[40:55]
    ds_read_b128 v[80:83], v1 offset:13312
    buffer_load_dwordx4 v[204:207], v1, s[44:47], s96 offen offset:3072 sc1
    v_and_b32 v111, 0xffff0000, v108
    s_waitcnt lgkmcnt(5)
    v_mfma_f32_32x32x16_bf16 v[56:71], v[92:95], v[168:171], v[56:71]
    ds_read_b128 v[84:87], v1 offset:46080
    v_sub_f32 v111, v110, v111
    v_cvt_pk_bf16_f32 v109, v111, 0
    s_waitcnt vmcnt(12) lgkmcnt(5)
    v_mfma_f32_32x32x16_bf16 v[40:55], v[96:99], v[172:175], v[40:55]
    ds_read_b128 v[88:91], v1 offset:14336
    s_xor_b32 s96, s70, 20480
    buffer_load_dwordx4 v[208:211], v1, s[44:47], s96 offen offset:0 sc1
    s_waitcnt lgkmcnt(5)
    v_mfma_f32_32x32x16_bf16 v[56:71], v[100:103], v[172:175], v[56:71]
    ds_read_b128 v[92:95], v1 offset:47104
    v_or3_b32 v12, v12, v168, v172
    s_waitcnt vmcnt(12) lgkmcnt(5)
    v_mfma_f32_32x32x16_bf16 v[40:55], v[72:75], v[176:179], v[40:55]
    ds_read_b128 v[96:99], v1 offset:15360
    buffer_load_dwordx4 v[212:215], v1, s[44:47], s96 offen offset:1024 sc1
    s_waitcnt lgkmcnt(5)
    v_mfma_f32_32x32x16_bf16 v[56:71], v[76:79], v[176:179], v[56:71]
    ds_read_b128 v[100:103], v1 offset:48128
    s_waitcnt vmcnt(12) lgkmcnt(5)
    v_mfma_f32_32x32x16_bf16 v[40:55], v[80:83], v[180:183], v[40:55]
    ds_read_b128 v[72:75], v1 offset:16384
    buffer_load_dwordx4 v[216:219], v1, s[44:47], s96 offen offset:2048 sc1
    s_waitcnt lgkmcnt(5)
    v_mfma_f32_32x32x16_bf16 v[56:71], v[84:87], v[180:183], v[56:71]
    ds_read_b128 v[76:79], v1 offset:49152
    v_or3_b32 v12, v12, v176, v180
    s_waitcnt vmcnt(12) lgkmcnt(5)
    v_mfma_f32_32x32x16_bf16 v[40:55], v[88:91], v[184:187], v[40:55]
    ds_read_b128 v[80:83], v1 offset:17408
    buffer_load_dwordx4 v[220:223], v1, s[44:47], s96 offen offset:3072 sc1
    s_waitcnt lgkmcnt(5)
    v_mfma_f32_32x32x16_bf16 v[56:71], v[92:95], v[184:187], v[56:71]
    ds_read_b128 v[84:87], v1 offset:50176
    s_waitcnt vmcnt(12) lgkmcnt(5)
    v_mfma_f32_32x32x16_bf16 v[40:55], v[96:99], v[188:191], v[40:55]
    ds_read_b128 v[88:91], v1 offset:18432
    s_xor_b32 s96, s70, 24576
    buffer_load_dwordx4 v[224:227], v1, s[44:47], s96 offen offset:0 sc1
    s_waitcnt lgkmcnt(5)
    v_mfma_f32_32x32x16_bf16 v[56:71], v[100:103], v[188:191], v[56:71]
    ds_read_b128 v[92:95], v1 offset:51200
    s_waitcnt vmcnt(9)
    v_max3_u32 v120, v112, v113, v114
    v_max_u32 v120, v120, v115
    v_or3_b32 v12, v12, v184, v188
    s_waitcnt vmcnt(8) lgkmcnt(5)
    v_mfma_f32_32x32x16_bf16 v[40:55], v[72:75], v[192:195], v[40:55]
    ds_read_b128 v[96:99], v1 offset:19456
    buffer_load_dwordx4 v[228:231], v1, s[44:47], s96 offen offset:1024 sc1
    v_cmp_eq_u32 vcc, -1, v120
    s_waitcnt lgkmcnt(5)
    v_mfma_f32_32x32x16_bf16 v[56:71], v[76:79], v[192:195], v[56:71]
    ds_read_b128 v[100:103], v1 offset:52224
    s_cbranch_vccnz Lstre_17
Lstok_18:
    s_waitcnt vmcnt(8) lgkmcnt(5)
    v_mfma_f32_32x32x16_bf16 v[40:55], v[80:83], v[196:199], v[40:55]
    ds_read_b128 v[72:75], v1 offset:20480
    buffer_load_dwordx4 v[232:235], v1, s[44:47], s96 offen offset:2048 sc1
    v_add_f32 v112, v112, v113
    s_waitcnt lgkmcnt(5)
    v_mfma_f32_32x32x16_bf16 v[56:71], v[84:87], v[196:199], v[56:71]
    ds_read_b128 v[76:79], v1 offset:53248
    v_add_f32 v114, v114, v115
    v_add_f32 v112, v112, v114
    v_or3_b32 v12, v12, v192, v196
    s_waitcnt vmcnt(8) lgkmcnt(5)
    v_mfma_f32_32x32x16_bf16 v[40:55], v[88:91], v[200:203], v[40:55]
    ds_read_b128 v[80:83], v1 offset:21504
    buffer_load_dwordx4 v[236:239], v1, s[44:47], s96 offen offset:3072 sc1
    v_mul_f32 v112, 0x3b000000, v112
    s_waitcnt lgkmcnt(5)
    v_mfma_f32_32x32x16_bf16 v[56:71], v[92:95], v[200:203], v[56:71]
    ds_read_b128 v[84:87], v1 offset:54272
    v_mov_b32 v113, v112
    s_nop 1
    v_permlane32_swap_b32 v112, v113
    s_waitcnt vmcnt(8) lgkmcnt(5)
    v_mfma_f32_32x32x16_bf16 v[40:55], v[96:99], v[204:207], v[40:55]
    ds_read_b128 v[88:91], v1 offset:22528
    s_xor_b32 s96, s70, 28672
    buffer_load_dwordx4 v[240:243], v1, s[44:47], s96 offen offset:0 sc1
    v_fma_f32 v113, -v112, v112, v113
    s_waitcnt lgkmcnt(5)
    v_mfma_f32_32x32x16_bf16 v[56:71], v[100:103], v[204:207], v[56:71]
    ds_read_b128 v[92:95], v1 offset:55296
    v_max_f32 v113, 0, v113
    v_add_f32 v113, 0x3727c5ac, v113
    v_or3_b32 v12, v12, v200, v204
    s_waitcnt vmcnt(8) lgkmcnt(5)
    v_mfma_f32_32x32x16_bf16 v[40:55], v[72:75], v[208:211], v[40:55]
    ds_read_b128 v[96:99], v1 offset:23552
    buffer_load_dwordx4 v[244:247], v1, s[44:47], s96 offen offset:1024 sc1
    v_rsq_f32 v120, v113
    s_waitcnt lgkmcnt(5)
    v_mfma_f32_32x32x16_bf16 v[56:71], v[76:79], v[208:211], v[56:71]
    ds_read_b128 v[100:103], v1 offset:56320
    v_cvt_pk_bf16_f32 v117, -v112, 0
    v_lshlrev_b32 v114, 16, v117
    s_waitcnt vmcnt(8) lgkmcnt(5)
    v_mfma_f32_32x32x16_bf16 v[40:55], v[80:83], v[212:215], v[40:55]
    ds_read_b128 v[72:75], v1 offset:24576
    buffer_load_dwordx4 v[248:251], v1, s[44:47], s96 offen offset:2048 sc1
    v_sub_f32 v114, -v112, v114
    s_waitcnt lgkmcnt(5)
    v_mfma_f32_32x32x16_bf16 v[56:71], v[84:87], v[212:215], v[56:71]
    ds_read_b128 v[76:79], v1 offset:57344
    v_cvt_pk_bf16_f32 v116, -v112, v114
    v_mul_f32 v118, 0x3fb8aa3b, v120
    v_or3_b32 v12, v12, v208, v212
    s_waitcnt vmcnt(8) lgkmcnt(5)
    v_mfma_f32_32x32x16_bf16 v[40:55], v[88:91], v[216:219], v[40:55]
    ds_read_b128 v[80:83], v1 offset:25600
    buffer_load_dwordx4 v[252:255], v1, s[44:47], s96 offen offset:3072 sc1
    s_waitcnt lgkmcnt(5)
    v_mfma_f32_32x32x16_bf16 v[56:71], v[92:95], v[216:219], v[56:71]
    ds_read_b128 v[84:87], v1 offset:58368
    s_waitcnt vmcnt(8) lgkmcnt(5)
    v_mfma_f32_32x32x16_bf16 v[40:55], v[96:99], v[220:223], v[40:55]
    ds_read_b128 v[88:91], v1 offset:26624
    s_waitcnt lgkmcnt(5)
    v_mfma_f32_32x32x16_bf16 v[56:71], v[100:103], v[220:223], v[56:71]
    ds_read_b128 v[92:95], v1 offset:59392
    v_or3_b32 v12, v12, v216, v220
    s_waitcnt vmcnt(7) lgkmcnt(5)
    v_mfma_f32_32x32x16_bf16 v[40:55], v[72:75], v[224:227], v[40:55]
    ds_read_b128 v[96:99], v1 offset:27648
    s_waitcnt lgkmcnt(5)
    v_mfma_f32_32x32x16_bf16 v[56:71], v[76:79], v[224:227], v[56:71]
    ds_read_b128 v[100:103], v1 offset:60416
    s_waitcnt vmcnt(6) lgkmcnt(5)
    v_mfma_f32_32x32x16_bf16 v[40:55], v[80:83], v[228:231], v[40:55]
    ds_read_b128 v[72:75], v1 offset:28672
    s_waitcnt lgkmcnt(5)
    v_mfma_f32_32x32x16_bf16 v[56:71], v[84:87], v[228:231], v[56:71]
    ds_read_b128 v[76:79], v1 offset:29696
    v_or3_b32 v12, v12, v224, v228
    s_waitcnt vmcnt(5) lgkmcnt(5)
    v_mfma_f32_32x32x16_bf16 v[40:55], v[88:91], v[232:235], v[40:55]
    ds_read_b128 v[80:83], v1 offset:30720
    s_waitcnt lgkmcnt(5)
    v_mfma_f32_32x32x16_bf16 v[56:71], v[92:95], v[232:235], v[56:71]
    ds_read_b128 v[84:87], v1 offset:31744
    s_waitcnt vmcnt(4) lgkmcnt(5)
    v_mfma_f32_32x32x16_bf16 v[40:55], v[96:99], v[236:239], v[40:55]
    s_add_u32 m0, s81, 90112
    ds_read_b128 v[88:91], v1 offset:61440
    buffer_load_dwordx4 v5, s[40:43], m0 offen offset:0 sc1 lds
    s_waitcnt lgkmcnt(5)
    v_mfma_f32_32x32x16_bf16 v[56:71], v[100:103], v[236:239], v[56:71]
    ds_read_b128 v[92:95], v1 offset:62464
    buffer_load_dwordx4 v5, s[40:43], m0 offen offset:1024 sc1 lds
    v_or3_b32 v12, v12, v232, v236
    s_waitcnt vmcnt(5) lgkmcnt(5)
    v_mfma_f32_32x32x16_bf16 v[40:55], v[72:75], v[240:243], v[40:55]
    s_add_u32 m0, s81, 98304
    ds_read_b128 v[96:99], v1 offset:63488
    buffer_load_dwordx4 v5, s[40:43], m0 offen offset:0 sc1 lds
    v_mfma_f32_32x32x8_bf16 v[40:55], v[104:105], v[116:117], v[40:55]
    s_waitcnt vmcnt(5) lgkmcnt(5)
    v_mfma_f32_32x32x16_bf16 v[40:55], v[76:79], v[244:247], v[40:55]
    ds_read_b128 v[100:103], v1 offset:64512
    buffer_load_dwordx4 v5, s[40:43], m0 offen offset:1024 sc1 lds
    v_mfma_f32_32x32x8_bf16 v[56:71], v[108:109], v[116:117], v[56:71]
    s_waitcnt vmcnt(5) lgkmcnt(5)
    s_add_u32 m0, s81, 106496
    v_mfma_f32_32x32x16_bf16 v[40:55], v[80:83], v[248:251], v[40:55]
    buffer_load_dwordx4 v5, s[40:43], m0 offen offset:0 sc1 lds
    v_or3_b32 v12, v12, v240, v244
    s_waitcnt vmcnt(5) lgkmcnt(4)
    v_mfma_f32_32x32x16_bf16 v[40:55], v[84:87], v[252:255], v[40:55]
    buffer_load_dwordx4 v5, s[40:43], m0 offen offset:1024 sc1 lds
    v_or3_b32 v12, v12, v248, v252
    s_waitcnt lgkmcnt(3)
    s_add_u32 m0, s81, 114688
    v_mfma_f32_32x32x16_bf16 v[56:71], v[88:91], v[240:243], v[56:71]
    buffer_load_dwordx4 v5, s[40:43], m0 offen offset:0 sc1 lds
    v_and_b32 v12, 1, v12
    v_cmp_ne_u32 vcc, 0, v12
    s_waitcnt lgkmcnt(2)
    v_mfma_f32_32x32x16_bf16 v[56:71], v[92:95], v[244:247], v[56:71]
    buffer_load_dwordx4 v5, s[40:43], m0 offen offset:1024 sc1 lds
    v_max3_f32 v119, v40, v41, v42
    v_max3_f32 v121, v43, v44, v45
    v_max3_f32 v119, v119, v46, v47
    v_max3_f32 v121, v121, v48, v49
    v_max3_f32 v119, v119, v50, v51
    v_max3_f32 v121, v121, v52, v53
    s_waitcnt lgkmcnt(1)
    v_mfma_f32_32x32x16_bf16 v[56:71], v[96:99], v[248:251], v[56:71]
    s_add_u32 s95, s8, 524288
    buffer_load_dwordx4 a[128:131], v1, s[40:43], s95 offen offset:0 sc1
    v_max3_f32 v119, v119, v54, v55
    v_max_f32 v119, v119, v121
    v_mul_f32 v119, -v119, v118
    v_min3_f32 v122, v40, v41, v42
    v_min3_f32 v123, v43, v44, v45
    v_min3_f32 v122, v122, v46, v47
    s_waitcnt lgkmcnt(0)
    v_mfma_f32_32x32x16_bf16 v[56:71], v[100:103], v[252:255], v[56:71]
    buffer_load_dwordx4 a[132:135], v1, s[40:43], s95 offen offset:1024 sc1
    v_min3_f32 v123, v123, v48, v49
    v_min3_f32 v122, v122, v50, v51
    v_min3_f32 v123, v123, v52, v53
    v_min3_f32 v122, v122, v54, v55
    v_min_f32_e64 v122, v122, v123
    s_cbranch_vccnz L_xbad1
    v_pk_fma_f32 v[72:73], v[40:41], v[118:119], v[118:119] op_sel:[0,0,1] op_sel_hi:[1,0,1]
    v_pk_fma_f32 v[74:75], v[42:43], v[118:119], v[118:119] op_sel:[0,0,1] op_sel_hi:[1,0,1]
    v_pk_fma_f32 v[76:77], v[44:45], v[118:119], v[118:119] op_sel:[0,0,1] op_sel_hi:[1,0,1]
    v_pk_fma_f32 v[78:79], v[46:47], v[118:119], v[118:119] op_sel:[0,0,1] op_sel_hi:[1,0,1]
    v_pk_fma_f32 v[80:81], v[48:49], v[118:119], v[118:119] op_sel:[0,0,1] op_sel_hi:[1,0,1]
    v_pk_fma_f32 v[82:83], v[50:51], v[118:119], v[118:119] op_sel:[0,0,1] op_sel_hi:[1,0,1]
    v_pk_fma_f32 v[84:85], v[52:53], v[118:119], v[118:119] op_sel:[0,0,1] op_sel_hi:[1,0,1]
    v_pk_fma_f32 v[86:87], v[54:55], v[118:119], v[118:119] op_sel:[0,0,1] op_sel_hi:[1,0,1]
    v_pk_mul_f32 v[56:57], v[56:57], v[120:121] op_sel_hi:[1,0]
    v_pk_mul_f32 v[58:59], v[58:59], v[120:121] op_sel_hi:[1,0]
    v_pk_mul_f32 v[60:61], v[60:61], v[120:121] op_sel_hi:[1,0]
    v_pk_mul_f32 v[62:63], v[62:63], v[120:121] op_sel_hi:[1,0]
    v_cvt_pk_bf16_f32 v56, v56, v57
    v_cvt_pk_bf16_f32 v57, v58, v59
    v_cvt_pk_bf16_f32 v58, v60, v61
    v_cvt_pk_bf16_f32 v59, v62, v63
    ds_write_b128 v8, v[56:59]
    v_pk_mul_f32 v[64:65], v[64:65], v[120:121] op_sel_hi:[1,0]
    v_pk_mul_f32 v[66:67], v[66:67], v[120:121] op_sel_hi:[1,0]
    v_pk_mul_f32 v[68:69], v[68:69], v[120:121] op_sel_hi:[1,0]
    v_pk_mul_f32 v[70:71], v[70:71], v[120:121] op_sel_hi:[1,0]
    buffer_load_dwordx4 a[136:139], v1, s[40:43], s95 offen offset:2048 sc1
    v_cvt_pk_bf16_f32 v60, v64, v65
    v_cvt_pk_bf16_f32 v61, v66, v67
    v_cvt_pk_bf16_f32 v62, v68, v69
    v_cvt_pk_bf16_f32 v63, v70, v71
    v_exp_f32 v72, v72
    v_exp_f32 v73, v73
    v_exp_f32 v74, v74
    v_exp_f32 v75, v75
    v_exp_f32 v76, v76
    v_exp_f32 v77, v77
    ds_write_b128 v8, v[60:63] offset:4096
    v_exp_f32 v78, v78
    v_exp_f32 v79, v79
    v_exp_f32 v80, v80
    v_exp_f32 v81, v81
    v_exp_f32 v82, v82
    v_exp_f32 v83, v83
    v_exp_f32 v84, v84
    v_exp_f32 v85, v85
    buffer_load_dwordx4 a[140:143], v1, s[40:43], s95 offen offset:3072 sc1
    v_exp_f32 v86, v86
    v_exp_f32 v87, v87
    v_pk_add_f32 v[124:125], v[72:73], v[74:75]
    v_pk_add_f32 v[112:113], v[76:77], v[78:79]
    v_pk_add_f32 v[124:125], v[124:125], v[80:81]
    v_pk_add_f32 v[112:113], v[112:113], v[82:83]
    v_pk_add_f32 v[124:125], v[124:125], v[84:85]
    v_pk_add_f32 v[112:113], v[112:113], v[86:87]
    v_pk_add_f32 v[124:125], v[124:125], v[112:113]
    v_add_f32 v124, v124, v125
    v_rcp_f32_e64 v124, v124
    s_nop 0
    v_pk_mul_f32 v[72:73], v[72:73], v[124:125] op_sel_hi:[1,0]
    v_pk_mul_f32 v[74:75], v[74:75], v[124:125] op_sel_hi:[1,0]
    v_pk_mul_f32 v[76:77], v[76:77], v[124:125] op_sel_hi:[1,0]
    v_pk_mul_f32 v[78:79], v[78:79], v[124:125] op_sel_hi:[1,0]
    v_cvt_pk_bf16_f32 v72, v72, v73
    v_cvt_pk_bf16_f32 v73, v74, v75
    v_cvt_pk_bf16_f32 v74, v76, v77
    v_cvt_pk_bf16_f32 v75, v78, v79
    ds_write_b128 v126, v[72:75]
    v_pk_mul_f32 v[80:81], v[80:81], v[124:125] op_sel_hi:[1,0]
    v_pk_mul_f32 v[82:83], v[82:83], v[124:125] op_sel_hi:[1,0]
    v_pk_mul_f32 v[84:85], v[84:85], v[124:125] op_sel_hi:[1,0]
    v_pk_mul_f32 v[86:87], v[86:87], v[124:125] op_sel_hi:[1,0]
    v_cvt_pk_bf16_f32 v76, v80, v81
    v_cvt_pk_bf16_f32 v77, v82, v83
    v_cvt_pk_bf16_f32 v78, v84, v85
    v_cvt_pk_bf16_f32 v79, v86, v87
    v_mul_f32_e64 v119, v122, v118
    v_pk_fma_f32 v[88:89], v[40:41], v[118:119], v[118:119] op_sel:[0,0,1] op_sel_hi:[1,0,1] neg_lo:[1,0,0] neg_hi:[1,0,0]
    s_add_u32 s95, s8, 528384
    buffer_load_dwordx4 a[144:147], v1, s[40:43], s95 offen offset:0 sc1
    v_pk_fma_f32 v[90:91], v[42:43], v[118:119], v[118:119] op_sel:[0,0,1] op_sel_hi:[1,0,1] neg_lo:[1,0,0] neg_hi:[1,0,0]
    v_pk_fma_f32 v[92:93], v[44:45], v[118:119], v[118:119] op_sel:[0,0,1] op_sel_hi:[1,0,1] neg_lo:[1,0,0] neg_hi:[1,0,0]
    v_pk_fma_f32 v[94:95], v[46:47], v[118:119], v[118:119] op_sel:[0,0,1] op_sel_hi:[1,0,1] neg_lo:[1,0,0] neg_hi:[1,0,0]
    v_pk_fma_f32 v[96:97], v[48:49], v[118:119], v[118:119] op_sel:[0,0,1] op_sel_hi:[1,0,1] neg_lo:[1,0,0] neg_hi:[1,0,0]
    ds_write_b128 v127, v[76:79]
    v_pk_fma_f32 v[98:99], v[50:51], v[118:119], v[118:119] op_sel:[0,0,1] op_sel_hi:[1,0,1] neg_lo:[1,0,0] neg_hi:[1,0,0]
    v_pk_fma_f32 v[100:101], v[52:53], v[118:119], v[118:119] op_sel:[0,0,1] op_sel_hi:[1,0,1] neg_lo:[1,0,0] neg_hi:[1,0,0]
    v_pk_fma_f32 v[102:103], v[54:55], v[118:119], v[118:119] op_sel:[0,0,1] op_sel_hi:[1,0,1] neg_lo:[1,0,0] neg_hi:[1,0,0]
    v_exp_f32 v88, v88
    v_exp_f32 v89, v89
    v_exp_f32 v90, v90
    v_exp_f32 v91, v91
    v_exp_f32 v92, v92
    v_exp_f32 v93, v93
    v_exp_f32 v94, v94
    v_exp_f32 v95, v95
    v_exp_f32 v96, v96
    v_exp_f32 v97, v97
    v_exp_f32 v98, v98
    v_exp_f32 v99, v99
    v_exp_f32 v100, v100
    buffer_load_dwordx4 a[148:151], v1, s[40:43], s95 offen offset:1024 sc1
    v_exp_f32 v101, v101
    v_exp_f32 v102, v102
    v_exp_f32 v103, v103
    v_pk_add_f32 v[124:125], v[88:89], v[90:91]
    v_pk_add_f32 v[112:113], v[92:93], v[94:95]
    v_pk_add_f32 v[124:125], v[124:125], v[96:97]
    v_pk_add_f32 v[112:113], v[112:113], v[98:99]
    v_pk_add_f32 v[124:125], v[124:125], v[100:101]
    v_pk_add_f32 v[112:113], v[112:113], v[102:103]
    v_pk_add_f32 v[124:125], v[124:125], v[112:113]
    v_add_f32 v124, v124, v125
    v_rcp_f32_e64 v124, v124
    s_nop 0
    v_pk_mul_f32 v[88:89], v[88:89], v[124:125] op_sel_hi:[1,0]
    v_pk_mul_f32 v[90:91], v[90:91], v[124:125] op_sel_hi:[1,0]
    v_pk_mul_f32 v[92:93], v[92:93], v[124:125] op_sel_hi:[1,0]
    v_pk_mul_f32 v[94:95], v[94:95], v[124:125] op_sel_hi:[1,0]
    v_cvt_pk_bf16_f32 v88, v88, v89
    v_cvt_pk_bf16_f32 v89, v90, v91
    v_cvt_pk_bf16_f32 v90, v92, v93
    v_cvt_pk_bf16_f32 v91, v94, v95
    ds_write_b128 v126, v[88:91] offset:4096
    v_pk_mul_f32 v[96:97], v[96:97], v[124:125] op_sel_hi:[1,0]
    v_pk_mul_f32 v[98:99], v[98:99], v[124:125] op_sel_hi:[1,0]
    v_pk_mul_f32 v[100:101], v[100:101], v[124:125] op_sel_hi:[1,0]
    v_pk_mul_f32 v[102:103], v[102:103], v[124:125] op_sel_hi:[1,0]
    v_cvt_pk_bf16_f32 v92, v96, v97
    v_cvt_pk_bf16_f32 v93, v98, v99
    v_cvt_pk_bf16_f32 v94, v100, v101
    v_cvt_pk_bf16_f32 v95, v102, v103
    buffer_load_dwordx4 a[152:155], v1, s[40:43], s95 offen offset:2048 sc1
    ds_write_b128 v127, v[92:95] offset:4096
    v_add_u32 v123, 0x10000, v1
    v_mov_b32 v64, 0x3f803f80
    v_mov_b32 v65, 0x3f803f80
    v_mov_b32 v66, 0x3f803f80
    v_mov_b32 v67, 0x3f803f80
    buffer_load_dwordx4 a[156:159], v1, s[40:43], s95 offen offset:3072 sc1
    s_waitcnt vmcnt(8)
    s_waitcnt lgkmcnt(0)
    s_barrier
    s_nop 0
    ds_read_b64_tr_b16 v[72:73], v9 offset:0
    ds_read_b64_tr_b16 v[74:75], v9 offset:512
    ds_read_b64_tr_b16 v[76:77], v10 offset:0
    ds_read_b64_tr_b16 v[78:79], v10 offset:512
    ds_read_b64_tr_b16 v[80:81], v9 offset:1024
    ds_read_b64_tr_b16 v[82:83], v9 offset:1536
    ds_read_b64_tr_b16 v[84:85], v10 offset:1024
    ds_read_b64_tr_b16 v[86:87], v10 offset:1536
    ds_read_b64_tr_b16 v[88:89], v9 offset:2048
    ds_read_b64_tr_b16 v[90:91], v9 offset:2560
    ds_read_b64_tr_b16 v[92:93], v10 offset:2048
    ds_read_b64_tr_b16 v[94:95], v10 offset:2560
    ds_read_b64_tr_b16 v[96:97], v9 offset:3072
    ds_read_b64_tr_b16 v[98:99], v9 offset:3584
    ds_read_b64_tr_b16 v[100:101], v10 offset:3072
    ds_read_b64_tr_b16 v[102:103], v10 offset:3584
    s_add_u32 s95, s9, 524288
    buffer_load_dwordx4 a[160:163], v1, s[40:43], s95 offen offset:0 sc1
    s_waitcnt lgkmcnt(12)
    v_mfma_f32_16x16x32_bf16 v[56:59], v[72:75], v[76:79], 0
    v_mfma_f32_16x16x32_bf16 v[60:63], v[72:75], v[64:67], 0
    s_waitcnt lgkmcnt(8)
    v_mfma_f32_16x16x32_bf16 v[56:59], v[80:83], v[84:87], v[56:59]
    v_mfma_f32_16x16x32_bf16 v[60:63], v[80:83], v[64:67], v[60:63]
    s_waitcnt lgkmcnt(4)
    v_mfma_f32_16x16x32_bf16 v[56:59], v[88:91], v[92:95], v[56:59]
    v_mfma_f32_16x16x32_bf16 v[60:63], v[88:91], v[64:67], v[60:63]
    s_waitcnt lgkmcnt(0)
    v_mfma_f32_16x16x32_bf16 v[56:59], v[96:99], v[100:103], v[56:59]
    v_mfma_f32_16x16x32_bf16 v[60:63], v[96:99], v[64:67], v[60:63]
    v_mov_b32 v40, 1
    s_add_u32 s84, s74, 557056
    ds_read_b128 v[72:75], v123 offset:24576
    ds_read_b128 v[76:79], v123 offset:25600
    s_nop 0
    v_cvt_pk_bf16_f32 v56, v56, v57
    v_cvt_pk_bf16_f32 v57, v58, v59
    s_nop 0
    v_cvt_pk_bf16_f32 v58, v60, v61
    v_cvt_pk_bf16_f32 v59, v62, v63
    s_nop 0
    v_permlane32_swap_b32 v56, v58
    v_permlane32_swap_b32 v57, v59
    s_mov_b32 exec_hi, 0x00010001
    buffer_store_dwordx4 v[56:59], v11, s[40:43], s84 offen sc1
    s_mov_b64 exec, 1
    buffer_store_dword v40, off, s[40:43], s78 offset:1088
    s_mov_b64 exec, -1
    ds_read_b128 v[80:83], v123 offset:26624
    ds_read_b128 v[84:87], v123 offset:27648
    ds_read_b128 v[88:91], v123 offset:28672
    ds_read_b128 v[92:95], v123 offset:29696
    s_waitcnt lgkmcnt(5)
    v_mfma_f32_32x32x16_bf16 v[40:55], v[72:75], v[128:131], 0
    ds_read_b128 v[96:99], v123 offset:30720
    buffer_load_dwordx4 a[164:167], v1, s[40:43], s95 offen offset:1024 sc1
    s_waitcnt lgkmcnt(5)
    v_mfma_f32_32x32x16_bf16 v[40:55], v[76:79], v[132:135], v[40:55]
    ds_read_b128 v[100:103], v123 offset:31744
    s_waitcnt lgkmcnt(5)
    v_mfma_f32_32x32x16_bf16 v[40:55], v[80:83], v[136:139], v[40:55]
    ds_read_b128 v[72:75], v123 offset:32768
    buffer_load_dwordx4 a[168:171], v1, s[40:43], s95 offen offset:2048 sc1
    s_waitcnt lgkmcnt(5)
    v_mfma_f32_32x32x16_bf16 v[40:55], v[84:87], v[140:143], v[40:55]
    ds_read_b128 v[76:79], v123 offset:33792
    s_waitcnt lgkmcnt(5)
    v_mfma_f32_32x32x16_bf16 v[40:55], v[88:91], v[144:147], v[40:55]
    ds_read_b128 v[80:83], v123 offset:34816
    ds_read2st64_b32 v[112:113], v22 offset0:20 offset1:21
    ds_read2st64_b32 v[114:115], v22 offset0:22 offset1:23
    buffer_load_dwordx4 a[172:175], v1, s[40:43], s95 offen offset:3072 sc1
    s_waitcnt lgkmcnt(7)
    v_mfma_f32_32x32x16_bf16 v[40:55], v[92:95], v[148:151], v[40:55]
    ds_read_b128 v[84:87], v123 offset:35840
    s_waitcnt lgkmcnt(7)
    v_mfma_f32_32x32x16_bf16 v[40:55], v[96:99], v[152:155], v[40:55]
    ds_read_b128 v[88:91], v123 offset:36864
    s_add_u32 s95, s9, 528384
    buffer_load_dwordx4 a[176:179], v1, s[40:43], s95 offen offset:0 sc1
    s_waitcnt lgkmcnt(7)
    v_mfma_f32_32x32x16_bf16 v[40:55], v[100:103], v[156:159], v[40:55]
    ds_read_b128 v[92:95], v123 offset:37888
    s_waitcnt lgkmcnt(7)
    v_mfma_f32_32x32x16_bf16 v[40:55], v[72:75], v[160:163], v[40:55]
    ds_read_b128 v[96:99], v123 offset:38912
    s_waitcnt lgkmcnt(4)
    v_add_f32 v112, v112, v113
    v_add_f32 v114, v114, v115
    v_add_f32 v114, v112, v114
    buffer_load_dwordx4 a[180:183], v1, s[40:43], s95 offen offset:1024 sc1
    v_mfma_f32_32x32x16_bf16 v[40:55], v[76:79], v[164:167], v[40:55]
    ds_read_b128 v[100:103], v123 offset:39936
    v_cvt_pk_bf16_f32 v112, v114, v114
    v_and_b32 v115, 0xffff0000, v112
    v_sub_f32 v115, v114, v115
    v_mfma_f32_32x32x16_bf16 v[40:55], v[80:83], v[168:171], v[40:55]
    ds_read_b128 v[72:75], v123 offset:40960
    v_cvt_pk_bf16_f32 v113, v115, 0
    buffer_load_dwordx4 a[120:123], v1, s[40:43], s95 offen offset:2048 sc1
    s_waitcnt lgkmcnt(5)
    v_mfma_f32_32x32x16_bf16 v[40:55], v[84:87], v[172:175], v[40:55]
    ds_read_b128 v[76:79], v123 offset:41984
    s_waitcnt lgkmcnt(5)
    v_mfma_f32_32x32x16_bf16 v[40:55], v[88:91], v[176:179], v[40:55]
    ds_read_b128 v[80:83], v123 offset:43008
    buffer_load_dwordx4 a[124:127], v1, s[40:43], s95 offen offset:3072 sc1
    s_waitcnt lgkmcnt(5)
    v_mfma_f32_32x32x16_bf16 v[40:55], v[92:95], v[180:183], v[40:55]
    ds_read_b128 v[84:87], v123 offset:44032
    v_mfma_f32_32x32x8_bf16 v[40:55], v[112:113], v[116:117], v[40:55]
    ds_write_b128 v21, a[184:187] offset:0
    s_waitcnt lgkmcnt(6)
    v_mfma_f32_32x32x16_bf16 v[40:55], v[96:99], v[184:187], v[40:55]
    ds_read_b128 v[88:91], v123 offset:45056
    s_add_u32 s95, s10, 524288
    s_waitcnt lgkmcnt(1)
    buffer_load_dwordx4 a[184:187], v1, s[40:43], s95 offen offset:0 sc1
    v_mfma_f32_32x32x16_bf16 v[40:55], v[100:103], v[188:191], v[40:55]
    ds_read_b128 v[92:95], v123 offset:46080
    ds_write_b128 v21, a[188:191] offset:1024
    v_mfma_f32_32x32x16_bf16 v[40:55], v[72:75], v[192:195], v[40:55]
    ds_read_b128 v[96:99], v123 offset:47104
    s_waitcnt lgkmcnt(1)
    buffer_load_dwordx4 a[188:191], v1, s[40:43], s95 offen offset:1024 sc1
    v_mfma_f32_32x32x16_bf16 v[40:55], v[76:79], v[196:199], v[40:55]
    ds_read_b128 v[100:103], v123 offset:48128
    ds_write_b128 v21, a[192:195] offset:8192
    v_mfma_f32_32x32x16_bf16 v[40:55], v[80:83], v[200:203], v[40:55]
    ds_read_b128 v[72:75], v123 offset:49152
    s_waitcnt lgkmcnt(1)
    buffer_load_dwordx4 a[192:195], v1, s[40:43], s95 offen offset:2048 sc1
    s_add_u32 s12, s75, 557056
    v_mfma_f32_32x32x16_bf16 v[40:55], v[84:87], v[204:207], v[40:55]
    ds_read_b128 v[76:79], v123 offset:50176
    s_add_u32 s13, s75, 696320
    ds_write_b128 v21, a[196:199] offset:9216
    v_mfma_f32_32x32x16_bf16 v[40:55], v[88:91], v[208:211], v[40:55]
    ds_read_b128 v[80:83], v123 offset:51200
    s_waitcnt lgkmcnt(1)
    buffer_load_dwordx4 a[196:199], v1, s[40:43], s95 offen offset:3072 sc1
    s_add_u32 s14, s75, 835584
    v_mfma_f32_32x32x16_bf16 v[40:55], v[92:95], v[212:215], v[40:55]
    ds_read_b128 v[84:87], v123 offset:52224
    s_add_u32 s15, s75, 974848
    ds_write_b128 v21, a[200:203] offset:16384
    v_mfma_f32_32x32x16_bf16 v[40:55], v[96:99], v[216:219], v[40:55]
    ds_read_b128 v[88:91], v123 offset:53248
    s_add_u32 s95, s10, 528384
    s_waitcnt lgkmcnt(1)
    buffer_load_dwordx4 a[200:203], v1, s[40:43], s95 offen offset:0 sc1
    s_mov_b32 s67, 1
    v_mfma_f32_32x32x16_bf16 v[40:55], v[100:103], v[220:223], v[40:55]
    ds_read_b128 v[92:95], v123 offset:54272
    buffer_load_dwordx4 v[132:135], v13, s[40:43], s12 offen offset:0 sc1
    ds_write_b128 v21, a[204:207] offset:17408
    v_mfma_f32_32x32x16_bf16 v[40:55], v[72:75], v[224:227], v[40:55]
    ds_read_b128 v[96:99], v123 offset:55296
    buffer_load_dwordx4 v[136:139], v13, s[40:43], s12 offen offset:256 sc1
L_pg4:
    s_cbranch_execz L_pgret0
    v_mfma_f32_32x32x16_bf16 v[40:55], v[76:79], v[228:231], v[40:55]
    ds_read_b128 v[100:103], v123 offset:56320
    buffer_load_dwordx4 v[140:143], v13, s[40:43], s13 offen offset:0 sc1
    ds_write_b128 v21, a[208:211] offset:24576
    v_mfma_f32_32x32x16_bf16 v[40:55], v[80:83], v[232:235], v[40:55]
    buffer_load_dwordx4 v[144:147], v13, s[40:43], s13 offen offset:256 sc1
    v_mfma_f32_32x32x16_bf16 v[40:55], v[84:87], v[236:239], v[40:55]
    buffer_load_dwordx4 v[128:131], v14, s[40:43], s12 offen sc1
    ds_write_b128 v21, a[212:215] offset:25600
    s_waitcnt lgkmcnt(6)
    v_mfma_f32_32x32x16_bf16 v[40:55], v[88:91], v[240:243], v[40:55]
    buffer_load_dwordx4 v[148:151], v13, s[40:43], s14 offen offset:0 sc1
    s_waitcnt lgkmcnt(5)
    v_mfma_f32_32x32x16_bf16 v[40:55], v[92:95], v[244:247], v[40:55]
    buffer_load_dwordx4 v[152:155], v13, s[40:43], s14 offen offset:256 sc1
    ds_write_b128 v21, a[216:219] offset:32768
    s_waitcnt lgkmcnt(4)
    v_mfma_f32_32x32x16_bf16 v[40:55], v[96:99], v[248:251], v[40:55]
    v_add_u32 v115, 0x10000, v21
    buffer_load_dwordx4 v[156:159], v13, s[40:43], s15 offen offset:0 sc1
    s_waitcnt lgkmcnt(3)
    v_mfma_f32_32x32x16_bf16 v[40:55], v[100:103], v[252:255], v[40:55]
    buffer_load_dwordx4 v[160:163], v13, s[40:43], s15 offen offset:256 sc1
    buffer_load_dword v164, v19, s[40:43], 0 offen offset:64 sc1
    ds_write_b128 v21, a[220:223] offset:33792
    ds_read_b128 v[192:195], v2 offset:36864
    ds_read_b128 v[196:199], v2 offset:37888
    s_nop 6
    v_max3_f32 v119, v40, v41, v42
    v_max3_f32 v121, v43, v44, v45
    v_max3_f32 v119, v119, v46, v47
    v_max3_f32 v121, v121, v48, v49
    v_max3_f32 v119, v119, v50, v51
    v_max3_f32 v121, v121, v52, v53
    v_max3_f32 v119, v119, v54, v55
    v_max_f32_e64 v119, v119, v121
    v_mul_f32 v119, -v119, v118
    v_pk_fma_f32 v[72:73], v[40:41], v[118:119], v[118:119] op_sel:[0,0,1] op_sel_hi:[1,0,1]
    v_pk_fma_f32 v[74:75], v[42:43], v[118:119], v[118:119] op_sel:[0,0,1] op_sel_hi:[1,0,1]
    v_pk_fma_f32 v[76:77], v[44:45], v[118:119], v[118:119] op_sel:[0,0,1] op_sel_hi:[1,0,1]
    v_pk_fma_f32 v[78:79], v[46:47], v[118:119], v[118:119] op_sel:[0,0,1] op_sel_hi:[1,0,1]
    v_pk_fma_f32 v[80:81], v[48:49], v[118:119], v[118:119] op_sel:[0,0,1] op_sel_hi:[1,0,1]
    ds_write_b128 v21, a[224:227] offset:40960
    v_pk_fma_f32 v[82:83], v[50:51], v[118:119], v[118:119] op_sel:[0,0,1] op_sel_hi:[1,0,1]
    v_pk_fma_f32 v[84:85], v[52:53], v[118:119], v[118:119] op_sel:[0,0,1] op_sel_hi:[1,0,1]
    buffer_load_dwordx4 a[204:207], v1, s[40:43], s95 offen offset:1024 sc1
    v_pk_fma_f32 v[86:87], v[54:55], v[118:119], v[118:119] op_sel:[0,0,1] op_sel_hi:[1,0,1]
    v_exp_f32 v72, v72
    v_exp_f32 v73, v73
    v_exp_f32 v74, v74
    v_exp_f32 v75, v75
    v_exp_f32 v76, v76
    v_exp_f32 v77, v77
    v_exp_f32 v78, v78
    ds_write_b128 v21, a[228:231] offset:41984
    v_exp_f32 v79, v79
    s_waitcnt lgkmcnt(7)
    buffer_load_dwordx4 a[208:211], v1, s[40:43], s95 offen offset:2048 sc1
    v_exp_f32 v80, v80
    v_exp_f32 v81, v81
    v_exp_f32 v82, v82
    v_exp_f32 v83, v83
    v_exp_f32 v84, v84
    v_exp_f32 v85, v85
    v_exp_f32 v86, v86
    v_exp_f32 v87, v87
    s_waitcnt lgkmcnt(6)
    buffer_load_dwordx4 a[212:215], v1, s[40:43], s95 offen offset:3072 sc1
    v_pk_add_f32 v[124:125], v[72:73], v[74:75]
    v_pk_add_f32 v[112:113], v[76:77], v[78:79]
    v_pk_add_f32 v[124:125], v[124:125], v[80:81]
    v_pk_add_f32 v[112:113], v[112:113], v[82:83]
    v_pk_add_f32 v[124:125], v[124:125], v[84:85]
    v_pk_add_f32 v[112:113], v[112:113], v[86:87]
    v_pk_add_f32 v[124:125], v[124:125], v[112:113]
    v_add_f32 v124, v124, v125
    v_rcp_f32_e64 v124, v124
    s_nop 0
    v_pk_mul_f32 v[72:73], v[72:73], v[124:125] op_sel_hi:[1,0]
    v_pk_mul_f32 v[74:75], v[74:75], v[124:125] op_sel_hi:[1,0]
    v_pk_mul_f32 v[76:77], v[76:77], v[124:125] op_sel_hi:[1,0]
    v_pk_mul_f32 v[78:79], v[78:79], v[124:125] op_sel_hi:[1,0]
    v_pk_mul_f32 v[80:81], v[80:81], v[124:125] op_sel_hi:[1,0]
    v_pk_mul_f32 v[82:83], v[82:83], v[124:125] op_sel_hi:[1,0]
    s_add_u32 s95, s11, 524288
    s_waitcnt lgkmcnt(5)
    s_nop 0
    buffer_load_dwordx4 a[216:219], v1, s[40:43], s95 offen offset:0 sc1
    v_pk_mul_f32 v[84:85], v[84:85], v[124:125] op_sel_hi:[1,0]
    v_pk_mul_f32 v[86:87], v[86:87], v[124:125] op_sel_hi:[1,0]
    v_cvt_pk_bf16_f32 v72, v72, v73
    v_cvt_pk_bf16_f32 v73, v74, v75
    v_cvt_pk_bf16_f32 v74, v76, v77
    v_cvt_pk_bf16_f32 v75, v78, v79
    v_cvt_pk_bf16_f32 v76, v80, v81
    v_cvt_pk_bf16_f32 v77, v82, v83
    v_cvt_pk_bf16_f32 v78, v84, v85
    v_cvt_pk_bf16_f32 v79, v86, v87
    v_min3_f32 v122, v40, v41, v42
    v_min3_f32 v123, v43, v44, v45
    v_min3_f32 v122, v122, v46, v47
    v_min3_f32 v123, v123, v48, v49
    v_min3_f32 v122, v122, v50, v51
    v_min3_f32 v123, v123, v52, v53
    s_waitcnt lgkmcnt(4)
    buffer_load_dwordx4 a[220:223], v1, s[40:43], s95 offen offset:1024 sc1
    v_min3_f32 v122, v122, v54, v55
    v_min_f32 v122, v122, v123
    v_mul_f32_e64 v119, v122, v118
    v_pk_fma_f32 v[88:89], v[40:41], v[118:119], v[118:119] op_sel:[0,0,1] op_sel_hi:[1,0,1] neg_lo:[1,0,0] neg_hi:[1,0,0]
    v_pk_fma_f32 v[90:91], v[42:43], v[118:119], v[118:119] op_sel:[0,0,1] op_sel_hi:[1,0,1] neg_lo:[1,0,0] neg_hi:[1,0,0]
    v_pk_fma_f32 v[92:93], v[44:45], v[118:119], v[118:119] op_sel:[0,0,1] op_sel_hi:[1,0,1] neg_lo:[1,0,0] neg_hi:[1,0,0]
    v_pk_fma_f32 v[94:95], v[46:47], v[118:119], v[118:119] op_sel:[0,0,1] op_sel_hi:[1,0,1] neg_lo:[1,0,0] neg_hi:[1,0,0]
    v_pk_fma_f32 v[96:97], v[48:49], v[118:119], v[118:119] op_sel:[0,0,1] op_sel_hi:[1,0,1] neg_lo:[1,0,0] neg_hi:[1,0,0]
    v_pk_fma_f32 v[98:99], v[50:51], v[118:119], v[118:119] op_sel:[0,0,1] op_sel_hi:[1,0,1] neg_lo:[1,0,0] neg_hi:[1,0,0]
    v_pk_fma_f32 v[100:101], v[52:53], v[118:119], v[118:119] op_sel:[0,0,1] op_sel_hi:[1,0,1] neg_lo:[1,0,0] neg_hi:[1,0,0]
    v_pk_fma_f32 v[102:103], v[54:55], v[118:119], v[118:119] op_sel:[0,0,1] op_sel_hi:[1,0,1] neg_lo:[1,0,0] neg_hi:[1,0,0]
    v_exp_f32 v88, v88
    v_exp_f32 v89, v89
    v_exp_f32 v90, v90
    s_waitcnt lgkmcnt(1)
    buffer_load_dwordx4 a[224:227], v1, s[40:43], s95 offen offset:2048 sc1
    v_exp_f32 v91, v91
    v_exp_f32 v92, v92
    v_exp_f32 v93, v93
    v_exp_f32 v94, v94
    v_exp_f32 v95, v95
    v_exp_f32 v96, v96
    v_exp_f32 v97, v97
    v_exp_f32 v98, v98
    s_waitcnt lgkmcnt(0)
    buffer_load_dwordx4 a[228:231], v1, s[40:43], s95 offen offset:3072 sc1
    v_exp_f32 v99, v99
    v_exp_f32 v100, v100
    v_exp_f32 v101, v101
    v_exp_f32 v102, v102
    v_exp_f32 v103, v103
    v_pk_add_f32 v[124:125], v[88:89], v[90:91]
    v_pk_add_f32 v[112:113], v[92:93], v[94:95]
    v_pk_add_f32 v[124:125], v[124:125], v[96:97]
    v_pk_add_f32 v[112:113], v[112:113], v[98:99]
    v_pk_add_f32 v[124:125], v[124:125], v[100:101]
    v_pk_add_f32 v[112:113], v[112:113], v[102:103]
    v_pk_add_f32 v[124:125], v[124:125], v[112:113]
    v_add_f32 v124, v124, v125
    v_rcp_f32_e64 v124, v124
    s_nop 0
    v_pk_mul_f32 v[88:89], v[88:89], v[124:125] op_sel_hi:[1,0]
    v_pk_mul_f32 v[90:91], v[90:91], v[124:125] op_sel_hi:[1,0]
    v_pk_mul_f32 v[92:93], v[92:93], v[124:125] op_sel_hi:[1,0]
    v_pk_mul_f32 v[94:95], v[94:95], v[124:125] op_sel_hi:[1,0]
    v_pk_mul_f32 v[96:97], v[96:97], v[124:125] op_sel_hi:[1,0]
    v_pk_mul_f32 v[98:99], v[98:99], v[124:125] op_sel_hi:[1,0]
    v_pk_mul_f32 v[100:101], v[100:101], v[124:125] op_sel_hi:[1,0]
    v_pk_mul_f32 v[102:103], v[102:103], v[124:125] op_sel_hi:[1,0]
    s_waitcnt vmcnt(16)
    v_mfma_f32_16x16x32_bf16 v[56:59], v[192:195], v[132:135], 0
    v_cvt_pk_bf16_f32 v88, v88, v89
    v_cvt_pk_bf16_f32 v89, v90, v91
    s_waitcnt vmcnt(15)
    v_mfma_f32_16x16x32_bf16 v[56:59], v[196:199], v[136:139], v[56:59]
    v_cvt_pk_bf16_f32 v90, v92, v93
    v_cvt_pk_bf16_f32 v91, v94, v95
    s_waitcnt vmcnt(14)
    v_mfma_f32_16x16x32_bf16 v[56:59], v[192:195], v[140:143], v[56:59]
    v_cvt_pk_bf16_f32 v92, v96, v97
    v_cvt_pk_bf16_f32 v93, v98, v99
    s_waitcnt vmcnt(13)
    v_mfma_f32_16x16x32_bf16 v[56:59], v[196:199], v[144:147], v[56:59]
    v_cvt_pk_bf16_f32 v94, v100, v101
    v_cvt_pk_bf16_f32 v95, v102, v103
    v_permlane32_swap_b32 v72, v88
    v_permlane32_swap_b32 v73, v89
    v_permlane32_swap_b32 v74, v90
    v_permlane32_swap_b32 v75, v91
L_part1:
    s_waitcnt vmcnt(12)
    v_mfma_f32_16x16x32_bf16 v[60:63], v[192:195], v[128:131], 0
    s_waitcnt vmcnt(11)
    v_mfma_f32_16x16x32_bf16 v[56:59], v[192:195], v[148:151], v[56:59]
    s_waitcnt vmcnt(10)
    v_mfma_f32_16x16x32_bf16 v[56:59], v[196:199], v[152:155], v[56:59]
    s_waitcnt vmcnt(9)
    v_mfma_f32_16x16x32_bf16 v[56:59], v[192:195], v[156:159], v[56:59]
    v_cvt_pk_bf16_f32 v64, v60, v61
    v_cvt_pk_bf16_f32 v65, v62, v63
    s_waitcnt vmcnt(8)
    v_mfma_f32_16x16x32_bf16 v[56:59], v[196:199], v[160:163], v[56:59]
    s_mov_b64 exec, 0x00ff00ff
    ds_write_b64 v16, v[64:65]
    s_mov_b64 exec, -1
    s_nop 4
    v_cmp_u_f32 vcc, v56, v60
    v_cvt_pk_bf16_f32 v56, v56, v57
    v_cvt_pk_bf16_f32 v57, v58, v59
    ds_write_b64 v15, v[56:57]
    s_cbranch_vccnz L_partre
L_partok1:
    v_permlane32_swap_b32 v76, v92
    v_permlane32_swap_b32 v77, v93
    v_permlane32_swap_b32 v78, v94
    v_permlane32_swap_b32 v79, v95
    s_waitcnt lgkmcnt(0)
    s_barrier
    ds_read_b128 v[128:131], v17 offset:0
    ds_read_b128 v[132:135], v17 offset:16
    ds_read_b128 v[136:139], v17 offset:1600
    ds_read_b128 v[140:143], v17 offset:1616
    s_waitcnt lgkmcnt(3)
    v_mfma_f32_32x32x16_bf16 v[40:55], v[128:131], v[72:75], 0
    v_mov_b32 v106, 2
    s_waitcnt vmcnt(7)
    v_cmp_gt_u32 vcc, 1, v164
    s_waitcnt lgkmcnt(2)
    v_mfma_f32_32x32x16_bf16 v[40:55], v[132:135], v[76:79], v[40:55]
    s_cbranch_vccnz Lrefa_20
Lfc_19:
    s_waitcnt lgkmcnt(0)
    v_mfma_f32_32x32x16_bf16 v[56:71], v[136:139], v[88:91], 0
    v_mfma_f32_32x32x16_bf16 v[56:71], v[140:143], v[92:95], v[56:71]
    v_add_f32 v48, v48, v50
    v_add_f32 v49, v49, v51
    v_add_f32 v48, 0x358637bd, v48
    v_add_f32 v48, v48, v49
    v_rcp_f32_e64 v48, v48
    s_nop 0
    v_pk_mul_f32 v[40:41], v[40:41], v[48:49] op_sel_hi:[1,0]
    v_pk_mul_f32 v[42:43], v[42:43], v[48:49] op_sel_hi:[1,0]
    v_pk_mul_f32 v[44:45], v[44:45], v[48:49] op_sel_hi:[1,0]
    v_pk_mul_f32 v[46:47], v[46:47], v[48:49] op_sel_hi:[1,0]
    v_bfi_b32 v40, s60, v40, v4
    v_cvt_pk_bf16_f32 v40, v40, v41
    v_cvt_pk_bf16_f32 v41, v42, v43
    v_cvt_pk_bf16_f32 v42, v44, v45
    v_cvt_pk_bf16_f32 v43, v46, v47
    buffer_store_dwordx4 v[40:43], v1, s[44:47], s71 offen offset:0
    v_add_f32 v64, v64, v66
    v_add_f32 v65, v65, v67
    v_add_f32 v64, 0x358637bd, v64
    v_add_f32 v64, v64, v65
    v_rcp_f32_e64 v64, v64
    s_nop 0
    v_pk_mul_f32 v[56:57], v[56:57], v[64:65] op_sel_hi:[1,0]
    v_pk_mul_f32 v[58:59], v[58:59], v[64:65] op_sel_hi:[1,0]
    v_pk_mul_f32 v[60:61], v[60:61], v[64:65] op_sel_hi:[1,0]
    v_pk_mul_f32 v[62:63], v[62:63], v[64:65] op_sel_hi:[1,0]
    v_bfi_b32 v56, s60, v56, v4
    v_cvt_pk_bf16_f32 v56, v56, v57
    v_cvt_pk_bf16_f32 v57, v58, v59
    v_cvt_pk_bf16_f32 v58, v60, v61
    v_cvt_pk_bf16_f32 v59, v62, v63
    buffer_store_dwordx4 v[56:59], v1, s[44:47], s71 offen offset:1024
    s_mov_b64 exec, 1
    buffer_store_dword v106, off, s[40:43], s78 offset:0
    s_mov_b64 exec, -1
    ds_write_b128 v21, a[232:235] offset:49152
    ds_write_b128 v21, a[236:239] offset:50176
    ds_write_b128 v21, a[240:243] offset:57344
    ds_write_b128 v21, a[244:247] offset:58368
    s_and_b32 s84, s8, 0x6000
    v_add_u32 v116, s84, v2
    s_and_b32 s84, s9, 0x6000
    v_add_u32 v117, s84, v2
    s_and_b32 s84, s10, 0x6000
    v_add_u32 v118, s84, v2
    s_and_b32 s84, s11, 0x6000
    v_add_u32 v119, s84, v2
    v_and_or_b32 v141, v20, 60, s61
L_ore1:
    s_lshl2_add_u32 m0, s81, 114688
    buffer_load_dword v127, v18, s[40:43], 0 offen sc1
    s_cmp_eq_u32 s66, s0
    s_cbranch_scc0 Lpchk_22
    ds_write_b128 v116, v[40:43] offset:0
    ds_write_b128 v116, v[56:59] offset:1024
    s_branch L_oown1
L_opoll1:
    buffer_load_dword v127, v18, s[40:43], 0 offen sc1
    s_sub_u32 s68, s68, 1
    s_cbranch_scc1 L_end
L_oown1:
    s_waitcnt vmcnt(0)
    v_cmp_gt_u32 vcc, 2, v127
    s_cbranch_vccnz L_opoll1
    s_branch L_ojoin1
Lpoll_21:
    buffer_load_dword v127, v18, s[40:43], 0 offen sc1
    s_sub_u32 s68, s68, 1
    s_cbranch_scc1 L_end
Lpchk_22:
    s_waitcnt vmcnt(0)
    v_cmp_gt_u32 vcc, 2, v127
    s_cbranch_vccnz Lpoll_21
    buffer_load_dwordx4 v1, s[44:47], s72 offen offset:0 sc1 lds
    buffer_load_dwordx4 v1, s[44:47], s72 offen offset:1024 sc1 lds
L_ojoin1:
    s_lshl2_add_u32 m0, s81, 116736
    s_xor_b32 s84, s72, 2048
    buffer_load_dwordx4 v1, s[44:47], s84 offen offset:0 sc1 lds
    buffer_load_dwordx4 v1, s[44:47], s84 offen offset:1024 sc1 lds
    s_lshl2_add_u32 m0, s81, 118784
    s_xor_b32 s84, s72, 4096
    buffer_load_dwordx4 v1, s[44:47], s84 offen offset:0 sc1 lds
    buffer_load_dwordx4 v1, s[44:47], s84 offen offset:1024 sc1 lds
    s_lshl2_add_u32 m0, s81, 120832
    s_xor_b32 s84, s72, 6144
    buffer_load_dwordx4 v1, s[44:47], s84 offen offset:0 sc1 lds
    s_barrier
    buffer_load_dwordx4 v1, s[44:47], s84 offen offset:1024 sc1 lds
L_oskip1:
    s_waitcnt vmcnt(7)
    ds_read_b128 v[72:75], v116 offset:0
    s_waitcnt vmcnt(6)
    ds_read_b128 v[76:79], v116 offset:1024
    s_waitcnt vmcnt(5)
    ds_read_b128 v[80:83], v116 offset:2048
    s_waitcnt lgkmcnt(2)
    v_mfma_f32_32x32x16_bf16 v[40:55], a[128:131], v[72:75], v[24:39]
    s_waitcnt vmcnt(4)
    ds_read_b128 v[84:87], v116 offset:3072
    s_waitcnt lgkmcnt(2)
    v_mfma_f32_32x32x16_bf16 v[40:55], a[132:135], v[76:79], v[40:55]
    v_bitop3_b32 v12, 1, v72, v76 bitop3:0x80
    s_waitcnt vmcnt(3)
    ds_read_b128 v[88:91], v116 offset:4096
    s_waitcnt lgkmcnt(2)
    v_mfma_f32_32x32x16_bf16 v[40:55], a[136:139], v[80:83], v[40:55]
    s_waitcnt vmcnt(2)
    ds_read_b128 v[92:95], v116 offset:5120
    s_waitcnt lgkmcnt(2)
    v_mfma_f32_32x32x16_bf16 v[40:55], a[140:143], v[84:87], v[40:55]
    v_bitop3_b32 v12, v12, v80, v84 bitop3:0x80
    s_waitcnt vmcnt(1)
    ds_read_b128 v[96:99], v116 offset:6144
    s_waitcnt lgkmcnt(2)
    v_mfma_f32_32x32x16_bf16 v[40:55], a[144:147], v[88:91], v[40:55]
    s_waitcnt vmcnt(0)
    ds_read_b128 v[100:103], v116 offset:7168
    s_barrier
    s_waitcnt lgkmcnt(2)
    v_mfma_f32_32x32x16_bf16 v[40:55], a[148:151], v[92:95], v[40:55]
    v_bitop3_b32 v12, v12, v88, v92 bitop3:0x80
    ds_read_b128 v[72:75], v117 offset:0
    ds_read_b128 v[76:79], v117 offset:1024
    s_add_u32 s95, s11, 528384
    buffer_load_dwordx4 a[232:235], v1, s[40:43], s95 offen offset:0 sc1
    s_waitcnt lgkmcnt(3)
    v_mfma_f32_32x32x16_bf16 v[40:55], a[152:155], v[96:99], v[40:55]
    ds_read_b128 v[80:83], v117 offset:2048
    ds_read_b128 v[84:87], v117 offset:3072
    s_waitcnt lgkmcnt(4)
    v_mfma_f32_32x32x16_bf16 v[40:55], a[156:159], v[100:103], v[40:55]
    v_bitop3_b32 v12, v12, v96, v100 bitop3:0x80
    v_cmp_eq_u32 vcc, 0, v12
    ds_read_b128 v[88:91], v117 offset:4096
    ds_read_b128 v[92:95], v117 offset:5120
    buffer_load_dwordx4 a[236:239], v1, s[40:43], s95 offen offset:1024 sc1
    s_waitcnt lgkmcnt(5)
    v_mfma_f32_32x32x16_bf16 v[40:55], a[160:163], v[72:75], v[40:55]
    ds_read_b128 v[96:99], v117 offset:6144
    ds_read_b128 v[100:103], v117 offset:7168
    s_cmp_eq_u64 vcc, 0
    s_cselect_b64 exec, 1, 0
    buffer_store_dword v106, off, s[40:43], s16 offset:64
    s_mov_b64 exec, -1
    s_cselect_b32 s62, 1, 0
    s_waitcnt lgkmcnt(6)
    v_mfma_f32_32x32x16_bf16 v[40:55], a[164:167], v[76:79], v[40:55]
    v_bitop3_b32 v12, v12, v72, v76 bitop3:0x80
    ds_read_b128 v[72:75], v118 offset:0
    buffer_load_dwordx4 a[240:243], v1, s[40:43], s95 offen offset:2048 sc1
    s_waitcnt lgkmcnt(6)
    v_mfma_f32_32x32x16_bf16 v[40:55], a[168:171], v[80:83], v[40:55]
    ds_read_b128 v[76:79], v118 offset:1024
    s_waitcnt lgkmcnt(6)
    v_mfma_f32_32x32x16_bf16 v[40:55], a[172:175], v[84:87], v[40:55]
    v_bitop3_b32 v12, v12, v80, v84 bitop3:0x80
    ds_read_b128 v[80:83], v118 offset:2048
    buffer_load_dwordx4 a[244:247], v1, s[40:43], s95 offen offset:3072 sc1
    s_waitcnt lgkmcnt(6)
    v_mfma_f32_32x32x16_bf16 v[40:55], a[176:179], v[88:91], v[40:55]
    ds_read_b128 v[84:87], v118 offset:3072
    s_waitcnt lgkmcnt(6)
    v_mfma_f32_32x32x16_bf16 v[40:55], a[180:183], v[92:95], v[40:55]
    v_bitop3_b32 v12, v12, v88, v92 bitop3:0x80
    ds_read_b128 v[88:91], v118 offset:4096
    s_waitcnt lgkmcnt(6)
    v_mfma_f32_32x32x16_bf16 v[40:55], a[120:123], v[96:99], v[40:55]
    ds_read_b128 v[92:95], v118 offset:5120
    s_waitcnt lgkmcnt(6)
    v_mfma_f32_32x32x16_bf16 v[40:55], a[124:127], v[100:103], v[40:55]
    v_bitop3_b32 v12, v12, v96, v100 bitop3:0x80
    ds_read_b128 v[96:99], v118 offset:6144
    s_waitcnt lgkmcnt(6)
    v_mfma_f32_32x32x16_bf16 v[40:55], a[184:187], v[72:75], v[40:55]
    ds_read_b128 v[100:103], v118 offset:7168
    s_waitcnt lgkmcnt(6)
    v_mfma_f32_32x32x16_bf16 v[40:55], a[188:191], v[76:79], v[40:55]
    v_bitop3_b32 v12, v12, v72, v76 bitop3:0x80
    ds_read_b128 v[72:75], v119 offset:0
    s_waitcnt lgkmcnt(6)
    v_mfma_f32_32x32x16_bf16 v[40:55], a[192:195], v[80:83], v[40:55]
    ds_read_b128 v[76:79], v119 offset:1024
    s_waitcnt lgkmcnt(6)
    v_mfma_f32_32x32x16_bf16 v[40:55], a[196:199], v[84:87], v[40:55]
    v_bitop3_b32 v12, v12, v80, v84 bitop3:0x80
    ds_read_b128 v[80:83], v119 offset:2048
    buffer_load_dword v140, v141, s[40:43], 0 offen offset:64 sc1
    s_waitcnt lgkmcnt(6)
    v_mfma_f32_32x32x16_bf16 v[40:55], a[200:203], v[88:91], v[40:55]
    ds_read_b128 v[84:87], v119 offset:3072
    s_waitcnt lgkmcnt(6)
    v_mfma_f32_32x32x16_bf16 v[40:55], a[204:207], v[92:95], v[40:55]
    v_bitop3_b32 v12, v12, v88, v92 bitop3:0x80
    ds_read_b128 v[88:91], v119 offset:4096
    s_waitcnt lgkmcnt(6)
    v_mfma_f32_32x32x16_bf16 v[40:55], a[208:211], v[96:99], v[40:55]
    ds_read_b128 v[92:95], v119 offset:5120
    s_waitcnt lgkmcnt(6)
    v_mfma_f32_32x32x16_bf16 v[40:55], a[212:215], v[100:103], v[40:55]
    v_bitop3_b32 v12, v12, v96, v100 bitop3:0x80
    ds_read_b128 v[96:99], v119 offset:6144
    s_waitcnt lgkmcnt(6)
    v_mfma_f32_32x32x16_bf16 v[40:55], a[216:219], v[72:75], v[40:55]
    ds_read_b128 v[100:103], v119 offset:7168
    s_waitcnt lgkmcnt(6)
    v_mfma_f32_32x32x16_bf16 v[40:55], a[220:223], v[76:79], v[40:55]
    v_bitop3_b32 v12, v12, v72, v76 bitop3:0x80
    s_waitcnt lgkmcnt(5)
    v_mfma_f32_32x32x16_bf16 v[40:55], a[224:227], v[80:83], v[40:55]
    s_waitcnt lgkmcnt(4)
    v_bitop3_b32 v12, v12, v80, v84 bitop3:0x80
    s_waitcnt lgkmcnt(2)
    v_bitop3_b32 v12, v12, v88, v92 bitop3:0x80
    v_mfma_f32_32x32x16_bf16 v[40:55], a[228:231], v[84:87], v[40:55]
    s_waitcnt lgkmcnt(0)
    v_bitop3_b32 v12, v12, v96, v100 bitop3:0x80
    v_cmp_eq_u32 vcc, 0, v12
    s_waitcnt vmcnt(5)
    v_mfma_f32_32x32x16_bf16 v[40:55], a[232:235], v[88:91], v[40:55]
    s_cbranch_vccnz L_obad1
    s_waitcnt vmcnt(4)
    v_mfma_f32_32x32x16_bf16 v[40:55], a[236:239], v[92:95], v[40:55]
    s_waitcnt vmcnt(0)
    v_cmp_gt_u32 vcc, 2, v140
    v_mfma_f32_32x32x16_bf16 v[40:55], a[240:243], v[96:99], v[40:55]
    s_cbranch_vccnz Lrefb_24
Lfc_23:
    v_mfma_f32_32x32x16_bf16 v[24:39], a[244:247], v[100:103], v[40:55]
    v_mov_b32 v62, 2
    s_nop 10
    v_cvt_pk_bf16_f32 v43, v30, v31
    v_cvt_pk_bf16_f32 v42, v28, v29
    v_cvt_pk_bf16_f32 v41, v26, v27
    v_cvt_pk_bf16_f32 v40, v24, v25
    v_and_b32_e64 v40, -2, v40
    buffer_store_dwordx4 v[40:43], v1, s[44:47], s73 offen offset:0
    v_cvt_pk_bf16_f32 v47, v38, v39
    v_cvt_pk_bf16_f32 v46, v36, v37
    v_cvt_pk_bf16_f32 v45, v34, v35
    v_cvt_pk_bf16_f32 v44, v32, v33
    v_and_b32 v44, -2, v44
    buffer_store_dwordx4 v[44:47], v1, s[44:47], s73 offen offset:1024
    s_mov_b64 exec, 1
    buffer_store_dword v62, off, s[40:43], s79 offset:0
    s_mov_b64 exec, -1
    s_nop 0
    v_pk_add_f32 v[56:57], v[24:25], v[26:27]
    v_pk_mul_f32 v[58:59], v[24:25], v[24:25]
    v_pk_fma_f32 v[58:59], v[26:27], v[26:27], v[58:59]
    v_pk_add_f32 v[56:57], v[56:57], v[28:29]
    v_pk_fma_f32 v[58:59], v[28:29], v[28:29], v[58:59]
    v_pk_add_f32 v[56:57], v[56:57], v[30:31]
    v_pk_fma_f32 v[58:59], v[30:31], v[30:31], v[58:59]
    v_pk_add_f32 v[56:57], v[56:57], v[32:33]
    v_pk_fma_f32 v[58:59], v[32:33], v[32:33], v[58:59]
    v_pk_add_f32 v[56:57], v[56:57], v[34:35]
    v_pk_fma_f32 v[58:59], v[34:35], v[34:35], v[58:59]
    v_pk_add_f32 v[56:57], v[56:57], v[36:37]
    v_pk_fma_f32 v[58:59], v[36:37], v[36:37], v[58:59]
    v_pk_add_f32 v[56:57], v[56:57], v[38:39]
    v_pk_fma_f32 v[58:59], v[38:39], v[38:39], v[58:59]
    v_add_f32 v56, v56, v57
    v_add_f32 v58, v58, v59
    s_lshl_b32 s84, s66, 8
    v_add_u32 v60, s84, v22
    v_permlane32_swap_b32 v56, v58
    v_add_f32 v56, v56, v58
    ds_write_b32 v60, v56 offset:6144
    s_waitcnt lgkmcnt(0)
    s_barrier
    ds_write_b128 v115, a[248:251] offset:49152
    ds_write_b128 v115, a[252:255] offset:50176
    s_cmp_lg_u32 s66, 0
    s_cbranch_scc1 Lst_25
    ds_read2st64_b32 v[56:57], v22 offset0:24 offset1:25
    ds_read2st64_b32 v[58:59], v22 offset0:26 offset1:27
    s_waitcnt lgkmcnt(0)
    v_add_f32 v56, v56, v57
    v_add_f32 v58, v58, v59
    v_add_f32 v56, v56, v58
    buffer_store_dword v56, v20, s[40:43], s76 offen offset:512
Lst_25:
    ds_read_b64_tr_b16 v[72:73], v3 offset:0
    ds_read_b64_tr_b16 v[74:75], v3 offset:256
    ds_read_b64_tr_b16 v[76:77], v3 offset:32768
    ds_read_b64_tr_b16 v[78:79], v3 offset:33024
    ds_read_b64_tr_b16 v[80:81], v3 offset:1024
    ds_read_b64_tr_b16 v[82:83], v3 offset:1280
    ds_read_b64_tr_b16 v[84:85], v3 offset:33792
    ds_read_b64_tr_b16 v[86:87], v3 offset:34048
    ds_read_b64_tr_b16 v[88:89], v3 offset:2048
    ds_read_b64_tr_b16 v[90:91], v3 offset:2304
    ds_read_b64_tr_b16 v[92:93], v3 offset:34816
    ds_read_b64_tr_b16 v[94:95], v3 offset:35072
    buffer_load_dword v127, v19, s[40:43], 0 offen sc1
    v_add_u32 v64, s1, v2
    v_add_u32 v65, s82, v2
    ds_write_b128 v64, v[40:43]
    ds_write_b128 v65, v[44:47]
    s_lshl_b32 s84, s66, 10
    v_add_u32 v66, s84, v2
    s_cmp_eq_u32 s66, s0
    s_cbranch_scc0 Lpchk_27
    s_branch L_xown2
L_xpoll2:
    buffer_load_dword v127, v19, s[40:43], 0 offen sc1
    s_sub_u32 s68, s68, 1
    s_cbranch_scc1 L_end
L_xown2:
    s_waitcnt vmcnt(0)
    v_cmp_gt_u32 vcc, 2, v127
    s_cbranch_vccnz L_xpoll2
    s_xor_b32 s96, s70, 8192
    buffer_load_dwordx4 v[160:163], v1, s[44:47], s96 offen offset:0 sc1
    s_waitcnt lgkmcnt(0)
    s_barrier
    ds_read_b128 v[128:131], v2 offset:47104
    ds_read_b128 v[132:135], v66 offset:8192
    ds_read_b128 v[136:139], v66 offset:12288
    ds_read_b128 v[140:143], v66 offset:16384
    ds_read_b128 v[144:147], v66 offset:20480
    ds_read_b128 v[148:151], v66 offset:24576
    ds_read_b128 v[152:155], v66 offset:28672
    ds_read_b128 v[156:159], v2 offset:46080
    s_waitcnt lgkmcnt(0)
    s_branch L_xjoin2
Lpoll_26:
    buffer_load_dword v127, v19, s[40:43], 0 offen sc1
    s_sub_u32 s68, s68, 1
    s_cbranch_scc1 L_end
Lpchk_27:
    s_waitcnt vmcnt(0)
    v_cmp_gt_u32 vcc, 2, v127
    s_cbranch_vccnz Lpoll_26
    s_xor_b32 s96, s70, 0
    buffer_load_dwordx4 v[128:131], v1, s[44:47], s96 offen offset:0 sc1
    buffer_load_dwordx4 v[132:135], v1, s[44:47], s96 offen offset:1024 sc1
    buffer_load_dwordx4 v[136:139], v1, s[44:47], s96 offen offset:2048 sc1
    buffer_load_dwordx4 v[140:143], v1, s[44:47], s96 offen offset:3072 sc1
    s_waitcnt lgkmcnt(0)
    s_barrier
L_xre2:
    s_xor_b32 s96, s70, 4096
    buffer_load_dwordx4 v[144:147], v1, s[44:47], s96 offen offset:0 sc1
    buffer_load_dwordx4 v[148:151], v1, s[44:47], s96 offen offset:1024 sc1
    buffer_load_dwordx4 v[152:155], v1, s[44:47], s96 offen offset:2048 sc1
    buffer_load_dwordx4 v[156:159], v1, s[44:47], s96 offen offset:3072 sc1
    s_xor_b32 s96, s70, 8192
    buffer_load_dwordx4 v[160:163], v1, s[44:47], s96 offen offset:0 sc1
L_xjoin2:
    s_waitcnt vmcnt(8)
    v_mfma_f32_32x32x16_bf16 v[40:55], v[72:75], v[128:131], 0
    ds_read_b64_tr_b16 v[96:97], v3 offset:3072
    ds_read_b64_tr_b16 v[98:99], v3 offset:3328
    buffer_load_dwordx4 v[164:167], v1, s[44:47], s96 offen offset:1024 sc1
    v_mfma_f32_32x32x16_bf16 v[56:71], v[76:79], v[128:131], 0
    ds_read_b64_tr_b16 v[100:101], v3 offset:35840
    ds_read_b64_tr_b16 v[102:103], v3 offset:36096
    s_waitcnt vmcnt(8)
    v_mfma_f32_32x32x16_bf16 v[40:55], v[80:83], v[132:135], v[40:55]
    ds_read_b64_tr_b16 v[72:73], v3 offset:4096
    ds_read_b64_tr_b16 v[74:75], v3 offset:4352
    buffer_load_dwordx4 v[168:171], v1, s[44:47], s96 offen offset:2048 sc1
    v_mfma_f32_32x32x16_bf16 v[56:71], v[84:87], v[132:135], v[56:71]
    ds_read_b64_tr_b16 v[76:77], v3 offset:36864
    ds_read_b64_tr_b16 v[78:79], v3 offset:37120
    v_or3_b32 v12, 0, v128, v132
    s_waitcnt vmcnt(8)
    v_mfma_f32_32x32x16_bf16 v[40:55], v[88:91], v[136:139], v[40:55]
    ds_read_b64_tr_b16 v[80:81], v3 offset:5120
    ds_read_b64_tr_b16 v[82:83], v3 offset:5376
    buffer_load_dwordx4 v[172:175], v1, s[44:47], s96 offen offset:3072 sc1
    v_mfma_f32_32x32x16_bf16 v[56:71], v[92:95], v[136:139], v[56:71]
    ds_read_b64_tr_b16 v[84:85], v3 offset:37888
    ds_read_b64_tr_b16 v[86:87], v3 offset:38144
    ds_read2st64_b32 v[104:105], v22 offset0:0 offset1:1
    ds_read2st64_b32 v[106:107], v22 offset0:2 offset1:3
    s_waitcnt vmcnt(8) lgkmcnt(12)
    v_mfma_f32_32x32x16_bf16 v[40:55], v[96:99], v[140:143], v[40:55]
    ds_read_b64_tr_b16 v[88:89], v3 offset:6144
    ds_read_b64_tr_b16 v[90:91], v3 offset:6400
    s_xor_b32 s96, s70, 12288
    buffer_load_dwordx4 v[176:179], v1, s[44:47], s96 offen offset:0 sc1
    s_waitcnt lgkmcnt(12)
    v_mfma_f32_32x32x16_bf16 v[56:71], v[100:103], v[140:143], v[56:71]
    ds_read_b64_tr_b16 v[92:93], v3 offset:38912
    ds_read_b64_tr_b16 v[94:95], v3 offset:39168
    ds_read2st64_b32 v[108:109], v22 offset0:4 offset1:5
    ds_read2st64_b32 v[110:111], v22 offset0:6 offset1:7
    v_or3_b32 v12, v12, v136, v140
    s_waitcnt vmcnt(8) lgkmcnt(14)
    v_mfma_f32_32x32x16_bf16 v[40:55], v[72:75], v[144:147], v[40:55]
    ds_read_b64_tr_b16 v[96:97], v3 offset:7168
    ds_read_b64_tr_b16 v[98:99], v3 offset:7424
    buffer_load_dwordx4 v[180:183], v1, s[44:47], s96 offen offset:1024 sc1
    s_waitcnt lgkmcnt(14)
    v_mfma_f32_32x32x16_bf16 v[56:71], v[76:79], v[144:147], v[56:71]
    ds_read_b64_tr_b16 v[100:101], v3 offset:39936
    ds_read_b64_tr_b16 v[102:103], v3 offset:40192
    s_waitcnt vmcnt(8) lgkmcnt(14)
    v_mfma_f32_32x32x16_bf16 v[40:55], v[80:83], v[148:151], v[40:55]
    ds_read_b64_tr_b16 v[72:73], v3 offset:8192
    ds_read_b64_tr_b16 v[74:75], v3 offset:8448
    buffer_load_dwordx4 v[184:187], v1, s[44:47], s96 offen offset:2048 sc1
    s_waitcnt lgkmcnt(14)
    v_mfma_f32_32x32x16_bf16 v[56:71], v[84:87], v[148:151], v[56:71]
    ds_read_b64_tr_b16 v[76:77], v3 offset:40960
    ds_read_b64_tr_b16 v[78:79], v3 offset:41216
    v_or3_b32 v12, v12, v144, v148
    s_waitcnt vmcnt(8) lgkmcnt(12)
    v_mfma_f32_32x32x16_bf16 v[40:55], v[88:91], v[152:155], v[40:55]
    ds_read_b64_tr_b16 v[80:81], v3 offset:9216
    ds_read_b64_tr_b16 v[82:83], v3 offset:9472
    buffer_load_dwordx4 v[188:191], v1, s[44:47], s96 offen offset:3072 sc1
    buffer_load_dword v112, v20, s[40:43], s77 offen offset:512 sc1
L_pg5:
    s_cbranch_execz L_partre
    buffer_load_dword v113, v20, s[40:43], s77 offen offset:1536 sc1
    buffer_load_dword v114, v20, s[40:43], s77 offen offset:2560 sc1
    buffer_load_dword v115, v20, s[40:43], s77 offen offset:3584 sc1
    s_waitcnt lgkmcnt(12)
    v_mfma_f32_32x32x16_bf16 v[56:71], v[92:95], v[152:155], v[56:71]
    ds_read_b64_tr_b16 v[84:85], v3 offset:41984
    ds_read_b64_tr_b16 v[86:87], v3 offset:42240
    s_waitcnt lgkmcnt(12)
    v_add_f32 v104, v104, v105
    v_add_f32 v106, v106, v107
    s_waitcnt vmcnt(12) lgkmcnt(10)
    v_mfma_f32_32x32x16_bf16 v[40:55], v[96:99], v[156:159], v[40:55]
    ds_read_b64_tr_b16 v[88:89], v3 offset:10240
    ds_read_b64_tr_b16 v[90:91], v3 offset:10496
    s_xor_b32 s96, s70, 16384
    buffer_load_dwordx4 v[192:195], v1, s[44:47], s96 offen offset:0 sc1
    v_add_f32 v106, v104, v106
    s_waitcnt lgkmcnt(10)
    v_mfma_f32_32x32x16_bf16 v[56:71], v[100:103], v[156:159], v[56:71]
    ds_read_b64_tr_b16 v[92:93], v3 offset:43008
    ds_read_b64_tr_b16 v[94:95], v3 offset:43264
    v_cvt_pk_bf16_f32 v104, v106, v106
    v_and_b32 v107, 0xffff0000, v104
    v_or3_b32 v12, v12, v152, v156
    s_waitcnt vmcnt(12) lgkmcnt(10)
    v_mfma_f32_32x32x16_bf16 v[40:55], v[72:75], v[160:163], v[40:55]
    ds_read_b64_tr_b16 v[96:97], v3 offset:11264
    ds_read_b64_tr_b16 v[98:99], v3 offset:11520
    buffer_load_dwordx4 v[196:199], v1, s[44:47], s96 offen offset:1024 sc1
    v_sub_f32 v107, v106, v107
    s_waitcnt lgkmcnt(10)
    v_mfma_f32_32x32x16_bf16 v[56:71], v[76:79], v[160:163], v[56:71]
    ds_read_b64_tr_b16 v[100:101], v3 offset:44032
    ds_read_b64_tr_b16 v[102:103], v3 offset:44288
    v_cvt_pk_bf16_f32 v105, v107, 0
    v_add_f32 v108, v108, v109
    s_waitcnt vmcnt(12) lgkmcnt(10)
    v_mfma_f32_32x32x16_bf16 v[40:55], v[80:83], v[164:167], v[40:55]
    ds_read_b64_tr_b16 v[72:73], v3 offset:12288
    ds_read_b64_tr_b16 v[74:75], v3 offset:12544
    buffer_load_dwordx4 v[200:203], v1, s[44:47], s96 offen offset:2048 sc1
    v_add_f32 v110, v110, v111
    s_waitcnt lgkmcnt(10)
    v_mfma_f32_32x32x16_bf16 v[56:71], v[84:87], v[164:167], v[56:71]
    ds_read_b64_tr_b16 v[76:77], v3 offset:45056
    ds_read_b64_tr_b16 v[78:79], v3 offset:45312
    v_add_f32 v110, v108, v110
    v_cvt_pk_bf16_f32 v108, v110, v110
    v_or3_b32 v12, v12, v160, v164
    s_waitcnt vmcnt(12) lgkmcnt(10)
    v_mfma_f32_32x32x16_bf16 v[40:55], v[88:91], v[168:171], v[40:55]
    ds_read_b64_tr_b16 v[80:81], v3 offset:13312
    ds_read_b64_tr_b16 v[82:83], v3 offset:13568
    buffer_load_dwordx4 v[204:207], v1, s[44:47], s96 offen offset:3072 sc1
    v_and_b32 v111, 0xffff0000, v108
    s_waitcnt lgkmcnt(10)
    v_mfma_f32_32x32x16_bf16 v[56:71], v[92:95], v[168:171], v[56:71]
    ds_read_b64_tr_b16 v[84:85], v3 offset:46080
    ds_read_b64_tr_b16 v[86:87], v3 offset:46336
    v_sub_f32 v111, v110, v111
    v_cvt_pk_bf16_f32 v109, v111, 0
    s_waitcnt vmcnt(12) lgkmcnt(10)
    v_mfma_f32_32x32x16_bf16 v[40:55], v[96:99], v[172:175], v[40:55]
    ds_read_b64_tr_b16 v[88:89], v3 offset:14336
    ds_read_b64_tr_b16 v[90:91], v3 offset:14592
    s_xor_b32 s96, s70, 20480
    buffer_load_dwordx4 v[208:211], v1, s[44:47], s96 offen offset:0 sc1
    s_waitcnt lgkmcnt(10)
    v_mfma_f32_32x32x16_bf16 v[56:71], v[100:103], v[172:175], v[56:71]
    ds_read_b64_tr_b16 v[92:93], v3 offset:47104
    ds_read_b64_tr_b16 v[94:95], v3 offset:47360
    v_or3_b32 v12, v12, v168, v172
    s_waitcnt vmcnt(12) lgkmcnt(10)
    v_mfma_f32_32x32x16_bf16 v[40:55], v[72:75], v[176:179], v[40:55]
    ds_read_b64_tr_b16 v[96:97], v3 offset:15360
    ds_read_b64_tr_b16 v[98:99], v3 offset:15616
    buffer_load_dwordx4 v[212:215], v1, s[44:47], s96 offen offset:1024 sc1
    s_waitcnt lgkmcnt(10)
    v_mfma_f32_32x32x16_bf16 v[56:71], v[76:79], v[176:179], v[56:71]
    ds_read_b64_tr_b16 v[100:101], v3 offset:48128
    ds_read_b64_tr_b16 v[102:103], v3 offset:48384
    s_waitcnt vmcnt(12) lgkmcnt(10)
    v_mfma_f32_32x32x16_bf16 v[40:55], v[80:83], v[180:183], v[40:55]
    ds_read_b64_tr_b16 v[72:73], v3 offset:16384
    ds_read_b64_tr_b16 v[74:75], v3 offset:16640
    buffer_load_dwordx4 v[216:219], v1, s[44:47], s96 offen offset:2048 sc1
    s_waitcnt lgkmcnt(10)
    v_mfma_f32_32x32x16_bf16 v[56:71], v[84:87], v[180:183], v[56:71]
    ds_read_b64_tr_b16 v[76:77], v3 offset:49152
    ds_read_b64_tr_b16 v[78:79], v3 offset:49408
    v_or3_b32 v12, v12, v176, v180
    s_waitcnt vmcnt(12) lgkmcnt(10)
    v_mfma_f32_32x32x16_bf16 v[40:55], v[88:91], v[184:187], v[40:55]
    ds_read_b64_tr_b16 v[80:81], v3 offset:17408
    ds_read_b64_tr_b16 v[82:83], v3 offset:17664
    buffer_load_dwordx4 v[220:223], v1, s[44:47], s96 offen offset:3072 sc1
    s_waitcnt lgkmcnt(10)
    v_mfma_f32_32x32x16_bf16 v[56:71], v[92:95], v[184:187], v[56:71]
    ds_read_b64_tr_b16 v[84:85], v3 offset:50176
    ds_read_b64_tr_b16 v[86:87], v3 offset:50432
    s_waitcnt vmcnt(12) lgkmcnt(10)
    v_mfma_f32_32x32x16_bf16 v[40:55], v[96:99], v[188:191], v[40:55]
    ds_read_b64_tr_b16 v[88:89], v3 offset:18432
    ds_read_b64_tr_b16 v[90:91], v3 offset:18688
    s_xor_b32 s96, s70, 24576
    buffer_load_dwordx4 v[224:227], v1, s[44:47], s96 offen offset:0 sc1
    s_waitcnt lgkmcnt(10)
    v_mfma_f32_32x32x16_bf16 v[56:71], v[100:103], v[188:191], v[56:71]
    ds_read_b64_tr_b16 v[92:93], v3 offset:51200
    ds_read_b64_tr_b16 v[94:95], v3 offset:51456
    s_waitcnt vmcnt(9)
    v_max3_u32 v120, v112, v113, v114
    v_max_u32 v120, v120, v115
    v_or3_b32 v12, v12, v184, v188
    s_waitcnt vmcnt(8) lgkmcnt(10)
    v_mfma_f32_32x32x16_bf16 v[40:55], v[72:75], v[192:195], v[40:55]
    ds_read_b64_tr_b16 v[96:97], v3 offset:19456
    ds_read_b64_tr_b16 v[98:99], v3 offset:19712
    buffer_load_dwordx4 v[228:231], v1, s[44:47], s96 offen offset:1024 sc1
    v_cmp_eq_u32 vcc, -1, v120
    s_waitcnt lgkmcnt(10)
    v_mfma_f32_32x32x16_bf16 v[56:71], v[76:79], v[192:195], v[56:71]
    ds_read_b64_tr_b16 v[100:101], v3 offset:52224
    ds_read_b64_tr_b16 v[102:103], v3 offset:52480
    s_cbranch_vccnz Lstre_28
Lstok_29:
    s_waitcnt vmcnt(8) lgkmcnt(10)
    v_mfma_f32_32x32x16_bf16 v[40:55], v[80:83], v[196:199], v[40:55]
    ds_read_b64_tr_b16 v[72:73], v3 offset:20480
    ds_read_b64_tr_b16 v[74:75], v3 offset:20736
    buffer_load_dwordx4 v[232:235], v1, s[44:47], s96 offen offset:2048 sc1
    v_add_f32 v112, v112, v113
    s_waitcnt lgkmcnt(10)
    v_mfma_f32_32x32x16_bf16 v[56:71], v[84:87], v[196:199], v[56:71]
    ds_read_b64_tr_b16 v[76:77], v3 offset:53248
    ds_read_b64_tr_b16 v[78:79], v3 offset:53504
    v_add_f32 v114, v114, v115
    v_add_f32 v112, v112, v114
    v_or3_b32 v12, v12, v192, v196
    s_waitcnt vmcnt(8) lgkmcnt(10)
    v_mfma_f32_32x32x16_bf16 v[40:55], v[88:91], v[200:203], v[40:55]
    ds_read_b64_tr_b16 v[80:81], v3 offset:21504
    ds_read_b64_tr_b16 v[82:83], v3 offset:21760
    buffer_load_dwordx4 v[236:239], v1, s[44:47], s96 offen offset:3072 sc1
    v_mul_f32 v112, 0x3b000000, v112
    s_waitcnt lgkmcnt(10)
    v_mfma_f32_32x32x16_bf16 v[56:71], v[92:95], v[200:203], v[56:71]
    ds_read_b64_tr_b16 v[84:85], v3 offset:54272
    ds_read_b64_tr_b16 v[86:87], v3 offset:54528
    v_mov_b32 v113, v112
    v_cmp_gt_u32 vcc, 32, v0
    s_waitcnt vmcnt(8) lgkmcnt(10)
    v_mfma_f32_32x32x16_bf16 v[40:55], v[96:99], v[204:207], v[40:55]
    ds_read_b64_tr_b16 v[88:89], v3 offset:22528
    ds_read_b64_tr_b16 v[90:91], v3 offset:22784
    s_xor_b32 s96, s70, 28672
    buffer_load_dwordx4 v[240:243], v1, s[44:47], s96 offen offset:0 sc1
    v_permlane32_swap_b32 v112, v113
    s_waitcnt lgkmcnt(10)
    v_mfma_f32_32x32x16_bf16 v[56:71], v[100:103], v[204:207], v[56:71]
    ds_read_b64_tr_b16 v[92:93], v3 offset:55296
    ds_read_b64_tr_b16 v[94:95], v3 offset:55552
    v_fma_f32 v113, -v112, v112, v113
    v_cndmask_b32 v112, 0, v112, vcc
    v_or3_b32 v12, v12, v200, v204
    s_waitcnt vmcnt(8) lgkmcnt(10)
    v_mfma_f32_32x32x16_bf16 v[40:55], v[72:75], v[208:211], v[40:55]
    ds_read_b64_tr_b16 v[96:97], v3 offset:23552
    ds_read_b64_tr_b16 v[98:99], v3 offset:23808
    buffer_load_dwordx4 v[244:247], v1, s[44:47], s96 offen offset:1024 sc1
    v_max_f32 v113, 0, v113
    s_waitcnt lgkmcnt(10)
    v_mfma_f32_32x32x16_bf16 v[56:71], v[76:79], v[208:211], v[56:71]
    ds_read_b64_tr_b16 v[100:101], v3 offset:56320
    ds_read_b64_tr_b16 v[102:103], v3 offset:56576
    v_add_f32 v113, 0x3727c5ac, v113
    v_rsq_f32 v120, v113
    s_waitcnt vmcnt(8) lgkmcnt(10)
    v_mfma_f32_32x32x16_bf16 v[40:55], v[80:83], v[212:215], v[40:55]
    ds_read_b64_tr_b16 v[72:73], v3 offset:24576
    ds_read_b64_tr_b16 v[74:75], v3 offset:24832
    buffer_load_dwordx4 v[248:251], v1, s[44:47], s96 offen offset:2048 sc1
    v_cvt_pk_bf16_f32 v117, -v112, 0
    s_waitcnt lgkmcnt(10)
    v_mfma_f32_32x32x16_bf16 v[56:71], v[84:87], v[212:215], v[56:71]
    ds_read_b64_tr_b16 v[76:77], v3 offset:57344
    ds_read_b64_tr_b16 v[78:79], v3 offset:57600
    v_lshlrev_b32 v114, 16, v117
    v_sub_f32 v114, -v112, v114
    v_or3_b32 v12, v12, v208, v212
    s_waitcnt vmcnt(8) lgkmcnt(10)
    v_mfma_f32_32x32x16_bf16 v[40:55], v[88:91], v[216:219], v[40:55]
    ds_read_b64_tr_b16 v[80:81], v3 offset:25600
    ds_read_b64_tr_b16 v[82:83], v3 offset:25856
    buffer_load_dwordx4 v[252:255], v1, s[44:47], s96 offen offset:3072 sc1
    v_cvt_pk_bf16_f32 v116, -v112, v114
    s_waitcnt lgkmcnt(10)
    v_mfma_f32_32x32x16_bf16 v[56:71], v[92:95], v[216:219], v[56:71]
    ds_read_b64_tr_b16 v[84:85], v3 offset:58368
    ds_read_b64_tr_b16 v[86:87], v3 offset:58624
    v_mul_f32 v118, 0x3fb8aa3b, v120
    s_waitcnt vmcnt(8) lgkmcnt(10)
    v_mfma_f32_32x32x16_bf16 v[40:55], v[96:99], v[220:223], v[40:55]
    ds_read_b64_tr_b16 v[88:89], v3 offset:26624
    ds_read_b64_tr_b16 v[90:91], v3 offset:26880
    s_waitcnt lgkmcnt(10)
    v_mfma_f32_32x32x16_bf16 v[56:71], v[100:103], v[220:223], v[56:71]
    ds_read_b64_tr_b16 v[92:93], v3 offset:59392
    ds_read_b64_tr_b16 v[94:95], v3 offset:59648
    v_or3_b32 v12, v12, v216, v220
    s_waitcnt vmcnt(7) lgkmcnt(10)
    v_mfma_f32_32x32x16_bf16 v[40:55], v[72:75], v[224:227], v[40:55]
    ds_read_b64_tr_b16 v[96:97], v3 offset:27648
    ds_read_b64_tr_b16 v[98:99], v3 offset:27904
    s_waitcnt lgkmcnt(10)
    v_mfma_f32_32x32x16_bf16 v[56:71], v[76:79], v[224:227], v[56:71]
    ds_read_b64_tr_b16 v[100:101], v3 offset:60416
    ds_read_b64_tr_b16 v[102:103], v3 offset:60672
    s_waitcnt vmcnt(6) lgkmcnt(10)
    v_mfma_f32_32x32x16_bf16 v[40:55], v[80:83], v[228:231], v[40:55]
    ds_read_b64_tr_b16 v[72:73], v3 offset:28672
    ds_read_b64_tr_b16 v[74:75], v3 offset:28928
    s_waitcnt lgkmcnt(10)
    v_mfma_f32_32x32x16_bf16 v[56:71], v[84:87], v[228:231], v[56:71]
    ds_read_b64_tr_b16 v[76:77], v3 offset:61440
    ds_read_b64_tr_b16 v[78:79], v3 offset:61696
    v_or3_b32 v12, v12, v224, v228
    s_waitcnt vmcnt(5) lgkmcnt(10)
    v_mfma_f32_32x32x16_bf16 v[40:55], v[88:91], v[232:235], v[40:55]
    ds_read_b64_tr_b16 v[80:81], v3 offset:29696
    ds_read_b64_tr_b16 v[82:83], v3 offset:29952
    s_waitcnt lgkmcnt(10)
    v_mfma_f32_32x32x16_bf16 v[56:71], v[92:95], v[232:235], v[56:71]
    ds_read_b64_tr_b16 v[84:85], v3 offset:30720
    ds_read_b64_tr_b16 v[86:87], v3 offset:30976
    s_waitcnt vmcnt(4) lgkmcnt(10)
    v_mfma_f32_32x32x16_bf16 v[40:55], v[96:99], v[236:239], v[40:55]
    ds_read_b64_tr_b16 v[88:89], v3 offset:31744
    ds_read_b64_tr_b16 v[90:91], v3 offset:32000
    s_waitcnt lgkmcnt(10)
    v_mfma_f32_32x32x16_bf16 v[56:71], v[100:103], v[236:239], v[56:71]
    ds_read_b64_tr_b16 v[92:93], v3 offset:62464
    ds_read_b64_tr_b16 v[94:95], v3 offset:62720
    v_or3_b32 v12, v12, v232, v236
    s_waitcnt vmcnt(3) lgkmcnt(10)
    v_mfma_f32_32x32x16_bf16 v[40:55], v[72:75], v[240:243], v[40:55]
    ds_read_b64_tr_b16 v[96:97], v3 offset:63488
    ds_read_b64_tr_b16 v[98:99], v3 offset:63744
    v_mfma_f32_32x32x8_bf16 v[40:55], v[104:105], v[116:117], v[40:55]
    s_waitcnt lgkmcnt(10)
    v_mfma_f32_32x32x16_bf16 v[56:71], v[76:79], v[240:243], v[56:71]
    ds_read_b64_tr_b16 v[100:101], v3 offset:64512
    ds_read_b64_tr_b16 v[102:103], v3 offset:64768
    v_mfma_f32_32x32x8_bf16 v[56:71], v[108:109], v[116:117], v[56:71]
    s_waitcnt vmcnt(2) lgkmcnt(10)
    v_mfma_f32_32x32x16_bf16 v[40:55], v[80:83], v[244:247], v[40:55]
    s_add_u32 s95, s11, 4096
    buffer_load_dwordx4 a[248:251], v1, s[40:43], s95 offen offset:2048 sc1
    s_waitcnt vmcnt(2) lgkmcnt(8)
    v_mfma_f32_32x32x16_bf16 v[40:55], v[84:87], v[248:251], v[40:55]
    buffer_load_dwordx4 a[252:255], v1, s[40:43], s95 offen offset:3072 sc1
    ds_read_b128 v[104:107], v2 offset:32768
    ds_read_b128 v[108:111], v2 offset:33792
    v_or3_b32 v12, v12, v240, v244
    s_waitcnt vmcnt(2) lgkmcnt(8)
    v_mfma_f32_32x32x16_bf16 v[40:55], v[88:91], v[252:255], v[40:55]
    v_or3_b32 v12, v12, v248, v252
    s_waitcnt lgkmcnt(6)
    v_mfma_f32_32x32x16_bf16 v[56:71], v[92:95], v[244:247], v[56:71]
    v_and_b32 v12, 1, v12
    v_cmp_ne_u32 vcc, 0, v12
    s_waitcnt lgkmcnt(4)
    v_mfma_f32_32x32x16_bf16 v[56:71], v[96:99], v[248:251], v[56:71]
    v_cvt_pk_bf16_f32 v40, v40, v41
    v_cvt_pk_bf16_f32 v41, v42, v43
    v_cvt_pk_bf16_f32 v42, v44, v45
    v_cvt_pk_bf16_f32 v43, v46, v47
    s_waitcnt lgkmcnt(2)
    v_mfma_f32_32x32x16_bf16 v[56:71], v[100:103], v[252:255], v[56:71]
    v_cvt_pk_bf16_f32 v44, v48, v49
    v_cvt_pk_bf16_f32 v45, v50, v51
    v_cvt_pk_bf16_f32 v46, v52, v53
    v_cvt_pk_bf16_f32 v47, v54, v55
    s_waitcnt lgkmcnt(0)
    v_mfma_f32_32x32x16_bf16 v[72:87], v[104:107], v[40:43], 0
    s_cbranch_vccnz L_xbad2
    v_mfma_f32_32x32x16_bf16 v[88:103], v[108:111], v[44:47], 0
    v_mul_f32 v56, v56, v120
    v_mul_f32 v57, v57, v120
    v_mul_f32 v58, v58, v120
    v_mul_f32 v59, v59, v120
    v_mul_f32 v60, v60, v120
    v_mul_f32 v61, v61, v120
    v_mul_f32 v62, v62, v120
    v_mul_f32_e64 v63, v63, v120
    v_cvt_pk_bf16_f32 v56, v56, v57
    v_cvt_pk_bf16_f32 v57, v58, v59
    v_cvt_pk_bf16_f32 v58, v60, v61
    v_cvt_pk_bf16_f32 v59, v62, v63
    ds_write_b128 v8, v[56:59]
    v_pk_mul_f32 v[64:65], v[64:65], v[120:121] op_sel_hi:[1,0]
    v_pk_mul_f32 v[66:67], v[66:67], v[120:121] op_sel_hi:[1,0]
    v_pk_mul_f32 v[68:69], v[68:69], v[120:121] op_sel_hi:[1,0]
    v_pk_mul_f32 v[70:71], v[70:71], v[120:121] op_sel_hi:[1,0]
    v_cvt_pk_bf16_f32 v60, v64, v65
    v_cvt_pk_bf16_f32 v61, v66, v67
    v_cvt_pk_bf16_f32 v62, v68, v69
    v_cvt_pk_bf16_f32 v63, v70, v71
    v_max3_f32 v122, v72, v73, v74
    v_max3_f32 v123, v75, v76, v77
    v_max3_f32 v122, v122, v78, v79
    v_max3_f32 v123, v123, v80, v81
    v_max3_f32 v122, v122, v82, v83
    v_max3_f32 v123, v123, v84, v85
    ds_write_b128 v8, v[60:63] offset:4096
    v_max3_f32 v122, v122, v86, v87
    v_max_f32_e64 v122, v122, v123
    v_mul_f32 v119, -v122, v118
    v_pk_fma_f32 v[72:73], v[72:73], v[118:119], v[118:119] op_sel:[0,0,1] op_sel_hi:[1,0,1]
    v_pk_fma_f32 v[74:75], v[74:75], v[118:119], v[118:119] op_sel:[0,0,1] op_sel_hi:[1,0,1]
    v_pk_fma_f32 v[76:77], v[76:77], v[118:119], v[118:119] op_sel:[0,0,1] op_sel_hi:[1,0,1]
    v_pk_fma_f32 v[78:79], v[78:79], v[118:119], v[118:119] op_sel:[0,0,1] op_sel_hi:[1,0,1]
    v_pk_fma_f32 v[80:81], v[80:81], v[118:119], v[118:119] op_sel:[0,0,1] op_sel_hi:[1,0,1]
    v_pk_fma_f32 v[82:83], v[82:83], v[118:119], v[118:119] op_sel:[0,0,1] op_sel_hi:[1,0,1]
    v_pk_fma_f32 v[84:85], v[84:85], v[118:119], v[118:119] op_sel:[0,0,1] op_sel_hi:[1,0,1]
    v_pk_fma_f32 v[86:87], v[86:87], v[118:119], v[118:119] op_sel:[0,0,1] op_sel_hi:[1,0,1]
    v_exp_f32 v72, v72
    v_exp_f32 v73, v73
    v_exp_f32 v74, v74
    v_exp_f32 v75, v75
    v_exp_f32 v76, v76
    v_exp_f32 v77, v77
    v_exp_f32 v78, v78
    v_exp_f32 v79, v79
    v_exp_f32 v80, v80
    v_exp_f32 v81, v81
    v_exp_f32 v82, v82
    v_exp_f32 v83, v83
    v_exp_f32 v84, v84
    v_exp_f32 v85, v85
    v_exp_f32 v86, v86
    v_exp_f32 v87, v87
    v_pk_add_f32 v[124:125], v[72:73], v[74:75]
    v_pk_add_f32 v[126:127], v[76:77], v[78:79]
    v_pk_add_f32 v[124:125], v[124:125], v[80:81]
    v_pk_add_f32 v[126:127], v[126:127], v[82:83]
    v_pk_add_f32 v[124:125], v[124:125], v[84:85]
    v_pk_add_f32 v[126:127], v[126:127], v[86:87]
    v_pk_add_f32 v[124:125], v[124:125], v[126:127]
    v_add_f32 v124, v124, v125
    v_rcp_f32_e64 v124, v124
    s_nop 0
    v_pk_mul_f32 v[72:73], v[72:73], v[124:125] op_sel_hi:[1,0]
    v_pk_mul_f32 v[74:75], v[74:75], v[124:125] op_sel_hi:[1,0]
    v_pk_mul_f32 v[76:77], v[76:77], v[124:125] op_sel_hi:[1,0]
    v_pk_mul_f32 v[78:79], v[78:79], v[124:125] op_sel_hi:[1,0]
    v_cvt_pk_bf16_f32 v72, v72, v73
    v_cvt_pk_bf16_f32 v73, v74, v75
    v_cvt_pk_bf16_f32 v74, v76, v77
    v_cvt_pk_bf16_f32 v75, v78, v79
    ds_write_b128 v6, v[72:75]
    v_pk_mul_f32 v[80:81], v[80:81], v[124:125] op_sel_hi:[1,0]
    v_pk_mul_f32 v[82:83], v[82:83], v[124:125] op_sel_hi:[1,0]
    v_pk_mul_f32 v[84:85], v[84:85], v[124:125] op_sel_hi:[1,0]
    v_pk_mul_f32 v[86:87], v[86:87], v[124:125] op_sel_hi:[1,0]
    v_cvt_pk_bf16_f32 v76, v80, v81
    v_cvt_pk_bf16_f32 v77, v82, v83
    v_cvt_pk_bf16_f32 v78, v84, v85
    v_cvt_pk_bf16_f32 v79, v86, v87
    v_max3_f32 v122, v88, v89, v90
    v_max3_f32 v123, v91, v92, v93
    v_max3_f32 v122, v122, v94, v95
    v_max3_f32 v123, v123, v96, v97
    v_max3_f32 v122, v122, v98, v99
    v_max3_f32 v123, v123, v100, v101
    ds_write_b128 v7, v[76:79]
    v_max3_f32 v122, v122, v102, v103
    v_max_f32_e64 v122, v122, v123
    v_mul_f32 v119, -v122, v118
    v_pk_fma_f32 v[88:89], v[88:89], v[118:119], v[118:119] op_sel:[0,0,1] op_sel_hi:[1,0,1]
    v_pk_fma_f32 v[90:91], v[90:91], v[118:119], v[118:119] op_sel:[0,0,1] op_sel_hi:[1,0,1]
    v_pk_fma_f32 v[92:93], v[92:93], v[118:119], v[118:119] op_sel:[0,0,1] op_sel_hi:[1,0,1]
    v_pk_fma_f32 v[94:95], v[94:95], v[118:119], v[118:119] op_sel:[0,0,1] op_sel_hi:[1,0,1]
    v_pk_fma_f32 v[96:97], v[96:97], v[118:119], v[118:119] op_sel:[0,0,1] op_sel_hi:[1,0,1]
    v_pk_fma_f32 v[98:99], v[98:99], v[118:119], v[118:119] op_sel:[0,0,1] op_sel_hi:[1,0,1]
    v_pk_fma_f32 v[100:101], v[100:101], v[118:119], v[118:119] op_sel:[0,0,1] op_sel_hi:[1,0,1]
    v_pk_fma_f32 v[102:103], v[102:103], v[118:119], v[118:119] op_sel:[0,0,1] op_sel_hi:[1,0,1]
    v_exp_f32 v88, v88
    v_exp_f32 v89, v89
    v_exp_f32 v90, v90
    v_exp_f32 v91, v91
    v_exp_f32 v92, v92
    v_exp_f32 v93, v93
    v_exp_f32 v94, v94
    v_exp_f32 v95, v95
    v_exp_f32 v96, v96
    v_exp_f32 v97, v97
    v_exp_f32 v98, v98
    v_exp_f32 v99, v99
    v_exp_f32 v100, v100
    v_exp_f32 v101, v101
    v_exp_f32 v102, v102
    v_exp_f32 v103, v103
    v_pk_add_f32 v[124:125], v[88:89], v[90:91]
    v_pk_add_f32 v[126:127], v[92:93], v[94:95]
    v_pk_add_f32 v[124:125], v[124:125], v[96:97]
    v_pk_add_f32 v[126:127], v[126:127], v[98:99]
    v_pk_add_f32 v[124:125], v[124:125], v[100:101]
    v_pk_add_f32 v[126:127], v[126:127], v[102:103]
    v_pk_add_f32 v[124:125], v[124:125], v[126:127]
    v_add_f32 v124, v124, v125
    v_rcp_f32_e64 v124, v124
    s_nop 0
    v_pk_mul_f32 v[88:89], v[88:89], v[124:125] op_sel_hi:[1,0]
    v_pk_mul_f32 v[90:91], v[90:91], v[124:125] op_sel_hi:[1,0]
    v_pk_mul_f32 v[92:93], v[92:93], v[124:125] op_sel_hi:[1,0]
    v_pk_mul_f32 v[94:95], v[94:95], v[124:125] op_sel_hi:[1,0]
    v_cvt_pk_bf16_f32 v88, v88, v89
    v_cvt_pk_bf16_f32 v89, v90, v91
    v_cvt_pk_bf16_f32 v90, v92, v93
    v_cvt_pk_bf16_f32 v91, v94, v95
    ds_write_b128 v6, v[88:91] offset:8192
    v_pk_mul_f32 v[96:97], v[96:97], v[124:125] op_sel_hi:[1,0]
    v_pk_mul_f32 v[98:99], v[98:99], v[124:125] op_sel_hi:[1,0]
    v_pk_mul_f32 v[100:101], v[100:101], v[124:125] op_sel_hi:[1,0]
    v_pk_mul_f32 v[102:103], v[102:103], v[124:125] op_sel_hi:[1,0]
    v_cvt_pk_bf16_f32 v92, v96, v97
    v_cvt_pk_bf16_f32 v93, v98, v99
    v_cvt_pk_bf16_f32 v94, v100, v101
    v_cvt_pk_bf16_f32 v95, v102, v103
    ds_write_b128 v7, v[92:95] offset:8192
    v_mov_b32 v64, 0x3f803f80
    v_mov_b32 v65, 0x3f803f80
    v_mov_b32 v66, 0x3f803f80
    v_mov_b32 v67, 0x3f803f80
    s_waitcnt lgkmcnt(0)
    s_barrier
    ds_read_b64_tr_b16 v[72:73], v9 offset:0
    ds_read_b64_tr_b16 v[74:75], v9 offset:512
    ds_read_b64_tr_b16 v[76:77], v10 offset:0
    ds_read_b64_tr_b16 v[78:79], v10 offset:512
    ds_read_b64_tr_b16 v[80:81], v9 offset:1024
    ds_read_b64_tr_b16 v[82:83], v9 offset:1536
    ds_read_b64_tr_b16 v[84:85], v10 offset:1024
    ds_read_b64_tr_b16 v[86:87], v10 offset:1536
    ds_read_b64_tr_b16 v[88:89], v9 offset:2048
    ds_read_b64_tr_b16 v[90:91], v9 offset:2560
    ds_read_b64_tr_b16 v[92:93], v10 offset:2048
    ds_read_b64_tr_b16 v[94:95], v10 offset:2560
    ds_read_b64_tr_b16 v[96:97], v9 offset:3072
    ds_read_b64_tr_b16 v[98:99], v9 offset:3584
    ds_read_b64_tr_b16 v[100:101], v10 offset:3072
    s_add_u32 m0, s81, 0
    ds_read_b64_tr_b16 v[102:103], v10 offset:3584
    buffer_load_dwordx4 v5, s[40:43], m0 offen offset:0 sc1 lds
    s_waitcnt lgkmcnt(12)
    v_mfma_f32_16x16x32_bf16 v[56:59], v[72:75], v[76:79], 0
    v_mfma_f32_16x16x32_bf16 v[60:63], v[72:75], v[64:67], 0
    s_waitcnt lgkmcnt(8)
    v_mfma_f32_16x16x32_bf16 v[56:59], v[80:83], v[84:87], v[56:59]
    v_mfma_f32_16x16x32_bf16 v[60:63], v[80:83], v[64:67], v[60:63]
    s_waitcnt lgkmcnt(4)
    v_mfma_f32_16x16x32_bf16 v[56:59], v[88:91], v[92:95], v[56:59]
    v_mfma_f32_16x16x32_bf16 v[60:63], v[88:91], v[64:67], v[60:63]
    s_waitcnt lgkmcnt(0)
    v_mfma_f32_16x16x32_bf16 v[56:59], v[96:99], v[100:103], v[56:59]
    v_mfma_f32_16x16x32_bf16 v[60:63], v[96:99], v[64:67], v[60:63]
    v_mov_b32 v40, 2
    s_add_u32 s84, s74, 1114112
    ds_read_b64_tr_b16 v[72:73], v4 offset:0
    ds_read_b64_tr_b16 v[74:75], v4 offset:256
    ds_read_b64_tr_b16 v[76:77], v4 offset:1024
    ds_read_b64_tr_b16 v[78:79], v4 offset:1280
    v_cvt_pk_bf16_f32 v56, v56, v57
    v_cvt_pk_bf16_f32 v57, v58, v59
    v_cvt_pk_bf16_f32 v58, v60, v61
    v_cvt_pk_bf16_f32 v59, v62, v63
    s_nop 0
    v_permlane32_swap_b32 v56, v58
    v_permlane32_swap_b32 v57, v59
    s_mov_b32 exec_hi, 0x00010001
    buffer_store_dwordx4 v[56:59], v11, s[40:43], s84 offen sc1
    s_mov_b64 exec, 1
    buffer_store_dword v40, off, s[40:43], s78 offset:1088
    s_mov_b64 exec, -1
    s_nop 0
    ds_read_b64_tr_b16 v[80:81], v4 offset:2048
    ds_read_b64_tr_b16 v[82:83], v4 offset:2304
    ds_read_b64_tr_b16 v[84:85], v4 offset:3072
    ds_read_b64_tr_b16 v[86:87], v4 offset:3328
    ds_read_b64_tr_b16 v[88:89], v4 offset:4096
    ds_read_b64_tr_b16 v[90:91], v4 offset:4352
    ds_read_b64_tr_b16 v[92:93], v4 offset:5120
    ds_read_b64_tr_b16 v[94:95], v4 offset:5376
    s_waitcnt lgkmcnt(10)
    v_mfma_f32_32x32x16_bf16 v[40:55], v[72:75], v[128:131], 0
    ds_read_b64_tr_b16 v[96:97], v4 offset:6144
    ds_read_b64_tr_b16 v[98:99], v4 offset:6400
    buffer_load_dwordx4 v5, s[40:43], m0 offen offset:1024 sc1 lds
    s_waitcnt lgkmcnt(10)
    v_mfma_f32_32x32x16_bf16 v[40:55], v[76:79], v[132:135], v[40:55]
    ds_read_b64_tr_b16 v[100:101], v4 offset:7168
    ds_read_b64_tr_b16 v[102:103], v4 offset:7424
    s_waitcnt lgkmcnt(10)
    v_mfma_f32_32x32x16_bf16 v[40:55], v[80:83], v[136:139], v[40:55]
    ds_read_b64_tr_b16 v[72:73], v4 offset:8192
    s_add_u32 m0, s81, 32768
    ds_read_b64_tr_b16 v[74:75], v4 offset:8448
    buffer_load_dwordx4 v5, s[40:43], m0 offen offset:0 sc1 lds
    s_waitcnt lgkmcnt(10)
    v_mfma_f32_32x32x16_bf16 v[40:55], v[84:87], v[140:143], v[40:55]
    ds_read_b64_tr_b16 v[76:77], v4 offset:9216
    ds_read_b64_tr_b16 v[78:79], v4 offset:9472
    s_waitcnt lgkmcnt(10)
    v_mfma_f32_32x32x16_bf16 v[40:55], v[88:91], v[144:147], v[40:55]
    ds_read_b64_tr_b16 v[80:81], v4 offset:10240
    ds_read_b64_tr_b16 v[82:83], v4 offset:10496
    ds_read2st64_b32 v[112:113], v22 offset0:8 offset1:9
    ds_read2st64_b32 v[114:115], v22 offset0:10 offset1:11
    buffer_load_dwordx4 v5, s[40:43], m0 offen offset:1024 sc1 lds
    s_waitcnt lgkmcnt(12)
    v_mfma_f32_32x32x16_bf16 v[40:55], v[92:95], v[148:151], v[40:55]
    ds_read_b64_tr_b16 v[84:85], v4 offset:11264
    ds_read_b64_tr_b16 v[86:87], v4 offset:11520
    s_waitcnt lgkmcnt(12)
    v_mfma_f32_32x32x16_bf16 v[40:55], v[96:99], v[152:155], v[40:55]
    ds_read_b64_tr_b16 v[88:89], v4 offset:12288
    ds_read_b64_tr_b16 v[90:91], v4 offset:12544
    s_waitcnt lgkmcnt(12)
    v_mfma_f32_32x32x16_bf16 v[40:55], v[100:103], v[156:159], v[40:55]
    ds_read_b64_tr_b16 v[92:93], v4 offset:13312
    ds_read_b64_tr_b16 v[94:95], v4 offset:13568
    s_waitcnt lgkmcnt(12)
    v_mfma_f32_32x32x16_bf16 v[40:55], v[72:75], v[160:163], v[40:55]
    ds_read_b64_tr_b16 v[96:97], v4 offset:14336
    ds_read_b64_tr_b16 v[98:99], v4 offset:14592
    s_waitcnt lgkmcnt(8)
    v_add_f32 v112, v112, v113
    v_add_f32 v114, v114, v115
    v_add_f32 v114, v112, v114
    v_mfma_f32_32x32x16_bf16 v[40:55], v[76:79], v[164:167], v[40:55]
    ds_read_b64_tr_b16 v[100:101], v4 offset:15360
    ds_read_b64_tr_b16 v[102:103], v4 offset:15616
    v_cvt_pk_bf16_f32 v112, v114, v114
    v_and_b32 v115, 0xffff0000, v112
    v_sub_f32 v115, v114, v115
    v_mfma_f32_32x32x16_bf16 v[40:55], v[80:83], v[168:171], v[40:55]
    ds_read_b64_tr_b16 v[72:73], v4 offset:16384
    ds_read_b64_tr_b16 v[74:75], v4 offset:16640
    v_cvt_pk_bf16_f32 v113, v115, 0
    s_waitcnt lgkmcnt(10)
    v_mfma_f32_32x32x16_bf16 v[40:55], v[84:87], v[172:175], v[40:55]
    ds_read_b64_tr_b16 v[76:77], v4 offset:17408
    ds_read_b64_tr_b16 v[78:79], v4 offset:17664
    s_waitcnt lgkmcnt(10)
    v_mfma_f32_32x32x16_bf16 v[40:55], v[88:91], v[176:179], v[40:55]
    ds_read_b64_tr_b16 v[80:81], v4 offset:18432
    ds_read_b64_tr_b16 v[82:83], v4 offset:18688
    s_waitcnt lgkmcnt(10)
    v_mfma_f32_32x32x16_bf16 v[40:55], v[92:95], v[180:183], v[40:55]
    ds_read_b64_tr_b16 v[84:85], v4 offset:19456
    ds_read_b64_tr_b16 v[86:87], v4 offset:19712
    v_mfma_f32_32x32x8_bf16 v[40:55], v[112:113], v[116:117], v[40:55]
    s_waitcnt lgkmcnt(10)
    v_mfma_f32_32x32x16_bf16 v[40:55], v[96:99], v[184:187], v[40:55]
    ds_read_b64_tr_b16 v[88:89], v4 offset:20480
    ds_read_b64_tr_b16 v[90:91], v4 offset:20736
    s_waitcnt lgkmcnt(10)
    v_mfma_f32_32x32x16_bf16 v[40:55], v[100:103], v[188:191], v[40:55]
    ds_read_b64_tr_b16 v[92:93], v4 offset:21504
    ds_read_b64_tr_b16 v[94:95], v4 offset:21760
    s_waitcnt lgkmcnt(10)
    v_mfma_f32_32x32x16_bf16 v[40:55], v[72:75], v[192:195], v[40:55]
    ds_read_b64_tr_b16 v[96:97], v4 offset:22528
    ds_read_b64_tr_b16 v[98:99], v4 offset:22784
    s_add_u32 s12, s75, 1114112
    s_waitcnt lgkmcnt(10)
    v_mfma_f32_32x32x16_bf16 v[40:55], v[76:79], v[196:199], v[40:55]
    ds_read_b64_tr_b16 v[100:101], v4 offset:23552
    ds_read_b64_tr_b16 v[102:103], v4 offset:23808
    s_add_u32 s13, s75, 1253376
    s_waitcnt lgkmcnt(10)
    v_mfma_f32_32x32x16_bf16 v[40:55], v[80:83], v[200:203], v[40:55]
    ds_read_b64_tr_b16 v[72:73], v4 offset:49152
    ds_read_b64_tr_b16 v[74:75], v4 offset:49408
    s_add_u32 s14, s75, 1392640
    s_waitcnt lgkmcnt(10)
    v_mfma_f32_32x32x16_bf16 v[40:55], v[84:87], v[204:207], v[40:55]
    ds_read_b64_tr_b16 v[76:77], v4 offset:50176
    ds_read_b64_tr_b16 v[78:79], v4 offset:50432
    s_add_u32 s15, s75, 1531904
    s_waitcnt lgkmcnt(10)
L_pg6:
    s_cbranch_execz L_pgret1
    v_mfma_f32_32x32x16_bf16 v[40:55], v[88:91], v[208:211], v[40:55]
    ds_read_b64_tr_b16 v[80:81], v4 offset:51200
    ds_read_b64_tr_b16 v[82:83], v4 offset:51456
    s_mov_b32 s67, 2
    s_waitcnt lgkmcnt(10)
    v_mfma_f32_32x32x16_bf16 v[40:55], v[92:95], v[212:215], v[40:55]
    ds_read_b64_tr_b16 v[84:85], v4 offset:52224
    ds_read_b64_tr_b16 v[86:87], v4 offset:52480
    buffer_load_dwordx4 v[132:135], v13, s[40:43], s12 offen offset:0 sc1
    s_waitcnt lgkmcnt(10)
    v_mfma_f32_32x32x16_bf16 v[40:55], v[96:99], v[216:219], v[40:55]
    ds_read_b64_tr_b16 v[88:89], v4 offset:53248
    ds_read_b64_tr_b16 v[90:91], v4 offset:53504
    buffer_load_dwordx4 v[136:139], v13, s[40:43], s12 offen offset:256 sc1
    s_waitcnt lgkmcnt(10)
    v_mfma_f32_32x32x16_bf16 v[40:55], v[100:103], v[220:223], v[40:55]
    ds_read_b64_tr_b16 v[92:93], v4 offset:54272
    ds_read_b64_tr_b16 v[94:95], v4 offset:54528
    buffer_load_dwordx4 v[140:143], v13, s[40:43], s13 offen offset:0 sc1
    s_waitcnt lgkmcnt(10)
    v_mfma_f32_32x32x16_bf16 v[40:55], v[72:75], v[224:227], v[40:55]
    ds_read_b64_tr_b16 v[96:97], v4 offset:55296
    ds_read_b64_tr_b16 v[98:99], v4 offset:55552
    buffer_load_dwordx4 v[144:147], v13, s[40:43], s13 offen offset:256 sc1
    s_waitcnt lgkmcnt(10)
    v_mfma_f32_32x32x16_bf16 v[40:55], v[76:79], v[228:231], v[40:55]
    ds_read_b64_tr_b16 v[100:101], v4 offset:56320
    ds_read_b64_tr_b16 v[102:103], v4 offset:56576
    buffer_load_dwordx4 v[128:131], v14, s[40:43], s12 offen sc1
    s_waitcnt lgkmcnt(10)
    v_mfma_f32_32x32x16_bf16 v[40:55], v[80:83], v[232:235], v[40:55]
    buffer_load_dwordx4 v[148:151], v13, s[40:43], s14 offen offset:0 sc1
    s_waitcnt lgkmcnt(8)
    v_mfma_f32_32x32x16_bf16 v[40:55], v[84:87], v[236:239], v[40:55]
    buffer_load_dwordx4 v[152:155], v13, s[40:43], s14 offen offset:256 sc1
    s_waitcnt lgkmcnt(6)
    v_mfma_f32_32x32x16_bf16 v[40:55], v[88:91], v[240:243], v[40:55]
    buffer_load_dwordx4 v[156:159], v13, s[40:43], s15 offen offset:0 sc1
    s_waitcnt lgkmcnt(4)
    v_mfma_f32_32x32x16_bf16 v[40:55], v[92:95], v[244:247], v[40:55]
    buffer_load_dwordx4 v[160:163], v13, s[40:43], s15 offen offset:256 sc1
    s_waitcnt lgkmcnt(2)
    v_mfma_f32_32x32x16_bf16 v[40:55], v[96:99], v[248:251], v[40:55]
    s_waitcnt lgkmcnt(0)
    v_mfma_f32_32x32x16_bf16 v[40:55], v[100:103], v[252:255], v[40:55]
    buffer_load_dword v164, v19, s[40:43], 0 offen offset:64 sc1
    ds_read_b128 v[192:195], v2 offset:36864
    ds_read_b128 v[196:199], v2 offset:37888
    s_nop 8
    v_cvt_pk_bf16_f32 v40, v40, v41
    v_cvt_pk_bf16_f32 v41, v42, v43
    v_cvt_pk_bf16_f32 v42, v44, v45
    v_cvt_pk_bf16_f32 v43, v46, v47
    v_cvt_pk_bf16_f32 v44, v48, v49
    v_cvt_pk_bf16_f32 v45, v50, v51
    v_cvt_pk_bf16_f32 v46, v52, v53
    v_cvt_pk_bf16_f32 v47, v54, v55
    v_mfma_f32_32x32x16_bf16 v[72:87], v[104:107], v[40:43], 0
    s_nop 0
    v_mfma_f32_32x32x16_bf16 v[88:103], v[108:111], v[44:47], 0
    s_nop 4
    v_max3_f32 v122, v72, v73, v74
    v_max3_f32 v123, v75, v76, v77
    v_max3_f32 v122, v122, v78, v79
    v_max3_f32 v123, v123, v80, v81
    v_max3_f32 v122, v122, v82, v83
    v_max3_f32 v123, v123, v84, v85
    v_max3_f32 v122, v122, v86, v87
    v_max_f32_e64 v122, v122, v123
    v_mul_f32 v119, -v122, v118
    v_pk_fma_f32 v[72:73], v[72:73], v[118:119], v[118:119] op_sel:[0,0,1] op_sel_hi:[1,0,1]
    v_pk_fma_f32 v[74:75], v[74:75], v[118:119], v[118:119] op_sel:[0,0,1] op_sel_hi:[1,0,1]
    v_pk_fma_f32 v[76:77], v[76:77], v[118:119], v[118:119] op_sel:[0,0,1] op_sel_hi:[1,0,1]
    v_pk_fma_f32 v[78:79], v[78:79], v[118:119], v[118:119] op_sel:[0,0,1] op_sel_hi:[1,0,1]
    v_pk_fma_f32 v[80:81], v[80:81], v[118:119], v[118:119] op_sel:[0,0,1] op_sel_hi:[1,0,1]
    v_pk_fma_f32 v[82:83], v[82:83], v[118:119], v[118:119] op_sel:[0,0,1] op_sel_hi:[1,0,1]
    v_pk_fma_f32 v[84:85], v[84:85], v[118:119], v[118:119] op_sel:[0,0,1] op_sel_hi:[1,0,1]
    v_pk_fma_f32 v[86:87], v[86:87], v[118:119], v[118:119] op_sel:[0,0,1] op_sel_hi:[1,0,1]
    v_exp_f32 v72, v72
    v_exp_f32 v73, v73
    v_exp_f32 v74, v74
    v_exp_f32 v75, v75
    v_exp_f32 v76, v76
    v_exp_f32 v77, v77
    v_exp_f32 v78, v78
    v_exp_f32 v79, v79
    v_exp_f32 v80, v80
    v_exp_f32 v81, v81
    v_exp_f32 v82, v82
    v_exp_f32 v83, v83
    v_exp_f32 v84, v84
    v_exp_f32 v85, v85
    v_exp_f32 v86, v86
    v_exp_f32 v87, v87
    v_pk_add_f32 v[124:125], v[72:73], v[74:75]
    v_pk_add_f32 v[126:127], v[76:77], v[78:79]
    v_pk_add_f32 v[124:125], v[124:125], v[80:81]
    v_pk_add_f32 v[126:127], v[126:127], v[82:83]
    v_pk_add_f32 v[124:125], v[124:125], v[84:85]
    v_pk_add_f32 v[126:127], v[126:127], v[86:87]
    v_pk_add_f32 v[124:125], v[124:125], v[126:127]
    v_add_f32 v124, v124, v125
    v_rcp_f32_e64 v124, v124
    s_nop 0
    v_pk_mul_f32 v[72:73], v[72:73], v[124:125] op_sel_hi:[1,0]
    v_pk_mul_f32 v[74:75], v[74:75], v[124:125] op_sel_hi:[1,0]
    v_pk_mul_f32 v[76:77], v[76:77], v[124:125] op_sel_hi:[1,0]
    v_pk_mul_f32 v[78:79], v[78:79], v[124:125] op_sel_hi:[1,0]
    v_pk_mul_f32 v[80:81], v[80:81], v[124:125] op_sel_hi:[1,0]
    v_pk_mul_f32 v[82:83], v[82:83], v[124:125] op_sel_hi:[1,0]
    v_pk_mul_f32 v[84:85], v[84:85], v[124:125] op_sel_hi:[1,0]
    v_pk_mul_f32 v[86:87], v[86:87], v[124:125] op_sel_hi:[1,0]
    v_cvt_pk_bf16_f32 v72, v72, v73
    v_cvt_pk_bf16_f32 v73, v74, v75
    v_cvt_pk_bf16_f32 v74, v76, v77
    v_cvt_pk_bf16_f32 v75, v78, v79
    v_cvt_pk_bf16_f32 v76, v80, v81
    v_cvt_pk_bf16_f32 v77, v82, v83
    v_cvt_pk_bf16_f32 v78, v84, v85
    v_cvt_pk_bf16_f32 v79, v86, v87
    v_max3_f32 v122, v88, v89, v90
    v_max3_f32 v123, v91, v92, v93
    v_max3_f32 v122, v122, v94, v95
    v_max3_f32 v123, v123, v96, v97
    v_max3_f32 v122, v122, v98, v99
    v_max3_f32 v123, v123, v100, v101
    v_max3_f32 v122, v122, v102, v103
    v_max_f32_e64 v122, v122, v123
    v_mul_f32 v119, -v122, v118
    v_pk_fma_f32 v[88:89], v[88:89], v[118:119], v[118:119] op_sel:[0,0,1] op_sel_hi:[1,0,1]
    v_pk_fma_f32 v[90:91], v[90:91], v[118:119], v[118:119] op_sel:[0,0,1] op_sel_hi:[1,0,1]
    v_pk_fma_f32 v[92:93], v[92:93], v[118:119], v[118:119] op_sel:[0,0,1] op_sel_hi:[1,0,1]
    v_pk_fma_f32 v[94:95], v[94:95], v[118:119], v[118:119] op_sel:[0,0,1] op_sel_hi:[1,0,1]
    v_pk_fma_f32 v[96:97], v[96:97], v[118:119], v[118:119] op_sel:[0,0,1] op_sel_hi:[1,0,1]
    v_pk_fma_f32 v[98:99], v[98:99], v[118:119], v[118:119] op_sel:[0,0,1] op_sel_hi:[1,0,1]
    v_pk_fma_f32 v[100:101], v[100:101], v[118:119], v[118:119] op_sel:[0,0,1] op_sel_hi:[1,0,1]
    v_pk_fma_f32 v[102:103], v[102:103], v[118:119], v[118:119] op_sel:[0,0,1] op_sel_hi:[1,0,1]
    v_exp_f32 v88, v88
    v_exp_f32 v89, v89
    v_exp_f32 v90, v90
    v_exp_f32 v91, v91
    v_exp_f32 v92, v92
    v_exp_f32 v93, v93
    v_exp_f32 v94, v94
    v_exp_f32 v95, v95
    v_exp_f32 v96, v96
    v_exp_f32 v97, v97
    v_exp_f32 v98, v98
    v_exp_f32 v99, v99
    v_exp_f32 v100, v100
    v_exp_f32 v101, v101
    v_exp_f32 v102, v102
    v_exp_f32 v103, v103
    v_pk_add_f32 v[124:125], v[88:89], v[90:91]
    v_pk_add_f32 v[126:127], v[92:93], v[94:95]
    v_pk_add_f32 v[124:125], v[124:125], v[96:97]
    v_pk_add_f32 v[126:127], v[126:127], v[98:99]
    v_pk_add_f32 v[124:125], v[124:125], v[100:101]
    v_pk_add_f32 v[126:127], v[126:127], v[102:103]
    v_pk_add_f32 v[124:125], v[124:125], v[126:127]
    v_add_f32 v124, v124, v125
    v_rcp_f32_e64 v124, v124
    s_nop 0
    v_pk_mul_f32 v[88:89], v[88:89], v[124:125] op_sel_hi:[1,0]
    v_pk_mul_f32 v[90:91], v[90:91], v[124:125] op_sel_hi:[1,0]
    v_pk_mul_f32 v[92:93], v[92:93], v[124:125] op_sel_hi:[1,0]
    v_pk_mul_f32 v[94:95], v[94:95], v[124:125] op_sel_hi:[1,0]
    v_pk_mul_f32 v[96:97], v[96:97], v[124:125] op_sel_hi:[1,0]
    v_pk_mul_f32 v[98:99], v[98:99], v[124:125] op_sel_hi:[1,0]
    v_pk_mul_f32 v[100:101], v[100:101], v[124:125] op_sel_hi:[1,0]
    v_pk_mul_f32 v[102:103], v[102:103], v[124:125] op_sel_hi:[1,0]
    s_waitcnt vmcnt(9) lgkmcnt(0)
    v_mfma_f32_16x16x32_bf16 v[56:59], v[192:195], v[132:135], 0
    v_cvt_pk_bf16_f32 v88, v88, v89
    v_cvt_pk_bf16_f32 v89, v90, v91
    s_waitcnt vmcnt(8)
    v_mfma_f32_16x16x32_bf16 v[56:59], v[196:199], v[136:139], v[56:59]
    v_cvt_pk_bf16_f32 v90, v92, v93
    v_cvt_pk_bf16_f32 v91, v94, v95
    s_waitcnt vmcnt(7)
    v_mfma_f32_16x16x32_bf16 v[56:59], v[192:195], v[140:143], v[56:59]
    v_cvt_pk_bf16_f32 v92, v96, v97
    v_cvt_pk_bf16_f32 v93, v98, v99
    s_waitcnt vmcnt(6)
    v_mfma_f32_16x16x32_bf16 v[56:59], v[196:199], v[144:147], v[56:59]
    v_cvt_pk_bf16_f32 v94, v100, v101
    v_cvt_pk_bf16_f32 v95, v102, v103
L_part2:
    s_waitcnt vmcnt(5)
    v_mfma_f32_16x16x32_bf16 v[60:63], v[192:195], v[128:131], 0
    s_waitcnt vmcnt(4)
    v_mfma_f32_16x16x32_bf16 v[56:59], v[192:195], v[148:151], v[56:59]
    s_waitcnt vmcnt(3)
    v_mfma_f32_16x16x32_bf16 v[56:59], v[196:199], v[152:155], v[56:59]
    s_waitcnt vmcnt(2)
    v_mfma_f32_16x16x32_bf16 v[56:59], v[192:195], v[156:159], v[56:59]
    v_cvt_pk_bf16_f32 v64, v60, v61
    v_cvt_pk_bf16_f32 v65, v62, v63
    s_waitcnt vmcnt(1)
    v_mfma_f32_16x16x32_bf16 v[56:59], v[196:199], v[160:163], v[56:59]
    s_mov_b64 exec, 0x00ff00ff
    ds_write_b64 v16, v[64:65]
    s_mov_b64 exec, -1
    s_nop 4
    v_cmp_u_f32 vcc, v56, v60
    v_cvt_pk_bf16_f32 v56, v56, v57
    v_cvt_pk_bf16_f32 v57, v58, v59
    ds_write_b64 v15, v[56:57]
    s_cbranch_vccnz L_partre
L_partok2:
    s_waitcnt lgkmcnt(0)
    s_barrier
    ds_read_b128 v[128:131], v17 offset:0
    ds_read_b128 v[132:135], v17 offset:16
    ds_read_b128 v[136:139], v17 offset:1600
    ds_read_b128 v[140:143], v17 offset:1616
    s_waitcnt lgkmcnt(3)
    v_mfma_f32_32x32x16_bf16 v[40:55], v[128:131], v[72:75], 0
    v_mov_b32 v106, 3
    s_waitcnt vmcnt(0)
    v_cmp_gt_u32 vcc, 2, v164
    s_waitcnt lgkmcnt(2)
    v_mfma_f32_32x32x16_bf16 v[40:55], v[132:135], v[76:79], v[40:55]
    s_cbranch_vccnz Lrefa_31
Lfc_30:
    s_waitcnt lgkmcnt(0)
    v_mfma_f32_32x32x16_bf16 v[56:71], v[136:139], v[88:91], 0
    v_mfma_f32_32x32x16_bf16 v[56:71], v[140:143], v[92:95], v[56:71]
    v_add_f32 v48, v48, v50
    v_add_f32 v49, v49, v51
    v_add_f32 v48, 0x358637bd, v48
    v_add_f32 v48, v48, v49
    v_rcp_f32_e64 v48, v48
    s_nop 0
    v_pk_mul_f32 v[40:41], v[40:41], v[48:49] op_sel_hi:[1,0]
    v_pk_mul_f32 v[42:43], v[42:43], v[48:49] op_sel_hi:[1,0]
    v_pk_mul_f32 v[44:45], v[44:45], v[48:49] op_sel_hi:[1,0]
    v_pk_mul_f32 v[46:47], v[46:47], v[48:49] op_sel_hi:[1,0]
    v_bfi_b32 v40, s60, v40, v4
    v_cvt_pk_bf16_f32 v40, v40, v41
    v_cvt_pk_bf16_f32 v41, v42, v43
    v_cvt_pk_bf16_f32 v42, v44, v45
    v_cvt_pk_bf16_f32 v43, v46, v47
    buffer_store_dwordx4 v[40:43], v1, s[44:47], s71 offen offset:0
    v_add_f32 v64, v64, v66
    v_add_f32 v65, v65, v67
    v_add_f32 v64, 0x358637bd, v64
    v_add_f32 v64, v64, v65
    v_rcp_f32_e64 v64, v64
    s_nop 0
    v_pk_mul_f32 v[56:57], v[56:57], v[64:65] op_sel_hi:[1,0]
    v_pk_mul_f32 v[58:59], v[58:59], v[64:65] op_sel_hi:[1,0]
    v_pk_mul_f32 v[60:61], v[60:61], v[64:65] op_sel_hi:[1,0]
    v_pk_mul_f32 v[62:63], v[62:63], v[64:65] op_sel_hi:[1,0]
    v_bfi_b32 v56, s60, v56, v4
    v_cvt_pk_bf16_f32 v56, v56, v57
    v_cvt_pk_bf16_f32 v57, v58, v59
    v_cvt_pk_bf16_f32 v58, v60, v61
    v_cvt_pk_bf16_f32 v59, v62, v63
    buffer_store_dwordx4 v[56:59], v1, s[44:47], s71 offen offset:1024
    s_mov_b64 exec, 1
    buffer_store_dword v106, off, s[40:43], s78 offset:0
    s_mov_b64 exec, -1
    s_and_b32 s84, s8, 0x6000
    v_add_u32 v116, s84, v2
    s_and_b32 s84, s9, 0x6000
    v_add_u32 v117, s84, v2
    s_and_b32 s84, s10, 0x6000
    v_add_u32 v118, s84, v2
    s_and_b32 s84, s11, 0x6000
    v_add_u32 v119, s84, v2
    v_and_or_b32 v141, v20, 60, s61
L_ore2:
    s_lshl2_add_u32 m0, s81, 114688
    buffer_load_dword v127, v18, s[40:43], 0 offen sc1
    s_cmp_eq_u32 s66, s0
    s_cbranch_scc0 Lpchk_33
    ds_write_b128 v116, v[40:43] offset:0
    ds_write_b128 v116, v[56:59] offset:1024
    s_branch L_oown2
L_opoll2:
    buffer_load_dword v127, v18, s[40:43], 0 offen sc1
    s_sub_u32 s68, s68, 1
    s_cbranch_scc1 L_end
L_oown2:
    s_waitcnt vmcnt(0)
    v_cmp_gt_u32 vcc, 3, v127
    s_cbranch_vccnz L_opoll2
    s_branch L_ojoin2
Lpoll_32:
    buffer_load_dword v127, v18, s[40:43], 0 offen sc1
    s_sub_u32 s68, s68, 1
    s_cbranch_scc1 L_end
Lpchk_33:
    s_waitcnt vmcnt(0)
    v_cmp_gt_u32 vcc, 3, v127
    s_cbranch_vccnz Lpoll_32
    buffer_load_dwordx4 v1, s[44:47], s72 offen offset:0 sc1 lds
    buffer_load_dwordx4 v1, s[44:47], s72 offen offset:1024 sc1 lds
L_ojoin2:
    s_lshl2_add_u32 m0, s81, 116736
    s_xor_b32 s84, s72, 2048
    buffer_load_dwordx4 v1, s[44:47], s84 offen offset:0 sc1 lds
    buffer_load_dwordx4 v1, s[44:47], s84 offen offset:1024 sc1 lds
    s_lshl2_add_u32 m0, s81, 118784
    s_xor_b32 s84, s72, 4096
    buffer_load_dwordx4 v1, s[44:47], s84 offen offset:0 sc1 lds
    buffer_load_dwordx4 v1, s[44:47], s84 offen offset:1024 sc1 lds
    s_lshl2_add_u32 m0, s81, 120832
    s_xor_b32 s84, s72, 6144
    buffer_load_dwordx4 v1, s[44:47], s84 offen offset:0 sc1 lds
    s_barrier
    buffer_load_dwordx4 v1, s[44:47], s84 offen offset:1024 sc1 lds
L_oskip2:
    s_waitcnt vmcnt(7)
    ds_read_b128 v[72:75], v116 offset:0
    s_waitcnt vmcnt(6)
    ds_read_b128 v[76:79], v116 offset:1024
    s_waitcnt vmcnt(5)
    ds_read_b128 v[80:83], v116 offset:2048
    s_waitcnt lgkmcnt(2)
    v_mfma_f32_32x32x16_bf16 v[40:55], a[0:3], v[72:75], v[24:39]
    s_waitcnt vmcnt(4)
    ds_read_b128 v[84:87], v116 offset:3072
    s_waitcnt lgkmcnt(2)
    v_mfma_f32_32x32x16_bf16 v[40:55], a[4:7], v[76:79], v[40:55]
    v_bitop3_b32 v12, 1, v72, v76 bitop3:0x80
    s_waitcnt vmcnt(3)
    ds_read_b128 v[88:91], v116 offset:4096
    s_waitcnt lgkmcnt(2)
    v_mfma_f32_32x32x16_bf16 v[40:55], a[8:11], v[80:83], v[40:55]
    s_waitcnt vmcnt(2)
    ds_read_b128 v[92:95], v116 offset:5120
    s_waitcnt lgkmcnt(2)
    v_mfma_f32_32x32x16_bf16 v[40:55], a[12:15], v[84:87], v[40:55]
    v_bitop3_b32 v12, v12, v80, v84 bitop3:0x80
    s_waitcnt vmcnt(1)
    ds_read_b128 v[96:99], v116 offset:6144
    s_waitcnt lgkmcnt(2)
    v_mfma_f32_32x32x16_bf16 v[40:55], a[16:19], v[88:91], v[40:55]
    s_waitcnt vmcnt(0)
    ds_read_b128 v[100:103], v116 offset:7168
    s_barrier
    s_waitcnt lgkmcnt(2)
    v_mfma_f32_32x32x16_bf16 v[40:55], a[20:23], v[92:95], v[40:55]
    v_bitop3_b32 v12, v12, v88, v92 bitop3:0x80
    ds_read_b128 v[72:75], v117 offset:0
    s_add_u32 m0, s81, 8192
    ds_read_b128 v[76:79], v117 offset:1024
    buffer_load_dwordx4 v5, s[40:43], m0 offen offset:0 sc1 lds
    s_waitcnt lgkmcnt(3)
    v_mfma_f32_32x32x16_bf16 v[40:55], a[24:27], v[96:99], v[40:55]
    ds_read_b128 v[80:83], v117 offset:2048
    ds_read_b128 v[84:87], v117 offset:3072
    s_waitcnt lgkmcnt(4)
    v_mfma_f32_32x32x16_bf16 v[40:55], a[28:31], v[100:103], v[40:55]
    v_bitop3_b32 v12, v12, v96, v100 bitop3:0x80
    v_cmp_eq_u32 vcc, 0, v12
    ds_read_b128 v[88:91], v117 offset:4096
    ds_read_b128 v[92:95], v117 offset:5120
    buffer_load_dwordx4 v5, s[40:43], m0 offen offset:1024 sc1 lds
    s_waitcnt lgkmcnt(5)
    v_mfma_f32_32x32x16_bf16 v[40:55], a[32:35], v[72:75], v[40:55]
    ds_read_b128 v[96:99], v117 offset:6144
    ds_read_b128 v[100:103], v117 offset:7168
    s_cmp_eq_u64 vcc, 0
    s_cselect_b64 exec, 1, 0
    buffer_store_dword v106, off, s[40:43], s16 offset:64
    s_mov_b64 exec, -1
    s_cselect_b32 s62, 1, 0
    s_waitcnt lgkmcnt(6)
    v_mfma_f32_32x32x16_bf16 v[40:55], a[36:39], v[76:79], v[40:55]
    v_bitop3_b32 v12, v12, v72, v76 bitop3:0x80
    s_add_u32 m0, s81, 40960
    ds_read_b128 v[72:75], v118 offset:0
    buffer_load_dwordx4 v5, s[40:43], m0 offen offset:0 sc1 lds
    s_waitcnt lgkmcnt(6)
    v_mfma_f32_32x32x16_bf16 v[40:55], a[40:43], v[80:83], v[40:55]
    ds_read_b128 v[76:79], v118 offset:1024
    s_waitcnt lgkmcnt(6)
    v_mfma_f32_32x32x16_bf16 v[40:55], a[44:47], v[84:87], v[40:55]
    v_bitop3_b32 v12, v12, v80, v84 bitop3:0x80
    ds_read_b128 v[80:83], v118 offset:2048
    buffer_load_dwordx4 v5, s[40:43], m0 offen offset:1024 sc1 lds
    s_waitcnt lgkmcnt(6)
    v_mfma_f32_32x32x16_bf16 v[40:55], a[48:51], v[88:91], v[40:55]
    ds_read_b128 v[84:87], v118 offset:3072
    s_waitcnt lgkmcnt(6)
    v_mfma_f32_32x32x16_bf16 v[40:55], a[52:55], v[92:95], v[40:55]
    v_bitop3_b32 v12, v12, v88, v92 bitop3:0x80
    s_add_u32 m0, s81, 16384
    ds_read_b128 v[88:91], v118 offset:4096
    buffer_load_dwordx4 v5, s[40:43], m0 offen offset:0 sc1 lds
    s_waitcnt lgkmcnt(6)
    v_mfma_f32_32x32x16_bf16 v[40:55], a[56:59], v[96:99], v[40:55]
    ds_read_b128 v[92:95], v118 offset:5120
    s_waitcnt lgkmcnt(6)
    v_mfma_f32_32x32x16_bf16 v[40:55], a[60:63], v[100:103], v[40:55]
    v_bitop3_b32 v12, v12, v96, v100 bitop3:0x80
    ds_read_b128 v[96:99], v118 offset:6144
    buffer_load_dwordx4 v5, s[40:43], m0 offen offset:1024 sc1 lds
    s_waitcnt lgkmcnt(6)
    v_mfma_f32_32x32x16_bf16 v[40:55], a[64:67], v[72:75], v[40:55]
    ds_read_b128 v[100:103], v118 offset:7168
    s_waitcnt lgkmcnt(6)
    v_mfma_f32_32x32x16_bf16 v[40:55], a[68:71], v[76:79], v[40:55]
    v_bitop3_b32 v12, v12, v72, v76 bitop3:0x80
    s_add_u32 m0, s81, 49152
    ds_read_b128 v[72:75], v119 offset:0
    buffer_load_dwordx4 v5, s[40:43], m0 offen offset:0 sc1 lds
    s_waitcnt lgkmcnt(6)
    v_mfma_f32_32x32x16_bf16 v[40:55], a[72:75], v[80:83], v[40:55]
    ds_read_b128 v[76:79], v119 offset:1024
    s_waitcnt lgkmcnt(6)
    v_mfma_f32_32x32x16_bf16 v[40:55], a[76:79], v[84:87], v[40:55]
    v_bitop3_b32 v12, v12, v80, v84 bitop3:0x80
    ds_read_b128 v[80:83], v119 offset:2048
    buffer_load_dword v140, v141, s[40:43], 0 offen offset:64 sc1
    buffer_load_dwordx4 v5, s[40:43], m0 offen offset:1024 sc1 lds
    s_waitcnt lgkmcnt(6)
    v_mfma_f32_32x32x16_bf16 v[40:55], a[80:83], v[88:91], v[40:55]
    ds_read_b128 v[84:87], v119 offset:3072
    s_waitcnt lgkmcnt(6)
    v_mfma_f32_32x32x16_bf16 v[40:55], a[84:87], v[92:95], v[40:55]
    v_bitop3_b32 v12, v12, v88, v92 bitop3:0x80
    s_add_u32 m0, s81, 24576
    ds_read_b128 v[88:91], v119 offset:4096
    buffer_load_dwordx4 v5, s[40:43], m0 offen offset:0 sc1 lds
    s_waitcnt lgkmcnt(6)
    v_mfma_f32_32x32x16_bf16 v[40:55], a[88:91], v[96:99], v[40:55]
    ds_read_b128 v[92:95], v119 offset:5120
    s_waitcnt lgkmcnt(6)
    v_mfma_f32_32x32x16_bf16 v[40:55], a[92:95], v[100:103], v[40:55]
    v_bitop3_b32 v12, v12, v96, v100 bitop3:0x80
    ds_read_b128 v[96:99], v119 offset:6144
    buffer_load_dwordx4 v5, s[40:43], m0 offen offset:1024 sc1 lds
    s_waitcnt lgkmcnt(6)
    v_mfma_f32_32x32x16_bf16 v[40:55], a[96:99], v[72:75], v[40:55]
    ds_read_b128 v[100:103], v119 offset:7168
    s_waitcnt lgkmcnt(6)
    v_mfma_f32_32x32x16_bf16 v[40:55], a[100:103], v[76:79], v[40:55]
    s_add_u32 m0, s81, 57344
    v_bitop3_b32 v12, v12, v72, v76 bitop3:0x80
    buffer_load_dwordx4 v5, s[40:43], m0 offen offset:0 sc1 lds
    s_waitcnt lgkmcnt(5)
    v_mfma_f32_32x32x16_bf16 v[40:55], a[104:107], v[80:83], v[40:55]
    s_waitcnt lgkmcnt(4)
    v_bitop3_b32 v12, v12, v80, v84 bitop3:0x80
    s_waitcnt lgkmcnt(2)
    v_bitop3_b32 v12, v12, v88, v92 bitop3:0x80
    v_mfma_f32_32x32x16_bf16 v[40:55], a[108:111], v[84:87], v[40:55]
    s_waitcnt lgkmcnt(0)
    v_bitop3_b32 v12, v12, v96, v100 bitop3:0x80
    v_cmp_eq_u32 vcc, 0, v12
    buffer_load_dwordx4 v5, s[40:43], m0 offen offset:1024 sc1 lds
    v_mfma_f32_32x32x16_bf16 v[40:55], a[112:115], v[88:91], v[40:55]
    s_cbranch_vccnz L_obad2
    v_mfma_f32_32x32x16_bf16 v[40:55], a[116:119], v[92:95], v[40:55]
    s_waitcnt vmcnt(5)
    v_cmp_gt_u32 vcc, 3, v140
    v_mfma_f32_32x32x16_bf16 v[40:55], a[248:251], v[96:99], v[40:55]
    s_cbranch_vccnz Lrefb_35
Lfc_34:
    v_mfma_f32_32x32x16_bf16 v[24:39], a[252:255], v[100:103], v[40:55]
    v_mov_b32 v62, 3
    s_nop 10
    v_cvt_pk_bf16_f32 v43, v30, v31
    v_cvt_pk_bf16_f32 v42, v28, v29
    v_cvt_pk_bf16_f32 v41, v26, v27
    v_cvt_pk_bf16_f32 v40, v24, v25
    v_and_b32_e64 v40, -2, v40
    buffer_store_dwordx4 v[40:43], v1, s[44:47], s73 offen offset:0
    v_cvt_pk_bf16_f32 v47, v38, v39
    v_cvt_pk_bf16_f32 v46, v36, v37
    v_cvt_pk_bf16_f32 v45, v34, v35
    v_cvt_pk_bf16_f32 v44, v32, v33
    v_and_b32 v44, -2, v44
    buffer_store_dwordx4 v[44:47], v1, s[44:47], s73 offen offset:1024
    s_mov_b64 exec, 1
    buffer_store_dword v62, off, s[40:43], s79 offset:0
    s_mov_b64 exec, -1
    s_nop 0
    v_pk_add_f32 v[56:57], v[24:25], v[26:27]
    v_pk_mul_f32 v[58:59], v[24:25], v[24:25]
    v_pk_fma_f32 v[58:59], v[26:27], v[26:27], v[58:59]
    v_pk_add_f32 v[56:57], v[56:57], v[28:29]
    v_pk_fma_f32 v[58:59], v[28:29], v[28:29], v[58:59]
    v_pk_add_f32 v[56:57], v[56:57], v[30:31]
    v_pk_fma_f32 v[58:59], v[30:31], v[30:31], v[58:59]
    v_pk_add_f32 v[56:57], v[56:57], v[32:33]
    v_pk_fma_f32 v[58:59], v[32:33], v[32:33], v[58:59]
    v_pk_add_f32 v[56:57], v[56:57], v[34:35]
    v_pk_fma_f32 v[58:59], v[34:35], v[34:35], v[58:59]
    v_pk_add_f32 v[56:57], v[56:57], v[36:37]
    v_pk_fma_f32 v[58:59], v[36:37], v[36:37], v[58:59]
    v_pk_add_f32 v[56:57], v[56:57], v[38:39]
    v_pk_fma_f32 v[58:59], v[38:39], v[38:39], v[58:59]
    v_add_f32 v56, v56, v57
    v_add_f32 v58, v58, v59
    s_lshl_b32 s84, s66, 8
    v_add_u32 v60, s84, v22
    v_permlane32_swap_b32 v56, v58
    v_add_f32 v56, v56, v58
    ds_write_b32 v60, v56 offset:6144
    s_waitcnt vmcnt(3) lgkmcnt(0)
    s_barrier
    s_cmp_lg_u32 s66, 0
    s_cbranch_scc1 Lst_36
    ds_read2st64_b32 v[56:57], v22 offset0:24 offset1:25
    ds_read2st64_b32 v[58:59], v22 offset0:26 offset1:27
    s_waitcnt lgkmcnt(0)
    v_add_f32 v56, v56, v57
    v_add_f32 v58, v58, v59
    v_add_f32 v56, v56, v58
    buffer_store_dword v56, v20, s[40:43], s76 offen offset:768
Lst_36:
    ds_read_b128 v[72:75], v1 offset:0
    ds_read_b128 v[76:79], v1 offset:32768
    ds_read_b128 v[80:83], v1 offset:1024
    ds_read_b128 v[84:87], v1 offset:33792
    ds_read_b128 v[88:91], v1 offset:2048
    ds_read_b128 v[92:95], v1 offset:34816
    buffer_load_dword v127, v19, s[40:43], 0 offen sc1
    v_add_u32 v64, s1, v2
    v_add_u32 v65, s82, v2
    ds_write_b128 v64, v[40:43]
    ds_write_b128 v65, v[44:47]
    s_lshl_b32 s84, s66, 10
    v_add_u32 v66, s84, v2
    s_cmp_eq_u32 s66, s0
    s_cbranch_scc0 Lpchk_38
    s_branch L_xown3
L_xpoll3:
    buffer_load_dword v127, v19, s[40:43], 0 offen sc1
    s_sub_u32 s68, s68, 1
    s_cbranch_scc1 L_end
L_xown3:
    s_waitcnt vmcnt(0)
    v_cmp_gt_u32 vcc, 3, v127
    s_cbranch_vccnz L_xpoll3
    s_xor_b32 s96, s70, 8192
    buffer_load_dwordx4 v[160:163], v1, s[44:47], s96 offen offset:0 sc1
    s_waitcnt lgkmcnt(0)
    s_barrier
    ds_read_b128 v[128:131], v2 offset:47104
    ds_read_b128 v[132:135], v66 offset:8192
    ds_read_b128 v[136:139], v66 offset:12288
    ds_read_b128 v[140:143], v66 offset:16384
    ds_read_b128 v[144:147], v66 offset:20480
    ds_read_b128 v[148:151], v66 offset:24576
    ds_read_b128 v[152:155], v66 offset:28672
    ds_read_b128 v[156:159], v2 offset:46080
    s_waitcnt lgkmcnt(0)
    s_branch L_xjoin3
Lpoll_37:
    buffer_load_dword v127, v19, s[40:43], 0 offen sc1
    s_sub_u32 s68, s68, 1
    s_cbranch_scc1 L_end
Lpchk_38:
    s_waitcnt vmcnt(0)
    v_cmp_gt_u32 vcc, 3, v127
    s_cbranch_vccnz Lpoll_37
    s_xor_b32 s96, s70, 0
    buffer_load_dwordx4 v[128:131], v1, s[44:47], s96 offen offset:0 sc1
    buffer_load_dwordx4 v[132:135], v1, s[44:47], s96 offen offset:1024 sc1
    buffer_load_dwordx4 v[136:139], v1, s[44:47], s96 offen offset:2048 sc1
    buffer_load_dwordx4 v[140:143], v1, s[44:47], s96 offen offset:3072 sc1
    s_waitcnt lgkmcnt(0)
    s_barrier
L_xre3:
    s_xor_b32 s96, s70, 4096
    buffer_load_dwordx4 v[144:147], v1, s[44:47], s96 offen offset:0 sc1
    buffer_load_dwordx4 v[148:151], v1, s[44:47], s96 offen offset:1024 sc1
    buffer_load_dwordx4 v[152:155], v1, s[44:47], s96 offen offset:2048 sc1
    buffer_load_dwordx4 v[156:159], v1, s[44:47], s96 offen offset:3072 sc1
    s_xor_b32 s96, s70, 8192
    buffer_load_dwordx4 v[160:163], v1, s[44:47], s96 offen offset:0 sc1
L_xjoin3:
    s_waitcnt vmcnt(8)
    v_mfma_f32_32x32x16_bf16 v[40:55], v[72:75], v[128:131], 0
    ds_read_b128 v[96:99], v1 offset:3072
    buffer_load_dwordx4 v[164:167], v1, s[44:47], s96 offen offset:1024 sc1
    v_mfma_f32_32x32x16_bf16 v[56:71], v[76:79], v[128:131], 0
    ds_read_b128 v[100:103], v1 offset:35840
    s_waitcnt vmcnt(8)
    v_mfma_f32_32x32x16_bf16 v[40:55], v[80:83], v[132:135], v[40:55]
    ds_read_b128 v[72:75], v1 offset:4096
    buffer_load_dwordx4 v[168:171], v1, s[44:47], s96 offen offset:2048 sc1
    v_mfma_f32_32x32x16_bf16 v[56:71], v[84:87], v[132:135], v[56:71]
    ds_read_b128 v[76:79], v1 offset:36864
    v_or3_b32 v12, 0, v128, v132
    v_and_b32 v122, 32, v0
    s_waitcnt vmcnt(8)
    v_mfma_f32_32x32x16_bf16 v[40:55], v[88:91], v[136:139], v[40:55]
    ds_read_b128 v[80:83], v1 offset:5120
    buffer_load_dwordx4 v[172:175], v1, s[44:47], s96 offen offset:3072 sc1
    v_mfma_f32_32x32x16_bf16 v[56:71], v[92:95], v[136:139], v[56:71]
    ds_read_b128 v[84:87], v1 offset:37888
    ds_read2st64_b32 v[104:105], v22 offset0:12 offset1:13
    ds_read2st64_b32 v[106:107], v22 offset0:14 offset1:15
    v_lshl_add_u32 v126, v122, 7, v6
    v_lshl_add_u32 v127, v122, 7, v7
    s_waitcnt vmcnt(8) lgkmcnt(7)
    v_mfma_f32_32x32x16_bf16 v[40:55], v[96:99], v[140:143], v[40:55]
    ds_read_b128 v[88:91], v1 offset:6144
    s_xor_b32 s96, s70, 12288
    buffer_load_dwordx4 v[176:179], v1, s[44:47], s96 offen offset:0 sc1
    s_waitcnt lgkmcnt(7)
    v_mfma_f32_32x32x16_bf16 v[56:71], v[100:103], v[140:143], v[56:71]
    ds_read_b128 v[92:95], v1 offset:38912
    ds_read2st64_b32 v[108:109], v22 offset0:16 offset1:17
    ds_read2st64_b32 v[110:111], v22 offset0:18 offset1:19
    v_or3_b32 v12, v12, v136, v140
    s_waitcnt vmcnt(8) lgkmcnt(9)
    v_mfma_f32_32x32x16_bf16 v[40:55], v[72:75], v[144:147], v[40:55]
    ds_read_b128 v[96:99], v1 offset:7168
    buffer_load_dwordx4 v[180:183], v1, s[44:47], s96 offen offset:1024 sc1
    s_waitcnt lgkmcnt(9)
    v_mfma_f32_32x32x16_bf16 v[56:71], v[76:79], v[144:147], v[56:71]
    ds_read_b128 v[100:103], v1 offset:39936
    s_waitcnt vmcnt(8) lgkmcnt(9)
    v_mfma_f32_32x32x16_bf16 v[40:55], v[80:83], v[148:151], v[40:55]
    ds_read_b128 v[72:75], v1 offset:8192
    buffer_load_dwordx4 v[184:187], v1, s[44:47], s96 offen offset:2048 sc1
    s_waitcnt lgkmcnt(9)
    v_mfma_f32_32x32x16_bf16 v[56:71], v[84:87], v[148:151], v[56:71]
    ds_read_b128 v[76:79], v1 offset:40960
    v_or3_b32 v12, v12, v144, v148
    s_waitcnt vmcnt(8) lgkmcnt(7)
    v_mfma_f32_32x32x16_bf16 v[40:55], v[88:91], v[152:155], v[40:55]
    ds_read_b128 v[80:83], v1 offset:9216
    buffer_load_dwordx4 v[188:191], v1, s[44:47], s96 offen offset:3072 sc1
    buffer_load_dword v112, v20, s[40:43], s77 offen offset:768 sc1
L_pg7:
    s_cbranch_execz L_pgret1
    buffer_load_dword v113, v20, s[40:43], s77 offen offset:1792 sc1
    buffer_load_dword v114, v20, s[40:43], s77 offen offset:2816 sc1
    buffer_load_dword v115, v20, s[40:43], s77 offen offset:3840 sc1
    s_waitcnt lgkmcnt(7)
    v_mfma_f32_32x32x16_bf16 v[56:71], v[92:95], v[152:155], v[56:71]
    ds_read_b128 v[84:87], v1 offset:41984
    s_waitcnt lgkmcnt(6)
    v_add_f32 v104, v104, v105
    v_add_f32 v106, v106, v107
    s_waitcnt vmcnt(12) lgkmcnt(5)
    v_mfma_f32_32x32x16_bf16 v[40:55], v[96:99], v[156:159], v[40:55]
    ds_read_b128 v[88:91], v1 offset:10240
    s_xor_b32 s96, s70, 16384
    buffer_load_dwordx4 v[192:195], v1, s[44:47], s96 offen offset:0 sc1
    v_add_f32 v106, v104, v106
    s_waitcnt lgkmcnt(5)
    v_mfma_f32_32x32x16_bf16 v[56:71], v[100:103], v[156:159], v[56:71]
    ds_read_b128 v[92:95], v1 offset:43008
    v_cvt_pk_bf16_f32 v104, v106, v106
    v_and_b32 v107, 0xffff0000, v104
    v_or3_b32 v12, v12, v152, v156
    s_waitcnt vmcnt(12) lgkmcnt(5)
    v_mfma_f32_32x32x16_bf16 v[40:55], v[72:75], v[160:163], v[40:55]
    ds_read_b128 v[96:99], v1 offset:11264
    buffer_load_dwordx4 v[196:199], v1, s[44:47], s96 offen offset:1024 sc1
    v_sub_f32 v107, v106, v107
    s_waitcnt lgkmcnt(5)
    v_mfma_f32_32x32x16_bf16 v[56:71], v[76:79], v[160:163], v[56:71]
    ds_read_b128 v[100:103], v1 offset:44032
    v_cvt_pk_bf16_f32 v105, v107, 0
    v_add_f32 v108, v108, v109
    s_waitcnt vmcnt(12) lgkmcnt(5)
    v_mfma_f32_32x32x16_bf16 v[40:55], v[80:83], v[164:167], v[40:55]
    ds_read_b128 v[72:75], v1 offset:12288
    buffer_load_dwordx4 v[200:203], v1, s[44:47], s96 offen offset:2048 sc1
    v_add_f32 v110, v110, v111
    s_waitcnt lgkmcnt(5)
    v_mfma_f32_32x32x16_bf16 v[56:71], v[84:87], v[164:167], v[56:71]
    ds_read_b128 v[76:79], v1 offset:45056
    v_add_f32 v110, v108, v110
    v_cvt_pk_bf16_f32 v108, v110, v110
    v_or3_b32 v12, v12, v160, v164
    s_waitcnt vmcnt(12) lgkmcnt(5)
    v_mfma_f32_32x32x16_bf16 v[40:55], v[88:91], v[168:171], v[40:55]
    ds_read_b128 v[80:83], v1 offset:13312
    buffer_load_dwordx4 v[204:207], v1, s[44:47], s96 offen offset:3072 sc1
    v_and_b32 v111, 0xffff0000, v108
    s_waitcnt lgkmcnt(5)
    v_mfma_f32_32x32x16_bf16 v[56:71], v[92:95], v[168:171], v[56:71]
    ds_read_b128 v[84:87], v1 offset:46080
    v_sub_f32 v111, v110, v111
    v_cvt_pk_bf16_f32 v109, v111, 0
    s_waitcnt vmcnt(12) lgkmcnt(5)
    v_mfma_f32_32x32x16_bf16 v[40:55], v[96:99], v[172:175], v[40:55]
    ds_read_b128 v[88:91], v1 offset:14336
    s_xor_b32 s96, s70, 20480
    buffer_load_dwordx4 v[208:211], v1, s[44:47], s96 offen offset:0 sc1
    s_waitcnt lgkmcnt(5)
    v_mfma_f32_32x32x16_bf16 v[56:71], v[100:103], v[172:175], v[56:71]
    ds_read_b128 v[92:95], v1 offset:47104
    v_or3_b32 v12, v12, v168, v172
    s_waitcnt vmcnt(12) lgkmcnt(5)
    v_mfma_f32_32x32x16_bf16 v[40:55], v[72:75], v[176:179], v[40:55]
    ds_read_b128 v[96:99], v1 offset:15360
    buffer_load_dwordx4 v[212:215], v1, s[44:47], s96 offen offset:1024 sc1
    s_waitcnt lgkmcnt(5)
    v_mfma_f32_32x32x16_bf16 v[56:71], v[76:79], v[176:179], v[56:71]
    ds_read_b128 v[100:103], v1 offset:48128
    s_waitcnt vmcnt(12) lgkmcnt(5)
    v_mfma_f32_32x32x16_bf16 v[40:55], v[80:83], v[180:183], v[40:55]
    ds_read_b128 v[72:75], v1 offset:16384
    buffer_load_dwordx4 v[216:219], v1, s[44:47], s96 offen offset:2048 sc1
    s_waitcnt lgkmcnt(5)
    v_mfma_f32_32x32x16_bf16 v[56:71], v[84:87], v[180:183], v[56:71]
    ds_read_b128 v[76:79], v1 offset:49152
    v_or3_b32 v12, v12, v176, v180
    s_waitcnt vmcnt(12) lgkmcnt(5)
    v_mfma_f32_32x32x16_bf16 v[40:55], v[88:91], v[184:187], v[40:55]
    ds_read_b128 v[80:83], v1 offset:17408
    buffer_load_dwordx4 v[220:223], v1, s[44:47], s96 offen offset:3072 sc1
    s_waitcnt lgkmcnt(5)
    v_mfma_f32_32x32x16_bf16 v[56:71], v[92:95], v[184:187], v[56:71]
    ds_read_b128 v[84:87], v1 offset:50176
    s_waitcnt vmcnt(12) lgkmcnt(5)
    v_mfma_f32_32x32x16_bf16 v[40:55], v[96:99], v[188:191], v[40:55]
    ds_read_b128 v[88:91], v1 offset:18432
    s_xor_b32 s96, s70, 24576
    buffer_load_dwordx4 v[224:227], v1, s[44:47], s96 offen offset:0 sc1
    s_waitcnt lgkmcnt(5)
    v_mfma_f32_32x32x16_bf16 v[56:71], v[100:103], v[188:191], v[56:71]
    ds_read_b128 v[92:95], v1 offset:51200
    s_waitcnt vmcnt(9)
    v_max3_u32 v120, v112, v113, v114
    v_max_u32 v120, v120, v115
    v_or3_b32 v12, v12, v184, v188
    s_waitcnt vmcnt(8) lgkmcnt(5)
    v_mfma_f32_32x32x16_bf16 v[40:55], v[72:75], v[192:195], v[40:55]
    ds_read_b128 v[96:99], v1 offset:19456
    buffer_load_dwordx4 v[228:231], v1, s[44:47], s96 offen offset:1024 sc1
    v_cmp_eq_u32 vcc, -1, v120
    s_waitcnt lgkmcnt(5)
    v_mfma_f32_32x32x16_bf16 v[56:71], v[76:79], v[192:195], v[56:71]
    ds_read_b128 v[100:103], v1 offset:52224
    s_cbranch_vccnz Lstre_39
Lstok_40:
    s_waitcnt vmcnt(8) lgkmcnt(5)
    v_mfma_f32_32x32x16_bf16 v[40:55], v[80:83], v[196:199], v[40:55]
    ds_read_b128 v[72:75], v1 offset:20480
    buffer_load_dwordx4 v[232:235], v1, s[44:47], s96 offen offset:2048 sc1
    v_add_f32 v112, v112, v113
    s_waitcnt lgkmcnt(5)
    v_mfma_f32_32x32x16_bf16 v[56:71], v[84:87], v[196:199], v[56:71]
    ds_read_b128 v[76:79], v1 offset:53248
    v_add_f32 v114, v114, v115
    v_add_f32 v112, v112, v114
    v_or3_b32 v12, v12, v192, v196
    s_waitcnt vmcnt(8) lgkmcnt(5)
    v_mfma_f32_32x32x16_bf16 v[40:55], v[88:91], v[200:203], v[40:55]
    ds_read_b128 v[80:83], v1 offset:21504
    buffer_load_dwordx4 v[236:239], v1, s[44:47], s96 offen offset:3072 sc1
    v_mul_f32 v112, 0x3b000000, v112
    s_waitcnt lgkmcnt(5)
    v_mfma_f32_32x32x16_bf16 v[56:71], v[92:95], v[200:203], v[56:71]
    ds_read_b128 v[84:87], v1 offset:54272
    v_mov_b32 v113, v112
    s_nop 1
    v_permlane32_swap_b32 v112, v113
    s_waitcnt vmcnt(8) lgkmcnt(5)
    v_mfma_f32_32x32x16_bf16 v[40:55], v[96:99], v[204:207], v[40:55]
    ds_read_b128 v[88:91], v1 offset:22528
    s_xor_b32 s96, s70, 28672
    buffer_load_dwordx4 v[240:243], v1, s[44:47], s96 offen offset:0 sc1
    v_fma_f32 v113, -v112, v112, v113
    s_waitcnt lgkmcnt(5)
    v_mfma_f32_32x32x16_bf16 v[56:71], v[100:103], v[204:207], v[56:71]
    ds_read_b128 v[92:95], v1 offset:55296
    v_max_f32 v113, 0, v113
    v_add_f32 v113, 0x3727c5ac, v113
    v_or3_b32 v12, v12, v200, v204
    s_waitcnt vmcnt(8) lgkmcnt(5)
    v_mfma_f32_32x32x16_bf16 v[40:55], v[72:75], v[208:211], v[40:55]
    ds_read_b128 v[96:99], v1 offset:23552
    buffer_load_dwordx4 v[244:247], v1, s[44:47], s96 offen offset:1024 sc1
    v_rsq_f32 v120, v113
    s_waitcnt lgkmcnt(5)
    v_mfma_f32_32x32x16_bf16 v[56:71], v[76:79], v[208:211], v[56:71]
    ds_read_b128 v[100:103], v1 offset:56320
    v_cvt_pk_bf16_f32 v117, -v112, 0
    v_lshlrev_b32 v114, 16, v117
    s_waitcnt vmcnt(8) lgkmcnt(5)
    v_mfma_f32_32x32x16_bf16 v[40:55], v[80:83], v[212:215], v[40:55]
    ds_read_b128 v[72:75], v1 offset:24576
    buffer_load_dwordx4 v[248:251], v1, s[44:47], s96 offen offset:2048 sc1
    v_sub_f32 v114, -v112, v114
    s_waitcnt lgkmcnt(5)
    v_mfma_f32_32x32x16_bf16 v[56:71], v[84:87], v[212:215], v[56:71]
    ds_read_b128 v[76:79], v1 offset:57344
    v_cvt_pk_bf16_f32 v116, -v112, v114
    v_mul_f32 v118, 0x3fb8aa3b, v120
    v_or3_b32 v12, v12, v208, v212
    s_waitcnt vmcnt(8) lgkmcnt(5)
    v_mfma_f32_32x32x16_bf16 v[40:55], v[88:91], v[216:219], v[40:55]
    ds_read_b128 v[80:83], v1 offset:25600
    buffer_load_dwordx4 v[252:255], v1, s[44:47], s96 offen offset:3072 sc1
    s_waitcnt lgkmcnt(5)
    v_mfma_f32_32x32x16_bf16 v[56:71], v[92:95], v[216:219], v[56:71]
    ds_read_b128 v[84:87], v1 offset:58368
    s_waitcnt vmcnt(8) lgkmcnt(5)
    v_mfma_f32_32x32x16_bf16 v[40:55], v[96:99], v[220:223], v[40:55]
    ds_read_b128 v[88:91], v1 offset:26624
    s_waitcnt lgkmcnt(5)
    v_mfma_f32_32x32x16_bf16 v[56:71], v[100:103], v[220:223], v[56:71]
    ds_read_b128 v[92:95], v1 offset:59392
    v_or3_b32 v12, v12, v216, v220
    s_waitcnt vmcnt(7) lgkmcnt(5)
    v_mfma_f32_32x32x16_bf16 v[40:55], v[72:75], v[224:227], v[40:55]
    ds_read_b128 v[96:99], v1 offset:27648
    s_waitcnt lgkmcnt(5)
    v_mfma_f32_32x32x16_bf16 v[56:71], v[76:79], v[224:227], v[56:71]
    ds_read_b128 v[100:103], v1 offset:60416
    s_waitcnt vmcnt(6) lgkmcnt(5)
    v_mfma_f32_32x32x16_bf16 v[40:55], v[80:83], v[228:231], v[40:55]
    ds_read_b128 v[72:75], v1 offset:28672
    s_waitcnt lgkmcnt(5)
    v_mfma_f32_32x32x16_bf16 v[56:71], v[84:87], v[228:231], v[56:71]
    ds_read_b128 v[76:79], v1 offset:29696
    v_or3_b32 v12, v12, v224, v228
    s_waitcnt vmcnt(5) lgkmcnt(5)
    v_mfma_f32_32x32x16_bf16 v[40:55], v[88:91], v[232:235], v[40:55]
    ds_read_b128 v[80:83], v1 offset:30720
    s_waitcnt lgkmcnt(5)
    v_mfma_f32_32x32x16_bf16 v[56:71], v[92:95], v[232:235], v[56:71]
    ds_read_b128 v[84:87], v1 offset:31744
    s_waitcnt vmcnt(4) lgkmcnt(5)
    v_mfma_f32_32x32x16_bf16 v[40:55], v[96:99], v[236:239], v[40:55]
    ds_read_b128 v[88:91], v1 offset:61440
    s_waitcnt lgkmcnt(5)
    v_mfma_f32_32x32x16_bf16 v[56:71], v[100:103], v[236:239], v[56:71]
    ds_read_b128 v[92:95], v1 offset:62464
    v_or3_b32 v12, v12, v232, v236
    s_waitcnt vmcnt(3) lgkmcnt(5)
    v_mfma_f32_32x32x16_bf16 v[40:55], v[72:75], v[240:243], v[40:55]
    ds_read_b128 v[96:99], v1 offset:63488
    v_mfma_f32_32x32x8_bf16 v[40:55], v[104:105], v[116:117], v[40:55]
    s_waitcnt vmcnt(2) lgkmcnt(5)
    v_mfma_f32_32x32x16_bf16 v[40:55], v[76:79], v[244:247], v[40:55]
    s_add_u32 m0, s81, 114688
    ds_read_b128 v[100:103], v1 offset:64512
    buffer_load_dwordx4 v5, s[40:43], m0 offen offset:0 sc1 lds
    v_mfma_f32_32x32x8_bf16 v[56:71], v[108:109], v[116:117], v[56:71]
    s_waitcnt vmcnt(2) lgkmcnt(5)
    v_mfma_f32_32x32x16_bf16 v[40:55], v[80:83], v[248:251], v[40:55]
    buffer_load_dwordx4 v5, s[40:43], m0 offen offset:1024 sc1 lds
    v_or3_b32 v12, v12, v240, v244
    s_waitcnt vmcnt(2) lgkmcnt(4)
    v_mfma_f32_32x32x16_bf16 v[40:55], v[84:87], v[252:255], v[40:55]
    v_or3_b32 v12, v12, v248, v252
    s_waitcnt lgkmcnt(3)
    v_mfma_f32_32x32x16_bf16 v[56:71], v[88:91], v[240:243], v[56:71]
    v_and_b32 v12, 1, v12
    v_cmp_ne_u32 vcc, 0, v12
    s_waitcnt lgkmcnt(2)
    v_mfma_f32_32x32x16_bf16 v[56:71], v[92:95], v[244:247], v[56:71]
    v_max3_f32 v119, v40, v41, v42
    v_max3_f32 v121, v43, v44, v45
    v_max3_f32 v119, v119, v46, v47
    v_max3_f32 v121, v121, v48, v49
    v_max3_f32 v119, v119, v50, v51
    v_max3_f32 v121, v121, v52, v53
    s_waitcnt lgkmcnt(1)
    v_mfma_f32_32x32x16_bf16 v[56:71], v[96:99], v[248:251], v[56:71]
    v_max3_f32 v119, v119, v54, v55
    v_max_f32_e64 v119, v119, v121
    v_mul_f32 v119, -v119, v118
    v_min3_f32 v122, v40, v41, v42
    v_min3_f32 v123, v43, v44, v45
    v_min3_f32 v122, v122, v46, v47
    s_waitcnt lgkmcnt(0)
    v_mfma_f32_32x32x16_bf16 v[56:71], v[100:103], v[252:255], v[56:71]
    v_min3_f32 v123, v123, v48, v49
    v_min3_f32 v122, v122, v50, v51
    v_min3_f32 v123, v123, v52, v53
    v_min3_f32 v122, v122, v54, v55
    v_min_f32_e64 v122, v122, v123
    s_cbranch_vccnz L_xbad3
    v_pk_fma_f32 v[72:73], v[40:41], v[118:119], v[118:119] op_sel:[0,0,1] op_sel_hi:[1,0,1]
    v_pk_fma_f32 v[74:75], v[42:43], v[118:119], v[118:119] op_sel:[0,0,1] op_sel_hi:[1,0,1]
    v_pk_fma_f32 v[76:77], v[44:45], v[118:119], v[118:119] op_sel:[0,0,1] op_sel_hi:[1,0,1]
    v_pk_fma_f32 v[78:79], v[46:47], v[118:119], v[118:119] op_sel:[0,0,1] op_sel_hi:[1,0,1]
    v_pk_fma_f32 v[80:81], v[48:49], v[118:119], v[118:119] op_sel:[0,0,1] op_sel_hi:[1,0,1]
    v_pk_fma_f32 v[82:83], v[50:51], v[118:119], v[118:119] op_sel:[0,0,1] op_sel_hi:[1,0,1]
    v_pk_fma_f32 v[84:85], v[52:53], v[118:119], v[118:119] op_sel:[0,0,1] op_sel_hi:[1,0,1]
    v_pk_fma_f32 v[86:87], v[54:55], v[118:119], v[118:119] op_sel:[0,0,1] op_sel_hi:[1,0,1]
    v_pk_mul_f32 v[56:57], v[56:57], v[120:121] op_sel_hi:[1,0]
    v_pk_mul_f32 v[58:59], v[58:59], v[120:121] op_sel_hi:[1,0]
    v_pk_mul_f32 v[60:61], v[60:61], v[120:121] op_sel_hi:[1,0]
    v_pk_mul_f32 v[62:63], v[62:63], v[120:121] op_sel_hi:[1,0]
    v_cvt_pk_bf16_f32 v56, v56, v57
    v_cvt_pk_bf16_f32 v57, v58, v59
    v_cvt_pk_bf16_f32 v58, v60, v61
    v_cvt_pk_bf16_f32 v59, v62, v63
    ds_write_b128 v8, v[56:59]
    v_pk_mul_f32 v[64:65], v[64:65], v[120:121] op_sel_hi:[1,0]
    v_pk_mul_f32 v[66:67], v[66:67], v[120:121] op_sel_hi:[1,0]
    v_pk_mul_f32 v[68:69], v[68:69], v[120:121] op_sel_hi:[1,0]
    v_pk_mul_f32 v[70:71], v[70:71], v[120:121] op_sel_hi:[1,0]
    v_cvt_pk_bf16_f32 v60, v64, v65
    v_cvt_pk_bf16_f32 v61, v66, v67
    v_cvt_pk_bf16_f32 v62, v68, v69
    v_cvt_pk_bf16_f32 v63, v70, v71
    v_exp_f32 v72, v72
    v_exp_f32 v73, v73
    v_exp_f32 v74, v74
    v_exp_f32 v75, v75
    v_exp_f32 v76, v76
    v_exp_f32 v77, v77
    ds_write_b128 v8, v[60:63] offset:4096
    v_exp_f32 v78, v78
    v_exp_f32 v79, v79
    v_exp_f32 v80, v80
    v_exp_f32 v81, v81
    v_exp_f32 v82, v82
    v_exp_f32 v83, v83
    v_exp_f32 v84, v84
    v_exp_f32 v85, v85
    v_exp_f32 v86, v86
    v_exp_f32 v87, v87
    v_pk_add_f32 v[124:125], v[72:73], v[74:75]
    v_pk_add_f32 v[112:113], v[76:77], v[78:79]
    v_pk_add_f32 v[124:125], v[124:125], v[80:81]
    v_pk_add_f32 v[112:113], v[112:113], v[82:83]
    v_pk_add_f32 v[124:125], v[124:125], v[84:85]
    v_pk_add_f32 v[112:113], v[112:113], v[86:87]
    v_pk_add_f32 v[124:125], v[124:125], v[112:113]
    v_add_f32 v124, v124, v125
    v_rcp_f32_e64 v124, v124
    s_nop 0
    v_pk_mul_f32 v[72:73], v[72:73], v[124:125] op_sel_hi:[1,0]
    v_pk_mul_f32 v[74:75], v[74:75], v[124:125] op_sel_hi:[1,0]
    v_pk_mul_f32 v[76:77], v[76:77], v[124:125] op_sel_hi:[1,0]
    v_pk_mul_f32 v[78:79], v[78:79], v[124:125] op_sel_hi:[1,0]
    v_cvt_pk_bf16_f32 v72, v72, v73
    v_cvt_pk_bf16_f32 v73, v74, v75
    v_cvt_pk_bf16_f32 v74, v76, v77
    v_cvt_pk_bf16_f32 v75, v78, v79
    ds_write_b128 v126, v[72:75]
    v_pk_mul_f32 v[80:81], v[80:81], v[124:125] op_sel_hi:[1,0]
    v_pk_mul_f32 v[82:83], v[82:83], v[124:125] op_sel_hi:[1,0]
    v_pk_mul_f32 v[84:85], v[84:85], v[124:125] op_sel_hi:[1,0]
    v_pk_mul_f32 v[86:87], v[86:87], v[124:125] op_sel_hi:[1,0]
    v_cvt_pk_bf16_f32 v76, v80, v81
    v_cvt_pk_bf16_f32 v77, v82, v83
    v_cvt_pk_bf16_f32 v78, v84, v85
    v_cvt_pk_bf16_f32 v79, v86, v87
    v_mul_f32_e64 v119, v122, v118
    v_pk_fma_f32 v[88:89], v[40:41], v[118:119], v[118:119] op_sel:[0,0,1] op_sel_hi:[1,0,1] neg_lo:[1,0,0] neg_hi:[1,0,0]
    v_pk_fma_f32 v[90:91], v[42:43], v[118:119], v[118:119] op_sel:[0,0,1] op_sel_hi:[1,0,1] neg_lo:[1,0,0] neg_hi:[1,0,0]
    v_pk_fma_f32 v[92:93], v[44:45], v[118:119], v[118:119] op_sel:[0,0,1] op_sel_hi:[1,0,1] neg_lo:[1,0,0] neg_hi:[1,0,0]
    v_pk_fma_f32 v[94:95], v[46:47], v[118:119], v[118:119] op_sel:[0,0,1] op_sel_hi:[1,0,1] neg_lo:[1,0,0] neg_hi:[1,0,0]
    v_pk_fma_f32 v[96:97], v[48:49], v[118:119], v[118:119] op_sel:[0,0,1] op_sel_hi:[1,0,1] neg_lo:[1,0,0] neg_hi:[1,0,0]
    ds_write_b128 v127, v[76:79]
    v_pk_fma_f32 v[98:99], v[50:51], v[118:119], v[118:119] op_sel:[0,0,1] op_sel_hi:[1,0,1] neg_lo:[1,0,0] neg_hi:[1,0,0]
    v_pk_fma_f32 v[100:101], v[52:53], v[118:119], v[118:119] op_sel:[0,0,1] op_sel_hi:[1,0,1] neg_lo:[1,0,0] neg_hi:[1,0,0]
    v_pk_fma_f32 v[102:103], v[54:55], v[118:119], v[118:119] op_sel:[0,0,1] op_sel_hi:[1,0,1] neg_lo:[1,0,0] neg_hi:[1,0,0]
    v_exp_f32 v88, v88
    v_exp_f32 v89, v89
    v_exp_f32 v90, v90
    v_exp_f32 v91, v91
    v_exp_f32 v92, v92
    v_exp_f32 v93, v93
    v_exp_f32 v94, v94
    v_exp_f32 v95, v95
    v_exp_f32 v96, v96
    v_exp_f32 v97, v97
    v_exp_f32 v98, v98
    v_exp_f32 v99, v99
    v_exp_f32 v100, v100
    v_exp_f32 v101, v101
    v_exp_f32 v102, v102
    v_exp_f32 v103, v103
    v_pk_add_f32 v[124:125], v[88:89], v[90:91]
    v_pk_add_f32 v[112:113], v[92:93], v[94:95]
    v_pk_add_f32 v[124:125], v[124:125], v[96:97]
    v_pk_add_f32 v[112:113], v[112:113], v[98:99]
    v_pk_add_f32 v[124:125], v[124:125], v[100:101]
    v_pk_add_f32 v[112:113], v[112:113], v[102:103]
    v_pk_add_f32 v[124:125], v[124:125], v[112:113]
    v_add_f32 v124, v124, v125
    v_rcp_f32_e64 v124, v124
    s_nop 0
    v_pk_mul_f32 v[88:89], v[88:89], v[124:125] op_sel_hi:[1,0]
    v_pk_mul_f32 v[90:91], v[90:91], v[124:125] op_sel_hi:[1,0]
    v_pk_mul_f32 v[92:93], v[92:93], v[124:125] op_sel_hi:[1,0]
    v_pk_mul_f32 v[94:95], v[94:95], v[124:125] op_sel_hi:[1,0]
    v_cvt_pk_bf16_f32 v88, v88, v89
    v_cvt_pk_bf16_f32 v89, v90, v91
    v_cvt_pk_bf16_f32 v90, v92, v93
    v_cvt_pk_bf16_f32 v91, v94, v95
    ds_write_b128 v126, v[88:91] offset:4096
    v_pk_mul_f32 v[96:97], v[96:97], v[124:125] op_sel_hi:[1,0]
    v_pk_mul_f32 v[98:99], v[98:99], v[124:125] op_sel_hi:[1,0]
    v_pk_mul_f32 v[100:101], v[100:101], v[124:125] op_sel_hi:[1,0]
    v_pk_mul_f32 v[102:103], v[102:103], v[124:125] op_sel_hi:[1,0]
    v_cvt_pk_bf16_f32 v92, v96, v97
    v_cvt_pk_bf16_f32 v93, v98, v99
    v_cvt_pk_bf16_f32 v94, v100, v101
    v_cvt_pk_bf16_f32 v95, v102, v103
    ds_write_b128 v127, v[92:95] offset:4096
    v_add_u32 v123, 0x10000, v1
    v_mov_b32 v64, 0x3f803f80
    v_mov_b32 v65, 0x3f803f80
    v_mov_b32 v66, 0x3f803f80
    v_mov_b32 v67, 0x3f803f80
    s_waitcnt vmcnt(0) lgkmcnt(0)
    s_barrier
    ds_read_b64_tr_b16 v[72:73], v9 offset:0
    ds_read_b64_tr_b16 v[74:75], v9 offset:512
    ds_read_b64_tr_b16 v[76:77], v10 offset:0
    ds_read_b64_tr_b16 v[78:79], v10 offset:512
    ds_read_b64_tr_b16 v[80:81], v9 offset:1024
    ds_read_b64_tr_b16 v[82:83], v9 offset:1536
    ds_read_b64_tr_b16 v[84:85], v10 offset:1024
    ds_read_b64_tr_b16 v[86:87], v10 offset:1536
    ds_read_b64_tr_b16 v[88:89], v9 offset:2048
    ds_read_b64_tr_b16 v[90:91], v9 offset:2560
    ds_read_b64_tr_b16 v[92:93], v10 offset:2048
    ds_read_b64_tr_b16 v[94:95], v10 offset:2560
    ds_read_b64_tr_b16 v[96:97], v9 offset:3072
    ds_read_b64_tr_b16 v[98:99], v9 offset:3584
    ds_read_b64_tr_b16 v[100:101], v10 offset:3072
    ds_read_b64_tr_b16 v[102:103], v10 offset:3584
    s_waitcnt lgkmcnt(12)
    v_mfma_f32_16x16x32_bf16 v[56:59], v[72:75], v[76:79], 0
    v_mfma_f32_16x16x32_bf16 v[60:63], v[72:75], v[64:67], 0
    s_waitcnt lgkmcnt(8)
    v_mfma_f32_16x16x32_bf16 v[56:59], v[80:83], v[84:87], v[56:59]
    v_mfma_f32_16x16x32_bf16 v[60:63], v[80:83], v[64:67], v[60:63]
    s_waitcnt lgkmcnt(4)
    v_mfma_f32_16x16x32_bf16 v[56:59], v[88:91], v[92:95], v[56:59]
    v_mfma_f32_16x16x32_bf16 v[60:63], v[88:91], v[64:67], v[60:63]
    s_waitcnt lgkmcnt(0)
    v_mfma_f32_16x16x32_bf16 v[56:59], v[96:99], v[100:103], v[56:59]
    v_mfma_f32_16x16x32_bf16 v[60:63], v[96:99], v[64:67], v[60:63]
    v_mov_b32 v40, 3
    s_add_u32 s84, s74, 1671168
    ds_read_b128 v[72:75], v123 offset:24576
    ds_read_b128 v[76:79], v123 offset:25600
    s_nop 0
    v_cvt_pk_bf16_f32 v56, v56, v57
    v_cvt_pk_bf16_f32 v57, v58, v59
    s_nop 0
    v_cvt_pk_bf16_f32 v58, v60, v61
    v_cvt_pk_bf16_f32 v59, v62, v63
    s_nop 0
    v_permlane32_swap_b32 v56, v58
    v_permlane32_swap_b32 v57, v59
    s_mov_b32 exec_hi, 0x00010001
    buffer_store_dwordx4 v[56:59], v11, s[40:43], s84 offen sc1
    s_mov_b64 exec, 1
    buffer_store_dword v40, off, s[40:43], s78 offset:1088
    s_mov_b64 exec, -1
    ds_read_b128 v[80:83], v123 offset:26624
    ds_read_b128 v[84:87], v123 offset:27648
    ds_read_b128 v[88:91], v123 offset:28672
    ds_read_b128 v[92:95], v123 offset:29696
    s_waitcnt lgkmcnt(5)
    v_mfma_f32_32x32x16_bf16 v[40:55], v[72:75], v[128:131], 0
    ds_read_b128 v[96:99], v123 offset:30720
    s_waitcnt lgkmcnt(5)
    v_mfma_f32_32x32x16_bf16 v[40:55], v[76:79], v[132:135], v[40:55]
    ds_read_b128 v[100:103], v123 offset:31744
    s_waitcnt lgkmcnt(5)
    v_mfma_f32_32x32x16_bf16 v[40:55], v[80:83], v[136:139], v[40:55]
    ds_read_b128 v[72:75], v123 offset:32768
    s_waitcnt lgkmcnt(5)
    v_mfma_f32_32x32x16_bf16 v[40:55], v[84:87], v[140:143], v[40:55]
    ds_read_b128 v[76:79], v123 offset:33792
    s_waitcnt lgkmcnt(5)
    v_mfma_f32_32x32x16_bf16 v[40:55], v[88:91], v[144:147], v[40:55]
    ds_read_b128 v[80:83], v123 offset:34816
    ds_read2st64_b32 v[112:113], v22 offset0:20 offset1:21
    ds_read2st64_b32 v[114:115], v22 offset0:22 offset1:23
    s_waitcnt lgkmcnt(7)
    v_mfma_f32_32x32x16_bf16 v[40:55], v[92:95], v[148:151], v[40:55]
    ds_read_b128 v[84:87], v123 offset:35840
    s_waitcnt lgkmcnt(7)
    v_mfma_f32_32x32x16_bf16 v[40:55], v[96:99], v[152:155], v[40:55]
    ds_read_b128 v[88:91], v123 offset:36864
    s_waitcnt lgkmcnt(7)
    v_mfma_f32_32x32x16_bf16 v[40:55], v[100:103], v[156:159], v[40:55]
    ds_read_b128 v[92:95], v123 offset:37888
    s_waitcnt lgkmcnt(7)
    v_mfma_f32_32x32x16_bf16 v[40:55], v[72:75], v[160:163], v[40:55]
    ds_read_b128 v[96:99], v123 offset:38912
    s_waitcnt lgkmcnt(4)
    v_add_f32 v112, v112, v113
    v_add_f32 v114, v114, v115
    v_add_f32 v114, v112, v114
    v_mfma_f32_32x32x16_bf16 v[40:55], v[76:79], v[164:167], v[40:55]
    ds_read_b128 v[100:103], v123 offset:39936
    v_cvt_pk_bf16_f32 v112, v114, v114
    v_and_b32 v115, 0xffff0000, v112
    v_sub_f32 v115, v114, v115
    v_mfma_f32_32x32x16_bf16 v[40:55], v[80:83], v[168:171], v[40:55]
    ds_read_b128 v[72:75], v123 offset:40960
    v_cvt_pk_bf16_f32 v113, v115, 0
    s_waitcnt lgkmcnt(5)
    v_mfma_f32_32x32x16_bf16 v[40:55], v[84:87], v[172:175], v[40:55]
    ds_read_b128 v[76:79], v123 offset:41984
    s_waitcnt lgkmcnt(5)
    v_mfma_f32_32x32x16_bf16 v[40:55], v[88:91], v[176:179], v[40:55]
    ds_read_b128 v[80:83], v123 offset:43008
    s_waitcnt lgkmcnt(5)
    v_mfma_f32_32x32x16_bf16 v[40:55], v[92:95], v[180:183], v[40:55]
    ds_read_b128 v[84:87], v123 offset:44032
    v_mfma_f32_32x32x8_bf16 v[40:55], v[112:113], v[116:117], v[40:55]
    s_waitcnt lgkmcnt(5)
    v_mfma_f32_32x32x16_bf16 v[40:55], v[96:99], v[184:187], v[40:55]
    ds_read_b128 v[88:91], v123 offset:45056
    s_waitcnt lgkmcnt(5)
    v_mfma_f32_32x32x16_bf16 v[40:55], v[100:103], v[188:191], v[40:55]
    ds_read_b128 v[92:95], v123 offset:46080
    s_waitcnt lgkmcnt(5)
    v_mfma_f32_32x32x16_bf16 v[40:55], v[72:75], v[192:195], v[40:55]
    ds_read_b128 v[96:99], v123 offset:47104
    s_add_u32 s12, s75, 1671168
    s_waitcnt lgkmcnt(5)
    v_mfma_f32_32x32x16_bf16 v[40:55], v[76:79], v[196:199], v[40:55]
    ds_read_b128 v[100:103], v123 offset:48128
    s_add_u32 s13, s75, 1810432
    s_waitcnt lgkmcnt(5)
    v_mfma_f32_32x32x16_bf16 v[40:55], v[80:83], v[200:203], v[40:55]
    ds_read_b128 v[72:75], v123 offset:49152
    s_add_u32 s14, s75, 1949696
    s_waitcnt lgkmcnt(5)
    v_mfma_f32_32x32x16_bf16 v[40:55], v[84:87], v[204:207], v[40:55]
    ds_read_b128 v[76:79], v123 offset:50176
    s_add_u32 s15, s75, 2088960
    s_waitcnt lgkmcnt(5)
    v_mfma_f32_32x32x16_bf16 v[40:55], v[88:91], v[208:211], v[40:55]
    ds_read_b128 v[80:83], v123 offset:51200
    s_mov_b32 s67, 3
    s_waitcnt lgkmcnt(5)
    v_mfma_f32_32x32x16_bf16 v[40:55], v[92:95], v[212:215], v[40:55]
    ds_read_b128 v[84:87], v123 offset:52224
    buffer_load_dwordx4 v[132:135], v13, s[40:43], s12 offen offset:0 sc1
    s_waitcnt lgkmcnt(5)
    v_mfma_f32_32x32x16_bf16 v[40:55], v[96:99], v[216:219], v[40:55]
    ds_read_b128 v[88:91], v123 offset:53248
    buffer_load_dwordx4 v[136:139], v13, s[40:43], s12 offen offset:256 sc1
    s_waitcnt lgkmcnt(5)
    v_mfma_f32_32x32x16_bf16 v[40:55], v[100:103], v[220:223], v[40:55]
    ds_read_b128 v[92:95], v123 offset:54272
    buffer_load_dwordx4 v[140:143], v13, s[40:43], s13 offen offset:0 sc1
    s_waitcnt lgkmcnt(5)
    v_mfma_f32_32x32x16_bf16 v[40:55], v[72:75], v[224:227], v[40:55]
    ds_read_b128 v[96:99], v123 offset:55296
    buffer_load_dwordx4 v[144:147], v13, s[40:43], s13 offen offset:256 sc1
    s_waitcnt lgkmcnt(5)
    v_mfma_f32_32x32x16_bf16 v[40:55], v[76:79], v[228:231], v[40:55]
    ds_read_b128 v[100:103], v123 offset:56320
    buffer_load_dwordx4 v[128:131], v14, s[40:43], s12 offen sc1
    s_waitcnt lgkmcnt(5)
    v_mfma_f32_32x32x16_bf16 v[40:55], v[80:83], v[232:235], v[40:55]
    buffer_load_dwordx4 v[148:151], v13, s[40:43], s14 offen offset:0 sc1
    s_waitcnt lgkmcnt(4)
    v_mfma_f32_32x32x16_bf16 v[40:55], v[84:87], v[236:239], v[40:55]
    buffer_load_dwordx4 v[152:155], v13, s[40:43], s14 offen offset:256 sc1
    s_waitcnt lgkmcnt(3)
    v_mfma_f32_32x32x16_bf16 v[40:55], v[88:91], v[240:243], v[40:55]
    buffer_load_dwordx4 v[156:159], v13, s[40:43], s15 offen offset:0 sc1
    s_waitcnt lgkmcnt(2)
    v_mfma_f32_32x32x16_bf16 v[40:55], v[92:95], v[244:247], v[40:55]
    buffer_load_dwordx4 v[160:163], v13, s[40:43], s15 offen offset:256 sc1
    s_waitcnt lgkmcnt(1)
    v_mfma_f32_32x32x16_bf16 v[40:55], v[96:99], v[248:251], v[40:55]
    s_waitcnt lgkmcnt(0)
    v_mfma_f32_32x32x16_bf16 v[40:55], v[100:103], v[252:255], v[40:55]
    buffer_load_dword v164, v19, s[40:43], 0 offen offset:64 sc1
    ds_read_b128 v[192:195], v2 offset:36864
    ds_read_b128 v[196:199], v2 offset:37888
    s_nop 8
    s_nop 0
    v_max3_f32 v119, v40, v41, v42
    v_max3_f32 v121, v43, v44, v45
    v_max3_f32 v119, v119, v46, v47
    v_max3_f32 v121, v121, v48, v49
    v_max3_f32 v119, v119, v50, v51
    v_max3_f32 v121, v121, v52, v53
    v_max3_f32 v119, v119, v54, v55
    v_max_f32_e64 v119, v119, v121
    v_mul_f32 v119, -v119, v118
    v_pk_fma_f32 v[72:73], v[40:41], v[118:119], v[118:119] op_sel:[0,0,1] op_sel_hi:[1,0,1]
    v_pk_fma_f32 v[74:75], v[42:43], v[118:119], v[118:119] op_sel:[0,0,1] op_sel_hi:[1,0,1]
    v_pk_fma_f32 v[76:77], v[44:45], v[118:119], v[118:119] op_sel:[0,0,1] op_sel_hi:[1,0,1]
    v_pk_fma_f32 v[78:79], v[46:47], v[118:119], v[118:119] op_sel:[0,0,1] op_sel_hi:[1,0,1]
    v_pk_fma_f32 v[80:81], v[48:49], v[118:119], v[118:119] op_sel:[0,0,1] op_sel_hi:[1,0,1]
    v_pk_fma_f32 v[82:83], v[50:51], v[118:119], v[118:119] op_sel:[0,0,1] op_sel_hi:[1,0,1]
    v_pk_fma_f32 v[84:85], v[52:53], v[118:119], v[118:119] op_sel:[0,0,1] op_sel_hi:[1,0,1]
    v_pk_fma_f32 v[86:87], v[54:55], v[118:119], v[118:119] op_sel:[0,0,1] op_sel_hi:[1,0,1]
    v_exp_f32 v72, v72
    v_exp_f32 v73, v73
    v_exp_f32 v74, v74
    v_exp_f32 v75, v75
    v_exp_f32 v76, v76
    v_exp_f32 v77, v77
    v_exp_f32 v78, v78
    v_exp_f32 v79, v79
    v_exp_f32 v80, v80
    v_exp_f32 v81, v81
    v_exp_f32 v82, v82
    v_exp_f32 v83, v83
    v_exp_f32 v84, v84
    v_exp_f32 v85, v85
    v_exp_f32 v86, v86
    v_exp_f32 v87, v87
    v_pk_add_f32 v[124:125], v[72:73], v[74:75]
    v_pk_add_f32 v[112:113], v[76:77], v[78:79]
    v_pk_add_f32 v[124:125], v[124:125], v[80:81]
    v_pk_add_f32 v[112:113], v[112:113], v[82:83]
    v_pk_add_f32 v[124:125], v[124:125], v[84:85]
    v_pk_add_f32 v[112:113], v[112:113], v[86:87]
    v_pk_add_f32 v[124:125], v[124:125], v[112:113]
    v_add_f32 v124, v124, v125
    v_rcp_f32_e64 v124, v124
    s_nop 0
    v_pk_mul_f32 v[72:73], v[72:73], v[124:125] op_sel_hi:[1,0]
    v_pk_mul_f32 v[74:75], v[74:75], v[124:125] op_sel_hi:[1,0]
    v_pk_mul_f32 v[76:77], v[76:77], v[124:125] op_sel_hi:[1,0]
    v_pk_mul_f32 v[78:79], v[78:79], v[124:125] op_sel_hi:[1,0]
    v_pk_mul_f32 v[80:81], v[80:81], v[124:125] op_sel_hi:[1,0]
    v_pk_mul_f32 v[82:83], v[82:83], v[124:125] op_sel_hi:[1,0]
    v_pk_mul_f32 v[84:85], v[84:85], v[124:125] op_sel_hi:[1,0]
    v_pk_mul_f32 v[86:87], v[86:87], v[124:125] op_sel_hi:[1,0]
    v_cvt_pk_bf16_f32 v72, v72, v73
    v_cvt_pk_bf16_f32 v73, v74, v75
    v_cvt_pk_bf16_f32 v74, v76, v77
    v_cvt_pk_bf16_f32 v75, v78, v79
    v_cvt_pk_bf16_f32 v76, v80, v81
    v_cvt_pk_bf16_f32 v77, v82, v83
    v_cvt_pk_bf16_f32 v78, v84, v85
    v_cvt_pk_bf16_f32 v79, v86, v87
    v_min3_f32 v122, v40, v41, v42
L_pg8:
    s_cbranch_execz L_pgret1
    s_nop 0
    v_min3_f32 v123, v43, v44, v45
    v_min3_f32 v122, v122, v46, v47
    v_min3_f32 v123, v123, v48, v49
    v_min3_f32 v122, v122, v50, v51
    v_min3_f32 v123, v123, v52, v53
    v_min3_f32 v122, v122, v54, v55
    v_min_f32 v122, v122, v123
    v_mul_f32 v119, v122, v118
    v_pk_fma_f32 v[88:89], v[40:41], v[118:119], v[118:119] op_sel:[0,0,1] op_sel_hi:[1,0,1] neg_lo:[1,0,0] neg_hi:[1,0,0]
    v_pk_fma_f32 v[90:91], v[42:43], v[118:119], v[118:119] op_sel:[0,0,1] op_sel_hi:[1,0,1] neg_lo:[1,0,0] neg_hi:[1,0,0]
    v_pk_fma_f32 v[92:93], v[44:45], v[118:119], v[118:119] op_sel:[0,0,1] op_sel_hi:[1,0,1] neg_lo:[1,0,0] neg_hi:[1,0,0]
    v_pk_fma_f32 v[94:95], v[46:47], v[118:119], v[118:119] op_sel:[0,0,1] op_sel_hi:[1,0,1] neg_lo:[1,0,0] neg_hi:[1,0,0]
    v_pk_fma_f32 v[96:97], v[48:49], v[118:119], v[118:119] op_sel:[0,0,1] op_sel_hi:[1,0,1] neg_lo:[1,0,0] neg_hi:[1,0,0]
    v_pk_fma_f32 v[98:99], v[50:51], v[118:119], v[118:119] op_sel:[0,0,1] op_sel_hi:[1,0,1] neg_lo:[1,0,0] neg_hi:[1,0,0]
    v_pk_fma_f32 v[100:101], v[52:53], v[118:119], v[118:119] op_sel:[0,0,1] op_sel_hi:[1,0,1] neg_lo:[1,0,0] neg_hi:[1,0,0]
    v_pk_fma_f32 v[102:103], v[54:55], v[118:119], v[118:119] op_sel:[0,0,1] op_sel_hi:[1,0,1] neg_lo:[1,0,0] neg_hi:[1,0,0]
    v_exp_f32 v88, v88
    v_exp_f32 v89, v89
    v_exp_f32 v90, v90
    v_exp_f32 v91, v91
    v_exp_f32 v92, v92
    v_exp_f32 v93, v93
    v_exp_f32 v94, v94
    v_exp_f32 v95, v95
    v_exp_f32 v96, v96
    v_exp_f32 v97, v97
    v_exp_f32 v98, v98
    v_exp_f32 v99, v99
    v_exp_f32 v100, v100
    v_exp_f32 v101, v101
    v_exp_f32 v102, v102
    v_exp_f32 v103, v103
    v_pk_add_f32 v[124:125], v[88:89], v[90:91]
    v_pk_add_f32 v[112:113], v[92:93], v[94:95]
    v_pk_add_f32 v[124:125], v[124:125], v[96:97]
    v_pk_add_f32 v[112:113], v[112:113], v[98:99]
    v_pk_add_f32 v[124:125], v[124:125], v[100:101]
    v_pk_add_f32 v[112:113], v[112:113], v[102:103]
    v_pk_add_f32 v[124:125], v[124:125], v[112:113]
    v_add_f32 v124, v124, v125
    v_rcp_f32_e64 v124, v124
    s_nop 0
    v_pk_mul_f32 v[88:89], v[88:89], v[124:125] op_sel_hi:[1,0]
    v_pk_mul_f32 v[90:91], v[90:91], v[124:125] op_sel_hi:[1,0]
    v_pk_mul_f32 v[92:93], v[92:93], v[124:125] op_sel_hi:[1,0]
    v_pk_mul_f32 v[94:95], v[94:95], v[124:125] op_sel_hi:[1,0]
    v_pk_mul_f32 v[96:97], v[96:97], v[124:125] op_sel_hi:[1,0]
    v_pk_mul_f32 v[98:99], v[98:99], v[124:125] op_sel_hi:[1,0]
    v_pk_mul_f32 v[100:101], v[100:101], v[124:125] op_sel_hi:[1,0]
    v_pk_mul_f32 v[102:103], v[102:103], v[124:125] op_sel_hi:[1,0]
    s_waitcnt vmcnt(9) lgkmcnt(0)
    v_mfma_f32_16x16x32_bf16 v[56:59], v[192:195], v[132:135], 0
    v_cvt_pk_bf16_f32 v88, v88, v89
    v_cvt_pk_bf16_f32 v89, v90, v91
    s_waitcnt vmcnt(8)
    v_mfma_f32_16x16x32_bf16 v[56:59], v[196:199], v[136:139], v[56:59]
    v_cvt_pk_bf16_f32 v90, v92, v93
    v_cvt_pk_bf16_f32 v91, v94, v95
    s_waitcnt vmcnt(7)
    v_mfma_f32_16x16x32_bf16 v[56:59], v[192:195], v[140:143], v[56:59]
    v_cvt_pk_bf16_f32 v92, v96, v97
    v_cvt_pk_bf16_f32 v93, v98, v99
    s_waitcnt vmcnt(6)
    v_mfma_f32_16x16x32_bf16 v[56:59], v[196:199], v[144:147], v[56:59]
    v_cvt_pk_bf16_f32 v94, v100, v101
    v_cvt_pk_bf16_f32 v95, v102, v103
    v_permlane32_swap_b32 v72, v88
    v_permlane32_swap_b32 v73, v89
    v_permlane32_swap_b32 v74, v90
    v_permlane32_swap_b32 v75, v91
L_part3:
    s_waitcnt vmcnt(5)
    v_mfma_f32_16x16x32_bf16 v[60:63], v[192:195], v[128:131], 0
    s_waitcnt vmcnt(4)
    v_mfma_f32_16x16x32_bf16 v[56:59], v[192:195], v[148:151], v[56:59]
    s_waitcnt vmcnt(3)
    v_mfma_f32_16x16x32_bf16 v[56:59], v[196:199], v[152:155], v[56:59]
    s_waitcnt vmcnt(2)
    v_mfma_f32_16x16x32_bf16 v[56:59], v[192:195], v[156:159], v[56:59]
    v_cvt_pk_bf16_f32 v64, v60, v61
    v_cvt_pk_bf16_f32 v65, v62, v63
    s_waitcnt vmcnt(1)
    v_mfma_f32_16x16x32_bf16 v[56:59], v[196:199], v[160:163], v[56:59]
    s_mov_b64 exec, 0x00ff00ff
    ds_write_b64 v16, v[64:65]
    s_mov_b64 exec, -1
    s_nop 4
    v_cmp_u_f32 vcc, v56, v60
    v_cvt_pk_bf16_f32 v56, v56, v57
    v_cvt_pk_bf16_f32 v57, v58, v59
    ds_write_b64 v15, v[56:57]
    s_cbranch_vccnz L_partre
L_partok3:
    v_permlane32_swap_b32 v76, v92
    v_permlane32_swap_b32 v77, v93
    v_permlane32_swap_b32 v78, v94
    v_permlane32_swap_b32 v79, v95
    s_waitcnt lgkmcnt(0)
    s_barrier
    ds_read_b128 v[128:131], v17 offset:0
    ds_read_b128 v[132:135], v17 offset:16
    ds_read_b128 v[136:139], v17 offset:1600
    ds_read_b128 v[140:143], v17 offset:1616
    s_waitcnt lgkmcnt(3)
    v_mfma_f32_32x32x16_bf16 v[40:55], v[128:131], v[72:75], 0
    v_mov_b32 v106, 4
    s_waitcnt vmcnt(0)
    v_cmp_gt_u32 vcc, 3, v164
    s_waitcnt lgkmcnt(2)
    v_mfma_f32_32x32x16_bf16 v[40:55], v[132:135], v[76:79], v[40:55]
    s_cbranch_vccnz Lrefa_42
Lfc_41:
    s_waitcnt lgkmcnt(0)
    v_mfma_f32_32x32x16_bf16 v[56:71], v[136:139], v[88:91], 0
    v_mfma_f32_32x32x16_bf16 v[56:71], v[140:143], v[92:95], v[56:71]
    v_add_f32 v48, v48, v50
    v_add_f32 v49, v49, v51
    v_add_f32 v48, 0x358637bd, v48
    v_add_f32 v48, v48, v49
    v_rcp_f32_e64 v48, v48
    s_nop 0
    v_pk_mul_f32 v[40:41], v[40:41], v[48:49] op_sel_hi:[1,0]
    v_pk_mul_f32 v[42:43], v[42:43], v[48:49] op_sel_hi:[1,0]
    v_pk_mul_f32 v[44:45], v[44:45], v[48:49] op_sel_hi:[1,0]
    v_pk_mul_f32 v[46:47], v[46:47], v[48:49] op_sel_hi:[1,0]
    v_bfi_b32 v40, s60, v40, v4
    v_cvt_pk_bf16_f32 v40, v40, v41
    v_cvt_pk_bf16_f32 v41, v42, v43
    v_cvt_pk_bf16_f32 v42, v44, v45
    v_cvt_pk_bf16_f32 v43, v46, v47
    buffer_store_dwordx4 v[40:43], v1, s[44:47], s71 offen offset:0
    v_add_f32 v64, v64, v66
    v_add_f32 v65, v65, v67
    v_add_f32 v64, 0x358637bd, v64
    v_add_f32 v64, v64, v65
    v_rcp_f32_e64 v64, v64
    s_nop 0
    v_pk_mul_f32 v[56:57], v[56:57], v[64:65] op_sel_hi:[1,0]
    v_pk_mul_f32 v[58:59], v[58:59], v[64:65] op_sel_hi:[1,0]
    v_pk_mul_f32 v[60:61], v[60:61], v[64:65] op_sel_hi:[1,0]
    v_pk_mul_f32 v[62:63], v[62:63], v[64:65] op_sel_hi:[1,0]
    v_bfi_b32 v56, s60, v56, v4
    v_cvt_pk_bf16_f32 v56, v56, v57
    v_cvt_pk_bf16_f32 v57, v58, v59
    v_cvt_pk_bf16_f32 v58, v60, v61
    v_cvt_pk_bf16_f32 v59, v62, v63
    buffer_store_dwordx4 v[56:59], v1, s[44:47], s71 offen offset:1024
    s_mov_b64 exec, 1
    buffer_store_dword v106, off, s[40:43], s78 offset:0
    s_mov_b64 exec, -1
    s_and_b32 s84, s8, 0x6000
    v_add_u32 v116, s84, v2
    s_and_b32 s84, s9, 0x6000
    v_add_u32 v117, s84, v2
    s_and_b32 s84, s10, 0x6000
    v_add_u32 v118, s84, v2
    s_and_b32 s84, s11, 0x6000
    v_add_u32 v119, s84, v2
    v_and_or_b32 v141, v20, 60, s61
L_ore3:
    s_lshl2_add_u32 m0, s81, 114688
    buffer_load_dword v127, v18, s[40:43], 0 offen sc1
    s_cmp_eq_u32 s66, s0
    s_cbranch_scc0 Lpchk_44
    ds_write_b128 v116, v[40:43] offset:0
    ds_write_b128 v116, v[56:59] offset:1024
    s_branch L_oown3
L_opoll3:
    buffer_load_dword v127, v18, s[40:43], 0 offen sc1
    s_sub_u32 s68, s68, 1
    s_cbranch_scc1 L_end
L_oown3:
    s_waitcnt vmcnt(0)
    v_cmp_gt_u32 vcc, 4, v127
    s_cbranch_vccnz L_opoll3
    s_branch L_ojoin3
Lpoll_43:
    buffer_load_dword v127, v18, s[40:43], 0 offen sc1
    s_sub_u32 s68, s68, 1
    s_cbranch_scc1 L_end
Lpchk_44:
    s_waitcnt vmcnt(0)
    v_cmp_gt_u32 vcc, 4, v127
    s_cbranch_vccnz Lpoll_43
    buffer_load_dwordx4 v1, s[44:47], s72 offen offset:0 sc1 lds
    buffer_load_dwordx4 v1, s[44:47], s72 offen offset:1024 sc1 lds
L_ojoin3:
    s_lshl2_add_u32 m0, s81, 116736
    s_xor_b32 s84, s72, 2048
    buffer_load_dwordx4 v1, s[44:47], s84 offen offset:0 sc1 lds
    buffer_load_dwordx4 v1, s[44:47], s84 offen offset:1024 sc1 lds
    s_lshl2_add_u32 m0, s81, 118784
    s_xor_b32 s84, s72, 4096
    buffer_load_dwordx4 v1, s[44:47], s84 offen offset:0 sc1 lds
    buffer_load_dwordx4 v1, s[44:47], s84 offen offset:1024 sc1 lds
    s_lshl2_add_u32 m0, s81, 120832
    s_xor_b32 s84, s72, 6144
    buffer_load_dwordx4 v1, s[44:47], s84 offen offset:0 sc1 lds
    s_barrier
    buffer_load_dwordx4 v1, s[44:47], s84 offen offset:1024 sc1 lds
L_oskip3:
    s_waitcnt vmcnt(7)
    ds_read_b128 v[72:75], v116 offset:0
    s_waitcnt vmcnt(6)
    ds_read_b128 v[76:79], v116 offset:1024
    s_waitcnt vmcnt(5)
    ds_read_b128 v[80:83], v116 offset:2048
    s_waitcnt lgkmcnt(2)
    v_mfma_f32_32x32x16_bf16 v[40:55], a[128:131], v[72:75], v[24:39]
    s_waitcnt vmcnt(4)
    ds_read_b128 v[84:87], v116 offset:3072
    s_waitcnt lgkmcnt(2)
    v_mfma_f32_32x32x16_bf16 v[40:55], a[132:135], v[76:79], v[40:55]
    v_bitop3_b32 v12, 1, v72, v76 bitop3:0x80
    s_waitcnt vmcnt(3)
    ds_read_b128 v[88:91], v116 offset:4096
    s_waitcnt lgkmcnt(2)
    v_mfma_f32_32x32x16_bf16 v[40:55], a[136:139], v[80:83], v[40:55]
    s_waitcnt vmcnt(2)
    ds_read_b128 v[92:95], v116 offset:5120
    s_waitcnt lgkmcnt(2)
    v_mfma_f32_32x32x16_bf16 v[40:55], a[140:143], v[84:87], v[40:55]
    v_bitop3_b32 v12, v12, v80, v84 bitop3:0x80
    s_waitcnt vmcnt(1)
    ds_read_b128 v[96:99], v116 offset:6144
    s_waitcnt lgkmcnt(2)
    v_mfma_f32_32x32x16_bf16 v[40:55], a[144:147], v[88:91], v[40:55]
    s_waitcnt vmcnt(0)
    ds_read_b128 v[100:103], v116 offset:7168
    s_barrier
    s_waitcnt lgkmcnt(2)
    v_mfma_f32_32x32x16_bf16 v[40:55], a[148:151], v[92:95], v[40:55]
    v_bitop3_b32 v12, v12, v88, v92 bitop3:0x80
    ds_read_b128 v[72:75], v117 offset:0
    ds_read_b128 v[76:79], v117 offset:1024
    s_waitcnt lgkmcnt(3)
    v_mfma_f32_32x32x16_bf16 v[40:55], a[152:155], v[96:99], v[40:55]
    ds_read_b128 v[80:83], v117 offset:2048
    ds_read_b128 v[84:87], v117 offset:3072
    s_waitcnt lgkmcnt(4)
    v_mfma_f32_32x32x16_bf16 v[40:55], a[156:159], v[100:103], v[40:55]
    v_bitop3_b32 v12, v12, v96, v100 bitop3:0x80
    v_cmp_eq_u32 vcc, 0, v12
    ds_read_b128 v[88:91], v117 offset:4096
    ds_read_b128 v[92:95], v117 offset:5120
    s_waitcnt lgkmcnt(5)
    v_mfma_f32_32x32x16_bf16 v[40:55], a[160:163], v[72:75], v[40:55]
    ds_read_b128 v[96:99], v117 offset:6144
    ds_read_b128 v[100:103], v117 offset:7168
    s_cmp_eq_u64 vcc, 0
    s_cselect_b64 exec, 1, 0
    buffer_store_dword v106, off, s[40:43], s16 offset:64
    s_mov_b64 exec, -1
    s_cselect_b32 s62, 1, 0
    s_waitcnt lgkmcnt(6)
    v_mfma_f32_32x32x16_bf16 v[40:55], a[164:167], v[76:79], v[40:55]
    v_bitop3_b32 v12, v12, v72, v76 bitop3:0x80
    ds_read_b128 v[72:75], v118 offset:0
    s_waitcnt lgkmcnt(6)
    v_mfma_f32_32x32x16_bf16 v[40:55], a[168:171], v[80:83], v[40:55]
    ds_read_b128 v[76:79], v118 offset:1024
    v_and_b32 v104, 31, v0
    s_waitcnt lgkmcnt(6)
    v_mfma_f32_32x32x16_bf16 v[40:55], a[172:175], v[84:87], v[40:55]
    v_bitop3_b32 v12, v12, v80, v84 bitop3:0x80
    ds_read_b128 v[80:83], v118 offset:2048
    v_lshl_add_u32 v104, v104, 6, s81
    s_waitcnt lgkmcnt(6)
    v_mfma_f32_32x32x16_bf16 v[40:55], a[176:179], v[88:91], v[40:55]
    ds_read_b128 v[84:87], v118 offset:3072
    v_lshrrev_b32 v105, 4, v0
    s_waitcnt lgkmcnt(6)
    v_mfma_f32_32x32x16_bf16 v[40:55], a[180:183], v[92:95], v[40:55]
    v_bitop3_b32 v12, v12, v88, v92 bitop3:0x80
    ds_read_b128 v[88:91], v118 offset:4096
    v_xor_b32 v105, v105, v0
    s_waitcnt lgkmcnt(6)
    v_mfma_f32_32x32x16_bf16 v[40:55], a[120:123], v[96:99], v[40:55]
    ds_read_b128 v[92:95], v118 offset:5120
    v_and_b32 v105, 6, v105
    s_waitcnt lgkmcnt(6)
    v_mfma_f32_32x32x16_bf16 v[40:55], a[124:127], v[100:103], v[40:55]
    v_bitop3_b32 v12, v12, v96, v100 bitop3:0x80
    ds_read_b128 v[96:99], v118 offset:6144
    v_lshl_add_u32 v108, v105, 3, v104
    s_waitcnt lgkmcnt(6)
    v_mfma_f32_32x32x16_bf16 v[40:55], a[184:187], v[72:75], v[40:55]
    ds_read_b128 v[100:103], v118 offset:7168
    v_xor_b32 v109, 32, v108
    s_waitcnt lgkmcnt(6)
    v_mfma_f32_32x32x16_bf16 v[40:55], a[188:191], v[76:79], v[40:55]
    v_bitop3_b32 v12, v12, v72, v76 bitop3:0x80
    ds_read_b128 v[72:75], v119 offset:0
    v_lshrrev_b32 v104, 3, v0
    s_waitcnt lgkmcnt(6)
    v_mfma_f32_32x32x16_bf16 v[40:55], a[192:195], v[80:83], v[40:55]
    ds_read_b128 v[76:79], v119 offset:1024
    v_xor_b32 v104, v104, v0
    s_waitcnt lgkmcnt(6)
    v_mfma_f32_32x32x16_bf16 v[40:55], a[196:199], v[84:87], v[40:55]
    v_bitop3_b32 v12, v12, v80, v84 bitop3:0x80
    ds_read_b128 v[80:83], v119 offset:2048
    buffer_load_dword v140, v141, s[40:43], 0 offen offset:64 sc1
    v_and_b32 v104, 3, v104
    s_waitcnt lgkmcnt(6)
    v_mfma_f32_32x32x16_bf16 v[40:55], a[200:203], v[88:91], v[40:55]
    ds_read_b128 v[84:87], v119 offset:3072
    v_lshlrev_b32 v104, 4, v104
    s_waitcnt lgkmcnt(6)
    v_mfma_f32_32x32x16_bf16 v[40:55], a[204:207], v[92:95], v[40:55]
    v_bitop3_b32 v12, v12, v88, v92 bitop3:0x80
    ds_read_b128 v[88:91], v119 offset:4096
    v_lshrrev_b32 v105, 2, v0
    s_waitcnt lgkmcnt(6)
    v_mfma_f32_32x32x16_bf16 v[40:55], a[208:211], v[96:99], v[40:55]
    ds_read_b128 v[92:95], v119 offset:5120
    v_lshl_add_u32 v110, v105, 10, v104
    s_waitcnt lgkmcnt(6)
    v_mfma_f32_32x32x16_bf16 v[40:55], a[212:215], v[100:103], v[40:55]
    v_bitop3_b32 v12, v12, v96, v100 bitop3:0x80
    ds_read_b128 v[96:99], v119 offset:6144
    s_add_u32 s87, s89, 16384
    s_waitcnt lgkmcnt(6)
    v_mfma_f32_32x32x16_bf16 v[40:55], a[216:219], v[72:75], v[40:55]
    ds_read_b128 v[100:103], v119 offset:7168
    s_waitcnt lgkmcnt(6)
    v_mfma_f32_32x32x16_bf16 v[40:55], a[220:223], v[76:79], v[40:55]
    v_bitop3_b32 v12, v12, v72, v76 bitop3:0x80
    s_waitcnt lgkmcnt(5)
    v_mfma_f32_32x32x16_bf16 v[40:55], a[224:227], v[80:83], v[40:55]
    s_waitcnt lgkmcnt(4)
    v_bitop3_b32 v12, v12, v80, v84 bitop3:0x80
    s_waitcnt lgkmcnt(2)
    v_bitop3_b32 v12, v12, v88, v92 bitop3:0x80
    v_mfma_f32_32x32x16_bf16 v[40:55], a[228:231], v[84:87], v[40:55]
    s_waitcnt lgkmcnt(0)
    v_bitop3_b32 v12, v12, v96, v100 bitop3:0x80
    v_cmp_eq_u32 vcc, 0, v12
    v_mfma_f32_32x32x16_bf16 v[40:55], a[232:235], v[88:91], v[40:55]
    s_cbranch_vccnz L_obad3
    v_mfma_f32_32x32x16_bf16 v[40:55], a[236:239], v[92:95], v[40:55]
    s_waitcnt vmcnt(0)
    v_cmp_gt_u32 vcc, 4, v140
    v_mfma_f32_32x32x16_bf16 v[40:55], a[240:243], v[96:99], v[40:55]
    s_cbranch_vccnz Lrefb_46
Lfc_45:
    v_mfma_f32_32x32x16_bf16 v[24:39], a[244:247], v[100:103], v[40:55]
    s_nop 11
    s_nop 0
    v_cvt_pk_bf16_f32 v43, v30, v31
    v_cvt_pk_bf16_f32 v42, v28, v29
    v_cvt_pk_bf16_f32 v41, v26, v27
    v_cvt_pk_bf16_f32 v40, v24, v25
    ds_write_b128 v108, v[40:43]
    v_cvt_pk_bf16_f32 v47, v38, v39
    v_cvt_pk_bf16_f32 v46, v36, v37
    v_cvt_pk_bf16_f32 v45, v34, v35
    v_cvt_pk_bf16_f32 v44, v32, v33
    ds_write_b128 v109, v[44:47]
    ds_read_b128 v[56:59], v21 offset:0
    ds_read_b128 v[60:63], v21 offset:1024
    s_waitcnt lgkmcnt(1)
    buffer_store_dwordx4 v[56:59], v110, s[44:47], s89 offen
    s_waitcnt lgkmcnt(0)
    buffer_store_dwordx4 v[60:63], v110, s[44:47], s87 offen
    s_endpgm
L_cold0:
    s_endpgm
Lrdyr_7:
    s_sub_u32 s68, s68, 1
    s_cbranch_scc1 L_end
    buffer_load_dword v252, v34, s[48:51], 0 offen sc1
    s_waitcnt vmcnt(0)
    s_branch Lrdyp_6
L_rdyre:
    s_sub_u32 s68, s68, 1
    s_cbranch_scc1 L_end
    buffer_load_dword v38, v21, s[40:43], 0 offen sc1
    buffer_load_dword v112, v113, s[40:43], 0 offen sc1
    s_waitcnt vmcnt(0)
L_notrdy:
    v_cmp_gt_u32 vcc, 0x80, v38
    v_cmp_ne_u32 s[92:93], s84, v38
    s_cbranch_vccnz L_rdyre
    s_and_b32 s85, s93, 0xffff
    s_cbranch_scc0 L_switch
    s_branch L_switch_s
L_cold1:
.p2align 6
L_partre:
    s_cbranch_execz L_pgret1
    v_cmp_eq_u32 s[20:21], -1, v132
    v_cmp_eq_u32 s[22:23], -1, v136
    v_cmp_eq_u32 s[24:25], -1, v140
    v_cmp_eq_u32 s[26:27], -1, v144
    v_cmp_eq_u32 s[18:19], -1, v128
    v_cmp_eq_u32 s[28:29], -1, v148
    v_cmp_eq_u32 s[30:31], -1, v152
    v_cmp_eq_u32 s[56:57], -1, v156
    v_cmp_eq_u32 s[58:59], -1, v160
    s_mov_b64 exec, s[20:21]
    buffer_load_dwordx4 v[132:135], v13, s[40:43], s12 offen offset:0 sc1
    s_mov_b64 exec, s[22:23]
    buffer_load_dwordx4 v[136:139], v13, s[40:43], s12 offen offset:256 sc1
    s_mov_b64 exec, s[24:25]
    buffer_load_dwordx4 v[140:143], v13, s[40:43], s13 offen offset:0 sc1
    s_mov_b64 exec, s[26:27]
    buffer_load_dwordx4 v[144:147], v13, s[40:43], s13 offen offset:256 sc1
    s_mov_b64 exec, s[18:19]
    buffer_load_dwordx4 v[128:131], v14, s[40:43], s12 offen sc1
    s_mov_b64 exec, s[28:29]
    buffer_load_dwordx4 v[148:151], v13, s[40:43], s14 offen offset:0 sc1
    s_mov_b64 exec, s[30:31]
    buffer_load_dwordx4 v[152:155], v13, s[40:43], s14 offen offset:256 sc1
    s_mov_b64 exec, s[56:57]
    buffer_load_dwordx4 v[156:159], v13, s[40:43], s15 offen offset:0 sc1
    s_mov_b64 exec, s[58:59]
    buffer_load_dwordx4 v[160:163], v13, s[40:43], s15 offen offset:256 sc1
    s_mov_b64 exec, -1
    s_or_b64 s[18:19], s[18:19], s[20:21]
    s_or_b64 s[18:19], s[18:19], s[22:23]
    s_or_b64 s[18:19], s[18:19], s[24:25]
    s_or_b64 s[18:19], s[18:19], s[26:27]
    s_or_b64 s[18:19], s[18:19], s[28:29]
    s_or_b64 s[18:19], s[18:19], s[30:31]
    s_or_b64 s[18:19], s[18:19], s[56:57]
    s_or_b64 s[18:19], s[18:19], s[58:59]
    s_cbranch_scc0 L_scan
L_resum:
    s_sub_u32 s68, s68, 1
    s_cbranch_scc1 L_end
    s_cmp_eq_u32 s67, 0
    s_cbranch_scc1 L_part_w0
    s_cmp_eq_u32 s67, 1
    s_cbranch_scc1 L_part_w1
    s_cmp_eq_u32 s67, 2
    s_cbranch_scc1 L_part_w2
L_part_w3:
    s_waitcnt vmcnt(0)
    v_mfma_f32_16x16x32_bf16 v[56:59], v[192:195], v[132:135], 0
    v_mfma_f32_16x16x32_bf16 v[56:59], v[196:199], v[136:139], v[56:59]
    v_mfma_f32_16x16x32_bf16 v[56:59], v[192:195], v[140:143], v[56:59]
    v_mfma_f32_16x16x32_bf16 v[56:59], v[196:199], v[144:147], v[56:59]
    s_branch L_part3
L_part_w0:
    s_waitcnt vmcnt(0)
    s_branch L_part0
L_part_w1:
    s_waitcnt vmcnt(0)
    s_nop 1
    v_mfma_f32_16x16x32_bf16 v[56:59], v[192:195], v[132:135], 0
    v_mfma_f32_16x16x32_bf16 v[56:59], v[196:199], v[136:139], v[56:59]
    v_mfma_f32_16x16x32_bf16 v[56:59], v[192:195], v[140:143], v[56:59]
    v_mfma_f32_16x16x32_bf16 v[56:59], v[196:199], v[144:147], v[56:59]
    s_branch L_part1
L_part_w2:
    s_waitcnt vmcnt(0)
    s_nop 3
    v_mfma_f32_16x16x32_bf16 v[56:59], v[192:195], v[132:135], 0
    v_mfma_f32_16x16x32_bf16 v[56:59], v[196:199], v[136:139], v[56:59]
    v_mfma_f32_16x16x32_bf16 v[56:59], v[192:195], v[140:143], v[56:59]
    v_mfma_f32_16x16x32_bf16 v[56:59], v[196:199], v[144:147], v[56:59]
    s_branch L_part2
Lrefb_13:
    s_sub_u32 s68, s68, 1
    s_cbranch_scc1 L_end
    buffer_load_dword v140, v141, s[40:43], 0 offen offset:64 sc1
    s_waitcnt vmcnt(0)
    v_cmp_gt_u32 vcc, 1, v140
    s_cbranch_vccnz Lrefb_13
    s_branch Lfc_12
Lrefb_24:
    s_sub_u32 s68, s68, 1
    s_cbranch_scc1 L_end
    buffer_load_dword v140, v141, s[40:43], 0 offen offset:64 sc1
    s_waitcnt vmcnt(0)
    v_cmp_gt_u32 vcc, 2, v140
    s_cbranch_vccnz Lrefb_24
    s_branch Lfc_23
Lrefb_35:
    s_sub_u32 s68, s68, 1
    s_cbranch_scc1 L_end
    buffer_load_dword v140, v141, s[40:43], 0 offen offset:64 sc1
    s_waitcnt vmcnt(0)
    v_cmp_gt_u32 vcc, 3, v140
    s_cbranch_vccnz Lrefb_35
    s_branch Lfc_34
Lrefb_46:
    s_sub_u32 s68, s68, 1
    s_cbranch_scc1 L_end
    buffer_load_dword v140, v141, s[40:43], 0 offen offset:64 sc1
    s_waitcnt vmcnt(0)
    v_cmp_gt_u32 vcc, 4, v140
    s_cbranch_vccnz Lrefb_46
    s_branch Lfc_45
Lstre_17:
    s_sub_u32 s68, s68, 1
    s_cbranch_scc1 L_end
    buffer_load_dword v112, v20, s[40:43], s77 offen offset:256 sc1
    buffer_load_dword v113, v20, s[40:43], s77 offen offset:1280 sc1
    buffer_load_dword v114, v20, s[40:43], s77 offen offset:2304 sc1
    buffer_load_dword v115, v20, s[40:43], s77 offen offset:3328 sc1
    s_waitcnt vmcnt(0)
    v_max3_u32 v120, v112, v113, v114
    v_max_u32 v120, v120, v115
    v_cmp_eq_u32 vcc, -1, v120
    s_cbranch_vccnz Lstre_17
    s_branch Lstok_18
L_xbad1:
    s_sub_u32 s68, s68, 1
    s_cbranch_scc1 L_end
    s_waitcnt vmcnt(0) lgkmcnt(0)
    s_nop 7
    s_xor_b32 s96, s70, 0
    buffer_load_dwordx4 v[128:131], v1, s[44:47], s96 offen offset:0 sc1
    buffer_load_dwordx4 v[132:135], v1, s[44:47], s96 offen offset:1024 sc1
    buffer_load_dwordx4 v[136:139], v1, s[44:47], s96 offen offset:2048 sc1
    buffer_load_dwordx4 v[140:143], v1, s[44:47], s96 offen offset:3072 sc1
    s_xor_b32 s96, s70, 4096
    buffer_load_dwordx4 v[144:147], v1, s[44:47], s96 offen offset:0 sc1
    s_waitcnt lgkmcnt(0)
    s_branch L_xre1
Lrefa_20:
    s_sub_u32 s68, s68, 1
    s_cbranch_scc1 L_end
    buffer_load_dword v164, v19, s[40:43], 0 offen offset:64 sc1
    s_waitcnt vmcnt(0)
    v_cmp_gt_u32 vcc, 1, v164
    s_cbranch_vccnz Lrefa_20
    s_branch Lfc_19
L_obad1:
    s_sub_u32 s68, s68, 1
    s_cbranch_scc1 L_end
    s_waitcnt vmcnt(0) lgkmcnt(0)
    s_barrier
    s_nop 7
    s_cmp_eq_u32 s62, 0
    s_cbranch_scc0 L_okeep1
    s_cmp_eq_u32 s66, s0
    s_cbranch_scc1 L_opoll1
    s_branch L_ore1
L_okeep1:
    s_barrier
    s_branch L_oskip1
Lstre_28:
    s_sub_u32 s68, s68, 1
    s_cbranch_scc1 L_end
    buffer_load_dword v112, v20, s[40:43], s77 offen offset:512 sc1
    buffer_load_dword v113, v20, s[40:43], s77 offen offset:1536 sc1
    buffer_load_dword v114, v20, s[40:43], s77 offen offset:2560 sc1
    buffer_load_dword v115, v20, s[40:43], s77 offen offset:3584 sc1
    s_waitcnt vmcnt(0)
    v_max3_u32 v120, v112, v113, v114
    v_max_u32 v120, v120, v115
    v_cmp_eq_u32 vcc, -1, v120
    s_cbranch_vccnz Lstre_28
    s_branch Lstok_29
L_xbad2:
    s_sub_u32 s68, s68, 1
    s_cbranch_scc1 L_end
    s_waitcnt vmcnt(0) lgkmcnt(0)
    s_nop 7
    ds_read_b64_tr_b16 v[72:73], v3 offset:0
    ds_read_b64_tr_b16 v[74:75], v3 offset:256
    ds_read_b64_tr_b16 v[76:77], v3 offset:32768
    ds_read_b64_tr_b16 v[78:79], v3 offset:33024
    ds_read_b64_tr_b16 v[80:81], v3 offset:1024
    ds_read_b64_tr_b16 v[82:83], v3 offset:1280
    ds_read_b64_tr_b16 v[84:85], v3 offset:33792
    ds_read_b64_tr_b16 v[86:87], v3 offset:34048
    ds_read_b64_tr_b16 v[88:89], v3 offset:2048
    ds_read_b64_tr_b16 v[90:91], v3 offset:2304
    ds_read_b64_tr_b16 v[92:93], v3 offset:34816
    ds_read_b64_tr_b16 v[94:95], v3 offset:35072
    s_xor_b32 s96, s70, 0
    buffer_load_dwordx4 v[128:131], v1, s[44:47], s96 offen offset:0 sc1
    buffer_load_dwordx4 v[132:135], v1, s[44:47], s96 offen offset:1024 sc1
    buffer_load_dwordx4 v[136:139], v1, s[44:47], s96 offen offset:2048 sc1
    buffer_load_dwordx4 v[140:143], v1, s[44:47], s96 offen offset:3072 sc1
    s_waitcnt lgkmcnt(0)
    s_branch L_xre2
Lrefa_31:
    s_sub_u32 s68, s68, 1
    s_cbranch_scc1 L_end
    buffer_load_dword v164, v19, s[40:43], 0 offen offset:64 sc1
    s_waitcnt vmcnt(0)
    v_cmp_gt_u32 vcc, 2, v164
    s_cbranch_vccnz Lrefa_31
    s_branch Lfc_30
L_obad2:
    s_sub_u32 s68, s68, 1
    s_cbranch_scc1 L_end
    s_waitcnt vmcnt(0) lgkmcnt(0)
    s_barrier
    s_nop 7
    s_cmp_eq_u32 s62, 0
    s_cbranch_scc0 L_okeep2
    s_cmp_eq_u32 s66, s0
    s_cbranch_scc1 L_opoll2
    s_branch L_ore2
L_okeep2:
    s_barrier
    s_branch L_oskip2
Lstre_39:
    s_sub_u32 s68, s68, 1
    s_cbranch_scc1 L_end
    buffer_load_dword v112, v20, s[40:43], s77 offen offset:768 sc1
    buffer_load_dword v113, v20, s[40:43], s77 offen offset:1792 sc1
    buffer_load_dword v114, v20, s[40:43], s77 offen offset:2816 sc1
    buffer_load_dword v115, v20, s[40:43], s77 offen offset:3840 sc1
    s_waitcnt vmcnt(0)
    v_max3_u32 v120, v112, v113, v114
    v_max_u32 v120, v120, v115
    v_cmp_eq_u32 vcc, -1, v120
    s_cbranch_vccnz Lstre_39
    s_branch Lstok_40
L_xbad3:
    s_sub_u32 s68, s68, 1
    s_cbranch_scc1 L_end
    s_waitcnt vmcnt(0) lgkmcnt(0)
    s_nop 7
    ds_read_b128 v[72:75], v1 offset:0
    ds_read_b128 v[76:79], v1 offset:32768
    ds_read_b128 v[80:83], v1 offset:1024
    ds_read_b128 v[84:87], v1 offset:33792
    ds_read_b128 v[88:91], v1 offset:2048
    ds_read_b128 v[92:95], v1 offset:34816
    s_xor_b32 s96, s70, 0
    buffer_load_dwordx4 v[128:131], v1, s[44:47], s96 offen offset:0 sc1
    buffer_load_dwordx4 v[132:135], v1, s[44:47], s96 offen offset:1024 sc1
    buffer_load_dwordx4 v[136:139], v1, s[44:47], s96 offen offset:2048 sc1
    buffer_load_dwordx4 v[140:143], v1, s[44:47], s96 offen offset:3072 sc1
    s_waitcnt lgkmcnt(0)
    s_branch L_xre3
L_scan:
    v_max3_u32 v104, v128, v129, v130
    v_max3_u32 v104, v104, v131, v132
    v_max3_u32 v104, v104, v133, v134
    v_max3_u32 v104, v104, v135, v136
    v_max3_u32 v104, v104, v137, v138
    v_max3_u32 v104, v104, v139, v140
    v_max3_u32 v104, v104, v141, v142
    v_max3_u32 v104, v104, v143, v144
    v_max3_u32 v104, v104, v145, v146
    v_max3_u32 v104, v104, v147, v148
    v_max3_u32 v104, v104, v149, v150
    v_max3_u32 v104, v104, v151, v152
    v_max3_u32 v104, v104, v153, v154
    v_max3_u32 v104, v104, v155, v156
    v_max3_u32 v104, v104, v157, v158
    v_max3_u32 v104, v104, v159, v160
    v_max3_u32 v104, v104, v161, v162
    v_max_u32 v104, v104, v163
    v_cmp_eq_u32 vcc, -1, v104
    s_cbranch_vccnz L_all
    s_cmp_eq_u32 s67, 0
    s_cbranch_scc1 L_partok0
    s_cmp_eq_u32 s67, 1
    s_cbranch_scc1 L_partok1
    s_cmp_eq_u32 s67, 2
    s_cbranch_scc1 L_partok2
    s_branch L_partok3
L_all:
    buffer_load_dwordx4 v[128:131], v14, s[40:43], s12 offen sc1
    buffer_load_dwordx4 v[132:135], v13, s[40:43], s12 offen offset:0 sc1
    buffer_load_dwordx4 v[136:139], v13, s[40:43], s12 offen offset:256 sc1
    buffer_load_dwordx4 v[140:143], v13, s[40:43], s13 offen offset:0 sc1
    buffer_load_dwordx4 v[144:147], v13, s[40:43], s13 offen offset:256 sc1
    buffer_load_dwordx4 v[148:151], v13, s[40:43], s14 offen offset:0 sc1
    buffer_load_dwordx4 v[152:155], v13, s[40:43], s14 offen offset:256 sc1
    buffer_load_dwordx4 v[156:159], v13, s[40:43], s15 offen offset:0 sc1
    buffer_load_dwordx4 v[160:163], v13, s[40:43], s15 offen offset:256 sc1
    s_branch L_resum
Lrefa_42:
    s_sub_u32 s68, s68, 1
    s_cbranch_scc1 L_end
    buffer_load_dword v164, v19, s[40:43], 0 offen offset:64 sc1
    s_waitcnt vmcnt(0)
    v_cmp_gt_u32 vcc, 3, v164
    s_cbranch_vccnz Lrefa_42
    s_branch Lfc_41
L_obad3:
    s_sub_u32 s68, s68, 1
    s_cbranch_scc1 L_end
    s_waitcnt vmcnt(0) lgkmcnt(0)
    s_barrier
    s_nop 7
    s_cmp_eq_u32 s62, 0
    s_cbranch_scc0 L_okeep3
    s_cmp_eq_u32 s66, s0
    s_cbranch_scc1 L_opoll3
    s_branch L_ore3
L_okeep3:
    s_barrier
    s_branch L_oskip3
L_end:
    s_endpgm
L_switch_s:
    s_waitcnt lgkmcnt(4)
    s_barrier
    ds_read2st64_b32 v[104:105], v22 offset0:0 offset1:1
    ds_read2st64_b32 v[106:107], v22 offset0:2 offset1:3
    ds_read2st64_b32 v[108:109], v22 offset0:4 offset1:5
    ds_read2st64_b32 v[110:111], v22 offset0:6 offset1:7
    v_mfma_f32_32x32x16_bf16 v[40:55], v[76:79], v[244:247], v[40:55]
    ds_read_b64_tr_b16 v[100:101], v3 offset:64512
    ds_read_b64_tr_b16 v[102:103], v3 offset:64768
    s_mov_b32 exec_hi, 0
    buffer_store_dword v36, v20, s[40:43], s7 offen sc1
    s_mov_b32 exec_hi, -1
    v_mov_b32 v24, -1
    v_mov_b32 v25, -1
    v_mov_b32 v26, -1
    v_mov_b32 v27, -1
    s_add_u32 s87, s74, 557056
    s_mov_b32 exec_hi, 0
    buffer_store_dwordx4 v[24:27], v11, s[40:43], s87 offen sc1
    s_mov_b32 exec_hi, -1
    v_mul_f32 v112, 0x3b000000, v112
    v_mov_b32 v113, v112
    v_cmp_gt_u32 vcc, 32, v0
    v_mfma_f32_32x32x16_bf16 v[40:55], v[80:83], v[248:251], v[40:55]
    s_add_u32 m0, s81, 115712
    s_add_u32 s94, s23, 49152
    buffer_load_dwordx4 v5, s[32:35], s94 offen lds
    v_permlane32_swap_b32 v112, v113
    v_fma_f32 v113, -v112, v112, v113
    v_cndmask_b32 v112, 0, v112, vcc
    v_mfma_f32_32x32x16_bf16 v[56:71], v[84:87], v[240:243], v[56:71]
    v_cvt_pk_bf16_f32 v117, -v112, 0
    v_lshlrev_b32 v114, 16, v117
    v_sub_f32 v114, -v112, v114
    v_cvt_pk_bf16_f32 v116, -v112, v114
    v_mfma_f32_32x32x16_bf16 v[40:55], v[88:91], v[252:255], v[40:55]
    s_waitcnt lgkmcnt(2)
    v_add_f32 v104, v104, v105
    v_add_f32 v106, v106, v107
    v_add_f32 v106, v104, v106
    v_cvt_pk_bf16_f32 v104, v106, v106
    v_and_b32 v107, 0xffff0000, v104
    v_sub_f32 v107, v106, v107
    v_cvt_pk_bf16_f32 v105, v107, 0
    v_add_f32 v108, v108, v109
    v_add_f32 v110, v110, v111
    v_add_f32 v110, v108, v110
    v_mfma_f32_32x32x8_bf16 v[40:55], v[104:105], v[116:117], v[40:55]
    v_cvt_pk_bf16_f32 v108, v110, v110
    v_and_b32 v111, 0xffff0000, v108
    v_sub_f32 v111, v110, v111
    v_cvt_pk_bf16_f32 v109, v111, 0
    v_max_f32 v113, 0, v113
    v_mfma_f32_32x32x16_bf16 v[56:71], v[92:95], v[244:247], v[56:71]
    v_add_f32 v113, 0x3727c5ac, v113
    v_rsq_f32 v120, v113
    v_mfma_f32_32x32x8_bf16 v[56:71], v[108:109], v[116:117], v[56:71]
    v_mul_f32 v118, 0x3fb8aa3b, v120
    ds_read_b128 v[104:107], v2 offset:32768
    ds_read_b128 v[108:111], v2 offset:33792
    v_mfma_f32_32x32x16_bf16 v[56:71], v[96:99], v[248:251], v[56:71]
    v_cvt_pk_bf16_f32 v40, v40, v41
    v_cvt_pk_bf16_f32 v41, v42, v43
    v_cvt_pk_bf16_f32 v42, v44, v45
    v_cvt_pk_bf16_f32 v43, v46, v47
    s_waitcnt lgkmcnt(2)
    v_mfma_f32_32x32x16_bf16 v[56:71], v[100:103], v[252:255], v[56:71]
    v_cvt_pk_bf16_f32 v44, v48, v49
    v_cvt_pk_bf16_f32 v45, v50, v51
    v_cvt_pk_bf16_f32 v46, v52, v53
    v_cvt_pk_bf16_f32 v47, v54, v55
    s_waitcnt lgkmcnt(0)
    v_mfma_f32_32x32x16_bf16 v[72:87], v[104:107], v[40:43], 0
    v_mfma_f32_32x32x16_bf16 v[88:103], v[108:111], v[44:47], 0
    v_mul_f32 v56, v56, v120
    v_mul_f32 v57, v57, v120
    v_mul_f32 v58, v58, v120
    v_mul_f32 v59, v59, v120
    v_mul_f32 v60, v60, v120
    v_mul_f32 v61, v61, v120
    v_mul_f32 v62, v62, v120
    v_mul_f32 v63, v63, v120
    v_cvt_pk_bf16_f32 v56, v56, v57
    v_cvt_pk_bf16_f32 v57, v58, v59
    v_cvt_pk_bf16_f32 v58, v60, v61
    v_cvt_pk_bf16_f32 v59, v62, v63
    ds_write_b128 v8, v[56:59]
    v_pk_mul_f32 v[64:65], v[64:65], v[120:121] op_sel_hi:[1,0]
    v_pk_mul_f32 v[66:67], v[66:67], v[120:121] op_sel_hi:[1,0]
    v_pk_mul_f32 v[68:69], v[68:69], v[120:121] op_sel_hi:[1,0]
    v_pk_mul_f32 v[70:71], v[70:71], v[120:121] op_sel_hi:[1,0]
    s_add_u32 s95, s8, 0
    buffer_load_dwordx4 a[0:3], v1, s[40:43], s95 offen offset:0 sc1
    v_cvt_pk_bf16_f32 v60, v64, v65
    v_cvt_pk_bf16_f32 v61, v66, v67
    v_cvt_pk_bf16_f32 v62, v68, v69
    v_cvt_pk_bf16_f32 v63, v70, v71
    v_max3_f32 v122, v72, v73, v74
    v_max3_f32 v123, v75, v76, v77
    v_max3_f32 v122, v122, v78, v79
    v_max3_f32 v123, v123, v80, v81
    v_max3_f32 v122, v122, v82, v83
    v_max3_f32 v123, v123, v84, v85
    ds_write_b128 v8, v[60:63] offset:4096
    v_max3_f32 v122, v122, v86, v87
    v_max_f32 v122, v122, v123
    v_mul_f32 v119, -v122, v118
    v_pk_fma_f32 v[72:73], v[72:73], v[118:119], v[118:119] op_sel:[0,0,1] op_sel_hi:[1,0,1]
    v_pk_fma_f32 v[74:75], v[74:75], v[118:119], v[118:119] op_sel:[0,0,1] op_sel_hi:[1,0,1]
    v_pk_fma_f32 v[76:77], v[76:77], v[118:119], v[118:119] op_sel:[0,0,1] op_sel_hi:[1,0,1]
    buffer_load_dwordx4 a[4:7], v1, s[40:43], s95 offen offset:1024 sc1
    v_pk_fma_f32 v[78:79], v[78:79], v[118:119], v[118:119] op_sel:[0,0,1] op_sel_hi:[1,0,1]
    v_pk_fma_f32 v[80:81], v[80:81], v[118:119], v[118:119] op_sel:[0,0,1] op_sel_hi:[1,0,1]
    v_pk_fma_f32 v[82:83], v[82:83], v[118:119], v[118:119] op_sel:[0,0,1] op_sel_hi:[1,0,1]
    v_pk_fma_f32 v[84:85], v[84:85], v[118:119], v[118:119] op_sel:[0,0,1] op_sel_hi:[1,0,1]
    v_pk_fma_f32 v[86:87], v[86:87], v[118:119], v[118:119] op_sel:[0,0,1] op_sel_hi:[1,0,1]
    v_exp_f32 v72, v72
    v_exp_f32 v73, v73
    v_exp_f32 v74, v74
    v_exp_f32 v75, v75
    v_exp_f32 v76, v76
    v_exp_f32 v77, v77
    buffer_load_dwordx4 a[8:11], v1, s[40:43], s95 offen offset:2048 sc1
    v_exp_f32 v78, v78
    v_exp_f32 v79, v79
    v_exp_f32 v80, v80
    v_exp_f32 v81, v81
    v_exp_f32 v82, v82
    v_exp_f32 v83, v83
    v_exp_f32 v84, v84
    v_exp_f32 v85, v85
    buffer_load_dwordx4 a[12:15], v1, s[40:43], s95 offen offset:3072 sc1
    v_exp_f32 v86, v86
    v_exp_f32 v87, v87
    v_pk_add_f32 v[124:125], v[72:73], v[74:75]
    v_pk_add_f32 v[126:127], v[76:77], v[78:79]
    v_pk_add_f32 v[124:125], v[124:125], v[80:81]
    v_pk_add_f32 v[126:127], v[126:127], v[82:83]
    v_pk_add_f32 v[124:125], v[124:125], v[84:85]
    v_pk_add_f32 v[126:127], v[126:127], v[86:87]
    v_pk_add_f32 v[124:125], v[124:125], v[126:127]
    v_add_f32 v124, v124, v125
    v_rcp_f32 v124, v124
    s_nop 0
    v_pk_mul_f32 v[72:73], v[72:73], v[124:125] op_sel_hi:[1,0]
    v_pk_mul_f32 v[74:75], v[74:75], v[124:125] op_sel_hi:[1,0]
    s_add_u32 s95, s8, 4096
    buffer_load_dwordx4 a[16:19], v1, s[40:43], s95 offen offset:0 sc1
    v_pk_mul_f32 v[76:77], v[76:77], v[124:125] op_sel_hi:[1,0]
    v_pk_mul_f32 v[78:79], v[78:79], v[124:125] op_sel_hi:[1,0]
    v_cvt_pk_bf16_f32 v72, v72, v73
    v_cvt_pk_bf16_f32 v73, v74, v75
    v_cvt_pk_bf16_f32 v74, v76, v77
    v_cvt_pk_bf16_f32 v75, v78, v79
    ds_write_b128 v6, v[72:75]
    v_pk_mul_f32 v[80:81], v[80:81], v[124:125] op_sel_hi:[1,0]
    v_pk_mul_f32 v[82:83], v[82:83], v[124:125] op_sel_hi:[1,0]
    v_pk_mul_f32 v[84:85], v[84:85], v[124:125] op_sel_hi:[1,0]
    v_pk_mul_f32 v[86:87], v[86:87], v[124:125] op_sel_hi:[1,0]
    v_cvt_pk_bf16_f32 v76, v80, v81
    v_cvt_pk_bf16_f32 v77, v82, v83
    v_cvt_pk_bf16_f32 v78, v84, v85
    v_cvt_pk_bf16_f32 v79, v86, v87
    v_max3_f32 v122, v88, v89, v90
    v_max3_f32 v123, v91, v92, v93
    buffer_load_dwordx4 a[20:23], v1, s[40:43], s95 offen offset:1024 sc1
    v_max3_f32 v122, v122, v94, v95
    v_max3_f32 v123, v123, v96, v97
    v_max3_f32 v122, v122, v98, v99
    v_max3_f32 v123, v123, v100, v101
    ds_write_b128 v7, v[76:79]
    v_max3_f32 v122, v122, v102, v103
    v_max_f32 v122, v122, v123
    v_mul_f32 v119, -v122, v118
    v_pk_fma_f32 v[88:89], v[88:89], v[118:119], v[118:119] op_sel:[0,0,1] op_sel_hi:[1,0,1]
    v_pk_fma_f32 v[90:91], v[90:91], v[118:119], v[118:119] op_sel:[0,0,1] op_sel_hi:[1,0,1]
    v_pk_fma_f32 v[92:93], v[92:93], v[118:119], v[118:119] op_sel:[0,0,1] op_sel_hi:[1,0,1]
    v_pk_fma_f32 v[94:95], v[94:95], v[118:119], v[118:119] op_sel:[0,0,1] op_sel_hi:[1,0,1]
    v_pk_fma_f32 v[96:97], v[96:97], v[118:119], v[118:119] op_sel:[0,0,1] op_sel_hi:[1,0,1]
    v_pk_fma_f32 v[98:99], v[98:99], v[118:119], v[118:119] op_sel:[0,0,1] op_sel_hi:[1,0,1]
    v_pk_fma_f32 v[100:101], v[100:101], v[118:119], v[118:119] op_sel:[0,0,1] op_sel_hi:[1,0,1]
    v_pk_fma_f32 v[102:103], v[102:103], v[118:119], v[118:119] op_sel:[0,0,1] op_sel_hi:[1,0,1]
    v_exp_f32 v88, v88
    buffer_load_dwordx4 a[24:27], v1, s[40:43], s95 offen offset:2048 sc1
    v_exp_f32 v89, v89
    v_exp_f32 v90, v90
    v_exp_f32 v91, v91
    v_exp_f32 v92, v92
    v_exp_f32 v93, v93
    v_exp_f32 v94, v94
    v_exp_f32 v95, v95
    v_exp_f32 v96, v96
    buffer_load_dwordx4 a[28:31], v1, s[40:43], s95 offen offset:3072 sc1
    v_exp_f32 v97, v97
    v_exp_f32 v98, v98
    v_exp_f32 v99, v99
    v_exp_f32 v100, v100
    v_exp_f32 v101, v101
    v_exp_f32 v102, v102
    v_exp_f32 v103, v103
    v_pk_add_f32 v[124:125], v[88:89], v[90:91]
    v_pk_add_f32 v[126:127], v[92:93], v[94:95]
    s_add_u32 s95, s9, 0
    buffer_load_dwordx4 a[32:35], v1, s[40:43], s95 offen offset:0 sc1
    v_pk_add_f32 v[124:125], v[124:125], v[96:97]
    v_pk_add_f32 v[126:127], v[126:127], v[98:99]
    v_pk_add_f32 v[124:125], v[124:125], v[100:101]
    v_pk_add_f32 v[126:127], v[126:127], v[102:103]
    v_pk_add_f32 v[124:125], v[124:125], v[126:127]
    v_add_f32 v124, v124, v125
    v_rcp_f32 v124, v124
    s_nop 0
    v_pk_mul_f32 v[88:89], v[88:89], v[124:125] op_sel_hi:[1,0]
    v_pk_mul_f32 v[90:91], v[90:91], v[124:125] op_sel_hi:[1,0]
    v_pk_mul_f32 v[92:93], v[92:93], v[124:125] op_sel_hi:[1,0]
    v_pk_mul_f32 v[94:95], v[94:95], v[124:125] op_sel_hi:[1,0]
    v_cvt_pk_bf16_f32 v88, v88, v89
    v_cvt_pk_bf16_f32 v89, v90, v91
    v_cvt_pk_bf16_f32 v90, v92, v93
    v_cvt_pk_bf16_f32 v91, v94, v95
    buffer_load_dwordx4 a[36:39], v1, s[40:43], s95 offen offset:1024 sc1
    ds_write_b128 v6, v[88:91] offset:8192
    v_pk_mul_f32 v[96:97], v[96:97], v[124:125] op_sel_hi:[1,0]
    v_pk_mul_f32 v[98:99], v[98:99], v[124:125] op_sel_hi:[1,0]
    v_pk_mul_f32 v[100:101], v[100:101], v[124:125] op_sel_hi:[1,0]
    v_pk_mul_f32 v[102:103], v[102:103], v[124:125] op_sel_hi:[1,0]
    v_cvt_pk_bf16_f32 v92, v96, v97
    v_cvt_pk_bf16_f32 v93, v98, v99
    v_cvt_pk_bf16_f32 v94, v100, v101
    v_cvt_pk_bf16_f32 v95, v102, v103
    ds_write_b128 v7, v[92:95] offset:8192
    v_mov_b32 v64, 0x3f803f80
    v_mov_b32 v65, 0x3f803f80
    v_mov_b32 v66, 0x3f803f80
    v_mov_b32 v67, 0x3f803f80
    v_lshlrev_b32 v37, 3, v1
    s_mov_b64 exec, 0xffff
    buffer_load_dword v39, v37, s[44:47], s71 offen
    s_mov_b64 exec, -1
    s_waitcnt vmcnt(11)
    s_waitcnt lgkmcnt(0)
    s_barrier
    ds_read_b64_tr_b16 v[72:73], v9 offset:0
    ds_read_b64_tr_b16 v[74:75], v9 offset:512
    ds_read_b64_tr_b16 v[76:77], v10 offset:0
    ds_read_b64_tr_b16 v[78:79], v10 offset:512
    ds_read_b64_tr_b16 v[80:81], v9 offset:1024
    ds_read_b64_tr_b16 v[82:83], v9 offset:1536
    ds_read_b64_tr_b16 v[84:85], v10 offset:1024
    ds_read_b64_tr_b16 v[86:87], v10 offset:1536
    ds_read_b64_tr_b16 v[88:89], v9 offset:2048
    ds_read_b64_tr_b16 v[90:91], v9 offset:2560
    ds_read_b64_tr_b16 v[92:93], v10 offset:2048
    ds_read_b64_tr_b16 v[94:95], v10 offset:2560
    ds_read_b64_tr_b16 v[96:97], v9 offset:3072
    ds_read_b64_tr_b16 v[98:99], v9 offset:3584
    ds_read_b64_tr_b16 v[100:101], v10 offset:3072
    ds_read_b64_tr_b16 v[102:103], v10 offset:3584
    buffer_load_dwordx4 a[40:43], v1, s[40:43], s95 offen offset:2048 sc1
    s_waitcnt lgkmcnt(12)
    v_mfma_f32_16x16x32_bf16 v[56:59], v[72:75], v[76:79], 0
    v_mfma_f32_16x16x32_bf16 v[60:63], v[72:75], v[64:67], 0
    s_waitcnt lgkmcnt(8)
    v_mfma_f32_16x16x32_bf16 v[56:59], v[80:83], v[84:87], v[56:59]
    v_mfma_f32_16x16x32_bf16 v[60:63], v[80:83], v[64:67], v[60:63]
    s_waitcnt lgkmcnt(4)
    v_mfma_f32_16x16x32_bf16 v[56:59], v[88:91], v[92:95], v[56:59]
    v_mfma_f32_16x16x32_bf16 v[60:63], v[88:91], v[64:67], v[60:63]
    s_waitcnt lgkmcnt(0)
    v_mfma_f32_16x16x32_bf16 v[56:59], v[96:99], v[100:103], v[56:59]
    v_mfma_f32_16x16x32_bf16 v[60:63], v[96:99], v[64:67], v[60:63]
    s_add_u32 s84, s74, 0
    ds_read_b64_tr_b16 v[72:73], v4 offset:0
    ds_read_b64_tr_b16 v[74:75], v4 offset:256
    ds_read_b64_tr_b16 v[76:77], v4 offset:1024
    ds_read_b64_tr_b16 v[78:79], v4 offset:1280
    v_add_u32 v21, s81, v1
    v_add_u32 v5, s17, v1
    v_cvt_pk_bf16_f32 v56, v56, v57
    v_cvt_pk_bf16_f32 v57, v58, v59
    v_cvt_pk_bf16_f32 v58, v60, v61
    v_cvt_pk_bf16_f32 v59, v62, v63
    s_nop 0
    v_permlane32_swap_b32 v56, v58
    v_permlane32_swap_b32 v57, v59
    s_mov_b32 exec_hi, 0x00010001
    buffer_store_dwordx4 v[56:59], v11, s[40:43], s84 offen sc1
    s_mov_b64 exec, -1
    v_lshrrev_b32 v97, 5, v0
    v_mul_u32_u24 v97, 556544, v97
    s_lshl_b32 s87, s66, 9
    v_add3_u32 v96, v97, v1, s87
    v_mov_b32 v92, -1
    v_mov_b32 v93, -1
    v_mov_b32 v94, -1
    v_mov_b32 v95, -1
    s_add_u32 s84, s74, 1114112
    buffer_store_dwordx4 v[92:95], v96, s[40:43], s84 offen sc1
    ds_read_b64_tr_b16 v[80:81], v4 offset:2048
    ds_read_b64_tr_b16 v[82:83], v4 offset:2304
    ds_read_b64_tr_b16 v[84:85], v4 offset:3072
    ds_read_b64_tr_b16 v[86:87], v4 offset:3328
    ds_read_b64_tr_b16 v[88:89], v4 offset:4096
    ds_read_b64_tr_b16 v[90:91], v4 offset:4352
    s_waitcnt lgkmcnt(8)
    v_mfma_f32_32x32x16_bf16 v[40:55], v[72:75], v[128:131], 0
    ds_read_b64_tr_b16 v[92:93], v4 offset:5120
    ds_read_b64_tr_b16 v[94:95], v4 offset:5376
    v_add_u32 v122, s81, v4
    v_lshrrev_b32 v124, 2, v0
    v_lshrrev_b32 v125, 4, v0
    v_xor_b32 v124, v124, v125
    buffer_load_dwordx4 a[44:47], v1, s[40:43], s95 offen offset:3072 sc1
    s_waitcnt lgkmcnt(8)
    v_mfma_f32_32x32x16_bf16 v[40:55], v[76:79], v[132:135], v[40:55]
    ds_read_b64_tr_b16 v[96:97], v4 offset:6144
    ds_read_b64_tr_b16 v[98:99], v4 offset:6400
    v_and_b32 v124, 1, v124
    v_subrev_u32 v124, 1, v124
    v_and_b32 v124, 0x3f803f80, v124
    ds_read_b64_tr_b16 v[56:57], v122 offset:0
    ds_read_b64_tr_b16 v[58:59], v122 offset:256
    ds_read_b128 a[184:187], v21 offset:0
    s_waitcnt lgkmcnt(11)
    v_mfma_f32_32x32x16_bf16 v[40:55], v[80:83], v[136:139], v[40:55]
    ds_read_b64_tr_b16 v[100:101], v4 offset:7168
    ds_read_b64_tr_b16 v[102:103], v4 offset:7424
    v_mov_b32 v125, v124
    v_mov_b32 v126, v124
    v_mov_b32 v127, v124
    ds_read_b64_tr_b16 v[60:61], v122 offset:1024
    ds_read_b64_tr_b16 v[62:63], v122 offset:1280
    s_add_u32 s95, s9, 4096
    buffer_load_dwordx4 a[48:51], v1, s[40:43], s95 offen offset:0 sc1
    s_waitcnt lgkmcnt(13)
    v_mfma_f32_32x32x16_bf16 v[40:55], v[84:87], v[140:143], v[40:55]
    ds_read_b64_tr_b16 v[72:73], v4 offset:8192
    ds_read_b64_tr_b16 v[74:75], v4 offset:8448
    ds_read_b64_tr_b16 v[64:65], v122 offset:8192
    ds_read_b64_tr_b16 v[66:67], v122 offset:8448
    ds_read_b128 a[188:191], v21 offset:1024
    s_waitcnt lgkmcnt(15)
    v_mfma_f32_32x32x16_bf16 v[40:55], v[88:91], v[144:147], v[40:55]
    ds_read_b64_tr_b16 v[76:77], v4 offset:9216
    ds_read_b64_tr_b16 v[78:79], v4 offset:9472
    s_waitcnt lgkmcnt(12)
    v_mfma_f32_16x16x32_bf16 v[112:115], v[124:127], v[56:59], 0
    ds_read_b64_tr_b16 v[68:69], v122 offset:9216
    ds_read_b64_tr_b16 v[70:71], v122 offset:9472
    buffer_load_dwordx4 a[52:55], v1, s[40:43], s95 offen offset:1024 sc1
    v_mfma_f32_32x32x16_bf16 v[40:55], v[92:95], v[148:151], v[40:55]
    ds_read_b64_tr_b16 v[80:81], v4 offset:10240
    ds_read_b64_tr_b16 v[82:83], v4 offset:10496
    s_waitcnt lgkmcnt(11)
    v_mfma_f32_16x16x32_bf16 v[112:115], v[124:127], v[60:63], v[112:115]
    ds_read_b64_tr_b16 v[56:57], v122 offset:16384
    ds_read_b64_tr_b16 v[58:59], v122 offset:16640
    ds_read_b128 a[192:195], v21 offset:8192
    v_mfma_f32_32x32x16_bf16 v[40:55], v[96:99], v[152:155], v[40:55]
    ds_read_b64_tr_b16 v[84:85], v4 offset:11264
    ds_read_b64_tr_b16 v[86:87], v4 offset:11520
    s_waitcnt lgkmcnt(12)
    v_mfma_f32_16x16x32_bf16 v[112:115], v[124:127], v[64:67], v[112:115]
    ds_read_b64_tr_b16 v[60:61], v122 offset:17408
    ds_read_b64_tr_b16 v[62:63], v122 offset:17664
    buffer_load_dwordx4 a[56:59], v1, s[40:43], s95 offen offset:2048 sc1
    v_mfma_f32_32x32x16_bf16 v[40:55], v[100:103], v[156:159], v[40:55]
    ds_read_b64_tr_b16 v[88:89], v4 offset:12288
    ds_read_b64_tr_b16 v[90:91], v4 offset:12544
    s_waitcnt lgkmcnt(11)
    v_mfma_f32_16x16x32_bf16 v[112:115], v[124:127], v[68:71], v[112:115]
    ds_read_b64_tr_b16 v[64:65], v122 offset:49152
    ds_read_b64_tr_b16 v[66:67], v122 offset:49408
    ds_read_b128 a[196:199], v21 offset:9216
    v_mfma_f32_32x32x16_bf16 v[40:55], v[72:75], v[160:163], v[40:55]
    ds_read_b64_tr_b16 v[92:93], v4 offset:13312
    ds_read_b64_tr_b16 v[94:95], v4 offset:13568
    s_waitcnt lgkmcnt(12)
    v_mfma_f32_16x16x32_bf16 v[112:115], v[124:127], v[56:59], v[112:115]
    ds_read_b64_tr_b16 v[68:69], v122 offset:50176
    ds_read_b64_tr_b16 v[70:71], v122 offset:50432
    buffer_load_dwordx4 a[60:63], v1, s[40:43], s95 offen offset:3072 sc1
    v_mfma_f32_32x32x16_bf16 v[40:55], v[76:79], v[164:167], v[40:55]
    ds_read_b64_tr_b16 v[96:97], v4 offset:14336
    ds_read_b64_tr_b16 v[98:99], v4 offset:14592
    s_waitcnt lgkmcnt(11)
    v_mfma_f32_16x16x32_bf16 v[112:115], v[124:127], v[60:63], v[112:115]
    ds_read_b128 a[200:203], v21 offset:16384
    v_mfma_f32_32x32x16_bf16 v[40:55], v[80:83], v[168:171], v[40:55]
    ds_read_b64_tr_b16 v[100:101], v4 offset:15360
    ds_read_b64_tr_b16 v[102:103], v4 offset:15616
    s_waitcnt lgkmcnt(10)
    v_mfma_f32_16x16x32_bf16 v[112:115], v[124:127], v[64:67], v[112:115]
    s_add_u32 s95, s10, 0
    buffer_load_dwordx4 a[64:67], v1, s[40:43], s95 offen offset:0 sc1
    v_mfma_f32_32x32x16_bf16 v[40:55], v[84:87], v[172:175], v[40:55]
    ds_read_b64_tr_b16 v[72:73], v4 offset:16384
    ds_read_b64_tr_b16 v[74:75], v4 offset:16640
    s_waitcnt lgkmcnt(7)
    v_mfma_f32_16x16x32_bf16 v[112:115], v[124:127], v[68:71], v[112:115]
    ds_read_b128 a[204:207], v21 offset:17408
    v_mfma_f32_32x32x16_bf16 v[40:55], v[88:91], v[176:179], v[40:55]
    ds_read_b64_tr_b16 v[76:77], v4 offset:17408
    ds_read_b64_tr_b16 v[78:79], v4 offset:17664
    buffer_load_dwordx4 a[68:71], v1, s[40:43], s95 offen offset:1024 sc1
    v_mfma_f32_32x32x16_bf16 v[40:55], v[92:95], v[180:183], v[40:55]
    ds_read_b64_tr_b16 v[80:81], v4 offset:18432
    ds_read_b64_tr_b16 v[82:83], v4 offset:18688
    ds_read_b128 a[208:211], v21 offset:24576
    s_waitcnt lgkmcnt(11)
    v_mfma_f32_32x32x16_bf16 v[40:55], v[96:99], v[184:187], v[40:55]
    ds_read_b64_tr_b16 v[84:85], v4 offset:19456
    ds_read_b64_tr_b16 v[86:87], v4 offset:19712
    s_lshl_b32 s84, s66, 8
    v_add_u32 v122, s84, v22
    ds_write_b32 v122, v112 offset:2048
    buffer_load_dwordx4 a[72:75], v1, s[40:43], s95 offen offset:2048 sc1
    s_waitcnt lgkmcnt(11)
    v_mfma_f32_32x32x16_bf16 v[40:55], v[100:103], v[188:191], v[40:55]
    ds_read_b64_tr_b16 v[88:89], v4 offset:20480
    ds_read_b64_tr_b16 v[90:91], v4 offset:20736
    ds_read_b128 a[212:215], v21 offset:25600
    s_waitcnt lgkmcnt(12)
    v_mfma_f32_32x32x16_bf16 v[40:55], v[72:75], v[192:195], v[40:55]
    ds_read_b64_tr_b16 v[92:93], v4 offset:21504
    ds_read_b64_tr_b16 v[94:95], v4 offset:21760
    buffer_load_dwordx4 a[76:79], v1, s[40:43], s95 offen offset:3072 sc1
    s_waitcnt lgkmcnt(11)
    v_mfma_f32_32x32x16_bf16 v[40:55], v[76:79], v[196:199], v[40:55]
    ds_read_b64_tr_b16 v[96:97], v4 offset:22528
    ds_read_b64_tr_b16 v[98:99], v4 offset:22784
    s_waitcnt lgkmcnt(7)
    s_barrier
    ds_read_b128 a[216:219], v21 offset:32768
    v_mfma_f32_32x32x16_bf16 v[40:55], v[80:83], v[200:203], v[40:55]
    ds_read_b64_tr_b16 v[100:101], v4 offset:23552
    ds_read_b64_tr_b16 v[102:103], v4 offset:23808
    ds_read2st64_b32 v[112:113], v22 offset0:8 offset1:9
    ds_read2st64_b32 v[114:115], v22 offset0:10 offset1:11
    s_add_u32 s95, s10, 4096
    buffer_load_dwordx4 a[80:83], v1, s[40:43], s95 offen offset:0 sc1
    v_mfma_f32_32x32x16_bf16 v[40:55], v[84:87], v[204:207], v[40:55]
    ds_read_b64_tr_b16 v[72:73], v4 offset:49152
    ds_read_b64_tr_b16 v[74:75], v4 offset:49408
    ds_read_b128 a[220:223], v21 offset:33792
    s_waitcnt lgkmcnt(13)
    v_mfma_f32_32x32x16_bf16 v[40:55], v[88:91], v[208:211], v[40:55]
    ds_read_b64_tr_b16 v[76:77], v4 offset:50176
    ds_read_b64_tr_b16 v[78:79], v4 offset:50432
    buffer_load_dwordx4 a[84:87], v1, s[40:43], s95 offen offset:1024 sc1
    s_waitcnt lgkmcnt(12)
    v_mfma_f32_32x32x16_bf16 v[40:55], v[92:95], v[212:215], v[40:55]
    ds_read_b64_tr_b16 v[80:81], v4 offset:51200
    ds_read_b64_tr_b16 v[82:83], v4 offset:51456
    s_add_u32 s12, s75, 0
    ds_read_b128 a[224:227], v21 offset:40960
    s_waitcnt lgkmcnt(13)
    v_mfma_f32_32x32x16_bf16 v[40:55], v[96:99], v[216:219], v[40:55]
    ds_read_b64_tr_b16 v[84:85], v4 offset:52224
    ds_read_b64_tr_b16 v[86:87], v4 offset:52480
    s_waitcnt lgkmcnt(10)
    v_add_f32 v112, v112, v113
    v_add_f32 v114, v114, v115
    v_add_f32 v114, v112, v114
    buffer_load_dwordx4 a[88:91], v1, s[40:43], s95 offen offset:2048 sc1
    s_add_u32 s13, s75, 139264
    v_mfma_f32_32x32x16_bf16 v[40:55], v[100:103], v[220:223], v[40:55]
    ds_read_b64_tr_b16 v[88:89], v4 offset:53248
    ds_read_b64_tr_b16 v[90:91], v4 offset:53504
    v_cvt_pk_bf16_f32 v112, v114, v114
    v_and_b32 v115, 0xffff0000, v112
    v_sub_f32 v115, v114, v115
    s_add_u32 s14, s75, 278528
    ds_read_b128 a[228:231], v21 offset:41984
    s_waitcnt lgkmcnt(11)
    v_mfma_f32_32x32x16_bf16 v[40:55], v[72:75], v[224:227], v[40:55]
    ds_read_b64_tr_b16 v[92:93], v4 offset:54272
    ds_read_b64_tr_b16 v[94:95], v4 offset:54528
    v_cvt_pk_bf16_f32 v113, v115, 0
    buffer_load_dwordx4 a[92:95], v1, s[40:43], s95 offen offset:3072 sc1
    s_add_u32 s15, s75, 417792
    s_waitcnt lgkmcnt(10)
    v_mfma_f32_32x32x16_bf16 v[40:55], v[76:79], v[228:231], v[40:55]
    ds_read_b64_tr_b16 v[96:97], v4 offset:55296
    ds_read_b64_tr_b16 v[98:99], v4 offset:55552
    s_mov_b32 s67, 0
    ds_read_b128 a[232:235], v21 offset:49152
    s_waitcnt lgkmcnt(11)
    v_mfma_f32_32x32x16_bf16 v[40:55], v[80:83], v[232:235], v[40:55]
    ds_read_b64_tr_b16 v[100:101], v4 offset:56320
    ds_read_b64_tr_b16 v[102:103], v4 offset:56576
    buffer_load_dwordx4 v[132:135], v13, s[40:43], s12 offen offset:0 sc1
    s_waitcnt lgkmcnt(10)
    v_mfma_f32_32x32x16_bf16 v[40:55], v[84:87], v[236:239], v[40:55]
    v_mfma_f32_32x32x8_bf16 v[40:55], v[112:113], v[116:117], v[40:55]
    buffer_load_dwordx4 v[136:139], v13, s[40:43], s12 offen offset:256 sc1
    ds_read_b128 a[236:239], v21 offset:50176
    s_waitcnt lgkmcnt(9)
    v_mfma_f32_32x32x16_bf16 v[40:55], v[88:91], v[240:243], v[40:55]
    buffer_load_dwordx4 v[140:143], v13, s[40:43], s13 offen offset:0 sc1
    s_waitcnt lgkmcnt(6)
    v_mfma_f32_32x32x16_bf16 v[40:55], v[92:95], v[244:247], v[40:55]
    buffer_load_dwordx4 v[144:147], v13, s[40:43], s13 offen offset:256 sc1
    ds_read_b128 a[240:243], v21 offset:57344
    s_waitcnt lgkmcnt(5)
    v_mfma_f32_32x32x16_bf16 v[40:55], v[96:99], v[248:251], v[40:55]
    v_add_u32 v115, 0x10000, v21
    buffer_load_dwordx4 v[128:131], v14, s[40:43], s12 offen sc1
    s_waitcnt lgkmcnt(2)
    v_mfma_f32_32x32x16_bf16 v[40:55], v[100:103], v[252:255], v[40:55]
    buffer_load_dwordx4 v[148:151], v13, s[40:43], s14 offen offset:0 sc1
    buffer_load_dwordx4 v[152:155], v13, s[40:43], s14 offen offset:256 sc1
    buffer_load_dwordx4 v[156:159], v13, s[40:43], s15 offen offset:0 sc1
    buffer_load_dwordx4 v[160:163], v13, s[40:43], s15 offen offset:256 sc1
    ds_read_b128 a[244:247], v21 offset:58368
    ds_read_b128 v[192:195], v2 offset:36864
    ds_read_b128 v[196:199], v2 offset:37888
    ds_read_b128 a[248:251], v115 offset:49152
    ds_read_b128 a[252:255], v115 offset:50176
    s_nop 2
    v_cvt_pk_bf16_f32 v40, v40, v41
    v_cvt_pk_bf16_f32 v41, v42, v43
    v_cvt_pk_bf16_f32 v42, v44, v45
    v_cvt_pk_bf16_f32 v43, v46, v47
    v_cvt_pk_bf16_f32 v44, v48, v49
    v_cvt_pk_bf16_f32 v45, v50, v51
    v_cvt_pk_bf16_f32 v46, v52, v53
    v_cvt_pk_bf16_f32 v47, v54, v55
    v_mfma_f32_32x32x16_bf16 v[72:87], v[104:107], v[40:43], 0
    s_nop 0
    v_mfma_f32_32x32x16_bf16 v[88:103], v[108:111], v[44:47], 0
    s_nop 4
    v_max3_f32 v122, v72, v73, v74
    v_max3_f32 v123, v75, v76, v77
    v_max3_f32 v122, v122, v78, v79
    v_max3_f32 v123, v123, v80, v81
    v_max3_f32 v122, v122, v82, v83
    v_max3_f32 v123, v123, v84, v85
    v_max3_f32 v122, v122, v86, v87
    v_max_f32 v122, v122, v123
    s_add_u32 s95, s11, 0
    buffer_load_dwordx4 a[96:99], v1, s[40:43], s95 offen offset:0 sc1
    v_mul_f32 v119, -v122, v118
    v_pk_fma_f32 v[72:73], v[72:73], v[118:119], v[118:119] op_sel:[0,0,1] op_sel_hi:[1,0,1]
    v_pk_fma_f32 v[74:75], v[74:75], v[118:119], v[118:119] op_sel:[0,0,1] op_sel_hi:[1,0,1]
    v_pk_fma_f32 v[76:77], v[76:77], v[118:119], v[118:119] op_sel:[0,0,1] op_sel_hi:[1,0,1]
    v_pk_fma_f32 v[78:79], v[78:79], v[118:119], v[118:119] op_sel:[0,0,1] op_sel_hi:[1,0,1]
    v_pk_fma_f32 v[80:81], v[80:81], v[118:119], v[118:119] op_sel:[0,0,1] op_sel_hi:[1,0,1]
    v_pk_fma_f32 v[82:83], v[82:83], v[118:119], v[118:119] op_sel:[0,0,1] op_sel_hi:[1,0,1]
    v_pk_fma_f32 v[84:85], v[84:85], v[118:119], v[118:119] op_sel:[0,0,1] op_sel_hi:[1,0,1]
    v_pk_fma_f32 v[86:87], v[86:87], v[118:119], v[118:119] op_sel:[0,0,1] op_sel_hi:[1,0,1]
    v_exp_f32 v72, v72
    v_exp_f32 v73, v73
    v_exp_f32 v74, v74
    v_exp_f32 v75, v75
    buffer_load_dwordx4 a[100:103], v1, s[40:43], s95 offen offset:1024 sc1
    v_exp_f32 v76, v76
    v_exp_f32 v77, v77
    v_exp_f32 v78, v78
    v_exp_f32 v79, v79
    v_exp_f32 v80, v80
    v_exp_f32 v81, v81
    v_exp_f32 v82, v82
    v_exp_f32 v83, v83
    buffer_load_dwordx4 a[104:107], v1, s[40:43], s95 offen offset:2048 sc1
    v_exp_f32 v84, v84
    v_exp_f32 v85, v85
    v_exp_f32 v86, v86
    v_exp_f32 v87, v87
    v_pk_add_f32 v[124:125], v[72:73], v[74:75]
    v_pk_add_f32 v[126:127], v[76:77], v[78:79]
    v_pk_add_f32 v[124:125], v[124:125], v[80:81]
    v_pk_add_f32 v[126:127], v[126:127], v[82:83]
    v_pk_add_f32 v[124:125], v[124:125], v[84:85]
    v_pk_add_f32 v[126:127], v[126:127], v[86:87]
    v_pk_add_f32 v[124:125], v[124:125], v[126:127]
    v_add_f32 v124, v124, v125
    buffer_load_dwordx4 a[108:111], v1, s[40:43], s95 offen offset:3072 sc1
    v_rcp_f32 v124, v124
    s_nop 0
    v_pk_mul_f32 v[72:73], v[72:73], v[124:125] op_sel_hi:[1,0]
    v_pk_mul_f32 v[74:75], v[74:75], v[124:125] op_sel_hi:[1,0]
    v_pk_mul_f32 v[76:77], v[76:77], v[124:125] op_sel_hi:[1,0]
    v_pk_mul_f32 v[78:79], v[78:79], v[124:125] op_sel_hi:[1,0]
    v_pk_mul_f32 v[80:81], v[80:81], v[124:125] op_sel_hi:[1,0]
    v_pk_mul_f32 v[82:83], v[82:83], v[124:125] op_sel_hi:[1,0]
    v_pk_mul_f32 v[84:85], v[84:85], v[124:125] op_sel_hi:[1,0]
    v_pk_mul_f32 v[86:87], v[86:87], v[124:125] op_sel_hi:[1,0]
    v_cvt_pk_bf16_f32 v72, v72, v73
    v_cvt_pk_bf16_f32 v73, v74, v75
    v_cvt_pk_bf16_f32 v74, v76, v77
    v_cvt_pk_bf16_f32 v75, v78, v79
    v_cvt_pk_bf16_f32 v76, v80, v81
    v_cvt_pk_bf16_f32 v77, v82, v83
    s_add_u32 s95, s11, 4096
    buffer_load_dwordx4 a[112:115], v1, s[40:43], s95 offen offset:0 sc1
    v_cvt_pk_bf16_f32 v78, v84, v85
    v_cvt_pk_bf16_f32 v79, v86, v87
    v_max3_f32 v122, v88, v89, v90
    v_max3_f32 v123, v91, v92, v93
    v_max3_f32 v122, v122, v94, v95
    v_max3_f32 v123, v123, v96, v97
    v_max3_f32 v122, v122, v98, v99
    v_max3_f32 v123, v123, v100, v101
    v_max3_f32 v122, v122, v102, v103
    v_max_f32 v122, v122, v123
    v_mul_f32 v119, -v122, v118
    v_pk_fma_f32 v[88:89], v[88:89], v[118:119], v[118:119] op_sel:[0,0,1] op_sel_hi:[1,0,1]
    v_pk_fma_f32 v[90:91], v[90:91], v[118:119], v[118:119] op_sel:[0,0,1] op_sel_hi:[1,0,1]
    v_pk_fma_f32 v[92:93], v[92:93], v[118:119], v[118:119] op_sel:[0,0,1] op_sel_hi:[1,0,1]
    v_pk_fma_f32 v[94:95], v[94:95], v[118:119], v[118:119] op_sel:[0,0,1] op_sel_hi:[1,0,1]
    v_pk_fma_f32 v[96:97], v[96:97], v[118:119], v[118:119] op_sel:[0,0,1] op_sel_hi:[1,0,1]
    buffer_load_dwordx4 a[116:119], v1, s[40:43], s95 offen offset:1024 sc1
    v_pk_fma_f32 v[98:99], v[98:99], v[118:119], v[118:119] op_sel:[0,0,1] op_sel_hi:[1,0,1]
    v_pk_fma_f32 v[100:101], v[100:101], v[118:119], v[118:119] op_sel:[0,0,1] op_sel_hi:[1,0,1]
    v_pk_fma_f32 v[102:103], v[102:103], v[118:119], v[118:119] op_sel:[0,0,1] op_sel_hi:[1,0,1]
    v_exp_f32 v88, v88
    v_exp_f32 v89, v89
    v_exp_f32 v90, v90
    v_exp_f32 v91, v91
    v_exp_f32 v92, v92
    v_exp_f32 v93, v93
    v_exp_f32 v94, v94
    buffer_load_dwordx4 a[120:123], v1, s[40:43], s95 offen offset:2048 sc1
    v_exp_f32 v95, v95
    v_exp_f32 v96, v96
    v_exp_f32 v97, v97
    v_exp_f32 v98, v98
    v_exp_f32 v99, v99
    v_exp_f32 v100, v100
    v_exp_f32 v101, v101
    v_exp_f32 v102, v102
    buffer_load_dwordx4 a[124:127], v1, s[40:43], s95 offen offset:3072 sc1
    v_exp_f32 v103, v103
    v_pk_add_f32 v[124:125], v[88:89], v[90:91]
    v_pk_add_f32 v[126:127], v[92:93], v[94:95]
    v_pk_add_f32 v[124:125], v[124:125], v[96:97]
    v_pk_add_f32 v[126:127], v[126:127], v[98:99]
    v_pk_add_f32 v[124:125], v[124:125], v[100:101]
    v_pk_add_f32 v[126:127], v[126:127], v[102:103]
    v_pk_add_f32 v[124:125], v[124:125], v[126:127]
    v_add_f32 v124, v124, v125
    v_rcp_f32 v124, v124
    s_nop 0
    v_pk_mul_f32 v[88:89], v[88:89], v[124:125] op_sel_hi:[1,0]
    v_pk_mul_f32 v[90:91], v[90:91], v[124:125] op_sel_hi:[1,0]
    v_pk_mul_f32 v[92:93], v[92:93], v[124:125] op_sel_hi:[1,0]
    v_pk_mul_f32 v[94:95], v[94:95], v[124:125] op_sel_hi:[1,0]
    v_lshlrev_b32 v37, 3, v1
    s_mov_b64 exec, 0xff
    buffer_load_dword v39, v37, s[40:43], s76 offen
    s_mov_b64 exec, -1
    v_pk_mul_f32 v[96:97], v[96:97], v[124:125] op_sel_hi:[1,0]
    v_pk_mul_f32 v[98:99], v[98:99], v[124:125] op_sel_hi:[1,0]
    v_pk_mul_f32 v[100:101], v[100:101], v[124:125] op_sel_hi:[1,0]
    v_pk_mul_f32 v[102:103], v[102:103], v[124:125] op_sel_hi:[1,0]
    v_cvt_pk_bf16_f32 v88, v88, v89
    v_cvt_pk_bf16_f32 v89, v90, v91
    v_cvt_pk_bf16_f32 v90, v92, v93
    v_cvt_pk_bf16_f32 v91, v94, v95
    v_cvt_pk_bf16_f32 v92, v96, v97
    v_cvt_pk_bf16_f32 v93, v98, v99
    v_cvt_pk_bf16_f32 v94, v100, v101
    v_cvt_pk_bf16_f32 v95, v102, v103
    s_mov_b64 exec, 0xffff
    buffer_load_dword v206, v12, s[40:43], 0 offen sc1
    s_mov_b64 exec, -1
    s_waitcnt lgkmcnt(2)
L_part0_s:
    s_waitcnt vmcnt(18)
    v_mfma_f32_16x16x32_bf16 v[56:59], v[192:195], v[132:135], 0
    s_waitcnt vmcnt(17)
    v_mfma_f32_16x16x32_bf16 v[56:59], v[196:199], v[136:139], v[56:59]
    s_waitcnt vmcnt(16)
    v_mfma_f32_16x16x32_bf16 v[56:59], v[192:195], v[140:143], v[56:59]
    s_waitcnt vmcnt(15)
    v_mfma_f32_16x16x32_bf16 v[56:59], v[196:199], v[144:147], v[56:59]
    s_waitcnt vmcnt(14)
    v_mfma_f32_16x16x32_bf16 v[60:63], v[192:195], v[128:131], 0
    s_waitcnt vmcnt(13)
    v_mfma_f32_16x16x32_bf16 v[56:59], v[192:195], v[148:151], v[56:59]
    s_waitcnt vmcnt(12)
    v_mfma_f32_16x16x32_bf16 v[56:59], v[196:199], v[152:155], v[56:59]
    s_waitcnt vmcnt(11)
    v_mfma_f32_16x16x32_bf16 v[56:59], v[192:195], v[156:159], v[56:59]
    v_cvt_pk_bf16_f32 v64, v60, v61
    v_cvt_pk_bf16_f32 v65, v62, v63
    s_waitcnt vmcnt(10)
    v_mfma_f32_16x16x32_bf16 v[56:59], v[196:199], v[160:163], v[56:59]
    s_mov_b64 exec, 0x00ff00ff
    ds_write_b64 v16, v[64:65]
    s_mov_b64 exec, -1
    s_nop 4
    v_cmp_u_f32 vcc, v56, v60
    v_cvt_pk_bf16_f32 v56, v56, v57
    v_cvt_pk_bf16_f32 v57, v58, v59
    ds_write_b64 v15, v[56:57]
    s_cbranch_vccnz L_partre_s
L_partok0_s:
    s_waitcnt lgkmcnt(0)
    s_barrier
    ds_read_b128 v[128:131], v17 offset:0
    ds_read_b128 v[132:135], v17 offset:16
    ds_read_b128 v[136:139], v17 offset:1600
    ds_read_b128 v[140:143], v17 offset:1616
    s_waitcnt lgkmcnt(3)
    v_mfma_f32_32x32x16_bf16 v[40:55], v[128:131], v[72:75], 0
    v_mov_b32 v106, 1
    s_waitcnt lgkmcnt(2)
    v_mfma_f32_32x32x16_bf16 v[40:55], v[132:135], v[76:79], v[40:55]
    s_waitcnt lgkmcnt(0)
    v_mfma_f32_32x32x16_bf16 v[56:71], v[136:139], v[88:91], 0
    v_mfma_f32_32x32x16_bf16 v[56:71], v[140:143], v[92:95], v[56:71]
    v_add_f32 v48, v48, v50
    v_add_f32 v49, v49, v51
    v_add_f32 v48, 0x358637bd, v48
    v_add_f32 v48, v48, v49
    v_rcp_f32 v48, v48
    s_nop 0
    v_pk_mul_f32 v[40:41], v[40:41], v[48:49] op_sel_hi:[1,0]
    v_pk_mul_f32 v[42:43], v[42:43], v[48:49] op_sel_hi:[1,0]
    v_pk_mul_f32 v[44:45], v[44:45], v[48:49] op_sel_hi:[1,0]
    v_pk_mul_f32 v[46:47], v[46:47], v[48:49] op_sel_hi:[1,0]
    v_bfi_b32 v40, s60, v40, v4
    v_cvt_pk_bf16_f32 v40, v40, v41
    v_cvt_pk_bf16_f32 v41, v42, v43
    v_cvt_pk_bf16_f32 v42, v44, v45
    v_cvt_pk_bf16_f32 v43, v46, v47
    buffer_store_dwordx4 v[40:43], v1, s[44:47], s71 offen offset:0 sc1
    v_add_f32 v64, v64, v66
    v_add_f32 v65, v65, v67
    v_add_f32 v64, 0x358637bd, v64
    v_add_f32 v64, v64, v65
    v_rcp_f32 v64, v64
    s_nop 0
    v_pk_mul_f32 v[56:57], v[56:57], v[64:65] op_sel_hi:[1,0]
    v_pk_mul_f32 v[58:59], v[58:59], v[64:65] op_sel_hi:[1,0]
    v_pk_mul_f32 v[60:61], v[60:61], v[64:65] op_sel_hi:[1,0]
    v_pk_mul_f32 v[62:63], v[62:63], v[64:65] op_sel_hi:[1,0]
    v_bfi_b32 v56, s60, v56, v4
    v_cvt_pk_bf16_f32 v56, v56, v57
    v_cvt_pk_bf16_f32 v57, v58, v59
    v_cvt_pk_bf16_f32 v58, v60, v61
    v_cvt_pk_bf16_f32 v59, v62, v63
    buffer_store_dwordx4 v[56:59], v1, s[44:47], s71 offen offset:1024 sc1
    s_mov_b64 exec, 0
    s_cmp_eq_u32 s66, 0
    s_cmp_eq_u32 s66, 1
    s_cmp_eq_u32 s66, 2
L_pgret1_s:
    s_mov_b64 exec, -1
    s_mov_b64 exec, 1
    s_waitcnt vmcnt(0)
    buffer_store_dword v106, off, s[40:43], s78 offset:0 sc1
    s_mov_b64 exec, -1
    v_add_u32 v104, 0x18000, v21
    s_and_b32 s84, s8, 0x6000
    v_add_u32 v116, s84, v2
    s_and_b32 s84, s9, 0x6000
    v_add_u32 v117, s84, v2
    s_and_b32 s84, s10, 0x6000
    v_add_u32 v118, s84, v2
    s_and_b32 s84, s11, 0x6000
    v_add_u32 v119, s84, v2
    v_and_or_b32 v141, v20, 60, s61
    s_lshl_b32 s84, s0, 10
    s_lshl_b32 s85, s66, 13
    s_add_u32 s85, s85, s84
    s_add_u32 s1, s85, 4096
    s_add_u32 s82, s85, 8192
    s_cmp_eq_u32 s66, 0
    s_cselect_b32 s1, 47104, s1
    s_cmp_eq_u32 s66, 3
    s_cselect_b32 s82, 46080, s82
    s_and_b32 s84, s65, 3
    s_lshl_b32 s84, s84, 11
    s_add_u32 s72, s72, s84
L_ore0_s:
    s_lshl2_add_u32 m0, s81, 114688
    buffer_load_dword v127, v18, s[40:43], 0 offen sc1
    s_cmp_eq_u32 s66, s0
    s_cbranch_scc0 Lpchk_11_s
    ds_write_b128 v116, v[40:43] offset:0
    ds_write_b128 v116, v[56:59] offset:1024
    s_branch L_oown0_s
L_opoll0_s:
    buffer_load_dword v127, v18, s[40:43], 0 offen sc1
    s_sub_u32 s68, s68, 1
    s_cbranch_scc1 L_end
L_oown0_s:
    s_waitcnt vmcnt(0)
    v_cmp_gt_u32 vcc, 1, v127
    s_cbranch_vccnz L_opoll0_s
    s_branch L_ojoin0_s
Lpoll_10_s:
    buffer_load_dword v127, v18, s[40:43], 0 offen sc1
    s_sub_u32 s68, s68, 1
    s_cbranch_scc1 L_end
Lpchk_11_s:
    s_waitcnt vmcnt(0)
    v_cmp_gt_u32 vcc, 1, v127
    s_cbranch_vccnz Lpoll_10_s
    buffer_load_dwordx4 v1, s[44:47], s72 offen offset:0 sc1 lds
    buffer_load_dwordx4 v1, s[44:47], s72 offen offset:1024 sc1 lds
L_ojoin0_s:
    s_lshl2_add_u32 m0, s81, 116736
    s_xor_b32 s84, s72, 2048
    ds_read_b128 v[128:131], v104
    ds_read_b128 v[132:135], v104 offset:1024
    buffer_load_dwordx4 v1, s[44:47], s84 offen offset:0 sc1 lds
    buffer_load_dwordx4 v1, s[44:47], s84 offen offset:1024 sc1 lds
    s_lshl2_add_u32 m0, s81, 118784
    s_xor_b32 s84, s72, 4096
    buffer_load_dwordx4 v1, s[44:47], s84 offen offset:0 sc1 lds
    buffer_load_dwordx4 v1, s[44:47], s84 offen offset:1024 sc1 lds
    s_lshl2_add_u32 m0, s81, 120832
    s_xor_b32 s84, s72, 6144
    buffer_load_dwordx4 v1, s[44:47], s84 offen offset:0 sc1 lds
    s_waitcnt lgkmcnt(0)
    v_lshlrev_b32 v24, 16, v128
    v_and_b32 v25, 0xffff0000, v128
    v_lshlrev_b32 v26, 16, v129
    v_and_b32 v27, 0xffff0000, v129
    v_lshlrev_b32 v28, 16, v130
    v_and_b32 v29, 0xffff0000, v130
    v_lshlrev_b32 v30, 16, v131
    v_and_b32 v31, 0xffff0000, v131
    v_lshlrev_b32 v32, 16, v132
    v_and_b32 v33, 0xffff0000, v132
    v_lshlrev_b32 v34, 16, v133
    v_and_b32 v35, 0xffff0000, v133
    v_lshlrev_b32 v36, 16, v134
    v_and_b32 v37, 0xffff0000, v134
    v_lshlrev_b32 v38, 16, v135
    v_and_b32 v39, 0xffff0000, v135
    s_barrier
    buffer_load_dwordx4 v1, s[44:47], s84 offen offset:1024 sc1 lds
L_oskip0_s:
    s_waitcnt vmcnt(7)
    ds_read_b128 v[72:75], v116 offset:0
    s_waitcnt vmcnt(6)
    ds_read_b128 v[76:79], v116 offset:1024
    s_waitcnt vmcnt(5)
    ds_read_b128 v[80:83], v116 offset:2048
    s_waitcnt lgkmcnt(2)
    v_mfma_f32_32x32x16_bf16 v[24:39], a[0:3], v[72:75], v[24:39]
    s_waitcnt vmcnt(4)
    ds_read_b128 v[84:87], v116 offset:3072
    s_waitcnt lgkmcnt(2)
    v_mfma_f32_32x32x16_bf16 v[24:39], a[4:7], v[76:79], v[24:39]
    s_waitcnt vmcnt(3)
    ds_read_b128 v[88:91], v116 offset:4096
    s_waitcnt lgkmcnt(2)
    v_mfma_f32_32x32x16_bf16 v[24:39], a[8:11], v[80:83], v[24:39]
    s_waitcnt vmcnt(2)
    ds_read_b128 v[92:95], v116 offset:5120
    s_waitcnt lgkmcnt(2)
    v_mfma_f32_32x32x16_bf16 v[24:39], a[12:15], v[84:87], v[24:39]
    s_waitcnt vmcnt(1)
    ds_read_b128 v[96:99], v116 offset:6144
    s_waitcnt lgkmcnt(2)
    v_mfma_f32_32x32x16_bf16 v[24:39], a[16:19], v[88:91], v[24:39]
    s_waitcnt vmcnt(0)
    ds_read_b128 v[100:103], v116 offset:7168
    s_add_u32 m0, s81, 0
    s_barrier
    buffer_load_dwordx4 v5, s[40:43], m0 offen offset:0 sc1 lds
    s_waitcnt lgkmcnt(2)
    v_mfma_f32_32x32x16_bf16 v[24:39], a[20:23], v[92:95], v[24:39]
    ds_read_b128 v[72:75], v117 offset:0
    ds_read_b128 v[76:79], v117 offset:1024
    s_mov_b64 exec, 1
    buffer_store_dword v106, off, s[40:43], s16 offset:64 sc1
    s_mov_b64 exec, -1
    s_waitcnt lgkmcnt(3)
    v_mfma_f32_32x32x16_bf16 v[24:39], a[24:27], v[96:99], v[24:39]
    ds_read_b128 v[80:83], v117 offset:2048
    ds_read_b128 v[84:87], v117 offset:3072
    buffer_load_dwordx4 v5, s[40:43], m0 offen offset:1024 sc1 lds
    s_waitcnt lgkmcnt(4)
    v_mfma_f32_32x32x16_bf16 v[24:39], a[28:31], v[100:103], v[24:39]
    ds_read_b128 v[88:91], v117 offset:4096
    ds_read_b128 v[92:95], v117 offset:5120
    s_waitcnt lgkmcnt(5)
    v_mfma_f32_32x32x16_bf16 v[24:39], a[32:35], v[72:75], v[24:39]
    ds_read_b128 v[96:99], v117 offset:6144
    s_add_u32 m0, s81, 32768
    ds_read_b128 v[100:103], v117 offset:7168
    buffer_load_dwordx4 v5, s[40:43], m0 offen offset:0 sc1 lds
    s_waitcnt lgkmcnt(6)
    v_mfma_f32_32x32x16_bf16 v[24:39], a[36:39], v[76:79], v[24:39]
    ds_read_b128 v[72:75], v118 offset:0
    s_waitcnt lgkmcnt(6)
    v_mfma_f32_32x32x16_bf16 v[24:39], a[40:43], v[80:83], v[24:39]
    ds_read_b128 v[76:79], v118 offset:1024
    buffer_load_dwordx4 v5, s[40:43], m0 offen offset:1024 sc1 lds
    s_waitcnt lgkmcnt(6)
    v_mfma_f32_32x32x16_bf16 v[24:39], a[44:47], v[84:87], v[24:39]
    ds_read_b128 v[80:83], v118 offset:2048
    s_waitcnt lgkmcnt(6)
    v_mfma_f32_32x32x16_bf16 v[24:39], a[48:51], v[88:91], v[24:39]
    s_add_u32 m0, s81, 8192
    ds_read_b128 v[84:87], v118 offset:3072
    buffer_load_dwordx4 v5, s[40:43], m0 offen offset:0 sc1 lds
    s_waitcnt lgkmcnt(6)
    v_mfma_f32_32x32x16_bf16 v[24:39], a[52:55], v[92:95], v[24:39]
    ds_read_b128 v[88:91], v118 offset:4096
    s_waitcnt lgkmcnt(6)
    v_mfma_f32_32x32x16_bf16 v[24:39], a[56:59], v[96:99], v[24:39]
    ds_read_b128 v[92:95], v118 offset:5120
    buffer_load_dwordx4 v5, s[40:43], m0 offen offset:1024 sc1 lds
    s_waitcnt lgkmcnt(6)
    v_mfma_f32_32x32x16_bf16 v[24:39], a[60:63], v[100:103], v[24:39]
    ds_read_b128 v[96:99], v118 offset:6144
    buffer_load_dword v140, v141, s[40:43], 0 offen offset:64 sc1
    buffer_load_dword v144, v20, s[40:43], s63 offen offset:0 sc1
    buffer_load_dword v145, v20, s[40:43], s63 offen offset:256 sc1
    s_waitcnt lgkmcnt(6)
    v_mfma_f32_32x32x16_bf16 v[24:39], a[64:67], v[72:75], v[24:39]
    s_add_u32 m0, s81, 40960
    ds_read_b128 v[100:103], v118 offset:7168
    buffer_load_dwordx4 v5, s[40:43], m0 offen offset:0 sc1 lds
    s_waitcnt lgkmcnt(6)
    v_mfma_f32_32x32x16_bf16 v[24:39], a[68:71], v[76:79], v[24:39]
    ds_read_b128 v[72:75], v119 offset:0
    buffer_load_dword v146, v20, s[40:43], s63 offen offset:512 sc1
    buffer_load_dword v147, v20, s[40:43], s63 offen offset:768 sc1
    s_waitcnt lgkmcnt(6)
    v_mfma_f32_32x32x16_bf16 v[24:39], a[72:75], v[80:83], v[24:39]
    ds_read_b128 v[76:79], v119 offset:1024
    buffer_load_dwordx4 v5, s[40:43], m0 offen offset:1024 sc1 lds
    s_waitcnt lgkmcnt(6)
    v_mfma_f32_32x32x16_bf16 v[24:39], a[76:79], v[84:87], v[24:39]
    ds_read_b128 v[80:83], v119 offset:2048
    buffer_load_dword v148, v20, s[40:43], s63 offen offset:1024 sc1
    buffer_load_dword v149, v20, s[40:43], s63 offen offset:1280 sc1
    s_waitcnt lgkmcnt(6)
    v_mfma_f32_32x32x16_bf16 v[24:39], a[80:83], v[88:91], v[24:39]
    s_add_u32 m0, s81, 16384
    ds_read_b128 v[84:87], v119 offset:3072
    buffer_load_dwordx4 v5, s[40:43], m0 offen offset:0 sc1 lds
    s_waitcnt lgkmcnt(6)
    v_mfma_f32_32x32x16_bf16 v[24:39], a[84:87], v[92:95], v[24:39]
    ds_read_b128 v[88:91], v119 offset:4096
    s_waitcnt lgkmcnt(6)
    v_mfma_f32_32x32x16_bf16 v[24:39], a[88:91], v[96:99], v[24:39]
    ds_read_b128 v[92:95], v119 offset:5120
    buffer_load_dwordx4 v5, s[40:43], m0 offen offset:1024 sc1 lds
    s_waitcnt lgkmcnt(6)
    v_mfma_f32_32x32x16_bf16 v[24:39], a[92:95], v[100:103], v[24:39]
    ds_read_b128 v[96:99], v119 offset:6144
    s_waitcnt lgkmcnt(6)
    v_mfma_f32_32x32x16_bf16 v[24:39], a[96:99], v[72:75], v[24:39]
    s_add_u32 m0, s81, 49152
    ds_read_b128 v[100:103], v119 offset:7168
    buffer_load_dwordx4 v5, s[40:43], m0 offen offset:0 sc1 lds
    s_waitcnt lgkmcnt(6)
    v_mfma_f32_32x32x16_bf16 v[24:39], a[100:103], v[76:79], v[24:39]
    s_waitcnt lgkmcnt(5)
    v_mfma_f32_32x32x16_bf16 v[24:39], a[104:107], v[80:83], v[24:39]
    buffer_load_dwordx4 v5, s[40:43], m0 offen offset:1024 sc1 lds
    s_waitcnt lgkmcnt(4)
    v_mfma_f32_32x32x16_bf16 v[24:39], a[108:111], v[84:87], v[24:39]
    s_waitcnt lgkmcnt(3)
    v_mfma_f32_32x32x16_bf16 v[24:39], a[112:115], v[88:91], v[24:39]
    s_waitcnt lgkmcnt(2)
    v_mfma_f32_32x32x16_bf16 v[24:39], a[116:119], v[92:95], v[24:39]
    s_waitcnt vmcnt(12)
    v_cmp_gt_u32 vcc, 1, v140
    s_waitcnt lgkmcnt(1)
    v_mfma_f32_32x32x16_bf16 v[24:39], a[120:123], v[96:99], v[24:39]
    s_cbranch_vccnz Lrefb_13_s
Lfc_12_s:
    s_waitcnt lgkmcnt(0)
    v_mfma_f32_32x32x16_bf16 v[24:39], a[124:127], v[100:103], v[24:39]
    v_mov_b32 v62, 1
    s_nop 10
    v_cvt_pk_bf16_f32 v43, v30, v31
    v_cvt_pk_bf16_f32 v42, v28, v29
    v_cvt_pk_bf16_f32 v41, v26, v27
    v_cvt_pk_bf16_f32 v40, v24, v25
    v_and_b32 v40, -2, v40
    buffer_store_dwordx4 v[40:43], v1, s[44:47], s73 offen offset:0 sc1
    v_cvt_pk_bf16_f32 v47, v38, v39
    v_cvt_pk_bf16_f32 v46, v36, v37
    v_cvt_pk_bf16_f32 v45, v34, v35
    v_cvt_pk_bf16_f32 v44, v32, v33
    v_and_b32 v44, -2, v44
    buffer_store_dwordx4 v[44:47], v1, s[44:47], s73 offen offset:1024 sc1
    s_mov_b64 exec, 1
    s_waitcnt vmcnt(0)
    buffer_store_dword v62, off, s[40:43], s79 offset:0 sc1
    s_mov_b64 exec, -1
    v_pk_add_f32 v[56:57], v[24:25], v[26:27]
    v_pk_mul_f32 v[58:59], v[24:25], v[24:25]
    v_pk_fma_f32 v[58:59], v[26:27], v[26:27], v[58:59]
    v_pk_add_f32 v[56:57], v[56:57], v[28:29]
    v_pk_fma_f32 v[58:59], v[28:29], v[28:29], v[58:59]
    v_pk_add_f32 v[56:57], v[56:57], v[30:31]
    v_pk_fma_f32 v[58:59], v[30:31], v[30:31], v[58:59]
    v_pk_add_f32 v[56:57], v[56:57], v[32:33]
    v_pk_fma_f32 v[58:59], v[32:33], v[32:33], v[58:59]
    v_pk_add_f32 v[56:57], v[56:57], v[34:35]
    v_pk_fma_f32 v[58:59], v[34:35], v[34:35], v[58:59]
    v_pk_add_f32 v[56:57], v[56:57], v[36:37]
    v_pk_fma_f32 v[58:59], v[36:37], v[36:37], v[58:59]
    v_pk_add_f32 v[56:57], v[56:57], v[38:39]
    v_pk_fma_f32 v[58:59], v[38:39], v[38:39], v[58:59]
    v_add_f32 v56, v56, v57
    v_add_f32 v58, v58, v59
    s_lshl_b32 s84, s66, 8
    v_add_u32 v60, s84, v22
    v_permlane32_swap_b32 v56, v58
    v_add_f32 v56, v56, v58
    s_add_u32 m0, s81, 24576
    ds_write_b32 v60, v56 offset:6144
    buffer_load_dwordx4 v5, s[40:43], m0 offen offset:0 sc1 lds
    buffer_load_dwordx4 v5, s[40:43], m0 offen offset:1024 sc1 lds
    s_add_u32 m0, s81, 57344
    s_nop 0
    buffer_load_dwordx4 v5, s[40:43], m0 offen offset:0 sc1 lds
    s_waitcnt lgkmcnt(0)
    s_barrier
    s_cmp_lg_u32 s66, 0
    s_cbranch_scc1 Lst_14_s
    ds_read2st64_b32 v[56:57], v22 offset0:24 offset1:25
    ds_read2st64_b32 v[58:59], v22 offset0:26 offset1:27
    s_waitcnt lgkmcnt(0)
    v_add_f32 v56, v56, v57
    v_add_f32 v58, v58, v59
    v_add_f32 v56, v56, v58
    buffer_store_dword v56, v20, s[40:43], s76 offen offset:256 sc1
Lst_14_s:
    s_add_u32 m0, s81, 57344
    s_nop 0
    buffer_load_dwordx4 v5, s[40:43], m0 offen offset:1024 sc1 lds
    buffer_load_dword v127, v19, s[40:43], 0 offen sc1
    v_add_u32 v64, s1, v2
    v_add_u32 v65, s82, v2
    ds_write_b128 v64, v[40:43]
    ds_write_b128 v65, v[44:47]
    s_lshl_b32 s84, s66, 10
    v_add_u32 v66, s84, v2
    s_waitcnt vmcnt(12)
    v_add_f32 v104, v144, v145
    v_add_f32 v108, v146, v147
    v_add_f32 v112, v148, v149
    s_lshl_b32 s84, s66, 8
    v_add_u32 v120, s84, v22
    ds_write_b32 v120, v104 offset:3072
    ds_write_b32 v120, v108 offset:4096
    ds_write_b32 v120, v112 offset:5120
    s_cmp_eq_u32 s66, s0
    s_waitcnt lgkmcnt(3)
    s_barrier
    s_cbranch_scc0 Lpchk_16_s
    ds_read_b128 v[128:131], v2 offset:47104
    ds_read_b128 v[132:135], v66 offset:8192
    ds_read_b128 v[136:139], v66 offset:12288
    ds_read_b128 v[140:143], v66 offset:16384
    ds_read_b128 v[144:147], v66 offset:20480
    ds_read_b128 v[148:151], v66 offset:24576
    ds_read_b128 v[152:155], v66 offset:28672
    ds_read_b128 v[156:159], v2 offset:46080
    s_branch L_xown1_s
L_xpoll1_s:
    buffer_load_dword v127, v19, s[40:43], 0 offen sc1
    s_sub_u32 s68, s68, 1
    s_cbranch_scc1 L_end
L_xown1_s:
    s_waitcnt vmcnt(0)
    v_cmp_gt_u32 vcc, 1, v127
    s_cbranch_vccnz L_xpoll1_s
    s_xor_b32 s96, s70, 8192
    buffer_load_dwordx4 v[160:163], v1, s[44:47], s96 offen offset:0 sc1
    s_waitcnt lgkmcnt(0)
    s_barrier
    s_branch L_xjoin1_s
Lpoll_15_s:
    buffer_load_dword v127, v19, s[40:43], 0 offen sc1
    s_sub_u32 s68, s68, 1
    s_cbranch_scc1 L_end
Lpchk_16_s:
    s_waitcnt vmcnt(0)
    v_cmp_gt_u32 vcc, 1, v127
    s_cbranch_vccnz Lpoll_15_s
    s_xor_b32 s96, s70, 0
    buffer_load_dwordx4 v[128:131], v1, s[44:47], s96 offen offset:0 sc1
    buffer_load_dwordx4 v[132:135], v1, s[44:47], s96 offen offset:1024 sc1
    buffer_load_dwordx4 v[136:139], v1, s[44:47], s96 offen offset:2048 sc1
    buffer_load_dwordx4 v[140:143], v1, s[44:47], s96 offen offset:3072 sc1
    s_xor_b32 s96, s70, 4096
    buffer_load_dwordx4 v[144:147], v1, s[44:47], s96 offen offset:0 sc1
    s_waitcnt lgkmcnt(0)
    s_barrier
L_xre1_s:
    buffer_load_dwordx4 v[148:151], v1, s[44:47], s96 offen offset:1024 sc1
    buffer_load_dwordx4 v[152:155], v1, s[44:47], s96 offen offset:2048 sc1
    buffer_load_dwordx4 v[156:159], v1, s[44:47], s96 offen offset:3072 sc1
    s_xor_b32 s96, s70, 8192
    buffer_load_dwordx4 v[160:163], v1, s[44:47], s96 offen offset:0 sc1
L_xjoin1_s:
    ds_read_b128 v[72:75], v1 offset:0
    ds_read_b128 v[76:79], v1 offset:32768
    ds_read_b128 v[80:83], v1 offset:1024
    ds_read_b128 v[84:87], v1 offset:33792
    ds_read_b128 v[88:91], v1 offset:2048
    ds_read_b128 v[92:95], v1 offset:34816
    s_waitcnt vmcnt(8) lgkmcnt(5)
    v_mfma_f32_32x32x16_bf16 v[40:55], v[72:75], v[128:131], 0
    ds_read_b128 v[96:99], v1 offset:3072
    buffer_load_dwordx4 v[164:167], v1, s[44:47], s96 offen offset:1024 sc1
    s_waitcnt lgkmcnt(5)
    v_mfma_f32_32x32x16_bf16 v[56:71], v[76:79], v[128:131], 0
    ds_read_b128 v[100:103], v1 offset:35840
    s_waitcnt vmcnt(8) lgkmcnt(5)
    v_mfma_f32_32x32x16_bf16 v[40:55], v[80:83], v[132:135], v[40:55]
    ds_read_b128 v[72:75], v1 offset:4096
    buffer_load_dwordx4 v[168:171], v1, s[44:47], s96 offen offset:2048 sc1
    s_waitcnt lgkmcnt(5)
    v_mfma_f32_32x32x16_bf16 v[56:71], v[84:87], v[132:135], v[56:71]
    ds_read_b128 v[76:79], v1 offset:36864
    v_or3_b32 v12, 0, v128, v132
    v_and_b32 v122, 32, v0
    s_waitcnt vmcnt(8) lgkmcnt(5)
    v_mfma_f32_32x32x16_bf16 v[40:55], v[88:91], v[136:139], v[40:55]
    ds_read_b128 v[80:83], v1 offset:5120
    buffer_load_dwordx4 v[172:175], v1, s[44:47], s96 offen offset:3072 sc1
    s_waitcnt lgkmcnt(5)
    v_mfma_f32_32x32x16_bf16 v[56:71], v[92:95], v[136:139], v[56:71]
    ds_read_b128 v[84:87], v1 offset:37888
    ds_read2st64_b32 v[104:105], v22 offset0:12 offset1:13
    ds_read2st64_b32 v[106:107], v22 offset0:14 offset1:15
    v_lshl_add_u32 v126, v122, 7, v6
    v_lshl_add_u32 v127, v122, 7, v7
    s_waitcnt vmcnt(8) lgkmcnt(7)
    v_mfma_f32_32x32x16_bf16 v[40:55], v[96:99], v[140:143], v[40:55]
    ds_read_b128 v[88:91], v1 offset:6144
    s_xor_b32 s96, s70, 12288
    buffer_load_dwordx4 v[176:179], v1, s[44:47], s96 offen offset:0 sc1
    s_waitcnt lgkmcnt(7)
    v_mfma_f32_32x32x16_bf16 v[56:71], v[100:103], v[140:143], v[56:71]
    ds_read_b128 v[92:95], v1 offset:38912
    ds_read2st64_b32 v[108:109], v22 offset0:16 offset1:17
    ds_read2st64_b32 v[110:111], v22 offset0:18 offset1:19
    v_or3_b32 v12, v12, v136, v140
    s_waitcnt vmcnt(8) lgkmcnt(9)
    v_mfma_f32_32x32x16_bf16 v[40:55], v[72:75], v[144:147], v[40:55]
    ds_read_b128 v[96:99], v1 offset:7168
    buffer_load_dwordx4 v[180:183], v1, s[44:47], s96 offen offset:1024 sc1
    s_waitcnt lgkmcnt(9)
    v_mfma_f32_32x32x16_bf16 v[56:71], v[76:79], v[144:147], v[56:71]
    ds_read_b128 v[100:103], v1 offset:39936
    s_waitcnt vmcnt(8) lgkmcnt(9)
    v_mfma_f32_32x32x16_bf16 v[40:55], v[80:83], v[148:151], v[40:55]
    ds_read_b128 v[72:75], v1 offset:8192
    buffer_load_dwordx4 v[184:187], v1, s[44:47], s96 offen offset:2048 sc1
    s_waitcnt lgkmcnt(9)
    v_mfma_f32_32x32x16_bf16 v[56:71], v[84:87], v[148:151], v[56:71]
    ds_read_b128 v[76:79], v1 offset:40960
    v_or3_b32 v12, v12, v144, v148
    s_waitcnt vmcnt(8) lgkmcnt(7)
    v_mfma_f32_32x32x16_bf16 v[40:55], v[88:91], v[152:155], v[40:55]
    ds_read_b128 v[80:83], v1 offset:9216
    buffer_load_dwordx4 v[188:191], v1, s[44:47], s96 offen offset:3072 sc1
    buffer_load_dword v112, v20, s[40:43], s77 offen offset:256 sc1
    buffer_load_dword v113, v20, s[40:43], s77 offen offset:1280 sc1
    buffer_load_dword v114, v20, s[40:43], s77 offen offset:2304 sc1
    buffer_load_dword v115, v20, s[40:43], s77 offen offset:3328 sc1
    s_waitcnt lgkmcnt(7)
    v_mfma_f32_32x32x16_bf16 v[56:71], v[92:95], v[152:155], v[56:71]
    ds_read_b128 v[84:87], v1 offset:41984
    s_waitcnt lgkmcnt(6)
    v_add_f32 v104, v104, v105
    v_add_f32 v106, v106, v107
    s_waitcnt vmcnt(12) lgkmcnt(5)
    v_mfma_f32_32x32x16_bf16 v[40:55], v[96:99], v[156:159], v[40:55]
    ds_read_b128 v[88:91], v1 offset:10240
    s_xor_b32 s96, s70, 16384
    buffer_load_dwordx4 v[192:195], v1, s[44:47], s96 offen offset:0 sc1
    v_add_f32 v106, v104, v106
    s_waitcnt lgkmcnt(5)
    v_mfma_f32_32x32x16_bf16 v[56:71], v[100:103], v[156:159], v[56:71]
    ds_read_b128 v[92:95], v1 offset:43008
    v_cvt_pk_bf16_f32 v104, v106, v106
    v_and_b32 v107, 0xffff0000, v104
    v_or3_b32 v12, v12, v152, v156
    s_waitcnt vmcnt(12) lgkmcnt(5)
    v_mfma_f32_32x32x16_bf16 v[40:55], v[72:75], v[160:163], v[40:55]
    ds_read_b128 v[96:99], v1 offset:11264
    buffer_load_dwordx4 v[196:199], v1, s[44:47], s96 offen offset:1024 sc1
    v_sub_f32 v107, v106, v107
    s_waitcnt lgkmcnt(5)
    v_mfma_f32_32x32x16_bf16 v[56:71], v[76:79], v[160:163], v[56:71]
    ds_read_b128 v[100:103], v1 offset:44032
    v_cvt_pk_bf16_f32 v105, v107, 0
    v_add_f32 v108, v108, v109
    s_waitcnt vmcnt(12) lgkmcnt(5)
    v_mfma_f32_32x32x16_bf16 v[40:55], v[80:83], v[164:167], v[40:55]
    ds_read_b128 v[72:75], v1 offset:12288
    buffer_load_dwordx4 v[200:203], v1, s[44:47], s96 offen offset:2048 sc1
    v_add_f32 v110, v110, v111
    s_waitcnt lgkmcnt(5)
    v_mfma_f32_32x32x16_bf16 v[56:71], v[84:87], v[164:167], v[56:71]
    ds_read_b128 v[76:79], v1 offset:45056
    v_add_f32 v110, v108, v110
    v_cvt_pk_bf16_f32 v108, v110, v110
    v_or3_b32 v12, v12, v160, v164
    s_waitcnt vmcnt(12) lgkmcnt(5)
    v_mfma_f32_32x32x16_bf16 v[40:55], v[88:91], v[168:171], v[40:55]
    ds_read_b128 v[80:83], v1 offset:13312
    buffer_load_dwordx4 v[204:207], v1, s[44:47], s96 offen offset:3072 sc1
    v_and_b32 v111, 0xffff0000, v108
    s_waitcnt lgkmcnt(5)
    v_mfma_f32_32x32x16_bf16 v[56:71], v[92:95], v[168:171], v[56:71]
    ds_read_b128 v[84:87], v1 offset:46080
    v_sub_f32 v111, v110, v111
    v_cvt_pk_bf16_f32 v109, v111, 0
    s_waitcnt vmcnt(12) lgkmcnt(5)
    v_mfma_f32_32x32x16_bf16 v[40:55], v[96:99], v[172:175], v[40:55]
    ds_read_b128 v[88:91], v1 offset:14336
    s_xor_b32 s96, s70, 20480
    buffer_load_dwordx4 v[208:211], v1, s[44:47], s96 offen offset:0 sc1
    s_waitcnt lgkmcnt(5)
    v_mfma_f32_32x32x16_bf16 v[56:71], v[100:103], v[172:175], v[56:71]
    ds_read_b128 v[92:95], v1 offset:47104
    v_or3_b32 v12, v12, v168, v172
    s_waitcnt vmcnt(12) lgkmcnt(5)
    v_mfma_f32_32x32x16_bf16 v[40:55], v[72:75], v[176:179], v[40:55]
    ds_read_b128 v[96:99], v1 offset:15360
    buffer_load_dwordx4 v[212:215], v1, s[44:47], s96 offen offset:1024 sc1
    s_waitcnt lgkmcnt(5)
    v_mfma_f32_32x32x16_bf16 v[56:71], v[76:79], v[176:179], v[56:71]
    ds_read_b128 v[100:103], v1 offset:48128
    s_waitcnt vmcnt(12) lgkmcnt(5)
    v_mfma_f32_32x32x16_bf16 v[40:55], v[80:83], v[180:183], v[40:55]
    ds_read_b128 v[72:75], v1 offset:16384
    buffer_load_dwordx4 v[216:219], v1, s[44:47], s96 offen offset:2048 sc1
    s_waitcnt lgkmcnt(5)
    v_mfma_f32_32x32x16_bf16 v[56:71], v[84:87], v[180:183], v[56:71]
    ds_read_b128 v[76:79], v1 offset:49152
    v_or3_b32 v12, v12, v176, v180
    s_waitcnt vmcnt(12) lgkmcnt(5)
    v_mfma_f32_32x32x16_bf16 v[40:55], v[88:91], v[184:187], v[40:55]
    ds_read_b128 v[80:83], v1 offset:17408
    buffer_load_dwordx4 v[220:223], v1, s[44:47], s96 offen offset:3072 sc1
    s_waitcnt lgkmcnt(5)
    v_mfma_f32_32x32x16_bf16 v[56:71], v[92:95], v[184:187], v[56:71]
    ds_read_b128 v[84:87], v1 offset:50176
    s_waitcnt vmcnt(12) lgkmcnt(5)
    v_mfma_f32_32x32x16_bf16 v[40:55], v[96:99], v[188:191], v[40:55]
    ds_read_b128 v[88:91], v1 offset:18432
    s_xor_b32 s96, s70, 24576
    buffer_load_dwordx4 v[224:227], v1, s[44:47], s96 offen offset:0 sc1
    s_waitcnt lgkmcnt(5)
    v_mfma_f32_32x32x16_bf16 v[56:71], v[100:103], v[188:191], v[56:71]
    ds_read_b128 v[92:95], v1 offset:51200
    s_waitcnt vmcnt(9)
    v_max3_u32 v120, v112, v113, v114
    v_max_u32 v120, v120, v115
    v_or3_b32 v12, v12, v184, v188
    s_waitcnt vmcnt(8) lgkmcnt(5)
    v_mfma_f32_32x32x16_bf16 v[40:55], v[72:75], v[192:195], v[40:55]
    ds_read_b128 v[96:99], v1 offset:19456
    buffer_load_dwordx4 v[228:231], v1, s[44:47], s96 offen offset:1024 sc1
    v_cmp_eq_u32 vcc, -1, v120
    s_waitcnt lgkmcnt(5)
    v_mfma_f32_32x32x16_bf16 v[56:71], v[76:79], v[192:195], v[56:71]
    ds_read_b128 v[100:103], v1 offset:52224
    s_cbranch_vccnz Lstre_17_s
Lstok_18_s:
    s_waitcnt vmcnt(8) lgkmcnt(5)
    v_mfma_f32_32x32x16_bf16 v[40:55], v[80:83], v[196:199], v[40:55]
    ds_read_b128 v[72:75], v1 offset:20480
    buffer_load_dwordx4 v[232:235], v1, s[44:47], s96 offen offset:2048 sc1
    v_add_f32 v112, v112, v113
    s_waitcnt lgkmcnt(5)
    v_mfma_f32_32x32x16_bf16 v[56:71], v[84:87], v[196:199], v[56:71]
    ds_read_b128 v[76:79], v1 offset:53248
    v_add_f32 v114, v114, v115
    v_add_f32 v112, v112, v114
    v_or3_b32 v12, v12, v192, v196
    s_waitcnt vmcnt(8) lgkmcnt(5)
    v_mfma_f32_32x32x16_bf16 v[40:55], v[88:91], v[200:203], v[40:55]
    ds_read_b128 v[80:83], v1 offset:21504
    buffer_load_dwordx4 v[236:239], v1, s[44:47], s96 offen offset:3072 sc1
    v_mul_f32 v112, 0x3b000000, v112
    s_waitcnt lgkmcnt(5)
    v_mfma_f32_32x32x16_bf16 v[56:71], v[92:95], v[200:203], v[56:71]
    ds_read_b128 v[84:87], v1 offset:54272
    v_mov_b32 v113, v112
    s_nop 1
    v_permlane32_swap_b32 v112, v113
    s_waitcnt vmcnt(8) lgkmcnt(5)
    v_mfma_f32_32x32x16_bf16 v[40:55], v[96:99], v[204:207], v[40:55]
    ds_read_b128 v[88:91], v1 offset:22528
    s_xor_b32 s96, s70, 28672
    buffer_load_dwordx4 v[240:243], v1, s[44:47], s96 offen offset:0 sc1
    v_fma_f32 v113, -v112, v112, v113
    s_waitcnt lgkmcnt(5)
    v_mfma_f32_32x32x16_bf16 v[56:71], v[100:103], v[204:207], v[56:71]
    ds_read_b128 v[92:95], v1 offset:55296
    v_max_f32 v113, 0, v113
    v_add_f32 v113, 0x3727c5ac, v113
    v_or3_b32 v12, v12, v200, v204
    s_waitcnt vmcnt(8) lgkmcnt(5)
    v_mfma_f32_32x32x16_bf16 v[40:55], v[72:75], v[208:211], v[40:55]
    ds_read_b128 v[96:99], v1 offset:23552
    buffer_load_dwordx4 v[244:247], v1, s[44:47], s96 offen offset:1024 sc1
    v_rsq_f32 v120, v113
    s_waitcnt lgkmcnt(5)
    v_mfma_f32_32x32x16_bf16 v[56:71], v[76:79], v[208:211], v[56:71]
    ds_read_b128 v[100:103], v1 offset:56320
    v_cvt_pk_bf16_f32 v117, -v112, 0
    v_lshlrev_b32 v114, 16, v117
    s_waitcnt vmcnt(8) lgkmcnt(5)
    v_mfma_f32_32x32x16_bf16 v[40:55], v[80:83], v[212:215], v[40:55]
    ds_read_b128 v[72:75], v1 offset:24576
    buffer_load_dwordx4 v[248:251], v1, s[44:47], s96 offen offset:2048 sc1
    v_sub_f32 v114, -v112, v114
    s_waitcnt lgkmcnt(5)
    v_mfma_f32_32x32x16_bf16 v[56:71], v[84:87], v[212:215], v[56:71]
    ds_read_b128 v[76:79], v1 offset:57344
    v_cvt_pk_bf16_f32 v116, -v112, v114
    v_mul_f32 v118, 0x3fb8aa3b, v120
    v_or3_b32 v12, v12, v208, v212
    s_waitcnt vmcnt(8) lgkmcnt(5)
    v_mfma_f32_32x32x16_bf16 v[40:55], v[88:91], v[216:219], v[40:55]
    ds_read_b128 v[80:83], v1 offset:25600
    buffer_load_dwordx4 v[252:255], v1, s[44:47], s96 offen offset:3072 sc1
    s_waitcnt lgkmcnt(5)
    v_mfma_f32_32x32x16_bf16 v[56:71], v[92:95], v[216:219], v[56:71]
    ds_read_b128 v[84:87], v1 offset:58368
    s_waitcnt vmcnt(8) lgkmcnt(5)
    v_mfma_f32_32x32x16_bf16 v[40:55], v[96:99], v[220:223], v[40:55]
    ds_read_b128 v[88:91], v1 offset:26624
    s_waitcnt lgkmcnt(5)
    v_mfma_f32_32x32x16_bf16 v[56:71], v[100:103], v[220:223], v[56:71]
    ds_read_b128 v[92:95], v1 offset:59392
    v_or3_b32 v12, v12, v216, v220
    s_waitcnt vmcnt(7) lgkmcnt(5)
    v_mfma_f32_32x32x16_bf16 v[40:55], v[72:75], v[224:227], v[40:55]
    ds_read_b128 v[96:99], v1 offset:27648
    s_waitcnt lgkmcnt(5)
    v_mfma_f32_32x32x16_bf16 v[56:71], v[76:79], v[224:227], v[56:71]
    ds_read_b128 v[100:103], v1 offset:60416
    s_waitcnt vmcnt(6) lgkmcnt(5)
    v_mfma_f32_32x32x16_bf16 v[40:55], v[80:83], v[228:231], v[40:55]
    ds_read_b128 v[72:75], v1 offset:28672
    s_waitcnt lgkmcnt(5)
    v_mfma_f32_32x32x16_bf16 v[56:71], v[84:87], v[228:231], v[56:71]
    ds_read_b128 v[76:79], v1 offset:29696
    v_or3_b32 v12, v12, v224, v228
    s_waitcnt vmcnt(5) lgkmcnt(5)
    v_mfma_f32_32x32x16_bf16 v[40:55], v[88:91], v[232:235], v[40:55]
    ds_read_b128 v[80:83], v1 offset:30720
    s_waitcnt lgkmcnt(5)
    v_mfma_f32_32x32x16_bf16 v[56:71], v[92:95], v[232:235], v[56:71]
    ds_read_b128 v[84:87], v1 offset:31744
    s_waitcnt vmcnt(4) lgkmcnt(5)
    v_mfma_f32_32x32x16_bf16 v[40:55], v[96:99], v[236:239], v[40:55]
    s_add_u32 m0, s81, 90112
    ds_read_b128 v[88:91], v1 offset:61440
    buffer_load_dwordx4 v5, s[40:43], m0 offen offset:0 sc1 lds
    s_waitcnt lgkmcnt(5)
    v_mfma_f32_32x32x16_bf16 v[56:71], v[100:103], v[236:239], v[56:71]
    ds_read_b128 v[92:95], v1 offset:62464
    buffer_load_dwordx4 v5, s[40:43], m0 offen offset:1024 sc1 lds
    v_or3_b32 v12, v12, v232, v236
    s_waitcnt vmcnt(5) lgkmcnt(5)
    v_mfma_f32_32x32x16_bf16 v[40:55], v[72:75], v[240:243], v[40:55]
    s_add_u32 m0, s81, 98304
    ds_read_b128 v[96:99], v1 offset:63488
    buffer_load_dwordx4 v5, s[40:43], m0 offen offset:0 sc1 lds
    v_mfma_f32_32x32x8_bf16 v[40:55], v[104:105], v[116:117], v[40:55]
    s_waitcnt vmcnt(5) lgkmcnt(5)
    v_mfma_f32_32x32x16_bf16 v[40:55], v[76:79], v[244:247], v[40:55]
    ds_read_b128 v[100:103], v1 offset:64512
    buffer_load_dwordx4 v5, s[40:43], m0 offen offset:1024 sc1 lds
    v_mfma_f32_32x32x8_bf16 v[56:71], v[108:109], v[116:117], v[56:71]
    s_waitcnt vmcnt(5) lgkmcnt(5)
    s_add_u32 m0, s81, 106496
    v_mfma_f32_32x32x16_bf16 v[40:55], v[80:83], v[248:251], v[40:55]
    buffer_load_dwordx4 v5, s[40:43], m0 offen offset:0 sc1 lds
    v_or3_b32 v12, v12, v240, v244
    s_waitcnt vmcnt(5) lgkmcnt(4)
    v_mfma_f32_32x32x16_bf16 v[40:55], v[84:87], v[252:255], v[40:55]
    buffer_load_dwordx4 v5, s[40:43], m0 offen offset:1024 sc1 lds
    v_or3_b32 v12, v12, v248, v252
    s_waitcnt lgkmcnt(3)
    s_add_u32 m0, s81, 114688
    v_mfma_f32_32x32x16_bf16 v[56:71], v[88:91], v[240:243], v[56:71]
    buffer_load_dwordx4 v5, s[40:43], m0 offen offset:0 sc1 lds
    v_and_b32 v12, 1, v12
    v_cmp_ne_u32 vcc, 0, v12
    s_waitcnt lgkmcnt(2)
    v_mfma_f32_32x32x16_bf16 v[56:71], v[92:95], v[244:247], v[56:71]
    buffer_load_dwordx4 v5, s[40:43], m0 offen offset:1024 sc1 lds
    v_max3_f32 v119, v40, v41, v42
    v_max3_f32 v121, v43, v44, v45
    v_max3_f32 v119, v119, v46, v47
    v_max3_f32 v121, v121, v48, v49
    v_max3_f32 v119, v119, v50, v51
    v_max3_f32 v121, v121, v52, v53
    s_waitcnt lgkmcnt(1)
    v_mfma_f32_32x32x16_bf16 v[56:71], v[96:99], v[248:251], v[56:71]
    s_add_u32 s95, s8, 524288
    buffer_load_dwordx4 a[128:131], v1, s[40:43], s95 offen offset:0 sc1
    v_max3_f32 v119, v119, v54, v55
    v_max_f32 v119, v119, v121
    v_mul_f32 v119, -v119, v118
    v_min3_f32 v122, v40, v41, v42
    v_min3_f32 v123, v43, v44, v45
    v_min3_f32 v122, v122, v46, v47
    s_waitcnt lgkmcnt(0)
    v_mfma_f32_32x32x16_bf16 v[56:71], v[100:103], v[252:255], v[56:71]
    buffer_load_dwordx4 a[132:135], v1, s[40:43], s95 offen offset:1024 sc1
    v_min3_f32 v123, v123, v48, v49
    v_min3_f32 v122, v122, v50, v51
    v_min3_f32 v123, v123, v52, v53
    v_min3_f32 v122, v122, v54, v55
    v_min_f32 v122, v122, v123
    s_cbranch_vccnz L_xbad1_s
    v_pk_fma_f32 v[72:73], v[40:41], v[118:119], v[118:119] op_sel:[0,0,1] op_sel_hi:[1,0,1]
    v_pk_fma_f32 v[74:75], v[42:43], v[118:119], v[118:119] op_sel:[0,0,1] op_sel_hi:[1,0,1]
    v_pk_fma_f32 v[76:77], v[44:45], v[118:119], v[118:119] op_sel:[0,0,1] op_sel_hi:[1,0,1]
    v_pk_fma_f32 v[78:79], v[46:47], v[118:119], v[118:119] op_sel:[0,0,1] op_sel_hi:[1,0,1]
    v_pk_fma_f32 v[80:81], v[48:49], v[118:119], v[118:119] op_sel:[0,0,1] op_sel_hi:[1,0,1]
    v_pk_fma_f32 v[82:83], v[50:51], v[118:119], v[118:119] op_sel:[0,0,1] op_sel_hi:[1,0,1]
    v_pk_fma_f32 v[84:85], v[52:53], v[118:119], v[118:119] op_sel:[0,0,1] op_sel_hi:[1,0,1]
    v_pk_fma_f32 v[86:87], v[54:55], v[118:119], v[118:119] op_sel:[0,0,1] op_sel_hi:[1,0,1]
    v_pk_mul_f32 v[56:57], v[56:57], v[120:121] op_sel_hi:[1,0]
    v_pk_mul_f32 v[58:59], v[58:59], v[120:121] op_sel_hi:[1,0]
    v_pk_mul_f32 v[60:61], v[60:61], v[120:121] op_sel_hi:[1,0]
    v_pk_mul_f32 v[62:63], v[62:63], v[120:121] op_sel_hi:[1,0]
    v_cvt_pk_bf16_f32 v56, v56, v57
    v_cvt_pk_bf16_f32 v57, v58, v59
    v_cvt_pk_bf16_f32 v58, v60, v61
    v_cvt_pk_bf16_f32 v59, v62, v63
    ds_write_b128 v8, v[56:59]
    v_pk_mul_f32 v[64:65], v[64:65], v[120:121] op_sel_hi:[1,0]
    v_pk_mul_f32 v[66:67], v[66:67], v[120:121] op_sel_hi:[1,0]
    v_pk_mul_f32 v[68:69], v[68:69], v[120:121] op_sel_hi:[1,0]
    v_pk_mul_f32 v[70:71], v[70:71], v[120:121] op_sel_hi:[1,0]
    buffer_load_dwordx4 a[136:139], v1, s[40:43], s95 offen offset:2048 sc1
    v_cvt_pk_bf16_f32 v60, v64, v65
    v_cvt_pk_bf16_f32 v61, v66, v67
    v_cvt_pk_bf16_f32 v62, v68, v69
    v_cvt_pk_bf16_f32 v63, v70, v71
    v_exp_f32 v72, v72
    v_exp_f32 v73, v73
    v_exp_f32 v74, v74
    v_exp_f32 v75, v75
    v_exp_f32 v76, v76
    v_exp_f32 v77, v77
    ds_write_b128 v8, v[60:63] offset:4096
    v_exp_f32 v78, v78
    v_exp_f32 v79, v79
    v_exp_f32 v80, v80
    v_exp_f32 v81, v81
    v_exp_f32 v82, v82
    v_exp_f32 v83, v83
    v_exp_f32 v84, v84
    v_exp_f32 v85, v85
    buffer_load_dwordx4 a[140:143], v1, s[40:43], s95 offen offset:3072 sc1
    v_exp_f32 v86, v86
    v_exp_f32 v87, v87
    v_pk_add_f32 v[124:125], v[72:73], v[74:75]
    v_pk_add_f32 v[112:113], v[76:77], v[78:79]
    v_pk_add_f32 v[124:125], v[124:125], v[80:81]
    v_pk_add_f32 v[112:113], v[112:113], v[82:83]
    v_pk_add_f32 v[124:125], v[124:125], v[84:85]
    v_pk_add_f32 v[112:113], v[112:113], v[86:87]
    v_pk_add_f32 v[124:125], v[124:125], v[112:113]
    v_add_f32 v124, v124, v125
    v_rcp_f32 v124, v124
    s_nop 0
    v_pk_mul_f32 v[72:73], v[72:73], v[124:125] op_sel_hi:[1,0]
    v_pk_mul_f32 v[74:75], v[74:75], v[124:125] op_sel_hi:[1,0]
    v_pk_mul_f32 v[76:77], v[76:77], v[124:125] op_sel_hi:[1,0]
    v_pk_mul_f32 v[78:79], v[78:79], v[124:125] op_sel_hi:[1,0]
    v_cvt_pk_bf16_f32 v72, v72, v73
    v_cvt_pk_bf16_f32 v73, v74, v75
    v_cvt_pk_bf16_f32 v74, v76, v77
    v_cvt_pk_bf16_f32 v75, v78, v79
    ds_write_b128 v126, v[72:75]
    v_pk_mul_f32 v[80:81], v[80:81], v[124:125] op_sel_hi:[1,0]
    v_pk_mul_f32 v[82:83], v[82:83], v[124:125] op_sel_hi:[1,0]
    v_pk_mul_f32 v[84:85], v[84:85], v[124:125] op_sel_hi:[1,0]
    v_pk_mul_f32 v[86:87], v[86:87], v[124:125] op_sel_hi:[1,0]
    v_cvt_pk_bf16_f32 v76, v80, v81
    v_cvt_pk_bf16_f32 v77, v82, v83
    v_cvt_pk_bf16_f32 v78, v84, v85
    v_cvt_pk_bf16_f32 v79, v86, v87
    v_mul_f32 v119, v122, v118
    v_pk_fma_f32 v[88:89], v[40:41], v[118:119], v[118:119] op_sel:[0,0,1] op_sel_hi:[1,0,1] neg_lo:[1,0,0] neg_hi:[1,0,0]
    s_add_u32 s95, s8, 528384
    buffer_load_dwordx4 a[144:147], v1, s[40:43], s95 offen offset:0 sc1
    v_pk_fma_f32 v[90:91], v[42:43], v[118:119], v[118:119] op_sel:[0,0,1] op_sel_hi:[1,0,1] neg_lo:[1,0,0] neg_hi:[1,0,0]
    v_pk_fma_f32 v[92:93], v[44:45], v[118:119], v[118:119] op_sel:[0,0,1] op_sel_hi:[1,0,1] neg_lo:[1,0,0] neg_hi:[1,0,0]
    v_pk_fma_f32 v[94:95], v[46:47], v[118:119], v[118:119] op_sel:[0,0,1] op_sel_hi:[1,0,1] neg_lo:[1,0,0] neg_hi:[1,0,0]
    v_pk_fma_f32 v[96:97], v[48:49], v[118:119], v[118:119] op_sel:[0,0,1] op_sel_hi:[1,0,1] neg_lo:[1,0,0] neg_hi:[1,0,0]
    ds_write_b128 v127, v[76:79]
    v_pk_fma_f32 v[98:99], v[50:51], v[118:119], v[118:119] op_sel:[0,0,1] op_sel_hi:[1,0,1] neg_lo:[1,0,0] neg_hi:[1,0,0]
    v_pk_fma_f32 v[100:101], v[52:53], v[118:119], v[118:119] op_sel:[0,0,1] op_sel_hi:[1,0,1] neg_lo:[1,0,0] neg_hi:[1,0,0]
    v_pk_fma_f32 v[102:103], v[54:55], v[118:119], v[118:119] op_sel:[0,0,1] op_sel_hi:[1,0,1] neg_lo:[1,0,0] neg_hi:[1,0,0]
    v_exp_f32 v88, v88
    v_exp_f32 v89, v89
    v_exp_f32 v90, v90
    v_exp_f32 v91, v91
    v_exp_f32 v92, v92
    v_exp_f32 v93, v93
    v_exp_f32 v94, v94
    v_exp_f32 v95, v95
    v_exp_f32 v96, v96
    v_exp_f32 v97, v97
    v_exp_f32 v98, v98
    v_exp_f32 v99, v99
    v_exp_f32 v100, v100
    buffer_load_dwordx4 a[148:151], v1, s[40:43], s95 offen offset:1024 sc1
    v_exp_f32 v101, v101
    v_exp_f32 v102, v102
    v_exp_f32 v103, v103
    v_pk_add_f32 v[124:125], v[88:89], v[90:91]
    v_pk_add_f32 v[112:113], v[92:93], v[94:95]
    v_pk_add_f32 v[124:125], v[124:125], v[96:97]
    v_pk_add_f32 v[112:113], v[112:113], v[98:99]
    v_pk_add_f32 v[124:125], v[124:125], v[100:101]
    v_pk_add_f32 v[112:113], v[112:113], v[102:103]
    v_pk_add_f32 v[124:125], v[124:125], v[112:113]
    v_add_f32 v124, v124, v125
    v_rcp_f32 v124, v124
    s_nop 0
    v_pk_mul_f32 v[88:89], v[88:89], v[124:125] op_sel_hi:[1,0]
    v_pk_mul_f32 v[90:91], v[90:91], v[124:125] op_sel_hi:[1,0]
    v_pk_mul_f32 v[92:93], v[92:93], v[124:125] op_sel_hi:[1,0]
    v_pk_mul_f32 v[94:95], v[94:95], v[124:125] op_sel_hi:[1,0]
    v_cvt_pk_bf16_f32 v88, v88, v89
    v_cvt_pk_bf16_f32 v89, v90, v91
    v_cvt_pk_bf16_f32 v90, v92, v93
    v_cvt_pk_bf16_f32 v91, v94, v95
    ds_write_b128 v126, v[88:91] offset:4096
    v_pk_mul_f32 v[96:97], v[96:97], v[124:125] op_sel_hi:[1,0]
    v_pk_mul_f32 v[98:99], v[98:99], v[124:125] op_sel_hi:[1,0]
    v_pk_mul_f32 v[100:101], v[100:101], v[124:125] op_sel_hi:[1,0]
    v_pk_mul_f32 v[102:103], v[102:103], v[124:125] op_sel_hi:[1,0]
    v_cvt_pk_bf16_f32 v92, v96, v97
    v_cvt_pk_bf16_f32 v93, v98, v99
    v_cvt_pk_bf16_f32 v94, v100, v101
    v_cvt_pk_bf16_f32 v95, v102, v103
    buffer_load_dwordx4 a[152:155], v1, s[40:43], s95 offen offset:2048 sc1
    ds_write_b128 v127, v[92:95] offset:4096
    v_add_u32 v123, 0x10000, v1
    v_mov_b32 v64, 0x3f803f80
    v_mov_b32 v65, 0x3f803f80
    v_mov_b32 v66, 0x3f803f80
    v_mov_b32 v67, 0x3f803f80
    buffer_load_dwordx4 a[156:159], v1, s[40:43], s95 offen offset:3072 sc1
    s_waitcnt vmcnt(8)
    s_waitcnt lgkmcnt(0)
    s_barrier
    ds_read_b64_tr_b16 v[72:73], v9 offset:0
    ds_read_b64_tr_b16 v[74:75], v9 offset:512
    ds_read_b64_tr_b16 v[76:77], v10 offset:0
    ds_read_b64_tr_b16 v[78:79], v10 offset:512
    ds_read_b64_tr_b16 v[80:81], v9 offset:1024
    ds_read_b64_tr_b16 v[82:83], v9 offset:1536
    ds_read_b64_tr_b16 v[84:85], v10 offset:1024
    ds_read_b64_tr_b16 v[86:87], v10 offset:1536
    ds_read_b64_tr_b16 v[88:89], v9 offset:2048
    ds_read_b64_tr_b16 v[90:91], v9 offset:2560
    ds_read_b64_tr_b16 v[92:93], v10 offset:2048
    ds_read_b64_tr_b16 v[94:95], v10 offset:2560
    ds_read_b64_tr_b16 v[96:97], v9 offset:3072
    ds_read_b64_tr_b16 v[98:99], v9 offset:3584
    ds_read_b64_tr_b16 v[100:101], v10 offset:3072
    ds_read_b64_tr_b16 v[102:103], v10 offset:3584
    s_add_u32 s95, s9, 524288
    buffer_load_dwordx4 a[160:163], v1, s[40:43], s95 offen offset:0 sc1
    s_waitcnt lgkmcnt(12)
    v_mfma_f32_16x16x32_bf16 v[56:59], v[72:75], v[76:79], 0
    v_mfma_f32_16x16x32_bf16 v[60:63], v[72:75], v[64:67], 0
    s_waitcnt lgkmcnt(8)
    v_mfma_f32_16x16x32_bf16 v[56:59], v[80:83], v[84:87], v[56:59]
    v_mfma_f32_16x16x32_bf16 v[60:63], v[80:83], v[64:67], v[60:63]
    s_waitcnt lgkmcnt(4)
    v_mfma_f32_16x16x32_bf16 v[56:59], v[88:91], v[92:95], v[56:59]
    v_mfma_f32_16x16x32_bf16 v[60:63], v[88:91], v[64:67], v[60:63]
    s_waitcnt lgkmcnt(0)
    v_mfma_f32_16x16x32_bf16 v[56:59], v[96:99], v[100:103], v[56:59]
    v_mfma_f32_16x16x32_bf16 v[60:63], v[96:99], v[64:67], v[60:63]
    v_mov_b32 v40, 1
    s_add_u32 s84, s74, 557056
    ds_read_b128 v[72:75], v123 offset:24576
    ds_read_b128 v[76:79], v123 offset:25600
    s_nop 0
    v_cvt_pk_bf16_f32 v56, v56, v57
    v_cvt_pk_bf16_f32 v57, v58, v59
    s_nop 0
    v_cvt_pk_bf16_f32 v58, v60, v61
    v_cvt_pk_bf16_f32 v59, v62, v63
    s_nop 0
    v_permlane32_swap_b32 v56, v58
    v_permlane32_swap_b32 v57, v59
    s_mov_b32 exec_hi, 0x00010001
    buffer_store_dwordx4 v[56:59], v11, s[40:43], s84 offen sc1
    s_mov_b64 exec, 1
    buffer_store_dword v40, off, s[40:43], s78 offset:1088 sc1
    s_mov_b64 exec, -1
    ds_read_b128 v[80:83], v123 offset:26624
    ds_read_b128 v[84:87], v123 offset:27648
    ds_read_b128 v[88:91], v123 offset:28672
    ds_read_b128 v[92:95], v123 offset:29696
    s_waitcnt lgkmcnt(5)
    v_mfma_f32_32x32x16_bf16 v[40:55], v[72:75], v[128:131], 0
    ds_read_b128 v[96:99], v123 offset:30720
    buffer_load_dwordx4 a[164:167], v1, s[40:43], s95 offen offset:1024 sc1
    s_waitcnt lgkmcnt(5)
    v_mfma_f32_32x32x16_bf16 v[40:55], v[76:79], v[132:135], v[40:55]
    ds_read_b128 v[100:103], v123 offset:31744
    s_waitcnt lgkmcnt(5)
    v_mfma_f32_32x32x16_bf16 v[40:55], v[80:83], v[136:139], v[40:55]
    ds_read_b128 v[72:75], v123 offset:32768
    buffer_load_dwordx4 a[168:171], v1, s[40:43], s95 offen offset:2048 sc1
    s_waitcnt lgkmcnt(5)
    v_mfma_f32_32x32x16_bf16 v[40:55], v[84:87], v[140:143], v[40:55]
    ds_read_b128 v[76:79], v123 offset:33792
    s_waitcnt lgkmcnt(5)
    v_mfma_f32_32x32x16_bf16 v[40:55], v[88:91], v[144:147], v[40:55]
    ds_read_b128 v[80:83], v123 offset:34816
    ds_read2st64_b32 v[112:113], v22 offset0:20 offset1:21
    ds_read2st64_b32 v[114:115], v22 offset0:22 offset1:23
    buffer_load_dwordx4 a[172:175], v1, s[40:43], s95 offen offset:3072 sc1
    s_waitcnt lgkmcnt(7)
    v_mfma_f32_32x32x16_bf16 v[40:55], v[92:95], v[148:151], v[40:55]
    ds_read_b128 v[84:87], v123 offset:35840
    s_waitcnt lgkmcnt(7)
    v_mfma_f32_32x32x16_bf16 v[40:55], v[96:99], v[152:155], v[40:55]
    ds_read_b128 v[88:91], v123 offset:36864
    s_add_u32 s95, s9, 528384
    buffer_load_dwordx4 a[176:179], v1, s[40:43], s95 offen offset:0 sc1
    s_waitcnt lgkmcnt(7)
    v_mfma_f32_32x32x16_bf16 v[40:55], v[100:103], v[156:159], v[40:55]
    ds_read_b128 v[92:95], v123 offset:37888
    s_waitcnt lgkmcnt(7)
    v_mfma_f32_32x32x16_bf16 v[40:55], v[72:75], v[160:163], v[40:55]
    ds_read_b128 v[96:99], v123 offset:38912
    s_waitcnt lgkmcnt(4)
    v_add_f32 v112, v112, v113
    v_add_f32 v114, v114, v115
    v_add_f32 v114, v112, v114
    buffer_load_dwordx4 a[180:183], v1, s[40:43], s95 offen offset:1024 sc1
    v_mfma_f32_32x32x16_bf16 v[40:55], v[76:79], v[164:167], v[40:55]
    ds_read_b128 v[100:103], v123 offset:39936
    v_cvt_pk_bf16_f32 v112, v114, v114
    v_and_b32 v115, 0xffff0000, v112
    v_sub_f32 v115, v114, v115
    v_mfma_f32_32x32x16_bf16 v[40:55], v[80:83], v[168:171], v[40:55]
    ds_read_b128 v[72:75], v123 offset:40960
    v_cvt_pk_bf16_f32 v113, v115, 0
    buffer_load_dwordx4 a[120:123], v1, s[40:43], s95 offen offset:2048 sc1
    s_waitcnt lgkmcnt(5)
    v_mfma_f32_32x32x16_bf16 v[40:55], v[84:87], v[172:175], v[40:55]
    ds_read_b128 v[76:79], v123 offset:41984
    s_waitcnt lgkmcnt(5)
    v_mfma_f32_32x32x16_bf16 v[40:55], v[88:91], v[176:179], v[40:55]
    ds_read_b128 v[80:83], v123 offset:43008
    buffer_load_dwordx4 a[124:127], v1, s[40:43], s95 offen offset:3072 sc1
    s_waitcnt lgkmcnt(5)
    v_mfma_f32_32x32x16_bf16 v[40:55], v[92:95], v[180:183], v[40:55]
    ds_read_b128 v[84:87], v123 offset:44032
    v_mfma_f32_32x32x8_bf16 v[40:55], v[112:113], v[116:117], v[40:55]
    ds_write_b128 v21, a[184:187] offset:0
    s_waitcnt lgkmcnt(6)
    v_mfma_f32_32x32x16_bf16 v[40:55], v[96:99], v[184:187], v[40:55]
    ds_read_b128 v[88:91], v123 offset:45056
    s_add_u32 s95, s10, 524288
    s_waitcnt lgkmcnt(1)
    buffer_load_dwordx4 a[184:187], v1, s[40:43], s95 offen offset:0 sc1
    v_mfma_f32_32x32x16_bf16 v[40:55], v[100:103], v[188:191], v[40:55]
    ds_read_b128 v[92:95], v123 offset:46080
    ds_write_b128 v21, a[188:191] offset:1024
    v_mfma_f32_32x32x16_bf16 v[40:55], v[72:75], v[192:195], v[40:55]
    ds_read_b128 v[96:99], v123 offset:47104
    s_waitcnt lgkmcnt(1)
    buffer_load_dwordx4 a[188:191], v1, s[40:43], s95 offen offset:1024 sc1
    v_mfma_f32_32x32x16_bf16 v[40:55], v[76:79], v[196:199], v[40:55]
    ds_read_b128 v[100:103], v123 offset:48128
    ds_write_b128 v21, a[192:195] offset:8192
    v_mfma_f32_32x32x16_bf16 v[40:55], v[80:83], v[200:203], v[40:55]
    ds_read_b128 v[72:75], v123 offset:49152
    s_waitcnt lgkmcnt(1)
    buffer_load_dwordx4 a[192:195], v1, s[40:43], s95 offen offset:2048 sc1
    s_add_u32 s12, s75, 557056
    v_mfma_f32_32x32x16_bf16 v[40:55], v[84:87], v[204:207], v[40:55]
    ds_read_b128 v[76:79], v123 offset:50176
    s_add_u32 s13, s75, 696320
    ds_write_b128 v21, a[196:199] offset:9216
    v_mfma_f32_32x32x16_bf16 v[40:55], v[88:91], v[208:211], v[40:55]
    ds_read_b128 v[80:83], v123 offset:51200
    s_waitcnt lgkmcnt(1)
    buffer_load_dwordx4 a[196:199], v1, s[40:43], s95 offen offset:3072 sc1
    s_add_u32 s14, s75, 835584
    v_mfma_f32_32x32x16_bf16 v[40:55], v[92:95], v[212:215], v[40:55]
    ds_read_b128 v[84:87], v123 offset:52224
    s_add_u32 s15, s75, 974848
    ds_write_b128 v21, a[200:203] offset:16384
    v_mfma_f32_32x32x16_bf16 v[40:55], v[96:99], v[216:219], v[40:55]
    ds_read_b128 v[88:91], v123 offset:53248
    s_add_u32 s95, s10, 528384
    s_waitcnt lgkmcnt(1)
    buffer_load_dwordx4 a[200:203], v1, s[40:43], s95 offen offset:0 sc1
    s_mov_b32 s67, 1
    v_mfma_f32_32x32x16_bf16 v[40:55], v[100:103], v[220:223], v[40:55]
    ds_read_b128 v[92:95], v123 offset:54272
    buffer_load_dwordx4 v[132:135], v13, s[40:43], s12 offen offset:0 sc1
    ds_write_b128 v21, a[204:207] offset:17408
    v_mfma_f32_32x32x16_bf16 v[40:55], v[72:75], v[224:227], v[40:55]
    ds_read_b128 v[96:99], v123 offset:55296
    buffer_load_dwordx4 v[136:139], v13, s[40:43], s12 offen offset:256 sc1
    v_mfma_f32_32x32x16_bf16 v[40:55], v[76:79], v[228:231], v[40:55]
    ds_read_b128 v[100:103], v123 offset:56320
    buffer_load_dwordx4 v[140:143], v13, s[40:43], s13 offen offset:0 sc1
    ds_write_b128 v21, a[208:211] offset:24576
    v_mfma_f32_32x32x16_bf16 v[40:55], v[80:83], v[232:235], v[40:55]
    buffer_load_dwordx4 v[144:147], v13, s[40:43], s13 offen offset:256 sc1
    v_mfma_f32_32x32x16_bf16 v[40:55], v[84:87], v[236:239], v[40:55]
    buffer_load_dwordx4 v[128:131], v14, s[40:43], s12 offen sc1
    ds_write_b128 v21, a[212:215] offset:25600
    s_waitcnt lgkmcnt(6)
    v_mfma_f32_32x32x16_bf16 v[40:55], v[88:91], v[240:243], v[40:55]
    buffer_load_dwordx4 v[148:151], v13, s[40:43], s14 offen offset:0 sc1
    s_waitcnt lgkmcnt(5)
    v_mfma_f32_32x32x16_bf16 v[40:55], v[92:95], v[244:247], v[40:55]
    buffer_load_dwordx4 v[152:155], v13, s[40:43], s14 offen offset:256 sc1
    ds_write_b128 v21, a[216:219] offset:32768
    s_waitcnt lgkmcnt(4)
    v_mfma_f32_32x32x16_bf16 v[40:55], v[96:99], v[248:251], v[40:55]
    v_add_u32 v115, 0x10000, v21
    buffer_load_dwordx4 v[156:159], v13, s[40:43], s15 offen offset:0 sc1
    s_waitcnt lgkmcnt(3)
    v_mfma_f32_32x32x16_bf16 v[40:55], v[100:103], v[252:255], v[40:55]
    buffer_load_dwordx4 v[160:163], v13, s[40:43], s15 offen offset:256 sc1
    buffer_load_dword v164, v19, s[40:43], 0 offen offset:64 sc1
    ds_write_b128 v21, a[220:223] offset:33792
    ds_read_b128 v[192:195], v2 offset:36864
    ds_read_b128 v[196:199], v2 offset:37888
    s_nop 6
    v_max3_f32 v119, v40, v41, v42
    v_max3_f32 v121, v43, v44, v45
    v_max3_f32 v119, v119, v46, v47
    v_max3_f32 v121, v121, v48, v49
    v_max3_f32 v119, v119, v50, v51
    v_max3_f32 v121, v121, v52, v53
    v_max3_f32 v119, v119, v54, v55
    v_max_f32 v119, v119, v121
    v_mul_f32 v119, -v119, v118
    v_pk_fma_f32 v[72:73], v[40:41], v[118:119], v[118:119] op_sel:[0,0,1] op_sel_hi:[1,0,1]
    v_pk_fma_f32 v[74:75], v[42:43], v[118:119], v[118:119] op_sel:[0,0,1] op_sel_hi:[1,0,1]
    v_pk_fma_f32 v[76:77], v[44:45], v[118:119], v[118:119] op_sel:[0,0,1] op_sel_hi:[1,0,1]
    v_pk_fma_f32 v[78:79], v[46:47], v[118:119], v[118:119] op_sel:[0,0,1] op_sel_hi:[1,0,1]
    v_pk_fma_f32 v[80:81], v[48:49], v[118:119], v[118:119] op_sel:[0,0,1] op_sel_hi:[1,0,1]
    ds_write_b128 v21, a[224:227] offset:40960
    v_pk_fma_f32 v[82:83], v[50:51], v[118:119], v[118:119] op_sel:[0,0,1] op_sel_hi:[1,0,1]
    v_pk_fma_f32 v[84:85], v[52:53], v[118:119], v[118:119] op_sel:[0,0,1] op_sel_hi:[1,0,1]
    buffer_load_dwordx4 a[204:207], v1, s[40:43], s95 offen offset:1024 sc1
    v_pk_fma_f32 v[86:87], v[54:55], v[118:119], v[118:119] op_sel:[0,0,1] op_sel_hi:[1,0,1]
    v_exp_f32 v72, v72
    v_exp_f32 v73, v73
    v_exp_f32 v74, v74
    v_exp_f32 v75, v75
    v_exp_f32 v76, v76
    v_exp_f32 v77, v77
    v_exp_f32 v78, v78
    ds_write_b128 v21, a[228:231] offset:41984
    v_exp_f32 v79, v79
    s_waitcnt lgkmcnt(7)
    buffer_load_dwordx4 a[208:211], v1, s[40:43], s95 offen offset:2048 sc1
    v_exp_f32 v80, v80
    v_exp_f32 v81, v81
    v_exp_f32 v82, v82
    v_exp_f32 v83, v83
    v_exp_f32 v84, v84
    v_exp_f32 v85, v85
    v_exp_f32 v86, v86
    v_exp_f32 v87, v87
    s_waitcnt lgkmcnt(6)
    buffer_load_dwordx4 a[212:215], v1, s[40:43], s95 offen offset:3072 sc1
    v_pk_add_f32 v[124:125], v[72:73], v[74:75]
    v_pk_add_f32 v[112:113], v[76:77], v[78:79]
    v_pk_add_f32 v[124:125], v[124:125], v[80:81]
    v_pk_add_f32 v[112:113], v[112:113], v[82:83]
    v_pk_add_f32 v[124:125], v[124:125], v[84:85]
    v_pk_add_f32 v[112:113], v[112:113], v[86:87]
    v_pk_add_f32 v[124:125], v[124:125], v[112:113]
    v_add_f32 v124, v124, v125
    v_rcp_f32 v124, v124
    s_nop 0
    v_pk_mul_f32 v[72:73], v[72:73], v[124:125] op_sel_hi:[1,0]
    v_pk_mul_f32 v[74:75], v[74:75], v[124:125] op_sel_hi:[1,0]
    v_pk_mul_f32 v[76:77], v[76:77], v[124:125] op_sel_hi:[1,0]
    v_pk_mul_f32 v[78:79], v[78:79], v[124:125] op_sel_hi:[1,0]
    v_pk_mul_f32 v[80:81], v[80:81], v[124:125] op_sel_hi:[1,0]
    v_pk_mul_f32 v[82:83], v[82:83], v[124:125] op_sel_hi:[1,0]
    s_add_u32 s95, s11, 524288
    s_waitcnt lgkmcnt(5)
    buffer_load_dwordx4 a[216:219], v1, s[40:43], s95 offen offset:0 sc1
    v_pk_mul_f32 v[84:85], v[84:85], v[124:125] op_sel_hi:[1,0]
    v_pk_mul_f32 v[86:87], v[86:87], v[124:125] op_sel_hi:[1,0]
    v_cvt_pk_bf16_f32 v72, v72, v73
    v_cvt_pk_bf16_f32 v73, v74, v75
    v_cvt_pk_bf16_f32 v74, v76, v77
    v_cvt_pk_bf16_f32 v75, v78, v79
    v_cvt_pk_bf16_f32 v76, v80, v81
    v_cvt_pk_bf16_f32 v77, v82, v83
    v_cvt_pk_bf16_f32 v78, v84, v85
    v_cvt_pk_bf16_f32 v79, v86, v87
    v_min3_f32 v122, v40, v41, v42
    v_min3_f32 v123, v43, v44, v45
    v_min3_f32 v122, v122, v46, v47
    v_min3_f32 v123, v123, v48, v49
    v_min3_f32 v122, v122, v50, v51
    v_min3_f32 v123, v123, v52, v53
    s_waitcnt lgkmcnt(4)
    buffer_load_dwordx4 a[220:223], v1, s[40:43], s95 offen offset:1024 sc1
    v_min3_f32 v122, v122, v54, v55
    v_min_f32 v122, v122, v123
    v_mul_f32 v119, v122, v118
    v_pk_fma_f32 v[88:89], v[40:41], v[118:119], v[118:119] op_sel:[0,0,1] op_sel_hi:[1,0,1] neg_lo:[1,0,0] neg_hi:[1,0,0]
    v_pk_fma_f32 v[90:91], v[42:43], v[118:119], v[118:119] op_sel:[0,0,1] op_sel_hi:[1,0,1] neg_lo:[1,0,0] neg_hi:[1,0,0]
    v_pk_fma_f32 v[92:93], v[44:45], v[118:119], v[118:119] op_sel:[0,0,1] op_sel_hi:[1,0,1] neg_lo:[1,0,0] neg_hi:[1,0,0]
    v_pk_fma_f32 v[94:95], v[46:47], v[118:119], v[118:119] op_sel:[0,0,1] op_sel_hi:[1,0,1] neg_lo:[1,0,0] neg_hi:[1,0,0]
    v_pk_fma_f32 v[96:97], v[48:49], v[118:119], v[118:119] op_sel:[0,0,1] op_sel_hi:[1,0,1] neg_lo:[1,0,0] neg_hi:[1,0,0]
    v_pk_fma_f32 v[98:99], v[50:51], v[118:119], v[118:119] op_sel:[0,0,1] op_sel_hi:[1,0,1] neg_lo:[1,0,0] neg_hi:[1,0,0]
    v_pk_fma_f32 v[100:101], v[52:53], v[118:119], v[118:119] op_sel:[0,0,1] op_sel_hi:[1,0,1] neg_lo:[1,0,0] neg_hi:[1,0,0]
    v_pk_fma_f32 v[102:103], v[54:55], v[118:119], v[118:119] op_sel:[0,0,1] op_sel_hi:[1,0,1] neg_lo:[1,0,0] neg_hi:[1,0,0]
    v_exp_f32 v88, v88
    v_exp_f32 v89, v89
    v_exp_f32 v90, v90
    s_waitcnt lgkmcnt(1)
    buffer_load_dwordx4 a[224:227], v1, s[40:43], s95 offen offset:2048 sc1
    v_exp_f32 v91, v91
    v_exp_f32 v92, v92
    v_exp_f32 v93, v93
    v_exp_f32 v94, v94
    v_exp_f32 v95, v95
    v_exp_f32 v96, v96
    v_exp_f32 v97, v97
    v_exp_f32 v98, v98
    s_waitcnt lgkmcnt(0)
    buffer_load_dwordx4 a[228:231], v1, s[40:43], s95 offen offset:3072 sc1
    v_exp_f32 v99, v99
    v_exp_f32 v100, v100
    v_exp_f32 v101, v101
    v_exp_f32 v102, v102
    v_exp_f32 v103, v103
    v_pk_add_f32 v[124:125], v[88:89], v[90:91]
    v_pk_add_f32 v[112:113], v[92:93], v[94:95]
    v_pk_add_f32 v[124:125], v[124:125], v[96:97]
    v_pk_add_f32 v[112:113], v[112:113], v[98:99]
    v_pk_add_f32 v[124:125], v[124:125], v[100:101]
    v_pk_add_f32 v[112:113], v[112:113], v[102:103]
    v_pk_add_f32 v[124:125], v[124:125], v[112:113]
    v_add_f32 v124, v124, v125
    v_rcp_f32 v124, v124
    s_nop 0
    v_pk_mul_f32 v[88:89], v[88:89], v[124:125] op_sel_hi:[1,0]
    v_pk_mul_f32 v[90:91], v[90:91], v[124:125] op_sel_hi:[1,0]
    v_pk_mul_f32 v[92:93], v[92:93], v[124:125] op_sel_hi:[1,0]
    v_pk_mul_f32 v[94:95], v[94:95], v[124:125] op_sel_hi:[1,0]
    v_pk_mul_f32 v[96:97], v[96:97], v[124:125] op_sel_hi:[1,0]
    v_pk_mul_f32 v[98:99], v[98:99], v[124:125] op_sel_hi:[1,0]
    v_pk_mul_f32 v[100:101], v[100:101], v[124:125] op_sel_hi:[1,0]
    v_pk_mul_f32 v[102:103], v[102:103], v[124:125] op_sel_hi:[1,0]
    s_waitcnt vmcnt(16)
    v_mfma_f32_16x16x32_bf16 v[56:59], v[192:195], v[132:135], 0
    v_cvt_pk_bf16_f32 v88, v88, v89
    v_cvt_pk_bf16_f32 v89, v90, v91
    s_waitcnt vmcnt(15)
    v_mfma_f32_16x16x32_bf16 v[56:59], v[196:199], v[136:139], v[56:59]
    v_cvt_pk_bf16_f32 v90, v92, v93
    v_cvt_pk_bf16_f32 v91, v94, v95
    s_waitcnt vmcnt(14)
    v_mfma_f32_16x16x32_bf16 v[56:59], v[192:195], v[140:143], v[56:59]
    v_cvt_pk_bf16_f32 v92, v96, v97
    v_cvt_pk_bf16_f32 v93, v98, v99
    s_waitcnt vmcnt(13)
    v_mfma_f32_16x16x32_bf16 v[56:59], v[196:199], v[144:147], v[56:59]
    v_cvt_pk_bf16_f32 v94, v100, v101
    v_cvt_pk_bf16_f32 v95, v102, v103
    v_permlane32_swap_b32 v72, v88
    v_permlane32_swap_b32 v73, v89
    v_permlane32_swap_b32 v74, v90
    v_permlane32_swap_b32 v75, v91
L_part1_s:
    s_waitcnt vmcnt(12)
    v_mfma_f32_16x16x32_bf16 v[60:63], v[192:195], v[128:131], 0
    s_waitcnt vmcnt(11)
    v_mfma_f32_16x16x32_bf16 v[56:59], v[192:195], v[148:151], v[56:59]
    s_waitcnt vmcnt(10)
    v_mfma_f32_16x16x32_bf16 v[56:59], v[196:199], v[152:155], v[56:59]
    s_waitcnt vmcnt(9)
    v_mfma_f32_16x16x32_bf16 v[56:59], v[192:195], v[156:159], v[56:59]
    v_cvt_pk_bf16_f32 v64, v60, v61
    v_cvt_pk_bf16_f32 v65, v62, v63
    s_waitcnt vmcnt(8)
    v_mfma_f32_16x16x32_bf16 v[56:59], v[196:199], v[160:163], v[56:59]
    s_mov_b64 exec, 0x00ff00ff
    ds_write_b64 v16, v[64:65]
    s_mov_b64 exec, -1
    s_nop 4
    v_cmp_u_f32 vcc, v56, v60
    v_cvt_pk_bf16_f32 v56, v56, v57
    v_cvt_pk_bf16_f32 v57, v58, v59
    ds_write_b64 v15, v[56:57]
    s_cbranch_vccnz L_partre_s
L_partok1_s:
    v_permlane32_swap_b32 v76, v92
    v_permlane32_swap_b32 v77, v93
    v_permlane32_swap_b32 v78, v94
    v_permlane32_swap_b32 v79, v95
    s_waitcnt lgkmcnt(0)
    s_barrier
    ds_read_b128 v[128:131], v17 offset:0
    ds_read_b128 v[132:135], v17 offset:16
    ds_read_b128 v[136:139], v17 offset:1600
    ds_read_b128 v[140:143], v17 offset:1616
    s_waitcnt lgkmcnt(3)
    v_mfma_f32_32x32x16_bf16 v[40:55], v[128:131], v[72:75], 0
    v_mov_b32 v106, 2
    s_waitcnt vmcnt(7)
    v_cmp_gt_u32 vcc, 1, v164
    s_waitcnt lgkmcnt(2)
    v_mfma_f32_32x32x16_bf16 v[40:55], v[132:135], v[76:79], v[40:55]
    s_cbranch_vccnz Lrefa_20_s
Lfc_19_s:
    s_waitcnt lgkmcnt(0)
    v_mfma_f32_32x32x16_bf16 v[56:71], v[136:139], v[88:91], 0
    v_mfma_f32_32x32x16_bf16 v[56:71], v[140:143], v[92:95], v[56:71]
    v_add_f32 v48, v48, v50
    v_add_f32 v49, v49, v51
    v_add_f32 v48, 0x358637bd, v48
    v_add_f32 v48, v48, v49
    v_rcp_f32 v48, v48
    s_nop 0
    v_pk_mul_f32 v[40:41], v[40:41], v[48:49] op_sel_hi:[1,0]
    v_pk_mul_f32 v[42:43], v[42:43], v[48:49] op_sel_hi:[1,0]
    v_pk_mul_f32 v[44:45], v[44:45], v[48:49] op_sel_hi:[1,0]
    v_pk_mul_f32 v[46:47], v[46:47], v[48:49] op_sel_hi:[1,0]
    v_bfi_b32 v40, s60, v40, v4
    v_cvt_pk_bf16_f32 v40, v40, v41
    v_cvt_pk_bf16_f32 v41, v42, v43
    v_cvt_pk_bf16_f32 v42, v44, v45
    v_cvt_pk_bf16_f32 v43, v46, v47
    buffer_store_dwordx4 v[40:43], v1, s[44:47], s71 offen offset:0 sc1
    v_add_f32 v64, v64, v66
    v_add_f32 v65, v65, v67
    v_add_f32 v64, 0x358637bd, v64
    v_add_f32 v64, v64, v65
    v_rcp_f32 v64, v64
    s_nop 0
    v_pk_mul_f32 v[56:57], v[56:57], v[64:65] op_sel_hi:[1,0]
    v_pk_mul_f32 v[58:59], v[58:59], v[64:65] op_sel_hi:[1,0]
    v_pk_mul_f32 v[60:61], v[60:61], v[64:65] op_sel_hi:[1,0]
    v_pk_mul_f32 v[62:63], v[62:63], v[64:65] op_sel_hi:[1,0]
    v_bfi_b32 v56, s60, v56, v4
    v_cvt_pk_bf16_f32 v56, v56, v57
    v_cvt_pk_bf16_f32 v57, v58, v59
    v_cvt_pk_bf16_f32 v58, v60, v61
    v_cvt_pk_bf16_f32 v59, v62, v63
    buffer_store_dwordx4 v[56:59], v1, s[44:47], s71 offen offset:1024 sc1
    s_mov_b64 exec, 1
    s_waitcnt vmcnt(0)
    buffer_store_dword v106, off, s[40:43], s78 offset:0 sc1
    s_mov_b64 exec, -1
    ds_write_b128 v21, a[232:235] offset:49152
    ds_write_b128 v21, a[236:239] offset:50176
    ds_write_b128 v21, a[240:243] offset:57344
    ds_write_b128 v21, a[244:247] offset:58368
    s_and_b32 s84, s8, 0x6000
    v_add_u32 v116, s84, v2
    s_and_b32 s84, s9, 0x6000
    v_add_u32 v117, s84, v2
    s_and_b32 s84, s10, 0x6000
    v_add_u32 v118, s84, v2
    s_and_b32 s84, s11, 0x6000
    v_add_u32 v119, s84, v2
    v_and_or_b32 v141, v20, 60, s61
L_ore1_s:
    s_lshl2_add_u32 m0, s81, 114688
    buffer_load_dword v127, v18, s[40:43], 0 offen sc1
    s_cmp_eq_u32 s66, s0
    s_cbranch_scc0 Lpchk_22_s
    ds_write_b128 v116, v[40:43] offset:0
    ds_write_b128 v116, v[56:59] offset:1024
    s_branch L_oown1_s
L_opoll1_s:
    buffer_load_dword v127, v18, s[40:43], 0 offen sc1
    s_sub_u32 s68, s68, 1
    s_cbranch_scc1 L_end
L_oown1_s:
    s_waitcnt vmcnt(0)
    v_cmp_gt_u32 vcc, 2, v127
    s_cbranch_vccnz L_opoll1_s
    s_branch L_ojoin1_s
Lpoll_21_s:
    buffer_load_dword v127, v18, s[40:43], 0 offen sc1
    s_sub_u32 s68, s68, 1
    s_cbranch_scc1 L_end
Lpchk_22_s:
    s_waitcnt vmcnt(0)
    v_cmp_gt_u32 vcc, 2, v127
    s_cbranch_vccnz Lpoll_21_s
    buffer_load_dwordx4 v1, s[44:47], s72 offen offset:0 sc1 lds
    buffer_load_dwordx4 v1, s[44:47], s72 offen offset:1024 sc1 lds
L_ojoin1_s:
    s_lshl2_add_u32 m0, s81, 116736
    s_xor_b32 s84, s72, 2048
    buffer_load_dwordx4 v1, s[44:47], s84 offen offset:0 sc1 lds
    buffer_load_dwordx4 v1, s[44:47], s84 offen offset:1024 sc1 lds
    s_lshl2_add_u32 m0, s81, 118784
    s_xor_b32 s84, s72, 4096
    buffer_load_dwordx4 v1, s[44:47], s84 offen offset:0 sc1 lds
    buffer_load_dwordx4 v1, s[44:47], s84 offen offset:1024 sc1 lds
    s_lshl2_add_u32 m0, s81, 120832
    s_xor_b32 s84, s72, 6144
    buffer_load_dwordx4 v1, s[44:47], s84 offen offset:0 sc1 lds
    s_barrier
    buffer_load_dwordx4 v1, s[44:47], s84 offen offset:1024 sc1 lds
L_oskip1_s:
    s_waitcnt vmcnt(7)
    ds_read_b128 v[72:75], v116 offset:0
    s_waitcnt vmcnt(6)
    ds_read_b128 v[76:79], v116 offset:1024
    s_waitcnt vmcnt(5)
    ds_read_b128 v[80:83], v116 offset:2048
    s_waitcnt lgkmcnt(2)
    v_mfma_f32_32x32x16_bf16 v[40:55], a[128:131], v[72:75], v[24:39]
    s_waitcnt vmcnt(4)
    ds_read_b128 v[84:87], v116 offset:3072
    s_waitcnt lgkmcnt(2)
    v_mfma_f32_32x32x16_bf16 v[40:55], a[132:135], v[76:79], v[40:55]
    v_bitop3_b32 v12, 1, v72, v76 bitop3:0x80
    s_waitcnt vmcnt(3)
    ds_read_b128 v[88:91], v116 offset:4096
    s_waitcnt lgkmcnt(2)
    v_mfma_f32_32x32x16_bf16 v[40:55], a[136:139], v[80:83], v[40:55]
    s_waitcnt vmcnt(2)
    ds_read_b128 v[92:95], v116 offset:5120
    s_waitcnt lgkmcnt(2)
    v_mfma_f32_32x32x16_bf16 v[40:55], a[140:143], v[84:87], v[40:55]
    v_bitop3_b32 v12, v12, v80, v84 bitop3:0x80
    s_waitcnt vmcnt(1)
    ds_read_b128 v[96:99], v116 offset:6144
    s_waitcnt lgkmcnt(2)
    v_mfma_f32_32x32x16_bf16 v[40:55], a[144:147], v[88:91], v[40:55]
    s_waitcnt vmcnt(0)
    ds_read_b128 v[100:103], v116 offset:7168
    s_barrier
    s_waitcnt lgkmcnt(2)
    v_mfma_f32_32x32x16_bf16 v[40:55], a[148:151], v[92:95], v[40:55]
    v_bitop3_b32 v12, v12, v88, v92 bitop3:0x80
    ds_read_b128 v[72:75], v117 offset:0
    ds_read_b128 v[76:79], v117 offset:1024
    s_add_u32 s95, s11, 528384
    buffer_load_dwordx4 a[232:235], v1, s[40:43], s95 offen offset:0 sc1
    s_waitcnt lgkmcnt(3)
    v_mfma_f32_32x32x16_bf16 v[40:55], a[152:155], v[96:99], v[40:55]
    ds_read_b128 v[80:83], v117 offset:2048
    ds_read_b128 v[84:87], v117 offset:3072
    s_waitcnt lgkmcnt(4)
    v_mfma_f32_32x32x16_bf16 v[40:55], a[156:159], v[100:103], v[40:55]
    v_bitop3_b32 v12, v12, v96, v100 bitop3:0x80
    v_cmp_eq_u32 vcc, 0, v12
    ds_read_b128 v[88:91], v117 offset:4096
    ds_read_b128 v[92:95], v117 offset:5120
    buffer_load_dwordx4 a[236:239], v1, s[40:43], s95 offen offset:1024 sc1
    s_waitcnt lgkmcnt(5)
    v_mfma_f32_32x32x16_bf16 v[40:55], a[160:163], v[72:75], v[40:55]
    ds_read_b128 v[96:99], v117 offset:6144
    ds_read_b128 v[100:103], v117 offset:7168
    s_cmp_eq_u64 vcc, 0
    s_cselect_b64 exec, 1, 0
    buffer_store_dword v106, off, s[40:43], s16 offset:64 sc1
    s_mov_b64 exec, -1
    s_cselect_b32 s62, 1, 0
    s_waitcnt lgkmcnt(6)
    v_mfma_f32_32x32x16_bf16 v[40:55], a[164:167], v[76:79], v[40:55]
    v_bitop3_b32 v12, v12, v72, v76 bitop3:0x80
    ds_read_b128 v[72:75], v118 offset:0
    buffer_load_dwordx4 a[240:243], v1, s[40:43], s95 offen offset:2048 sc1
    s_waitcnt lgkmcnt(6)
    v_mfma_f32_32x32x16_bf16 v[40:55], a[168:171], v[80:83], v[40:55]
    ds_read_b128 v[76:79], v118 offset:1024
    s_waitcnt lgkmcnt(6)
    v_mfma_f32_32x32x16_bf16 v[40:55], a[172:175], v[84:87], v[40:55]
    v_bitop3_b32 v12, v12, v80, v84 bitop3:0x80
    ds_read_b128 v[80:83], v118 offset:2048
    buffer_load_dwordx4 a[244:247], v1, s[40:43], s95 offen offset:3072 sc1
    s_waitcnt lgkmcnt(6)
    v_mfma_f32_32x32x16_bf16 v[40:55], a[176:179], v[88:91], v[40:55]
    ds_read_b128 v[84:87], v118 offset:3072
    s_waitcnt lgkmcnt(6)
    v_mfma_f32_32x32x16_bf16 v[40:55], a[180:183], v[92:95], v[40:55]
    v_bitop3_b32 v12, v12, v88, v92 bitop3:0x80
    ds_read_b128 v[88:91], v118 offset:4096
    s_waitcnt lgkmcnt(6)
    v_mfma_f32_32x32x16_bf16 v[40:55], a[120:123], v[96:99], v[40:55]
    ds_read_b128 v[92:95], v118 offset:5120
    s_waitcnt lgkmcnt(6)
    v_mfma_f32_32x32x16_bf16 v[40:55], a[124:127], v[100:103], v[40:55]
    v_bitop3_b32 v12, v12, v96, v100 bitop3:0x80
    ds_read_b128 v[96:99], v118 offset:6144
    s_waitcnt lgkmcnt(6)
    v_mfma_f32_32x32x16_bf16 v[40:55], a[184:187], v[72:75], v[40:55]
    ds_read_b128 v[100:103], v118 offset:7168
    s_waitcnt lgkmcnt(6)
    v_mfma_f32_32x32x16_bf16 v[40:55], a[188:191], v[76:79], v[40:55]
    v_bitop3_b32 v12, v12, v72, v76 bitop3:0x80
    ds_read_b128 v[72:75], v119 offset:0
    s_waitcnt lgkmcnt(6)
    v_mfma_f32_32x32x16_bf16 v[40:55], a[192:195], v[80:83], v[40:55]
    ds_read_b128 v[76:79], v119 offset:1024
    s_waitcnt lgkmcnt(6)
    v_mfma_f32_32x32x16_bf16 v[40:55], a[196:199], v[84:87], v[40:55]
    v_bitop3_b32 v12, v12, v80, v84 bitop3:0x80
    ds_read_b128 v[80:83], v119 offset:2048
    buffer_load_dword v140, v141, s[40:43], 0 offen offset:64 sc1
    s_waitcnt lgkmcnt(6)
    v_mfma_f32_32x32x16_bf16 v[40:55], a[200:203], v[88:91], v[40:55]
    ds_read_b128 v[84:87], v119 offset:3072
    s_waitcnt lgkmcnt(6)
    v_mfma_f32_32x32x16_bf16 v[40:55], a[204:207], v[92:95], v[40:55]
    v_bitop3_b32 v12, v12, v88, v92 bitop3:0x80
    ds_read_b128 v[88:91], v119 offset:4096
    s_waitcnt lgkmcnt(6)
    v_mfma_f32_32x32x16_bf16 v[40:55], a[208:211], v[96:99], v[40:55]
    ds_read_b128 v[92:95], v119 offset:5120
    s_waitcnt lgkmcnt(6)
    v_mfma_f32_32x32x16_bf16 v[40:55], a[212:215], v[100:103], v[40:55]
    v_bitop3_b32 v12, v12, v96, v100 bitop3:0x80
    ds_read_b128 v[96:99], v119 offset:6144
    s_waitcnt lgkmcnt(6)
    v_mfma_f32_32x32x16_bf16 v[40:55], a[216:219], v[72:75], v[40:55]
    ds_read_b128 v[100:103], v119 offset:7168
    s_waitcnt lgkmcnt(6)
    v_mfma_f32_32x32x16_bf16 v[40:55], a[220:223], v[76:79], v[40:55]
    v_bitop3_b32 v12, v12, v72, v76 bitop3:0x80
    s_waitcnt lgkmcnt(5)
    v_mfma_f32_32x32x16_bf16 v[40:55], a[224:227], v[80:83], v[40:55]
    s_waitcnt lgkmcnt(4)
    v_bitop3_b32 v12, v12, v80, v84 bitop3:0x80
    s_waitcnt lgkmcnt(2)
    v_bitop3_b32 v12, v12, v88, v92 bitop3:0x80
    v_mfma_f32_32x32x16_bf16 v[40:55], a[228:231], v[84:87], v[40:55]
    s_waitcnt lgkmcnt(0)
    v_bitop3_b32 v12, v12, v96, v100 bitop3:0x80
    v_cmp_eq_u32 vcc, 0, v12
    s_waitcnt vmcnt(5)
    v_mfma_f32_32x32x16_bf16 v[40:55], a[232:235], v[88:91], v[40:55]
    s_cbranch_vccnz L_obad1_s
    s_waitcnt vmcnt(4)
    v_mfma_f32_32x32x16_bf16 v[40:55], a[236:239], v[92:95], v[40:55]
    s_waitcnt vmcnt(0)
    v_cmp_gt_u32 vcc, 2, v140
    v_mfma_f32_32x32x16_bf16 v[40:55], a[240:243], v[96:99], v[40:55]
    s_cbranch_vccnz Lrefb_24_s
Lfc_23_s:
    v_mfma_f32_32x32x16_bf16 v[24:39], a[244:247], v[100:103], v[40:55]
    v_mov_b32 v62, 2
    s_nop 10
    v_cvt_pk_bf16_f32 v43, v30, v31
    v_cvt_pk_bf16_f32 v42, v28, v29
    v_cvt_pk_bf16_f32 v41, v26, v27
    v_cvt_pk_bf16_f32 v40, v24, v25
    v_and_b32 v40, -2, v40
    buffer_store_dwordx4 v[40:43], v1, s[44:47], s73 offen offset:0 sc1
    v_cvt_pk_bf16_f32 v47, v38, v39
    v_cvt_pk_bf16_f32 v46, v36, v37
    v_cvt_pk_bf16_f32 v45, v34, v35
    v_cvt_pk_bf16_f32 v44, v32, v33
    v_and_b32 v44, -2, v44
    buffer_store_dwordx4 v[44:47], v1, s[44:47], s73 offen offset:1024 sc1
    s_mov_b64 exec, 1
    s_waitcnt vmcnt(0)
    buffer_store_dword v62, off, s[40:43], s79 offset:0 sc1
    s_mov_b64 exec, -1
    v_pk_add_f32 v[56:57], v[24:25], v[26:27]
    v_pk_mul_f32 v[58:59], v[24:25], v[24:25]
    v_pk_fma_f32 v[58:59], v[26:27], v[26:27], v[58:59]
    v_pk_add_f32 v[56:57], v[56:57], v[28:29]
    v_pk_fma_f32 v[58:59], v[28:29], v[28:29], v[58:59]
    v_pk_add_f32 v[56:57], v[56:57], v[30:31]
    v_pk_fma_f32 v[58:59], v[30:31], v[30:31], v[58:59]
    v_pk_add_f32 v[56:57], v[56:57], v[32:33]
    v_pk_fma_f32 v[58:59], v[32:33], v[32:33], v[58:59]
    v_pk_add_f32 v[56:57], v[56:57], v[34:35]
    v_pk_fma_f32 v[58:59], v[34:35], v[34:35], v[58:59]
    v_pk_add_f32 v[56:57], v[56:57], v[36:37]
    v_pk_fma_f32 v[58:59], v[36:37], v[36:37], v[58:59]
    v_pk_add_f32 v[56:57], v[56:57], v[38:39]
    v_pk_fma_f32 v[58:59], v[38:39], v[38:39], v[58:59]
    v_add_f32 v56, v56, v57
    v_add_f32 v58, v58, v59
    s_lshl_b32 s84, s66, 8
    v_add_u32 v60, s84, v22
    v_permlane32_swap_b32 v56, v58
    v_add_f32 v56, v56, v58
    ds_write_b32 v60, v56 offset:6144
    s_waitcnt lgkmcnt(0)
    s_barrier
    ds_write_b128 v115, a[248:251] offset:49152
    ds_write_b128 v115, a[252:255] offset:50176
    s_cmp_lg_u32 s66, 0
    s_cbranch_scc1 Lst_25_s
    ds_read2st64_b32 v[56:57], v22 offset0:24 offset1:25
    ds_read2st64_b32 v[58:59], v22 offset0:26 offset1:27
    s_waitcnt lgkmcnt(0)
    v_add_f32 v56, v56, v57
    v_add_f32 v58, v58, v59
    v_add_f32 v56, v56, v58
    buffer_store_dword v56, v20, s[40:43], s76 offen offset:512 sc1
Lst_25_s:
    ds_read_b64_tr_b16 v[72:73], v3 offset:0
    ds_read_b64_tr_b16 v[74:75], v3 offset:256
    ds_read_b64_tr_b16 v[76:77], v3 offset:32768
    ds_read_b64_tr_b16 v[78:79], v3 offset:33024
    ds_read_b64_tr_b16 v[80:81], v3 offset:1024
    ds_read_b64_tr_b16 v[82:83], v3 offset:1280
    ds_read_b64_tr_b16 v[84:85], v3 offset:33792
    ds_read_b64_tr_b16 v[86:87], v3 offset:34048
    ds_read_b64_tr_b16 v[88:89], v3 offset:2048
    ds_read_b64_tr_b16 v[90:91], v3 offset:2304
    ds_read_b64_tr_b16 v[92:93], v3 offset:34816
    ds_read_b64_tr_b16 v[94:95], v3 offset:35072
    buffer_load_dword v127, v19, s[40:43], 0 offen sc1
    v_add_u32 v64, s1, v2
    v_add_u32 v65, s82, v2
    ds_write_b128 v64, v[40:43]
    ds_write_b128 v65, v[44:47]
    s_lshl_b32 s84, s66, 10
    v_add_u32 v66, s84, v2
    s_cmp_eq_u32 s66, s0
    s_cbranch_scc0 Lpchk_27_s
    s_branch L_xown2_s
L_xpoll2_s:
    buffer_load_dword v127, v19, s[40:43], 0 offen sc1
    s_sub_u32 s68, s68, 1
    s_cbranch_scc1 L_end
L_xown2_s:
    s_waitcnt vmcnt(0)
    v_cmp_gt_u32 vcc, 2, v127
    s_cbranch_vccnz L_xpoll2_s
    s_xor_b32 s96, s70, 8192
    buffer_load_dwordx4 v[160:163], v1, s[44:47], s96 offen offset:0 sc1
    s_waitcnt lgkmcnt(0)
    s_barrier
    ds_read_b128 v[128:131], v2 offset:47104
    ds_read_b128 v[132:135], v66 offset:8192
    ds_read_b128 v[136:139], v66 offset:12288
    ds_read_b128 v[140:143], v66 offset:16384
    ds_read_b128 v[144:147], v66 offset:20480
    ds_read_b128 v[148:151], v66 offset:24576
    ds_read_b128 v[152:155], v66 offset:28672
    ds_read_b128 v[156:159], v2 offset:46080
    s_waitcnt lgkmcnt(0)
    s_branch L_xjoin2_s
Lpoll_26_s:
    buffer_load_dword v127, v19, s[40:43], 0 offen sc1
    s_sub_u32 s68, s68, 1
    s_cbranch_scc1 L_end
Lpchk_27_s:
    s_waitcnt vmcnt(0)
    v_cmp_gt_u32 vcc, 2, v127
    s_cbranch_vccnz Lpoll_26_s
    s_xor_b32 s96, s70, 0
    buffer_load_dwordx4 v[128:131], v1, s[44:47], s96 offen offset:0 sc1
    buffer_load_dwordx4 v[132:135], v1, s[44:47], s96 offen offset:1024 sc1
    buffer_load_dwordx4 v[136:139], v1, s[44:47], s96 offen offset:2048 sc1
    buffer_load_dwordx4 v[140:143], v1, s[44:47], s96 offen offset:3072 sc1
    s_waitcnt lgkmcnt(0)
    s_barrier
L_xre2_s:
    s_xor_b32 s96, s70, 4096
    buffer_load_dwordx4 v[144:147], v1, s[44:47], s96 offen offset:0 sc1
    buffer_load_dwordx4 v[148:151], v1, s[44:47], s96 offen offset:1024 sc1
    buffer_load_dwordx4 v[152:155], v1, s[44:47], s96 offen offset:2048 sc1
    buffer_load_dwordx4 v[156:159], v1, s[44:47], s96 offen offset:3072 sc1
    s_xor_b32 s96, s70, 8192
    buffer_load_dwordx4 v[160:163], v1, s[44:47], s96 offen offset:0 sc1
L_xjoin2_s:
    s_waitcnt vmcnt(8)
    v_mfma_f32_32x32x16_bf16 v[40:55], v[72:75], v[128:131], 0
    ds_read_b64_tr_b16 v[96:97], v3 offset:3072
    ds_read_b64_tr_b16 v[98:99], v3 offset:3328
    buffer_load_dwordx4 v[164:167], v1, s[44:47], s96 offen offset:1024 sc1
    v_mfma_f32_32x32x16_bf16 v[56:71], v[76:79], v[128:131], 0
    ds_read_b64_tr_b16 v[100:101], v3 offset:35840
    ds_read_b64_tr_b16 v[102:103], v3 offset:36096
    s_waitcnt vmcnt(8)
    v_mfma_f32_32x32x16_bf16 v[40:55], v[80:83], v[132:135], v[40:55]
    ds_read_b64_tr_b16 v[72:73], v3 offset:4096
    ds_read_b64_tr_b16 v[74:75], v3 offset:4352
    buffer_load_dwordx4 v[168:171], v1, s[44:47], s96 offen offset:2048 sc1
    v_mfma_f32_32x32x16_bf16 v[56:71], v[84:87], v[132:135], v[56:71]
    ds_read_b64_tr_b16 v[76:77], v3 offset:36864
    ds_read_b64_tr_b16 v[78:79], v3 offset:37120
    v_or3_b32 v12, 0, v128, v132
    s_waitcnt vmcnt(8)
    v_mfma_f32_32x32x16_bf16 v[40:55], v[88:91], v[136:139], v[40:55]
    ds_read_b64_tr_b16 v[80:81], v3 offset:5120
    ds_read_b64_tr_b16 v[82:83], v3 offset:5376
    buffer_load_dwordx4 v[172:175], v1, s[44:47], s96 offen offset:3072 sc1
    v_mfma_f32_32x32x16_bf16 v[56:71], v[92:95], v[136:139], v[56:71]
    ds_read_b64_tr_b16 v[84:85], v3 offset:37888
    ds_read_b64_tr_b16 v[86:87], v3 offset:38144
    ds_read2st64_b32 v[104:105], v22 offset0:0 offset1:1
    ds_read2st64_b32 v[106:107], v22 offset0:2 offset1:3
    s_waitcnt vmcnt(8) lgkmcnt(12)
    v_mfma_f32_32x32x16_bf16 v[40:55], v[96:99], v[140:143], v[40:55]
    ds_read_b64_tr_b16 v[88:89], v3 offset:6144
    ds_read_b64_tr_b16 v[90:91], v3 offset:6400
    s_xor_b32 s96, s70, 12288
    buffer_load_dwordx4 v[176:179], v1, s[44:47], s96 offen offset:0 sc1
    s_waitcnt lgkmcnt(12)
    v_mfma_f32_32x32x16_bf16 v[56:71], v[100:103], v[140:143], v[56:71]
    ds_read_b64_tr_b16 v[92:93], v3 offset:38912
    ds_read_b64_tr_b16 v[94:95], v3 offset:39168
    ds_read2st64_b32 v[108:109], v22 offset0:4 offset1:5
    ds_read2st64_b32 v[110:111], v22 offset0:6 offset1:7
    v_or3_b32 v12, v12, v136, v140
    s_waitcnt vmcnt(8) lgkmcnt(14)
    v_mfma_f32_32x32x16_bf16 v[40:55], v[72:75], v[144:147], v[40:55]
    ds_read_b64_tr_b16 v[96:97], v3 offset:7168
    ds_read_b64_tr_b16 v[98:99], v3 offset:7424
    buffer_load_dwordx4 v[180:183], v1, s[44:47], s96 offen offset:1024 sc1
    s_waitcnt lgkmcnt(14)
    v_mfma_f32_32x32x16_bf16 v[56:71], v[76:79], v[144:147], v[56:71]
    ds_read_b64_tr_b16 v[100:101], v3 offset:39936
    ds_read_b64_tr_b16 v[102:103], v3 offset:40192
    s_waitcnt vmcnt(8) lgkmcnt(14)
    v_mfma_f32_32x32x16_bf16 v[40:55], v[80:83], v[148:151], v[40:55]
    ds_read_b64_tr_b16 v[72:73], v3 offset:8192
    ds_read_b64_tr_b16 v[74:75], v3 offset:8448
    buffer_load_dwordx4 v[184:187], v1, s[44:47], s96 offen offset:2048 sc1
    s_waitcnt lgkmcnt(14)
    v_mfma_f32_32x32x16_bf16 v[56:71], v[84:87], v[148:151], v[56:71]
    ds_read_b64_tr_b16 v[76:77], v3 offset:40960
    ds_read_b64_tr_b16 v[78:79], v3 offset:41216
    v_or3_b32 v12, v12, v144, v148
    s_waitcnt vmcnt(8) lgkmcnt(12)
    v_mfma_f32_32x32x16_bf16 v[40:55], v[88:91], v[152:155], v[40:55]
    ds_read_b64_tr_b16 v[80:81], v3 offset:9216
    ds_read_b64_tr_b16 v[82:83], v3 offset:9472
    buffer_load_dwordx4 v[188:191], v1, s[44:47], s96 offen offset:3072 sc1
    buffer_load_dword v112, v20, s[40:43], s77 offen offset:512 sc1
    buffer_load_dword v113, v20, s[40:43], s77 offen offset:1536 sc1
    buffer_load_dword v114, v20, s[40:43], s77 offen offset:2560 sc1
    buffer_load_dword v115, v20, s[40:43], s77 offen offset:3584 sc1
    s_waitcnt lgkmcnt(12)
    v_mfma_f32_32x32x16_bf16 v[56:71], v[92:95], v[152:155], v[56:71]
    ds_read_b64_tr_b16 v[84:85], v3 offset:41984
    ds_read_b64_tr_b16 v[86:87], v3 offset:42240
    s_waitcnt lgkmcnt(12)
    v_add_f32 v104, v104, v105
    v_add_f32 v106, v106, v107
    s_waitcnt vmcnt(12) lgkmcnt(10)
    v_mfma_f32_32x32x16_bf16 v[40:55], v[96:99], v[156:159], v[40:55]
    ds_read_b64_tr_b16 v[88:89], v3 offset:10240
    ds_read_b64_tr_b16 v[90:91], v3 offset:10496
    s_xor_b32 s96, s70, 16384
    buffer_load_dwordx4 v[192:195], v1, s[44:47], s96 offen offset:0 sc1
    v_add_f32 v106, v104, v106
    s_waitcnt lgkmcnt(10)
    v_mfma_f32_32x32x16_bf16 v[56:71], v[100:103], v[156:159], v[56:71]
    ds_read_b64_tr_b16 v[92:93], v3 offset:43008
    ds_read_b64_tr_b16 v[94:95], v3 offset:43264
    v_cvt_pk_bf16_f32 v104, v106, v106
    v_and_b32 v107, 0xffff0000, v104
    v_or3_b32 v12, v12, v152, v156
    s_waitcnt vmcnt(12) lgkmcnt(10)
    v_mfma_f32_32x32x16_bf16 v[40:55], v[72:75], v[160:163], v[40:55]
    ds_read_b64_tr_b16 v[96:97], v3 offset:11264
    ds_read_b64_tr_b16 v[98:99], v3 offset:11520
    buffer_load_dwordx4 v[196:199], v1, s[44:47], s96 offen offset:1024 sc1
    v_sub_f32 v107, v106, v107
    s_waitcnt lgkmcnt(10)
    v_mfma_f32_32x32x16_bf16 v[56:71], v[76:79], v[160:163], v[56:71]
    ds_read_b64_tr_b16 v[100:101], v3 offset:44032
    ds_read_b64_tr_b16 v[102:103], v3 offset:44288
    v_cvt_pk_bf16_f32 v105, v107, 0
    v_add_f32 v108, v108, v109
    s_waitcnt vmcnt(12) lgkmcnt(10)
    v_mfma_f32_32x32x16_bf16 v[40:55], v[80:83], v[164:167], v[40:55]
    ds_read_b64_tr_b16 v[72:73], v3 offset:12288
    ds_read_b64_tr_b16 v[74:75], v3 offset:12544
    buffer_load_dwordx4 v[200:203], v1, s[44:47], s96 offen offset:2048 sc1
    v_add_f32 v110, v110, v111
    s_waitcnt lgkmcnt(10)
    v_mfma_f32_32x32x16_bf16 v[56:71], v[84:87], v[164:167], v[56:71]
    ds_read_b64_tr_b16 v[76:77], v3 offset:45056
    ds_read_b64_tr_b16 v[78:79], v3 offset:45312
    v_add_f32 v110, v108, v110
    v_cvt_pk_bf16_f32 v108, v110, v110
    v_or3_b32 v12, v12, v160, v164
    s_waitcnt vmcnt(12) lgkmcnt(10)
    v_mfma_f32_32x32x16_bf16 v[40:55], v[88:91], v[168:171], v[40:55]
    ds_read_b64_tr_b16 v[80:81], v3 offset:13312
    ds_read_b64_tr_b16 v[82:83], v3 offset:13568
    buffer_load_dwordx4 v[204:207], v1, s[44:47], s96 offen offset:3072 sc1
    v_and_b32 v111, 0xffff0000, v108
    s_waitcnt lgkmcnt(10)
    v_mfma_f32_32x32x16_bf16 v[56:71], v[92:95], v[168:171], v[56:71]
    ds_read_b64_tr_b16 v[84:85], v3 offset:46080
    ds_read_b64_tr_b16 v[86:87], v3 offset:46336
    v_sub_f32 v111, v110, v111
    v_cvt_pk_bf16_f32 v109, v111, 0
    s_waitcnt vmcnt(12) lgkmcnt(10)
    v_mfma_f32_32x32x16_bf16 v[40:55], v[96:99], v[172:175], v[40:55]
    ds_read_b64_tr_b16 v[88:89], v3 offset:14336
    ds_read_b64_tr_b16 v[90:91], v3 offset:14592
    s_xor_b32 s96, s70, 20480
    buffer_load_dwordx4 v[208:211], v1, s[44:47], s96 offen offset:0 sc1
    s_waitcnt lgkmcnt(10)
    v_mfma_f32_32x32x16_bf16 v[56:71], v[100:103], v[172:175], v[56:71]
    ds_read_b64_tr_b16 v[92:93], v3 offset:47104
    ds_read_b64_tr_b16 v[94:95], v3 offset:47360
    v_or3_b32 v12, v12, v168, v172
    s_waitcnt vmcnt(12) lgkmcnt(10)
    v_mfma_f32_32x32x16_bf16 v[40:55], v[72:75], v[176:179], v[40:55]
    ds_read_b64_tr_b16 v[96:97], v3 offset:15360
    ds_read_b64_tr_b16 v[98:99], v3 offset:15616
    buffer_load_dwordx4 v[212:215], v1, s[44:47], s96 offen offset:1024 sc1
    s_waitcnt lgkmcnt(10)
    v_mfma_f32_32x32x16_bf16 v[56:71], v[76:79], v[176:179], v[56:71]
    ds_read_b64_tr_b16 v[100:101], v3 offset:48128
    ds_read_b64_tr_b16 v[102:103], v3 offset:48384
    s_waitcnt vmcnt(12) lgkmcnt(10)
    v_mfma_f32_32x32x16_bf16 v[40:55], v[80:83], v[180:183], v[40:55]
    ds_read_b64_tr_b16 v[72:73], v3 offset:16384
    ds_read_b64_tr_b16 v[74:75], v3 offset:16640
    buffer_load_dwordx4 v[216:219], v1, s[44:47], s96 offen offset:2048 sc1
    s_waitcnt lgkmcnt(10)
    v_mfma_f32_32x32x16_bf16 v[56:71], v[84:87], v[180:183], v[56:71]
    ds_read_b64_tr_b16 v[76:77], v3 offset:49152
    ds_read_b64_tr_b16 v[78:79], v3 offset:49408
    v_or3_b32 v12, v12, v176, v180
    s_waitcnt vmcnt(12) lgkmcnt(10)
    v_mfma_f32_32x32x16_bf16 v[40:55], v[88:91], v[184:187], v[40:55]
    ds_read_b64_tr_b16 v[80:81], v3 offset:17408
    ds_read_b64_tr_b16 v[82:83], v3 offset:17664
    buffer_load_dwordx4 v[220:223], v1, s[44:47], s96 offen offset:3072 sc1
    s_waitcnt lgkmcnt(10)
    v_mfma_f32_32x32x16_bf16 v[56:71], v[92:95], v[184:187], v[56:71]
    ds_read_b64_tr_b16 v[84:85], v3 offset:50176
    ds_read_b64_tr_b16 v[86:87], v3 offset:50432
    s_waitcnt vmcnt(12) lgkmcnt(10)
    v_mfma_f32_32x32x16_bf16 v[40:55], v[96:99], v[188:191], v[40:55]
    ds_read_b64_tr_b16 v[88:89], v3 offset:18432
    ds_read_b64_tr_b16 v[90:91], v3 offset:18688
    s_xor_b32 s96, s70, 24576
    buffer_load_dwordx4 v[224:227], v1, s[44:47], s96 offen offset:0 sc1
    s_waitcnt lgkmcnt(10)
    v_mfma_f32_32x32x16_bf16 v[56:71], v[100:103], v[188:191], v[56:71]
    ds_read_b64_tr_b16 v[92:93], v3 offset:51200
    ds_read_b64_tr_b16 v[94:95], v3 offset:51456
    s_waitcnt vmcnt(9)
    v_max3_u32 v120, v112, v113, v114
    v_max_u32 v120, v120, v115
    v_or3_b32 v12, v12, v184, v188
    s_waitcnt vmcnt(8) lgkmcnt(10)
    v_mfma_f32_32x32x16_bf16 v[40:55], v[72:75], v[192:195], v[40:55]
    ds_read_b64_tr_b16 v[96:97], v3 offset:19456
    ds_read_b64_tr_b16 v[98:99], v3 offset:19712
    buffer_load_dwordx4 v[228:231], v1, s[44:47], s96 offen offset:1024 sc1
    v_cmp_eq_u32 vcc, -1, v120
    s_waitcnt lgkmcnt(10)
    v_mfma_f32_32x32x16_bf16 v[56:71], v[76:79], v[192:195], v[56:71]
    ds_read_b64_tr_b16 v[100:101], v3 offset:52224
    ds_read_b64_tr_b16 v[102:103], v3 offset:52480
    s_cbranch_vccnz Lstre_28_s
Lstok_29_s:
    s_waitcnt vmcnt(8) lgkmcnt(10)
    v_mfma_f32_32x32x16_bf16 v[40:55], v[80:83], v[196:199], v[40:55]
    ds_read_b64_tr_b16 v[72:73], v3 offset:20480
    ds_read_b64_tr_b16 v[74:75], v3 offset:20736
    buffer_load_dwordx4 v[232:235], v1, s[44:47], s96 offen offset:2048 sc1
    v_add_f32 v112, v112, v113
    s_waitcnt lgkmcnt(10)
    v_mfma_f32_32x32x16_bf16 v[56:71], v[84:87], v[196:199], v[56:71]
    ds_read_b64_tr_b16 v[76:77], v3 offset:53248
    ds_read_b64_tr_b16 v[78:79], v3 offset:53504
    v_add_f32 v114, v114, v115
    v_add_f32 v112, v112, v114
    v_or3_b32 v12, v12, v192, v196
    s_waitcnt vmcnt(8) lgkmcnt(10)
    v_mfma_f32_32x32x16_bf16 v[40:55], v[88:91], v[200:203], v[40:55]
    ds_read_b64_tr_b16 v[80:81], v3 offset:21504
    ds_read_b64_tr_b16 v[82:83], v3 offset:21760
    buffer_load_dwordx4 v[236:239], v1, s[44:47], s96 offen offset:3072 sc1
    v_mul_f32 v112, 0x3b000000, v112
    s_waitcnt lgkmcnt(10)
    v_mfma_f32_32x32x16_bf16 v[56:71], v[92:95], v[200:203], v[56:71]
    ds_read_b64_tr_b16 v[84:85], v3 offset:54272
    ds_read_b64_tr_b16 v[86:87], v3 offset:54528
    v_mov_b32 v113, v112
    v_cmp_gt_u32 vcc, 32, v0
    s_waitcnt vmcnt(8) lgkmcnt(10)
    v_mfma_f32_32x32x16_bf16 v[40:55], v[96:99], v[204:207], v[40:55]
    ds_read_b64_tr_b16 v[88:89], v3 offset:22528
    ds_read_b64_tr_b16 v[90:91], v3 offset:22784
    s_xor_b32 s96, s70, 28672
    buffer_load_dwordx4 v[240:243], v1, s[44:47], s96 offen offset:0 sc1
    v_permlane32_swap_b32 v112, v113
    s_waitcnt lgkmcnt(10)
    v_mfma_f32_32x32x16_bf16 v[56:71], v[100:103], v[204:207], v[56:71]
    ds_read_b64_tr_b16 v[92:93], v3 offset:55296
    ds_read_b64_tr_b16 v[94:95], v3 offset:55552
    v_fma_f32 v113, -v112, v112, v113
    v_cndmask_b32 v112, 0, v112, vcc
    v_or3_b32 v12, v12, v200, v204
    s_waitcnt vmcnt(8) lgkmcnt(10)
    v_mfma_f32_32x32x16_bf16 v[40:55], v[72:75], v[208:211], v[40:55]
    ds_read_b64_tr_b16 v[96:97], v3 offset:23552
    ds_read_b64_tr_b16 v[98:99], v3 offset:23808
    buffer_load_dwordx4 v[244:247], v1, s[44:47], s96 offen offset:1024 sc1
    v_max_f32 v113, 0, v113
    s_waitcnt lgkmcnt(10)
    v_mfma_f32_32x32x16_bf16 v[56:71], v[76:79], v[208:211], v[56:71]
    ds_read_b64_tr_b16 v[100:101], v3 offset:56320
    ds_read_b64_tr_b16 v[102:103], v3 offset:56576
    v_add_f32 v113, 0x3727c5ac, v113
    v_rsq_f32 v120, v113
    s_waitcnt vmcnt(8) lgkmcnt(10)
    v_mfma_f32_32x32x16_bf16 v[40:55], v[80:83], v[212:215], v[40:55]
    ds_read_b64_tr_b16 v[72:73], v3 offset:24576
    ds_read_b64_tr_b16 v[74:75], v3 offset:24832
    buffer_load_dwordx4 v[248:251], v1, s[44:47], s96 offen offset:2048 sc1
    v_cvt_pk_bf16_f32 v117, -v112, 0
    s_waitcnt lgkmcnt(10)
    v_mfma_f32_32x32x16_bf16 v[56:71], v[84:87], v[212:215], v[56:71]
    ds_read_b64_tr_b16 v[76:77], v3 offset:57344
    ds_read_b64_tr_b16 v[78:79], v3 offset:57600
    v_lshlrev_b32 v114, 16, v117
    v_sub_f32 v114, -v112, v114
    v_or3_b32 v12, v12, v208, v212
    s_waitcnt vmcnt(8) lgkmcnt(10)
    v_mfma_f32_32x32x16_bf16 v[40:55], v[88:91], v[216:219], v[40:55]
    ds_read_b64_tr_b16 v[80:81], v3 offset:25600
    ds_read_b64_tr_b16 v[82:83], v3 offset:25856
    buffer_load_dwordx4 v[252:255], v1, s[44:47], s96 offen offset:3072 sc1
    v_cvt_pk_bf16_f32 v116, -v112, v114
    s_waitcnt lgkmcnt(10)
    v_mfma_f32_32x32x16_bf16 v[56:71], v[92:95], v[216:219], v[56:71]
    ds_read_b64_tr_b16 v[84:85], v3 offset:58368
    ds_read_b64_tr_b16 v[86:87], v3 offset:58624
    v_mul_f32 v118, 0x3fb8aa3b, v120
    s_waitcnt vmcnt(8) lgkmcnt(10)
    v_mfma_f32_32x32x16_bf16 v[40:55], v[96:99], v[220:223], v[40:55]
    ds_read_b64_tr_b16 v[88:89], v3 offset:26624
    ds_read_b64_tr_b16 v[90:91], v3 offset:26880
    s_waitcnt lgkmcnt(10)
    v_mfma_f32_32x32x16_bf16 v[56:71], v[100:103], v[220:223], v[56:71]
    ds_read_b64_tr_b16 v[92:93], v3 offset:59392
    ds_read_b64_tr_b16 v[94:95], v3 offset:59648
    v_or3_b32 v12, v12, v216, v220
    s_waitcnt vmcnt(7) lgkmcnt(10)
    v_mfma_f32_32x32x16_bf16 v[40:55], v[72:75], v[224:227], v[40:55]
    ds_read_b64_tr_b16 v[96:97], v3 offset:27648
    ds_read_b64_tr_b16 v[98:99], v3 offset:27904
    s_waitcnt lgkmcnt(10)
    v_mfma_f32_32x32x16_bf16 v[56:71], v[76:79], v[224:227], v[56:71]
    ds_read_b64_tr_b16 v[100:101], v3 offset:60416
    ds_read_b64_tr_b16 v[102:103], v3 offset:60672
    s_waitcnt vmcnt(6) lgkmcnt(10)
    v_mfma_f32_32x32x16_bf16 v[40:55], v[80:83], v[228:231], v[40:55]
    ds_read_b64_tr_b16 v[72:73], v3 offset:28672
    ds_read_b64_tr_b16 v[74:75], v3 offset:28928
    s_waitcnt lgkmcnt(10)
    v_mfma_f32_32x32x16_bf16 v[56:71], v[84:87], v[228:231], v[56:71]
    ds_read_b64_tr_b16 v[76:77], v3 offset:61440
    ds_read_b64_tr_b16 v[78:79], v3 offset:61696
    v_or3_b32 v12, v12, v224, v228
    s_waitcnt vmcnt(5) lgkmcnt(10)
    v_mfma_f32_32x32x16_bf16 v[40:55], v[88:91], v[232:235], v[40:55]
    ds_read_b64_tr_b16 v[80:81], v3 offset:29696
    ds_read_b64_tr_b16 v[82:83], v3 offset:29952
    s_waitcnt lgkmcnt(10)
    v_mfma_f32_32x32x16_bf16 v[56:71], v[92:95], v[232:235], v[56:71]
    ds_read_b64_tr_b16 v[84:85], v3 offset:30720
    ds_read_b64_tr_b16 v[86:87], v3 offset:30976
    s_waitcnt vmcnt(4) lgkmcnt(10)
    v_mfma_f32_32x32x16_bf16 v[40:55], v[96:99], v[236:239], v[40:55]
    ds_read_b64_tr_b16 v[88:89], v3 offset:31744
    ds_read_b64_tr_b16 v[90:91], v3 offset:32000
    s_waitcnt lgkmcnt(10)
    v_mfma_f32_32x32x16_bf16 v[56:71], v[100:103], v[236:239], v[56:71]
    ds_read_b64_tr_b16 v[92:93], v3 offset:62464
    ds_read_b64_tr_b16 v[94:95], v3 offset:62720
    v_or3_b32 v12, v12, v232, v236
    s_waitcnt vmcnt(3) lgkmcnt(10)
    v_mfma_f32_32x32x16_bf16 v[40:55], v[72:75], v[240:243], v[40:55]
    ds_read_b64_tr_b16 v[96:97], v3 offset:63488
    ds_read_b64_tr_b16 v[98:99], v3 offset:63744
    v_mfma_f32_32x32x8_bf16 v[40:55], v[104:105], v[116:117], v[40:55]
    s_waitcnt lgkmcnt(10)
    v_mfma_f32_32x32x16_bf16 v[56:71], v[76:79], v[240:243], v[56:71]
    ds_read_b64_tr_b16 v[100:101], v3 offset:64512
    ds_read_b64_tr_b16 v[102:103], v3 offset:64768
    v_mfma_f32_32x32x8_bf16 v[56:71], v[108:109], v[116:117], v[56:71]
    s_waitcnt vmcnt(2) lgkmcnt(10)
    v_mfma_f32_32x32x16_bf16 v[40:55], v[80:83], v[244:247], v[40:55]
    s_add_u32 s95, s11, 4096
    buffer_load_dwordx4 a[248:251], v1, s[40:43], s95 offen offset:2048 sc1
    s_waitcnt vmcnt(2) lgkmcnt(8)
    v_mfma_f32_32x32x16_bf16 v[40:55], v[84:87], v[248:251], v[40:55]
    buffer_load_dwordx4 a[252:255], v1, s[40:43], s95 offen offset:3072 sc1
    ds_read_b128 v[104:107], v2 offset:32768
    ds_read_b128 v[108:111], v2 offset:33792
    v_or3_b32 v12, v12, v240, v244
    s_waitcnt vmcnt(2) lgkmcnt(8)
    v_mfma_f32_32x32x16_bf16 v[40:55], v[88:91], v[252:255], v[40:55]
    v_or3_b32 v12, v12, v248, v252
    s_waitcnt lgkmcnt(6)
    v_mfma_f32_32x32x16_bf16 v[56:71], v[92:95], v[244:247], v[56:71]
    v_and_b32 v12, 1, v12
    v_cmp_ne_u32 vcc, 0, v12
    s_waitcnt lgkmcnt(4)
    v_mfma_f32_32x32x16_bf16 v[56:71], v[96:99], v[248:251], v[56:71]
    v_cvt_pk_bf16_f32 v40, v40, v41
    v_cvt_pk_bf16_f32 v41, v42, v43
    v_cvt_pk_bf16_f32 v42, v44, v45
    v_cvt_pk_bf16_f32 v43, v46, v47
    s_waitcnt lgkmcnt(2)
    v_mfma_f32_32x32x16_bf16 v[56:71], v[100:103], v[252:255], v[56:71]
    v_cvt_pk_bf16_f32 v44, v48, v49
    v_cvt_pk_bf16_f32 v45, v50, v51
    v_cvt_pk_bf16_f32 v46, v52, v53
    v_cvt_pk_bf16_f32 v47, v54, v55
    s_waitcnt lgkmcnt(0)
    v_mfma_f32_32x32x16_bf16 v[72:87], v[104:107], v[40:43], 0
    s_cbranch_vccnz L_xbad2_s
    v_mfma_f32_32x32x16_bf16 v[88:103], v[108:111], v[44:47], 0
    v_mul_f32 v56, v56, v120
    v_mul_f32 v57, v57, v120
    v_mul_f32 v58, v58, v120
    v_mul_f32 v59, v59, v120
    v_mul_f32 v60, v60, v120
    v_mul_f32 v61, v61, v120
    v_mul_f32 v62, v62, v120
    v_mul_f32 v63, v63, v120
    v_cvt_pk_bf16_f32 v56, v56, v57
    v_cvt_pk_bf16_f32 v57, v58, v59
    v_cvt_pk_bf16_f32 v58, v60, v61
    v_cvt_pk_bf16_f32 v59, v62, v63
    ds_write_b128 v8, v[56:59]
    v_pk_mul_f32 v[64:65], v[64:65], v[120:121] op_sel_hi:[1,0]
    v_pk_mul_f32 v[66:67], v[66:67], v[120:121] op_sel_hi:[1,0]
    v_pk_mul_f32 v[68:69], v[68:69], v[120:121] op_sel_hi:[1,0]
    v_pk_mul_f32 v[70:71], v[70:71], v[120:121] op_sel_hi:[1,0]
    v_cvt_pk_bf16_f32 v60, v64, v65
    v_cvt_pk_bf16_f32 v61, v66, v67
    v_cvt_pk_bf16_f32 v62, v68, v69
    v_cvt_pk_bf16_f32 v63, v70, v71
    v_max3_f32 v122, v72, v73, v74
    v_max3_f32 v123, v75, v76, v77
    v_max3_f32 v122, v122, v78, v79
    v_max3_f32 v123, v123, v80, v81
    v_max3_f32 v122, v122, v82, v83
    v_max3_f32 v123, v123, v84, v85
    ds_write_b128 v8, v[60:63] offset:4096
    v_max3_f32 v122, v122, v86, v87
    v_max_f32 v122, v122, v123
    v_mul_f32 v119, -v122, v118
    v_pk_fma_f32 v[72:73], v[72:73], v[118:119], v[118:119] op_sel:[0,0,1] op_sel_hi:[1,0,1]
    v_pk_fma_f32 v[74:75], v[74:75], v[118:119], v[118:119] op_sel:[0,0,1] op_sel_hi:[1,0,1]
    v_pk_fma_f32 v[76:77], v[76:77], v[118:119], v[118:119] op_sel:[0,0,1] op_sel_hi:[1,0,1]
    v_pk_fma_f32 v[78:79], v[78:79], v[118:119], v[118:119] op_sel:[0,0,1] op_sel_hi:[1,0,1]
    v_pk_fma_f32 v[80:81], v[80:81], v[118:119], v[118:119] op_sel:[0,0,1] op_sel_hi:[1,0,1]
    v_pk_fma_f32 v[82:83], v[82:83], v[118:119], v[118:119] op_sel:[0,0,1] op_sel_hi:[1,0,1]
    v_pk_fma_f32 v[84:85], v[84:85], v[118:119], v[118:119] op_sel:[0,0,1] op_sel_hi:[1,0,1]
    v_pk_fma_f32 v[86:87], v[86:87], v[118:119], v[118:119] op_sel:[0,0,1] op_sel_hi:[1,0,1]
    v_exp_f32 v72, v72
    v_exp_f32 v73, v73
    v_exp_f32 v74, v74
    v_exp_f32 v75, v75
    v_exp_f32 v76, v76
    v_exp_f32 v77, v77
    v_exp_f32 v78, v78
    v_exp_f32 v79, v79
    v_exp_f32 v80, v80
    v_exp_f32 v81, v81
    v_exp_f32 v82, v82
    v_exp_f32 v83, v83
    v_exp_f32 v84, v84
    v_exp_f32 v85, v85
    v_exp_f32 v86, v86
    v_exp_f32 v87, v87
    v_pk_add_f32 v[124:125], v[72:73], v[74:75]
    v_pk_add_f32 v[126:127], v[76:77], v[78:79]
    v_pk_add_f32 v[124:125], v[124:125], v[80:81]
    v_pk_add_f32 v[126:127], v[126:127], v[82:83]
    v_pk_add_f32 v[124:125], v[124:125], v[84:85]
    v_pk_add_f32 v[126:127], v[126:127], v[86:87]
    v_pk_add_f32 v[124:125], v[124:125], v[126:127]
    v_add_f32 v124, v124, v125
    v_rcp_f32 v124, v124
    s_nop 0
    v_pk_mul_f32 v[72:73], v[72:73], v[124:125] op_sel_hi:[1,0]
    v_pk_mul_f32 v[74:75], v[74:75], v[124:125] op_sel_hi:[1,0]
    v_pk_mul_f32 v[76:77], v[76:77], v[124:125] op_sel_hi:[1,0]
    v_pk_mul_f32 v[78:79], v[78:79], v[124:125] op_sel_hi:[1,0]
    v_cvt_pk_bf16_f32 v72, v72, v73
    v_cvt_pk_bf16_f32 v73, v74, v75
    v_cvt_pk_bf16_f32 v74, v76, v77
    v_cvt_pk_bf16_f32 v75, v78, v79
    ds_write_b128 v6, v[72:75]
    v_pk_mul_f32 v[80:81], v[80:81], v[124:125] op_sel_hi:[1,0]
    v_pk_mul_f32 v[82:83], v[82:83], v[124:125] op_sel_hi:[1,0]
    v_pk_mul_f32 v[84:85], v[84:85], v[124:125] op_sel_hi:[1,0]
    v_pk_mul_f32 v[86:87], v[86:87], v[124:125] op_sel_hi:[1,0]
    v_cvt_pk_bf16_f32 v76, v80, v81
    v_cvt_pk_bf16_f32 v77, v82, v83
    v_cvt_pk_bf16_f32 v78, v84, v85
    v_cvt_pk_bf16_f32 v79, v86, v87
    v_max3_f32 v122, v88, v89, v90
    v_max3_f32 v123, v91, v92, v93
    v_max3_f32 v122, v122, v94, v95
    v_max3_f32 v123, v123, v96, v97
    v_max3_f32 v122, v122, v98, v99
    v_max3_f32 v123, v123, v100, v101
    ds_write_b128 v7, v[76:79]
    v_max3_f32 v122, v122, v102, v103
    v_max_f32 v122, v122, v123
    v_mul_f32 v119, -v122, v118
    v_pk_fma_f32 v[88:89], v[88:89], v[118:119], v[118:119] op_sel:[0,0,1] op_sel_hi:[1,0,1]
    v_pk_fma_f32 v[90:91], v[90:91], v[118:119], v[118:119] op_sel:[0,0,1] op_sel_hi:[1,0,1]
    v_pk_fma_f32 v[92:93], v[92:93], v[118:119], v[118:119] op_sel:[0,0,1] op_sel_hi:[1,0,1]
    v_pk_fma_f32 v[94:95], v[94:95], v[118:119], v[118:119] op_sel:[0,0,1] op_sel_hi:[1,0,1]
    v_pk_fma_f32 v[96:97], v[96:97], v[118:119], v[118:119] op_sel:[0,0,1] op_sel_hi:[1,0,1]
    v_pk_fma_f32 v[98:99], v[98:99], v[118:119], v[118:119] op_sel:[0,0,1] op_sel_hi:[1,0,1]
    v_pk_fma_f32 v[100:101], v[100:101], v[118:119], v[118:119] op_sel:[0,0,1] op_sel_hi:[1,0,1]
    v_pk_fma_f32 v[102:103], v[102:103], v[118:119], v[118:119] op_sel:[0,0,1] op_sel_hi:[1,0,1]
    v_exp_f32 v88, v88
    v_exp_f32 v89, v89
    v_exp_f32 v90, v90
    v_exp_f32 v91, v91
    v_exp_f32 v92, v92
    v_exp_f32 v93, v93
    v_exp_f32 v94, v94
    v_exp_f32 v95, v95
    v_exp_f32 v96, v96
    v_exp_f32 v97, v97
    v_exp_f32 v98, v98
    v_exp_f32 v99, v99
    v_exp_f32 v100, v100
    v_exp_f32 v101, v101
    v_exp_f32 v102, v102
    v_exp_f32 v103, v103
    v_pk_add_f32 v[124:125], v[88:89], v[90:91]
    v_pk_add_f32 v[126:127], v[92:93], v[94:95]
    v_pk_add_f32 v[124:125], v[124:125], v[96:97]
    v_pk_add_f32 v[126:127], v[126:127], v[98:99]
    v_pk_add_f32 v[124:125], v[124:125], v[100:101]
    v_pk_add_f32 v[126:127], v[126:127], v[102:103]
    v_pk_add_f32 v[124:125], v[124:125], v[126:127]
    v_add_f32 v124, v124, v125
    v_rcp_f32 v124, v124
    s_nop 0
    v_pk_mul_f32 v[88:89], v[88:89], v[124:125] op_sel_hi:[1,0]
    v_pk_mul_f32 v[90:91], v[90:91], v[124:125] op_sel_hi:[1,0]
    v_pk_mul_f32 v[92:93], v[92:93], v[124:125] op_sel_hi:[1,0]
    v_pk_mul_f32 v[94:95], v[94:95], v[124:125] op_sel_hi:[1,0]
    v_cvt_pk_bf16_f32 v88, v88, v89
    v_cvt_pk_bf16_f32 v89, v90, v91
    v_cvt_pk_bf16_f32 v90, v92, v93
    v_cvt_pk_bf16_f32 v91, v94, v95
    ds_write_b128 v6, v[88:91] offset:8192
    v_pk_mul_f32 v[96:97], v[96:97], v[124:125] op_sel_hi:[1,0]
    v_pk_mul_f32 v[98:99], v[98:99], v[124:125] op_sel_hi:[1,0]
    v_pk_mul_f32 v[100:101], v[100:101], v[124:125] op_sel_hi:[1,0]
    v_pk_mul_f32 v[102:103], v[102:103], v[124:125] op_sel_hi:[1,0]
    v_cvt_pk_bf16_f32 v92, v96, v97
    v_cvt_pk_bf16_f32 v93, v98, v99
    v_cvt_pk_bf16_f32 v94, v100, v101
    v_cvt_pk_bf16_f32 v95, v102, v103
    ds_write_b128 v7, v[92:95] offset:8192
    v_mov_b32 v64, 0x3f803f80
    v_mov_b32 v65, 0x3f803f80
    v_mov_b32 v66, 0x3f803f80
    v_mov_b32 v67, 0x3f803f80
    s_waitcnt lgkmcnt(0)
    s_barrier
    ds_read_b64_tr_b16 v[72:73], v9 offset:0
    ds_read_b64_tr_b16 v[74:75], v9 offset:512
    ds_read_b64_tr_b16 v[76:77], v10 offset:0
    ds_read_b64_tr_b16 v[78:79], v10 offset:512
    ds_read_b64_tr_b16 v[80:81], v9 offset:1024
    ds_read_b64_tr_b16 v[82:83], v9 offset:1536
    ds_read_b64_tr_b16 v[84:85], v10 offset:1024
    ds_read_b64_tr_b16 v[86:87], v10 offset:1536
    ds_read_b64_tr_b16 v[88:89], v9 offset:2048
    ds_read_b64_tr_b16 v[90:91], v9 offset:2560
    ds_read_b64_tr_b16 v[92:93], v10 offset:2048
    ds_read_b64_tr_b16 v[94:95], v10 offset:2560
    ds_read_b64_tr_b16 v[96:97], v9 offset:3072
    ds_read_b64_tr_b16 v[98:99], v9 offset:3584
    ds_read_b64_tr_b16 v[100:101], v10 offset:3072
    s_add_u32 m0, s81, 0
    ds_read_b64_tr_b16 v[102:103], v10 offset:3584
    buffer_load_dwordx4 v5, s[40:43], m0 offen offset:0 sc1 lds
    s_waitcnt lgkmcnt(12)
    v_mfma_f32_16x16x32_bf16 v[56:59], v[72:75], v[76:79], 0
    v_mfma_f32_16x16x32_bf16 v[60:63], v[72:75], v[64:67], 0
    s_waitcnt lgkmcnt(8)
    v_mfma_f32_16x16x32_bf16 v[56:59], v[80:83], v[84:87], v[56:59]
    v_mfma_f32_16x16x32_bf16 v[60:63], v[80:83], v[64:67], v[60:63]
    s_waitcnt lgkmcnt(4)
    v_mfma_f32_16x16x32_bf16 v[56:59], v[88:91], v[92:95], v[56:59]
    v_mfma_f32_16x16x32_bf16 v[60:63], v[88:91], v[64:67], v[60:63]
    s_waitcnt lgkmcnt(0)
    v_mfma_f32_16x16x32_bf16 v[56:59], v[96:99], v[100:103], v[56:59]
    v_mfma_f32_16x16x32_bf16 v[60:63], v[96:99], v[64:67], v[60:63]
    v_mov_b32 v40, 2
    s_add_u32 s84, s74, 1114112
    ds_read_b64_tr_b16 v[72:73], v4 offset:0
    ds_read_b64_tr_b16 v[74:75], v4 offset:256
    ds_read_b64_tr_b16 v[76:77], v4 offset:1024
    ds_read_b64_tr_b16 v[78:79], v4 offset:1280
    v_cvt_pk_bf16_f32 v56, v56, v57
    v_cvt_pk_bf16_f32 v57, v58, v59
    v_cvt_pk_bf16_f32 v58, v60, v61
    v_cvt_pk_bf16_f32 v59, v62, v63
    s_nop 0
    v_permlane32_swap_b32 v56, v58
    v_permlane32_swap_b32 v57, v59
    s_mov_b32 exec_hi, 0x00010001
    buffer_store_dwordx4 v[56:59], v11, s[40:43], s84 offen sc1
    s_mov_b64 exec, 1
    buffer_store_dword v40, off, s[40:43], s78 offset:1088 sc1
    s_mov_b64 exec, -1
    ds_read_b64_tr_b16 v[80:81], v4 offset:2048
    ds_read_b64_tr_b16 v[82:83], v4 offset:2304
    ds_read_b64_tr_b16 v[84:85], v4 offset:3072
    ds_read_b64_tr_b16 v[86:87], v4 offset:3328
    ds_read_b64_tr_b16 v[88:89], v4 offset:4096
    ds_read_b64_tr_b16 v[90:91], v4 offset:4352
    ds_read_b64_tr_b16 v[92:93], v4 offset:5120
    ds_read_b64_tr_b16 v[94:95], v4 offset:5376
    s_waitcnt lgkmcnt(10)
    v_mfma_f32_32x32x16_bf16 v[40:55], v[72:75], v[128:131], 0
    ds_read_b64_tr_b16 v[96:97], v4 offset:6144
    ds_read_b64_tr_b16 v[98:99], v4 offset:6400
    buffer_load_dwordx4 v5, s[40:43], m0 offen offset:1024 sc1 lds
    s_waitcnt lgkmcnt(10)
    v_mfma_f32_32x32x16_bf16 v[40:55], v[76:79], v[132:135], v[40:55]
    ds_read_b64_tr_b16 v[100:101], v4 offset:7168
    ds_read_b64_tr_b16 v[102:103], v4 offset:7424
    s_waitcnt lgkmcnt(10)
    v_mfma_f32_32x32x16_bf16 v[40:55], v[80:83], v[136:139], v[40:55]
    ds_read_b64_tr_b16 v[72:73], v4 offset:8192
    s_add_u32 m0, s81, 32768
    ds_read_b64_tr_b16 v[74:75], v4 offset:8448
    buffer_load_dwordx4 v5, s[40:43], m0 offen offset:0 sc1 lds
    s_waitcnt lgkmcnt(10)
    v_mfma_f32_32x32x16_bf16 v[40:55], v[84:87], v[140:143], v[40:55]
    ds_read_b64_tr_b16 v[76:77], v4 offset:9216
    ds_read_b64_tr_b16 v[78:79], v4 offset:9472
    s_waitcnt lgkmcnt(10)
    v_mfma_f32_32x32x16_bf16 v[40:55], v[88:91], v[144:147], v[40:55]
    ds_read_b64_tr_b16 v[80:81], v4 offset:10240
    ds_read_b64_tr_b16 v[82:83], v4 offset:10496
    ds_read2st64_b32 v[112:113], v22 offset0:8 offset1:9
    ds_read2st64_b32 v[114:115], v22 offset0:10 offset1:11
    buffer_load_dwordx4 v5, s[40:43], m0 offen offset:1024 sc1 lds
    s_waitcnt lgkmcnt(12)
    v_mfma_f32_32x32x16_bf16 v[40:55], v[92:95], v[148:151], v[40:55]
    ds_read_b64_tr_b16 v[84:85], v4 offset:11264
    ds_read_b64_tr_b16 v[86:87], v4 offset:11520
    s_waitcnt lgkmcnt(12)
    v_mfma_f32_32x32x16_bf16 v[40:55], v[96:99], v[152:155], v[40:55]
    ds_read_b64_tr_b16 v[88:89], v4 offset:12288
    ds_read_b64_tr_b16 v[90:91], v4 offset:12544
    s_waitcnt lgkmcnt(12)
    v_mfma_f32_32x32x16_bf16 v[40:55], v[100:103], v[156:159], v[40:55]
    ds_read_b64_tr_b16 v[92:93], v4 offset:13312
    ds_read_b64_tr_b16 v[94:95], v4 offset:13568
    s_waitcnt lgkmcnt(12)
    v_mfma_f32_32x32x16_bf16 v[40:55], v[72:75], v[160:163], v[40:55]
    ds_read_b64_tr_b16 v[96:97], v4 offset:14336
    ds_read_b64_tr_b16 v[98:99], v4 offset:14592
    s_waitcnt lgkmcnt(8)
    v_add_f32 v112, v112, v113
    v_add_f32 v114, v114, v115
    v_add_f32 v114, v112, v114
    v_mfma_f32_32x32x16_bf16 v[40:55], v[76:79], v[164:167], v[40:55]
    ds_read_b64_tr_b16 v[100:101], v4 offset:15360
    ds_read_b64_tr_b16 v[102:103], v4 offset:15616
    v_cvt_pk_bf16_f32 v112, v114, v114
    v_and_b32 v115, 0xffff0000, v112
    v_sub_f32 v115, v114, v115
    v_mfma_f32_32x32x16_bf16 v[40:55], v[80:83], v[168:171], v[40:55]
    ds_read_b64_tr_b16 v[72:73], v4 offset:16384
    ds_read_b64_tr_b16 v[74:75], v4 offset:16640
    v_cvt_pk_bf16_f32 v113, v115, 0
    s_waitcnt lgkmcnt(10)
    v_mfma_f32_32x32x16_bf16 v[40:55], v[84:87], v[172:175], v[40:55]
    ds_read_b64_tr_b16 v[76:77], v4 offset:17408
    ds_read_b64_tr_b16 v[78:79], v4 offset:17664
    s_waitcnt lgkmcnt(10)
    v_mfma_f32_32x32x16_bf16 v[40:55], v[88:91], v[176:179], v[40:55]
    ds_read_b64_tr_b16 v[80:81], v4 offset:18432
    ds_read_b64_tr_b16 v[82:83], v4 offset:18688
    s_waitcnt lgkmcnt(10)
    v_mfma_f32_32x32x16_bf16 v[40:55], v[92:95], v[180:183], v[40:55]
    ds_read_b64_tr_b16 v[84:85], v4 offset:19456
    ds_read_b64_tr_b16 v[86:87], v4 offset:19712
    v_mfma_f32_32x32x8_bf16 v[40:55], v[112:113], v[116:117], v[40:55]
    s_waitcnt lgkmcnt(10)
    v_mfma_f32_32x32x16_bf16 v[40:55], v[96:99], v[184:187], v[40:55]
    ds_read_b64_tr_b16 v[88:89], v4 offset:20480
    ds_read_b64_tr_b16 v[90:91], v4 offset:20736
    s_waitcnt lgkmcnt(10)
    v_mfma_f32_32x32x16_bf16 v[40:55], v[100:103], v[188:191], v[40:55]
    ds_read_b64_tr_b16 v[92:93], v4 offset:21504
    ds_read_b64_tr_b16 v[94:95], v4 offset:21760
    s_waitcnt lgkmcnt(10)
    v_mfma_f32_32x32x16_bf16 v[40:55], v[72:75], v[192:195], v[40:55]
    ds_read_b64_tr_b16 v[96:97], v4 offset:22528
    ds_read_b64_tr_b16 v[98:99], v4 offset:22784
    s_add_u32 s12, s75, 1114112
    s_waitcnt lgkmcnt(10)
    v_mfma_f32_32x32x16_bf16 v[40:55], v[76:79], v[196:199], v[40:55]
    ds_read_b64_tr_b16 v[100:101], v4 offset:23552
    ds_read_b64_tr_b16 v[102:103], v4 offset:23808
    s_add_u32 s13, s75, 1253376
    s_waitcnt lgkmcnt(10)
    v_mfma_f32_32x32x16_bf16 v[40:55], v[80:83], v[200:203], v[40:55]
    ds_read_b64_tr_b16 v[72:73], v4 offset:49152
    ds_read_b64_tr_b16 v[74:75], v4 offset:49408
    s_add_u32 s14, s75, 1392640
    s_waitcnt lgkmcnt(10)
    v_mfma_f32_32x32x16_bf16 v[40:55], v[84:87], v[204:207], v[40:55]
    ds_read_b64_tr_b16 v[76:77], v4 offset:50176
    ds_read_b64_tr_b16 v[78:79], v4 offset:50432
    s_add_u32 s15, s75, 1531904
    s_waitcnt lgkmcnt(10)
    v_mfma_f32_32x32x16_bf16 v[40:55], v[88:91], v[208:211], v[40:55]
    ds_read_b64_tr_b16 v[80:81], v4 offset:51200
    ds_read_b64_tr_b16 v[82:83], v4 offset:51456
    s_mov_b32 s67, 2
    s_waitcnt lgkmcnt(10)
    v_mfma_f32_32x32x16_bf16 v[40:55], v[92:95], v[212:215], v[40:55]
    ds_read_b64_tr_b16 v[84:85], v4 offset:52224
    ds_read_b64_tr_b16 v[86:87], v4 offset:52480
    buffer_load_dwordx4 v[132:135], v13, s[40:43], s12 offen offset:0 sc1
    s_waitcnt lgkmcnt(10)
    v_mfma_f32_32x32x16_bf16 v[40:55], v[96:99], v[216:219], v[40:55]
    ds_read_b64_tr_b16 v[88:89], v4 offset:53248
    ds_read_b64_tr_b16 v[90:91], v4 offset:53504
    buffer_load_dwordx4 v[136:139], v13, s[40:43], s12 offen offset:256 sc1
    s_waitcnt lgkmcnt(10)
    v_mfma_f32_32x32x16_bf16 v[40:55], v[100:103], v[220:223], v[40:55]
    ds_read_b64_tr_b16 v[92:93], v4 offset:54272
    ds_read_b64_tr_b16 v[94:95], v4 offset:54528
    buffer_load_dwordx4 v[140:143], v13, s[40:43], s13 offen offset:0 sc1
    s_waitcnt lgkmcnt(10)
    v_mfma_f32_32x32x16_bf16 v[40:55], v[72:75], v[224:227], v[40:55]
    ds_read_b64_tr_b16 v[96:97], v4 offset:55296
    ds_read_b64_tr_b16 v[98:99], v4 offset:55552
    buffer_load_dwordx4 v[144:147], v13, s[40:43], s13 offen offset:256 sc1
    s_waitcnt lgkmcnt(10)
    v_mfma_f32_32x32x16_bf16 v[40:55], v[76:79], v[228:231], v[40:55]
    ds_read_b64_tr_b16 v[100:101], v4 offset:56320
    ds_read_b64_tr_b16 v[102:103], v4 offset:56576
    buffer_load_dwordx4 v[128:131], v14, s[40:43], s12 offen sc1
    s_waitcnt lgkmcnt(10)
    v_mfma_f32_32x32x16_bf16 v[40:55], v[80:83], v[232:235], v[40:55]
    buffer_load_dwordx4 v[148:151], v13, s[40:43], s14 offen offset:0 sc1
    s_waitcnt lgkmcnt(8)
    v_mfma_f32_32x32x16_bf16 v[40:55], v[84:87], v[236:239], v[40:55]
    buffer_load_dwordx4 v[152:155], v13, s[40:43], s14 offen offset:256 sc1
    s_waitcnt lgkmcnt(6)
    v_mfma_f32_32x32x16_bf16 v[40:55], v[88:91], v[240:243], v[40:55]
    buffer_load_dwordx4 v[156:159], v13, s[40:43], s15 offen offset:0 sc1
    s_waitcnt lgkmcnt(4)
    v_mfma_f32_32x32x16_bf16 v[40:55], v[92:95], v[244:247], v[40:55]
    buffer_load_dwordx4 v[160:163], v13, s[40:43], s15 offen offset:256 sc1
    s_waitcnt lgkmcnt(2)
    v_mfma_f32_32x32x16_bf16 v[40:55], v[96:99], v[248:251], v[40:55]
    s_waitcnt lgkmcnt(0)
    v_mfma_f32_32x32x16_bf16 v[40:55], v[100:103], v[252:255], v[40:55]
    buffer_load_dword v164, v19, s[40:43], 0 offen offset:64 sc1
    ds_read_b128 v[192:195], v2 offset:36864
    ds_read_b128 v[196:199], v2 offset:37888
    s_nop 8
    v_cvt_pk_bf16_f32 v40, v40, v41
    v_cvt_pk_bf16_f32 v41, v42, v43
    v_cvt_pk_bf16_f32 v42, v44, v45
    v_cvt_pk_bf16_f32 v43, v46, v47
    v_cvt_pk_bf16_f32 v44, v48, v49
    v_cvt_pk_bf16_f32 v45, v50, v51
    v_cvt_pk_bf16_f32 v46, v52, v53
    v_cvt_pk_bf16_f32 v47, v54, v55
    v_mfma_f32_32x32x16_bf16 v[72:87], v[104:107], v[40:43], 0
    s_nop 0
    v_mfma_f32_32x32x16_bf16 v[88:103], v[108:111], v[44:47], 0
    s_nop 4
    v_max3_f32 v122, v72, v73, v74
    v_max3_f32 v123, v75, v76, v77
    v_max3_f32 v122, v122, v78, v79
    v_max3_f32 v123, v123, v80, v81
    v_max3_f32 v122, v122, v82, v83
    v_max3_f32 v123, v123, v84, v85
    v_max3_f32 v122, v122, v86, v87
    v_max_f32 v122, v122, v123
    v_mul_f32 v119, -v122, v118
    v_pk_fma_f32 v[72:73], v[72:73], v[118:119], v[118:119] op_sel:[0,0,1] op_sel_hi:[1,0,1]
    v_pk_fma_f32 v[74:75], v[74:75], v[118:119], v[118:119] op_sel:[0,0,1] op_sel_hi:[1,0,1]
    v_pk_fma_f32 v[76:77], v[76:77], v[118:119], v[118:119] op_sel:[0,0,1] op_sel_hi:[1,0,1]
    v_pk_fma_f32 v[78:79], v[78:79], v[118:119], v[118:119] op_sel:[0,0,1] op_sel_hi:[1,0,1]
    v_pk_fma_f32 v[80:81], v[80:81], v[118:119], v[118:119] op_sel:[0,0,1] op_sel_hi:[1,0,1]
    v_pk_fma_f32 v[82:83], v[82:83], v[118:119], v[118:119] op_sel:[0,0,1] op_sel_hi:[1,0,1]
    v_pk_fma_f32 v[84:85], v[84:85], v[118:119], v[118:119] op_sel:[0,0,1] op_sel_hi:[1,0,1]
    v_pk_fma_f32 v[86:87], v[86:87], v[118:119], v[118:119] op_sel:[0,0,1] op_sel_hi:[1,0,1]
    v_exp_f32 v72, v72
    v_exp_f32 v73, v73
    v_exp_f32 v74, v74
    v_exp_f32 v75, v75
    v_exp_f32 v76, v76
    v_exp_f32 v77, v77
    v_exp_f32 v78, v78
    v_exp_f32 v79, v79
    v_exp_f32 v80, v80
    v_exp_f32 v81, v81
    v_exp_f32 v82, v82
    v_exp_f32 v83, v83
    v_exp_f32 v84, v84
    v_exp_f32 v85, v85
    v_exp_f32 v86, v86
    v_exp_f32 v87, v87
    v_pk_add_f32 v[124:125], v[72:73], v[74:75]
    v_pk_add_f32 v[126:127], v[76:77], v[78:79]
    v_pk_add_f32 v[124:125], v[124:125], v[80:81]
    v_pk_add_f32 v[126:127], v[126:127], v[82:83]
    v_pk_add_f32 v[124:125], v[124:125], v[84:85]
    v_pk_add_f32 v[126:127], v[126:127], v[86:87]
    v_pk_add_f32 v[124:125], v[124:125], v[126:127]
    v_add_f32 v124, v124, v125
    v_rcp_f32 v124, v124
    s_nop 0
    v_pk_mul_f32 v[72:73], v[72:73], v[124:125] op_sel_hi:[1,0]
    v_pk_mul_f32 v[74:75], v[74:75], v[124:125] op_sel_hi:[1,0]
    v_pk_mul_f32 v[76:77], v[76:77], v[124:125] op_sel_hi:[1,0]
    v_pk_mul_f32 v[78:79], v[78:79], v[124:125] op_sel_hi:[1,0]
    v_pk_mul_f32 v[80:81], v[80:81], v[124:125] op_sel_hi:[1,0]
    v_pk_mul_f32 v[82:83], v[82:83], v[124:125] op_sel_hi:[1,0]
    v_pk_mul_f32 v[84:85], v[84:85], v[124:125] op_sel_hi:[1,0]
    v_pk_mul_f32 v[86:87], v[86:87], v[124:125] op_sel_hi:[1,0]
    v_cvt_pk_bf16_f32 v72, v72, v73
    v_cvt_pk_bf16_f32 v73, v74, v75
    v_cvt_pk_bf16_f32 v74, v76, v77
    v_cvt_pk_bf16_f32 v75, v78, v79
    v_cvt_pk_bf16_f32 v76, v80, v81
    v_cvt_pk_bf16_f32 v77, v82, v83
    v_cvt_pk_bf16_f32 v78, v84, v85
    v_cvt_pk_bf16_f32 v79, v86, v87
    v_max3_f32 v122, v88, v89, v90
    v_max3_f32 v123, v91, v92, v93
    v_max3_f32 v122, v122, v94, v95
    v_max3_f32 v123, v123, v96, v97
    v_max3_f32 v122, v122, v98, v99
    v_max3_f32 v123, v123, v100, v101
    v_max3_f32 v122, v122, v102, v103
    v_max_f32 v122, v122, v123
    v_mul_f32 v119, -v122, v118
    v_pk_fma_f32 v[88:89], v[88:89], v[118:119], v[118:119] op_sel:[0,0,1] op_sel_hi:[1,0,1]
    v_pk_fma_f32 v[90:91], v[90:91], v[118:119], v[118:119] op_sel:[0,0,1] op_sel_hi:[1,0,1]
    v_pk_fma_f32 v[92:93], v[92:93], v[118:119], v[118:119] op_sel:[0,0,1] op_sel_hi:[1,0,1]
    v_pk_fma_f32 v[94:95], v[94:95], v[118:119], v[118:119] op_sel:[0,0,1] op_sel_hi:[1,0,1]
    v_pk_fma_f32 v[96:97], v[96:97], v[118:119], v[118:119] op_sel:[0,0,1] op_sel_hi:[1,0,1]
    v_pk_fma_f32 v[98:99], v[98:99], v[118:119], v[118:119] op_sel:[0,0,1] op_sel_hi:[1,0,1]
    v_pk_fma_f32 v[100:101], v[100:101], v[118:119], v[118:119] op_sel:[0,0,1] op_sel_hi:[1,0,1]
    v_pk_fma_f32 v[102:103], v[102:103], v[118:119], v[118:119] op_sel:[0,0,1] op_sel_hi:[1,0,1]
    v_exp_f32 v88, v88
    v_exp_f32 v89, v89
    v_exp_f32 v90, v90
    v_exp_f32 v91, v91
    v_exp_f32 v92, v92
    v_exp_f32 v93, v93
    v_exp_f32 v94, v94
    v_exp_f32 v95, v95
    v_exp_f32 v96, v96
    v_exp_f32 v97, v97
    v_exp_f32 v98, v98
    v_exp_f32 v99, v99
    v_exp_f32 v100, v100
    v_exp_f32 v101, v101
    v_exp_f32 v102, v102
    v_exp_f32 v103, v103
    v_pk_add_f32 v[124:125], v[88:89], v[90:91]
    v_pk_add_f32 v[126:127], v[92:93], v[94:95]
    v_pk_add_f32 v[124:125], v[124:125], v[96:97]
    v_pk_add_f32 v[126:127], v[126:127], v[98:99]
    v_pk_add_f32 v[124:125], v[124:125], v[100:101]
    v_pk_add_f32 v[126:127], v[126:127], v[102:103]
    v_pk_add_f32 v[124:125], v[124:125], v[126:127]
    v_add_f32 v124, v124, v125
    v_rcp_f32 v124, v124
    s_nop 0
    v_pk_mul_f32 v[88:89], v[88:89], v[124:125] op_sel_hi:[1,0]
    v_pk_mul_f32 v[90:91], v[90:91], v[124:125] op_sel_hi:[1,0]
    v_pk_mul_f32 v[92:93], v[92:93], v[124:125] op_sel_hi:[1,0]
    v_pk_mul_f32 v[94:95], v[94:95], v[124:125] op_sel_hi:[1,0]
    v_pk_mul_f32 v[96:97], v[96:97], v[124:125] op_sel_hi:[1,0]
    v_pk_mul_f32 v[98:99], v[98:99], v[124:125] op_sel_hi:[1,0]
    v_pk_mul_f32 v[100:101], v[100:101], v[124:125] op_sel_hi:[1,0]
    v_pk_mul_f32 v[102:103], v[102:103], v[124:125] op_sel_hi:[1,0]
    s_waitcnt vmcnt(9) lgkmcnt(0)
    v_mfma_f32_16x16x32_bf16 v[56:59], v[192:195], v[132:135], 0
    v_cvt_pk_bf16_f32 v88, v88, v89
    v_cvt_pk_bf16_f32 v89, v90, v91
    s_waitcnt vmcnt(8)
    v_mfma_f32_16x16x32_bf16 v[56:59], v[196:199], v[136:139], v[56:59]
    v_cvt_pk_bf16_f32 v90, v92, v93
    v_cvt_pk_bf16_f32 v91, v94, v95
    s_waitcnt vmcnt(7)
    v_mfma_f32_16x16x32_bf16 v[56:59], v[192:195], v[140:143], v[56:59]
    v_cvt_pk_bf16_f32 v92, v96, v97
    v_cvt_pk_bf16_f32 v93, v98, v99
    s_waitcnt vmcnt(6)
    v_mfma_f32_16x16x32_bf16 v[56:59], v[196:199], v[144:147], v[56:59]
    v_cvt_pk_bf16_f32 v94, v100, v101
    v_cvt_pk_bf16_f32 v95, v102, v103
L_part2_s:
    s_waitcnt vmcnt(5)
    v_mfma_f32_16x16x32_bf16 v[60:63], v[192:195], v[128:131], 0
    s_waitcnt vmcnt(4)
    v_mfma_f32_16x16x32_bf16 v[56:59], v[192:195], v[148:151], v[56:59]
    s_waitcnt vmcnt(3)
    v_mfma_f32_16x16x32_bf16 v[56:59], v[196:199], v[152:155], v[56:59]
    s_waitcnt vmcnt(2)
    v_mfma_f32_16x16x32_bf16 v[56:59], v[192:195], v[156:159], v[56:59]
    v_cvt_pk_bf16_f32 v64, v60, v61
    v_cvt_pk_bf16_f32 v65, v62, v63
    s_waitcnt vmcnt(1)
    v_mfma_f32_16x16x32_bf16 v[56:59], v[196:199], v[160:163], v[56:59]
    s_mov_b64 exec, 0x00ff00ff
    ds_write_b64 v16, v[64:65]
    s_mov_b64 exec, -1
    s_nop 4
    v_cmp_u_f32 vcc, v56, v60
    v_cvt_pk_bf16_f32 v56, v56, v57
    v_cvt_pk_bf16_f32 v57, v58, v59
    ds_write_b64 v15, v[56:57]
    s_cbranch_vccnz L_partre_s
L_partok2_s:
    s_waitcnt lgkmcnt(0)
    s_barrier
    ds_read_b128 v[128:131], v17 offset:0
    ds_read_b128 v[132:135], v17 offset:16
    ds_read_b128 v[136:139], v17 offset:1600
    ds_read_b128 v[140:143], v17 offset:1616
    s_waitcnt lgkmcnt(3)
    v_mfma_f32_32x32x16_bf16 v[40:55], v[128:131], v[72:75], 0
    v_mov_b32 v106, 3
    s_waitcnt vmcnt(0)
    v_cmp_gt_u32 vcc, 2, v164
    s_waitcnt lgkmcnt(2)
    v_mfma_f32_32x32x16_bf16 v[40:55], v[132:135], v[76:79], v[40:55]
    s_cbranch_vccnz Lrefa_31_s
Lfc_30_s:
    s_waitcnt lgkmcnt(0)
    v_mfma_f32_32x32x16_bf16 v[56:71], v[136:139], v[88:91], 0
    v_mfma_f32_32x32x16_bf16 v[56:71], v[140:143], v[92:95], v[56:71]
    v_add_f32 v48, v48, v50
    v_add_f32 v49, v49, v51
    v_add_f32 v48, 0x358637bd, v48
    v_add_f32 v48, v48, v49
    v_rcp_f32 v48, v48
    s_nop 0
    v_pk_mul_f32 v[40:41], v[40:41], v[48:49] op_sel_hi:[1,0]
    v_pk_mul_f32 v[42:43], v[42:43], v[48:49] op_sel_hi:[1,0]
    v_pk_mul_f32 v[44:45], v[44:45], v[48:49] op_sel_hi:[1,0]
    v_pk_mul_f32 v[46:47], v[46:47], v[48:49] op_sel_hi:[1,0]
    v_bfi_b32 v40, s60, v40, v4
    v_cvt_pk_bf16_f32 v40, v40, v41
    v_cvt_pk_bf16_f32 v41, v42, v43
    v_cvt_pk_bf16_f32 v42, v44, v45
    v_cvt_pk_bf16_f32 v43, v46, v47
    buffer_store_dwordx4 v[40:43], v1, s[44:47], s71 offen offset:0 sc1
    v_add_f32 v64, v64, v66
    v_add_f32 v65, v65, v67
    v_add_f32 v64, 0x358637bd, v64
    v_add_f32 v64, v64, v65
    v_rcp_f32 v64, v64
    s_nop 0
    v_pk_mul_f32 v[56:57], v[56:57], v[64:65] op_sel_hi:[1,0]
    v_pk_mul_f32 v[58:59], v[58:59], v[64:65] op_sel_hi:[1,0]
    v_pk_mul_f32 v[60:61], v[60:61], v[64:65] op_sel_hi:[1,0]
    v_pk_mul_f32 v[62:63], v[62:63], v[64:65] op_sel_hi:[1,0]
    v_bfi_b32 v56, s60, v56, v4
    v_cvt_pk_bf16_f32 v56, v56, v57
    v_cvt_pk_bf16_f32 v57, v58, v59
    v_cvt_pk_bf16_f32 v58, v60, v61
    v_cvt_pk_bf16_f32 v59, v62, v63
    buffer_store_dwordx4 v[56:59], v1, s[44:47], s71 offen offset:1024 sc1
    s_mov_b64 exec, 1
    s_waitcnt vmcnt(0)
    buffer_store_dword v106, off, s[40:43], s78 offset:0 sc1
    s_mov_b64 exec, -1
    s_and_b32 s84, s8, 0x6000
    v_add_u32 v116, s84, v2
    s_and_b32 s84, s9, 0x6000
    v_add_u32 v117, s84, v2
    s_and_b32 s84, s10, 0x6000
    v_add_u32 v118, s84, v2
    s_and_b32 s84, s11, 0x6000
    v_add_u32 v119, s84, v2
    v_and_or_b32 v141, v20, 60, s61
L_ore2_s:
    s_lshl2_add_u32 m0, s81, 114688
    buffer_load_dword v127, v18, s[40:43], 0 offen sc1
    s_cmp_eq_u32 s66, s0
    s_cbranch_scc0 Lpchk_33_s
    ds_write_b128 v116, v[40:43] offset:0
    ds_write_b128 v116, v[56:59] offset:1024
    s_branch L_oown2_s
L_opoll2_s:
    buffer_load_dword v127, v18, s[40:43], 0 offen sc1
    s_sub_u32 s68, s68, 1
    s_cbranch_scc1 L_end
L_oown2_s:
    s_waitcnt vmcnt(0)
    v_cmp_gt_u32 vcc, 3, v127
    s_cbranch_vccnz L_opoll2_s
    s_branch L_ojoin2_s
Lpoll_32_s:
    buffer_load_dword v127, v18, s[40:43], 0 offen sc1
    s_sub_u32 s68, s68, 1
    s_cbranch_scc1 L_end
Lpchk_33_s:
    s_waitcnt vmcnt(0)
    v_cmp_gt_u32 vcc, 3, v127
    s_cbranch_vccnz Lpoll_32_s
    buffer_load_dwordx4 v1, s[44:47], s72 offen offset:0 sc1 lds
    buffer_load_dwordx4 v1, s[44:47], s72 offen offset:1024 sc1 lds
L_ojoin2_s:
    s_lshl2_add_u32 m0, s81, 116736
    s_xor_b32 s84, s72, 2048
    buffer_load_dwordx4 v1, s[44:47], s84 offen offset:0 sc1 lds
    buffer_load_dwordx4 v1, s[44:47], s84 offen offset:1024 sc1 lds
    s_lshl2_add_u32 m0, s81, 118784
    s_xor_b32 s84, s72, 4096
    buffer_load_dwordx4 v1, s[44:47], s84 offen offset:0 sc1 lds
    buffer_load_dwordx4 v1, s[44:47], s84 offen offset:1024 sc1 lds
    s_lshl2_add_u32 m0, s81, 120832
    s_xor_b32 s84, s72, 6144
    buffer_load_dwordx4 v1, s[44:47], s84 offen offset:0 sc1 lds
    s_barrier
    buffer_load_dwordx4 v1, s[44:47], s84 offen offset:1024 sc1 lds
L_oskip2_s:
    s_waitcnt vmcnt(7)
    ds_read_b128 v[72:75], v116 offset:0
    s_waitcnt vmcnt(6)
    ds_read_b128 v[76:79], v116 offset:1024
    s_waitcnt vmcnt(5)
    ds_read_b128 v[80:83], v116 offset:2048
    s_waitcnt lgkmcnt(2)
    v_mfma_f32_32x32x16_bf16 v[40:55], a[0:3], v[72:75], v[24:39]
    s_waitcnt vmcnt(4)
    ds_read_b128 v[84:87], v116 offset:3072
    s_waitcnt lgkmcnt(2)
    v_mfma_f32_32x32x16_bf16 v[40:55], a[4:7], v[76:79], v[40:55]
    v_bitop3_b32 v12, 1, v72, v76 bitop3:0x80
    s_waitcnt vmcnt(3)
    ds_read_b128 v[88:91], v116 offset:4096
    s_waitcnt lgkmcnt(2)
    v_mfma_f32_32x32x16_bf16 v[40:55], a[8:11], v[80:83], v[40:55]
    s_waitcnt vmcnt(2)
    ds_read_b128 v[92:95], v116 offset:5120
    s_waitcnt lgkmcnt(2)
    v_mfma_f32_32x32x16_bf16 v[40:55], a[12:15], v[84:87], v[40:55]
    v_bitop3_b32 v12, v12, v80, v84 bitop3:0x80
    s_waitcnt vmcnt(1)
    ds_read_b128 v[96:99], v116 offset:6144
    s_waitcnt lgkmcnt(2)
    v_mfma_f32_32x32x16_bf16 v[40:55], a[16:19], v[88:91], v[40:55]
    s_waitcnt vmcnt(0)
    ds_read_b128 v[100:103], v116 offset:7168
    s_barrier
    s_waitcnt lgkmcnt(2)
    v_mfma_f32_32x32x16_bf16 v[40:55], a[20:23], v[92:95], v[40:55]
    v_bitop3_b32 v12, v12, v88, v92 bitop3:0x80
    ds_read_b128 v[72:75], v117 offset:0
    s_add_u32 m0, s81, 8192
    ds_read_b128 v[76:79], v117 offset:1024
    buffer_load_dwordx4 v5, s[40:43], m0 offen offset:0 sc1 lds
    s_waitcnt lgkmcnt(3)
    v_mfma_f32_32x32x16_bf16 v[40:55], a[24:27], v[96:99], v[40:55]
    ds_read_b128 v[80:83], v117 offset:2048
    ds_read_b128 v[84:87], v117 offset:3072
    s_waitcnt lgkmcnt(4)
    v_mfma_f32_32x32x16_bf16 v[40:55], a[28:31], v[100:103], v[40:55]
    v_bitop3_b32 v12, v12, v96, v100 bitop3:0x80
    v_cmp_eq_u32 vcc, 0, v12
    ds_read_b128 v[88:91], v117 offset:4096
    ds_read_b128 v[92:95], v117 offset:5120
    buffer_load_dwordx4 v5, s[40:43], m0 offen offset:1024 sc1 lds
    s_waitcnt lgkmcnt(5)
    v_mfma_f32_32x32x16_bf16 v[40:55], a[32:35], v[72:75], v[40:55]
    ds_read_b128 v[96:99], v117 offset:6144
    ds_read_b128 v[100:103], v117 offset:7168
    s_cmp_eq_u64 vcc, 0
    s_cselect_b64 exec, 1, 0
    buffer_store_dword v106, off, s[40:43], s16 offset:64 sc1
    s_mov_b64 exec, -1
    s_cselect_b32 s62, 1, 0
    s_waitcnt lgkmcnt(6)
    v_mfma_f32_32x32x16_bf16 v[40:55], a[36:39], v[76:79], v[40:55]
    v_bitop3_b32 v12, v12, v72, v76 bitop3:0x80
    s_add_u32 m0, s81, 40960
    ds_read_b128 v[72:75], v118 offset:0
    buffer_load_dwordx4 v5, s[40:43], m0 offen offset:0 sc1 lds
    s_waitcnt lgkmcnt(6)
    v_mfma_f32_32x32x16_bf16 v[40:55], a[40:43], v[80:83], v[40:55]
    ds_read_b128 v[76:79], v118 offset:1024
    s_waitcnt lgkmcnt(6)
    v_mfma_f32_32x32x16_bf16 v[40:55], a[44:47], v[84:87], v[40:55]
    v_bitop3_b32 v12, v12, v80, v84 bitop3:0x80
    ds_read_b128 v[80:83], v118 offset:2048
    buffer_load_dwordx4 v5, s[40:43], m0 offen offset:1024 sc1 lds
    s_waitcnt lgkmcnt(6)
    v_mfma_f32_32x32x16_bf16 v[40:55], a[48:51], v[88:91], v[40:55]
    ds_read_b128 v[84:87], v118 offset:3072
    s_waitcnt lgkmcnt(6)
    v_mfma_f32_32x32x16_bf16 v[40:55], a[52:55], v[92:95], v[40:55]
    v_bitop3_b32 v12, v12, v88, v92 bitop3:0x80
    s_add_u32 m0, s81, 16384
    ds_read_b128 v[88:91], v118 offset:4096
    buffer_load_dwordx4 v5, s[40:43], m0 offen offset:0 sc1 lds
    s_waitcnt lgkmcnt(6)
    v_mfma_f32_32x32x16_bf16 v[40:55], a[56:59], v[96:99], v[40:55]
    ds_read_b128 v[92:95], v118 offset:5120
    s_waitcnt lgkmcnt(6)
    v_mfma_f32_32x32x16_bf16 v[40:55], a[60:63], v[100:103], v[40:55]
    v_bitop3_b32 v12, v12, v96, v100 bitop3:0x80
    ds_read_b128 v[96:99], v118 offset:6144
    buffer_load_dwordx4 v5, s[40:43], m0 offen offset:1024 sc1 lds
    s_waitcnt lgkmcnt(6)
    v_mfma_f32_32x32x16_bf16 v[40:55], a[64:67], v[72:75], v[40:55]
    ds_read_b128 v[100:103], v118 offset:7168
    s_waitcnt lgkmcnt(6)
    v_mfma_f32_32x32x16_bf16 v[40:55], a[68:71], v[76:79], v[40:55]
    v_bitop3_b32 v12, v12, v72, v76 bitop3:0x80
    s_add_u32 m0, s81, 49152
    ds_read_b128 v[72:75], v119 offset:0
    buffer_load_dwordx4 v5, s[40:43], m0 offen offset:0 sc1 lds
    s_waitcnt lgkmcnt(6)
    v_mfma_f32_32x32x16_bf16 v[40:55], a[72:75], v[80:83], v[40:55]
    ds_read_b128 v[76:79], v119 offset:1024
    s_waitcnt lgkmcnt(6)
    v_mfma_f32_32x32x16_bf16 v[40:55], a[76:79], v[84:87], v[40:55]
    v_bitop3_b32 v12, v12, v80, v84 bitop3:0x80
    ds_read_b128 v[80:83], v119 offset:2048
    buffer_load_dword v140, v141, s[40:43], 0 offen offset:64 sc1
    buffer_load_dwordx4 v5, s[40:43], m0 offen offset:1024 sc1 lds
    s_waitcnt lgkmcnt(6)
    v_mfma_f32_32x32x16_bf16 v[40:55], a[80:83], v[88:91], v[40:55]
    ds_read_b128 v[84:87], v119 offset:3072
    s_waitcnt lgkmcnt(6)
    v_mfma_f32_32x32x16_bf16 v[40:55], a[84:87], v[92:95], v[40:55]
    v_bitop3_b32 v12, v12, v88, v92 bitop3:0x80
    s_add_u32 m0, s81, 24576
    ds_read_b128 v[88:91], v119 offset:4096
    buffer_load_dwordx4 v5, s[40:43], m0 offen offset:0 sc1 lds
    s_waitcnt lgkmcnt(6)
    v_mfma_f32_32x32x16_bf16 v[40:55], a[88:91], v[96:99], v[40:55]
    ds_read_b128 v[92:95], v119 offset:5120
    s_waitcnt lgkmcnt(6)
    v_mfma_f32_32x32x16_bf16 v[40:55], a[92:95], v[100:103], v[40:55]
    v_bitop3_b32 v12, v12, v96, v100 bitop3:0x80
    ds_read_b128 v[96:99], v119 offset:6144
    buffer_load_dwordx4 v5, s[40:43], m0 offen offset:1024 sc1 lds
    s_waitcnt lgkmcnt(6)
    v_mfma_f32_32x32x16_bf16 v[40:55], a[96:99], v[72:75], v[40:55]
    ds_read_b128 v[100:103], v119 offset:7168
    s_waitcnt lgkmcnt(6)
    v_mfma_f32_32x32x16_bf16 v[40:55], a[100:103], v[76:79], v[40:55]
    s_add_u32 m0, s81, 57344
    v_bitop3_b32 v12, v12, v72, v76 bitop3:0x80
    buffer_load_dwordx4 v5, s[40:43], m0 offen offset:0 sc1 lds
    s_waitcnt lgkmcnt(5)
    v_mfma_f32_32x32x16_bf16 v[40:55], a[104:107], v[80:83], v[40:55]
    s_waitcnt lgkmcnt(4)
    v_bitop3_b32 v12, v12, v80, v84 bitop3:0x80
    s_waitcnt lgkmcnt(2)
    v_bitop3_b32 v12, v12, v88, v92 bitop3:0x80
    v_mfma_f32_32x32x16_bf16 v[40:55], a[108:111], v[84:87], v[40:55]
    s_waitcnt lgkmcnt(0)
    v_bitop3_b32 v12, v12, v96, v100 bitop3:0x80
    v_cmp_eq_u32 vcc, 0, v12
    buffer_load_dwordx4 v5, s[40:43], m0 offen offset:1024 sc1 lds
    v_mfma_f32_32x32x16_bf16 v[40:55], a[112:115], v[88:91], v[40:55]
    s_cbranch_vccnz L_obad2_s
    v_mfma_f32_32x32x16_bf16 v[40:55], a[116:119], v[92:95], v[40:55]
    s_waitcnt vmcnt(5)
    v_cmp_gt_u32 vcc, 3, v140
    v_mfma_f32_32x32x16_bf16 v[40:55], a[248:251], v[96:99], v[40:55]
    s_cbranch_vccnz Lrefb_35_s
Lfc_34_s:
    v_mfma_f32_32x32x16_bf16 v[24:39], a[252:255], v[100:103], v[40:55]
    v_mov_b32 v62, 3
    s_nop 10
    v_cvt_pk_bf16_f32 v43, v30, v31
    v_cvt_pk_bf16_f32 v42, v28, v29
    v_cvt_pk_bf16_f32 v41, v26, v27
    v_cvt_pk_bf16_f32 v40, v24, v25
    v_and_b32 v40, -2, v40
    buffer_store_dwordx4 v[40:43], v1, s[44:47], s73 offen offset:0 sc1
    v_cvt_pk_bf16_f32 v47, v38, v39
    v_cvt_pk_bf16_f32 v46, v36, v37
    v_cvt_pk_bf16_f32 v45, v34, v35
    v_cvt_pk_bf16_f32 v44, v32, v33
    v_and_b32 v44, -2, v44
    buffer_store_dwordx4 v[44:47], v1, s[44:47], s73 offen offset:1024 sc1
    s_mov_b64 exec, 1
    s_waitcnt vmcnt(0)
    buffer_store_dword v62, off, s[40:43], s79 offset:0 sc1
    s_mov_b64 exec, -1
    v_pk_add_f32 v[56:57], v[24:25], v[26:27]
    v_pk_mul_f32 v[58:59], v[24:25], v[24:25]
    v_pk_fma_f32 v[58:59], v[26:27], v[26:27], v[58:59]
    v_pk_add_f32 v[56:57], v[56:57], v[28:29]
    v_pk_fma_f32 v[58:59], v[28:29], v[28:29], v[58:59]
    v_pk_add_f32 v[56:57], v[56:57], v[30:31]
    v_pk_fma_f32 v[58:59], v[30:31], v[30:31], v[58:59]
    v_pk_add_f32 v[56:57], v[56:57], v[32:33]
    v_pk_fma_f32 v[58:59], v[32:33], v[32:33], v[58:59]
    v_pk_add_f32 v[56:57], v[56:57], v[34:35]
    v_pk_fma_f32 v[58:59], v[34:35], v[34:35], v[58:59]
    v_pk_add_f32 v[56:57], v[56:57], v[36:37]
    v_pk_fma_f32 v[58:59], v[36:37], v[36:37], v[58:59]
    v_pk_add_f32 v[56:57], v[56:57], v[38:39]
    v_pk_fma_f32 v[58:59], v[38:39], v[38:39], v[58:59]
    v_add_f32 v56, v56, v57
    v_add_f32 v58, v58, v59
    s_lshl_b32 s84, s66, 8
    v_add_u32 v60, s84, v22
    v_permlane32_swap_b32 v56, v58
    v_add_f32 v56, v56, v58
    ds_write_b32 v60, v56 offset:6144
    s_waitcnt vmcnt(3) lgkmcnt(0)
    s_barrier
    s_cmp_lg_u32 s66, 0
    s_cbranch_scc1 Lst_36_s
    ds_read2st64_b32 v[56:57], v22 offset0:24 offset1:25
    ds_read2st64_b32 v[58:59], v22 offset0:26 offset1:27
    s_waitcnt lgkmcnt(0)
    v_add_f32 v56, v56, v57
    v_add_f32 v58, v58, v59
    v_add_f32 v56, v56, v58
    buffer_store_dword v56, v20, s[40:43], s76 offen offset:768 sc1
Lst_36_s:
    ds_read_b128 v[72:75], v1 offset:0
    ds_read_b128 v[76:79], v1 offset:32768
    ds_read_b128 v[80:83], v1 offset:1024
    ds_read_b128 v[84:87], v1 offset:33792
    ds_read_b128 v[88:91], v1 offset:2048
    ds_read_b128 v[92:95], v1 offset:34816
    buffer_load_dword v127, v19, s[40:43], 0 offen sc1
    v_add_u32 v64, s1, v2
    v_add_u32 v65, s82, v2
    ds_write_b128 v64, v[40:43]
    ds_write_b128 v65, v[44:47]
    s_lshl_b32 s84, s66, 10
    v_add_u32 v66, s84, v2
    s_cmp_eq_u32 s66, s0
    s_cbranch_scc0 Lpchk_38_s
    s_branch L_xown3_s
L_xpoll3_s:
    buffer_load_dword v127, v19, s[40:43], 0 offen sc1
    s_sub_u32 s68, s68, 1
    s_cbranch_scc1 L_end
L_xown3_s:
    s_waitcnt vmcnt(0)
    v_cmp_gt_u32 vcc, 3, v127
    s_cbranch_vccnz L_xpoll3_s
    s_xor_b32 s96, s70, 8192
    buffer_load_dwordx4 v[160:163], v1, s[44:47], s96 offen offset:0 sc1
    s_waitcnt lgkmcnt(0)
    s_barrier
    ds_read_b128 v[128:131], v2 offset:47104
    ds_read_b128 v[132:135], v66 offset:8192
    ds_read_b128 v[136:139], v66 offset:12288
    ds_read_b128 v[140:143], v66 offset:16384
    ds_read_b128 v[144:147], v66 offset:20480
    ds_read_b128 v[148:151], v66 offset:24576
    ds_read_b128 v[152:155], v66 offset:28672
    ds_read_b128 v[156:159], v2 offset:46080
    s_waitcnt lgkmcnt(0)
    s_branch L_xjoin3_s
Lpoll_37_s:
    buffer_load_dword v127, v19, s[40:43], 0 offen sc1
    s_sub_u32 s68, s68, 1
    s_cbranch_scc1 L_end
Lpchk_38_s:
    s_waitcnt vmcnt(0)
    v_cmp_gt_u32 vcc, 3, v127
    s_cbranch_vccnz Lpoll_37_s
    s_xor_b32 s96, s70, 0
    buffer_load_dwordx4 v[128:131], v1, s[44:47], s96 offen offset:0 sc1
    buffer_load_dwordx4 v[132:135], v1, s[44:47], s96 offen offset:1024 sc1
    buffer_load_dwordx4 v[136:139], v1, s[44:47], s96 offen offset:2048 sc1
    buffer_load_dwordx4 v[140:143], v1, s[44:47], s96 offen offset:3072 sc1
    s_waitcnt lgkmcnt(0)
    s_barrier
L_xre3_s:
    s_xor_b32 s96, s70, 4096
    buffer_load_dwordx4 v[144:147], v1, s[44:47], s96 offen offset:0 sc1
    buffer_load_dwordx4 v[148:151], v1, s[44:47], s96 offen offset:1024 sc1
    buffer_load_dwordx4 v[152:155], v1, s[44:47], s96 offen offset:2048 sc1
    buffer_load_dwordx4 v[156:159], v1, s[44:47], s96 offen offset:3072 sc1
    s_xor_b32 s96, s70, 8192
    buffer_load_dwordx4 v[160:163], v1, s[44:47], s96 offen offset:0 sc1
L_xjoin3_s:
    s_waitcnt vmcnt(8)
    v_mfma_f32_32x32x16_bf16 v[40:55], v[72:75], v[128:131], 0
    ds_read_b128 v[96:99], v1 offset:3072
    buffer_load_dwordx4 v[164:167], v1, s[44:47], s96 offen offset:1024 sc1
    v_mfma_f32_32x32x16_bf16 v[56:71], v[76:79], v[128:131], 0
    ds_read_b128 v[100:103], v1 offset:35840
    s_waitcnt vmcnt(8)
    v_mfma_f32_32x32x16_bf16 v[40:55], v[80:83], v[132:135], v[40:55]
    ds_read_b128 v[72:75], v1 offset:4096
    buffer_load_dwordx4 v[168:171], v1, s[44:47], s96 offen offset:2048 sc1
    v_mfma_f32_32x32x16_bf16 v[56:71], v[84:87], v[132:135], v[56:71]
    ds_read_b128 v[76:79], v1 offset:36864
    v_or3_b32 v12, 0, v128, v132
    v_and_b32 v122, 32, v0
    s_waitcnt vmcnt(8)
    v_mfma_f32_32x32x16_bf16 v[40:55], v[88:91], v[136:139], v[40:55]
    ds_read_b128 v[80:83], v1 offset:5120
    buffer_load_dwordx4 v[172:175], v1, s[44:47], s96 offen offset:3072 sc1
    v_mfma_f32_32x32x16_bf16 v[56:71], v[92:95], v[136:139], v[56:71]
    ds_read_b128 v[84:87], v1 offset:37888
    ds_read2st64_b32 v[104:105], v22 offset0:12 offset1:13
    ds_read2st64_b32 v[106:107], v22 offset0:14 offset1:15
    v_lshl_add_u32 v126, v122, 7, v6
    v_lshl_add_u32 v127, v122, 7, v7
    s_waitcnt vmcnt(8) lgkmcnt(7)
    v_mfma_f32_32x32x16_bf16 v[40:55], v[96:99], v[140:143], v[40:55]
    ds_read_b128 v[88:91], v1 offset:6144
    s_xor_b32 s96, s70, 12288
    buffer_load_dwordx4 v[176:179], v1, s[44:47], s96 offen offset:0 sc1
    s_waitcnt lgkmcnt(7)
    v_mfma_f32_32x32x16_bf16 v[56:71], v[100:103], v[140:143], v[56:71]
    ds_read_b128 v[92:95], v1 offset:38912
    ds_read2st64_b32 v[108:109], v22 offset0:16 offset1:17
    ds_read2st64_b32 v[110:111], v22 offset0:18 offset1:19
    v_or3_b32 v12, v12, v136, v140
    s_waitcnt vmcnt(8) lgkmcnt(9)
    v_mfma_f32_32x32x16_bf16 v[40:55], v[72:75], v[144:147], v[40:55]
    ds_read_b128 v[96:99], v1 offset:7168
    buffer_load_dwordx4 v[180:183], v1, s[44:47], s96 offen offset:1024 sc1
    s_waitcnt lgkmcnt(9)
    v_mfma_f32_32x32x16_bf16 v[56:71], v[76:79], v[144:147], v[56:71]
    ds_read_b128 v[100:103], v1 offset:39936
    s_waitcnt vmcnt(8) lgkmcnt(9)
    v_mfma_f32_32x32x16_bf16 v[40:55], v[80:83], v[148:151], v[40:55]
    ds_read_b128 v[72:75], v1 offset:8192
    buffer_load_dwordx4 v[184:187], v1, s[44:47], s96 offen offset:2048 sc1
    s_waitcnt lgkmcnt(9)
    v_mfma_f32_32x32x16_bf16 v[56:71], v[84:87], v[148:151], v[56:71]
    ds_read_b128 v[76:79], v1 offset:40960
    v_or3_b32 v12, v12, v144, v148
    s_waitcnt vmcnt(8) lgkmcnt(7)
    v_mfma_f32_32x32x16_bf16 v[40:55], v[88:91], v[152:155], v[40:55]
    ds_read_b128 v[80:83], v1 offset:9216
    buffer_load_dwordx4 v[188:191], v1, s[44:47], s96 offen offset:3072 sc1
    buffer_load_dword v112, v20, s[40:43], s77 offen offset:768 sc1
    buffer_load_dword v113, v20, s[40:43], s77 offen offset:1792 sc1
    buffer_load_dword v114, v20, s[40:43], s77 offen offset:2816 sc1
    buffer_load_dword v115, v20, s[40:43], s77 offen offset:3840 sc1
    s_waitcnt lgkmcnt(7)
    v_mfma_f32_32x32x16_bf16 v[56:71], v[92:95], v[152:155], v[56:71]
    ds_read_b128 v[84:87], v1 offset:41984
    s_waitcnt lgkmcnt(6)
    v_add_f32 v104, v104, v105
    v_add_f32 v106, v106, v107
    s_waitcnt vmcnt(12) lgkmcnt(5)
    v_mfma_f32_32x32x16_bf16 v[40:55], v[96:99], v[156:159], v[40:55]
    ds_read_b128 v[88:91], v1 offset:10240
    s_xor_b32 s96, s70, 16384
    buffer_load_dwordx4 v[192:195], v1, s[44:47], s96 offen offset:0 sc1
    v_add_f32 v106, v104, v106
    s_waitcnt lgkmcnt(5)
    v_mfma_f32_32x32x16_bf16 v[56:71], v[100:103], v[156:159], v[56:71]
    ds_read_b128 v[92:95], v1 offset:43008
    v_cvt_pk_bf16_f32 v104, v106, v106
    v_and_b32 v107, 0xffff0000, v104
    v_or3_b32 v12, v12, v152, v156
    s_waitcnt vmcnt(12) lgkmcnt(5)
    v_mfma_f32_32x32x16_bf16 v[40:55], v[72:75], v[160:163], v[40:55]
    ds_read_b128 v[96:99], v1 offset:11264
    buffer_load_dwordx4 v[196:199], v1, s[44:47], s96 offen offset:1024 sc1
    v_sub_f32 v107, v106, v107
    s_waitcnt lgkmcnt(5)
    v_mfma_f32_32x32x16_bf16 v[56:71], v[76:79], v[160:163], v[56:71]
    ds_read_b128 v[100:103], v1 offset:44032
    v_cvt_pk_bf16_f32 v105, v107, 0
    v_add_f32 v108, v108, v109
    s_waitcnt vmcnt(12) lgkmcnt(5)
    v_mfma_f32_32x32x16_bf16 v[40:55], v[80:83], v[164:167], v[40:55]
    ds_read_b128 v[72:75], v1 offset:12288
    buffer_load_dwordx4 v[200:203], v1, s[44:47], s96 offen offset:2048 sc1
    v_add_f32 v110, v110, v111
    s_waitcnt lgkmcnt(5)
    v_mfma_f32_32x32x16_bf16 v[56:71], v[84:87], v[164:167], v[56:71]
    ds_read_b128 v[76:79], v1 offset:45056
    v_add_f32 v110, v108, v110
    v_cvt_pk_bf16_f32 v108, v110, v110
    v_or3_b32 v12, v12, v160, v164
    s_waitcnt vmcnt(12) lgkmcnt(5)
    v_mfma_f32_32x32x16_bf16 v[40:55], v[88:91], v[168:171], v[40:55]
    ds_read_b128 v[80:83], v1 offset:13312
    buffer_load_dwordx4 v[204:207], v1, s[44:47], s96 offen offset:3072 sc1
    v_and_b32 v111, 0xffff0000, v108
    s_waitcnt lgkmcnt(5)
    v_mfma_f32_32x32x16_bf16 v[56:71], v[92:95], v[168:171], v[56:71]
    ds_read_b128 v[84:87], v1 offset:46080
    v_sub_f32 v111, v110, v111
    v_cvt_pk_bf16_f32 v109, v111, 0
    s_waitcnt vmcnt(12) lgkmcnt(5)
    v_mfma_f32_32x32x16_bf16 v[40:55], v[96:99], v[172:175], v[40:55]
    ds_read_b128 v[88:91], v1 offset:14336
    s_xor_b32 s96, s70, 20480
    buffer_load_dwordx4 v[208:211], v1, s[44:47], s96 offen offset:0 sc1
    s_waitcnt lgkmcnt(5)
    v_mfma_f32_32x32x16_bf16 v[56:71], v[100:103], v[172:175], v[56:71]
    ds_read_b128 v[92:95], v1 offset:47104
    v_or3_b32 v12, v12, v168, v172
    s_waitcnt vmcnt(12) lgkmcnt(5)
    v_mfma_f32_32x32x16_bf16 v[40:55], v[72:75], v[176:179], v[40:55]
    ds_read_b128 v[96:99], v1 offset:15360
    buffer_load_dwordx4 v[212:215], v1, s[44:47], s96 offen offset:1024 sc1
    s_waitcnt lgkmcnt(5)
    v_mfma_f32_32x32x16_bf16 v[56:71], v[76:79], v[176:179], v[56:71]
    ds_read_b128 v[100:103], v1 offset:48128
    s_waitcnt vmcnt(12) lgkmcnt(5)
    v_mfma_f32_32x32x16_bf16 v[40:55], v[80:83], v[180:183], v[40:55]
    ds_read_b128 v[72:75], v1 offset:16384
    buffer_load_dwordx4 v[216:219], v1, s[44:47], s96 offen offset:2048 sc1
    s_waitcnt lgkmcnt(5)
    v_mfma_f32_32x32x16_bf16 v[56:71], v[84:87], v[180:183], v[56:71]
    ds_read_b128 v[76:79], v1 offset:49152
    v_or3_b32 v12, v12, v176, v180
    s_waitcnt vmcnt(12) lgkmcnt(5)
    v_mfma_f32_32x32x16_bf16 v[40:55], v[88:91], v[184:187], v[40:55]
    ds_read_b128 v[80:83], v1 offset:17408
    buffer_load_dwordx4 v[220:223], v1, s[44:47], s96 offen offset:3072 sc1
    s_waitcnt lgkmcnt(5)
    v_mfma_f32_32x32x16_bf16 v[56:71], v[92:95], v[184:187], v[56:71]
    ds_read_b128 v[84:87], v1 offset:50176
    s_waitcnt vmcnt(12) lgkmcnt(5)
    v_mfma_f32_32x32x16_bf16 v[40:55], v[96:99], v[188:191], v[40:55]
    ds_read_b128 v[88:91], v1 offset:18432
    s_xor_b32 s96, s70, 24576
    buffer_load_dwordx4 v[224:227], v1, s[44:47], s96 offen offset:0 sc1
    s_waitcnt lgkmcnt(5)
    v_mfma_f32_32x32x16_bf16 v[56:71], v[100:103], v[188:191], v[56:71]
    ds_read_b128 v[92:95], v1 offset:51200
    s_waitcnt vmcnt(9)
    v_max3_u32 v120, v112, v113, v114
    v_max_u32 v120, v120, v115
    v_or3_b32 v12, v12, v184, v188
    s_waitcnt vmcnt(8) lgkmcnt(5)
    v_mfma_f32_32x32x16_bf16 v[40:55], v[72:75], v[192:195], v[40:55]
    ds_read_b128 v[96:99], v1 offset:19456
    buffer_load_dwordx4 v[228:231], v1, s[44:47], s96 offen offset:1024 sc1
    v_cmp_eq_u32 vcc, -1, v120
    s_waitcnt lgkmcnt(5)
    v_mfma_f32_32x32x16_bf16 v[56:71], v[76:79], v[192:195], v[56:71]
    ds_read_b128 v[100:103], v1 offset:52224
    s_cbranch_vccnz Lstre_39_s
Lstok_40_s:
    s_waitcnt vmcnt(8) lgkmcnt(5)
    v_mfma_f32_32x32x16_bf16 v[40:55], v[80:83], v[196:199], v[40:55]
    ds_read_b128 v[72:75], v1 offset:20480
    buffer_load_dwordx4 v[232:235], v1, s[44:47], s96 offen offset:2048 sc1
    v_add_f32 v112, v112, v113
    s_waitcnt lgkmcnt(5)
    v_mfma_f32_32x32x16_bf16 v[56:71], v[84:87], v[196:199], v[56:71]
    ds_read_b128 v[76:79], v1 offset:53248
    v_add_f32 v114, v114, v115
    v_add_f32 v112, v112, v114
    v_or3_b32 v12, v12, v192, v196
    s_waitcnt vmcnt(8) lgkmcnt(5)
    v_mfma_f32_32x32x16_bf16 v[40:55], v[88:91], v[200:203], v[40:55]
    ds_read_b128 v[80:83], v1 offset:21504
    buffer_load_dwordx4 v[236:239], v1, s[44:47], s96 offen offset:3072 sc1
    v_mul_f32 v112, 0x3b000000, v112
    s_waitcnt lgkmcnt(5)
    v_mfma_f32_32x32x16_bf16 v[56:71], v[92:95], v[200:203], v[56:71]
    ds_read_b128 v[84:87], v1 offset:54272
    v_mov_b32 v113, v112
    s_nop 1
    v_permlane32_swap_b32 v112, v113
    s_waitcnt vmcnt(8) lgkmcnt(5)
    v_mfma_f32_32x32x16_bf16 v[40:55], v[96:99], v[204:207], v[40:55]
    ds_read_b128 v[88:91], v1 offset:22528
    s_xor_b32 s96, s70, 28672
    buffer_load_dwordx4 v[240:243], v1, s[44:47], s96 offen offset:0 sc1
    v_fma_f32 v113, -v112, v112, v113
    s_waitcnt lgkmcnt(5)
    v_mfma_f32_32x32x16_bf16 v[56:71], v[100:103], v[204:207], v[56:71]
    ds_read_b128 v[92:95], v1 offset:55296
    v_max_f32 v113, 0, v113
    v_add_f32 v113, 0x3727c5ac, v113
    v_or3_b32 v12, v12, v200, v204
    s_waitcnt vmcnt(8) lgkmcnt(5)
    v_mfma_f32_32x32x16_bf16 v[40:55], v[72:75], v[208:211], v[40:55]
    ds_read_b128 v[96:99], v1 offset:23552
    buffer_load_dwordx4 v[244:247], v1, s[44:47], s96 offen offset:1024 sc1
    v_rsq_f32 v120, v113
    s_waitcnt lgkmcnt(5)
    v_mfma_f32_32x32x16_bf16 v[56:71], v[76:79], v[208:211], v[56:71]
    ds_read_b128 v[100:103], v1 offset:56320
    v_cvt_pk_bf16_f32 v117, -v112, 0
    v_lshlrev_b32 v114, 16, v117
    s_waitcnt vmcnt(8) lgkmcnt(5)
    v_mfma_f32_32x32x16_bf16 v[40:55], v[80:83], v[212:215], v[40:55]
    ds_read_b128 v[72:75], v1 offset:24576
    buffer_load_dwordx4 v[248:251], v1, s[44:47], s96 offen offset:2048 sc1
    v_sub_f32 v114, -v112, v114
    s_waitcnt lgkmcnt(5)
    v_mfma_f32_32x32x16_bf16 v[56:71], v[84:87], v[212:215], v[56:71]
    ds_read_b128 v[76:79], v1 offset:57344
    v_cvt_pk_bf16_f32 v116, -v112, v114
    v_mul_f32 v118, 0x3fb8aa3b, v120
    v_or3_b32 v12, v12, v208, v212
    s_waitcnt vmcnt(8) lgkmcnt(5)
    v_mfma_f32_32x32x16_bf16 v[40:55], v[88:91], v[216:219], v[40:55]
    ds_read_b128 v[80:83], v1 offset:25600
    buffer_load_dwordx4 v[252:255], v1, s[44:47], s96 offen offset:3072 sc1
    s_waitcnt lgkmcnt(5)
    v_mfma_f32_32x32x16_bf16 v[56:71], v[92:95], v[216:219], v[56:71]
    ds_read_b128 v[84:87], v1 offset:58368
    s_waitcnt vmcnt(8) lgkmcnt(5)
    v_mfma_f32_32x32x16_bf16 v[40:55], v[96:99], v[220:223], v[40:55]
    ds_read_b128 v[88:91], v1 offset:26624
    s_waitcnt lgkmcnt(5)
    v_mfma_f32_32x32x16_bf16 v[56:71], v[100:103], v[220:223], v[56:71]
    ds_read_b128 v[92:95], v1 offset:59392
    v_or3_b32 v12, v12, v216, v220
    s_waitcnt vmcnt(7) lgkmcnt(5)
    v_mfma_f32_32x32x16_bf16 v[40:55], v[72:75], v[224:227], v[40:55]
    ds_read_b128 v[96:99], v1 offset:27648
    s_waitcnt lgkmcnt(5)
    v_mfma_f32_32x32x16_bf16 v[56:71], v[76:79], v[224:227], v[56:71]
    ds_read_b128 v[100:103], v1 offset:60416
    s_waitcnt vmcnt(6) lgkmcnt(5)
    v_mfma_f32_32x32x16_bf16 v[40:55], v[80:83], v[228:231], v[40:55]
    ds_read_b128 v[72:75], v1 offset:28672
    s_waitcnt lgkmcnt(5)
    v_mfma_f32_32x32x16_bf16 v[56:71], v[84:87], v[228:231], v[56:71]
    ds_read_b128 v[76:79], v1 offset:29696
    v_or3_b32 v12, v12, v224, v228
    s_waitcnt vmcnt(5) lgkmcnt(5)
    v_mfma_f32_32x32x16_bf16 v[40:55], v[88:91], v[232:235], v[40:55]
    ds_read_b128 v[80:83], v1 offset:30720
    s_waitcnt lgkmcnt(5)
    v_mfma_f32_32x32x16_bf16 v[56:71], v[92:95], v[232:235], v[56:71]
    ds_read_b128 v[84:87], v1 offset:31744
    s_waitcnt vmcnt(4) lgkmcnt(5)
    v_mfma_f32_32x32x16_bf16 v[40:55], v[96:99], v[236:239], v[40:55]
    ds_read_b128 v[88:91], v1 offset:61440
    s_waitcnt lgkmcnt(5)
    v_mfma_f32_32x32x16_bf16 v[56:71], v[100:103], v[236:239], v[56:71]
    ds_read_b128 v[92:95], v1 offset:62464
    v_or3_b32 v12, v12, v232, v236
    s_waitcnt vmcnt(3) lgkmcnt(5)
    v_mfma_f32_32x32x16_bf16 v[40:55], v[72:75], v[240:243], v[40:55]
    ds_read_b128 v[96:99], v1 offset:63488
    v_mfma_f32_32x32x8_bf16 v[40:55], v[104:105], v[116:117], v[40:55]
    s_waitcnt vmcnt(2) lgkmcnt(5)
    v_mfma_f32_32x32x16_bf16 v[40:55], v[76:79], v[244:247], v[40:55]
    s_add_u32 m0, s81, 114688
    ds_read_b128 v[100:103], v1 offset:64512
    buffer_load_dwordx4 v5, s[40:43], m0 offen offset:0 sc1 lds
    v_mfma_f32_32x32x8_bf16 v[56:71], v[108:109], v[116:117], v[56:71]
    s_waitcnt vmcnt(2) lgkmcnt(5)
    v_mfma_f32_32x32x16_bf16 v[40:55], v[80:83], v[248:251], v[40:55]
    buffer_load_dwordx4 v5, s[40:43], m0 offen offset:1024 sc1 lds
    v_or3_b32 v12, v12, v240, v244
    s_waitcnt vmcnt(2) lgkmcnt(4)
    v_mfma_f32_32x32x16_bf16 v[40:55], v[84:87], v[252:255], v[40:55]
    v_or3_b32 v12, v12, v248, v252
    s_waitcnt lgkmcnt(3)
    v_mfma_f32_32x32x16_bf16 v[56:71], v[88:91], v[240:243], v[56:71]
    v_and_b32 v12, 1, v12
    v_cmp_ne_u32 vcc, 0, v12
    s_waitcnt lgkmcnt(2)
    v_mfma_f32_32x32x16_bf16 v[56:71], v[92:95], v[244:247], v[56:71]
    v_max3_f32 v119, v40, v41, v42
    v_max3_f32 v121, v43, v44, v45
    v_max3_f32 v119, v119, v46, v47
    v_max3_f32 v121, v121, v48, v49
    v_max3_f32 v119, v119, v50, v51
    v_max3_f32 v121, v121, v52, v53
    s_waitcnt lgkmcnt(1)
    v_mfma_f32_32x32x16_bf16 v[56:71], v[96:99], v[248:251], v[56:71]
    v_max3_f32 v119, v119, v54, v55
    v_max_f32 v119, v119, v121
    v_mul_f32 v119, -v119, v118
    v_min3_f32 v122, v40, v41, v42
    v_min3_f32 v123, v43, v44, v45
    v_min3_f32 v122, v122, v46, v47
    s_waitcnt lgkmcnt(0)
    v_mfma_f32_32x32x16_bf16 v[56:71], v[100:103], v[252:255], v[56:71]
    v_min3_f32 v123, v123, v48, v49
    v_min3_f32 v122, v122, v50, v51
    v_min3_f32 v123, v123, v52, v53
    v_min3_f32 v122, v122, v54, v55
    v_min_f32 v122, v122, v123
    s_cbranch_vccnz L_xbad3_s
    v_pk_fma_f32 v[72:73], v[40:41], v[118:119], v[118:119] op_sel:[0,0,1] op_sel_hi:[1,0,1]
    v_pk_fma_f32 v[74:75], v[42:43], v[118:119], v[118:119] op_sel:[0,0,1] op_sel_hi:[1,0,1]
    v_pk_fma_f32 v[76:77], v[44:45], v[118:119], v[118:119] op_sel:[0,0,1] op_sel_hi:[1,0,1]
    v_pk_fma_f32 v[78:79], v[46:47], v[118:119], v[118:119] op_sel:[0,0,1] op_sel_hi:[1,0,1]
    v_pk_fma_f32 v[80:81], v[48:49], v[118:119], v[118:119] op_sel:[0,0,1] op_sel_hi:[1,0,1]
    v_pk_fma_f32 v[82:83], v[50:51], v[118:119], v[118:119] op_sel:[0,0,1] op_sel_hi:[1,0,1]
    v_pk_fma_f32 v[84:85], v[52:53], v[118:119], v[118:119] op_sel:[0,0,1] op_sel_hi:[1,0,1]
    v_pk_fma_f32 v[86:87], v[54:55], v[118:119], v[118:119] op_sel:[0,0,1] op_sel_hi:[1,0,1]
    v_pk_mul_f32 v[56:57], v[56:57], v[120:121] op_sel_hi:[1,0]
    v_pk_mul_f32 v[58:59], v[58:59], v[120:121] op_sel_hi:[1,0]
    v_pk_mul_f32 v[60:61], v[60:61], v[120:121] op_sel_hi:[1,0]
    v_pk_mul_f32 v[62:63], v[62:63], v[120:121] op_sel_hi:[1,0]
    v_cvt_pk_bf16_f32 v56, v56, v57
    v_cvt_pk_bf16_f32 v57, v58, v59
    v_cvt_pk_bf16_f32 v58, v60, v61
    v_cvt_pk_bf16_f32 v59, v62, v63
    ds_write_b128 v8, v[56:59]
    v_pk_mul_f32 v[64:65], v[64:65], v[120:121] op_sel_hi:[1,0]
    v_pk_mul_f32 v[66:67], v[66:67], v[120:121] op_sel_hi:[1,0]
    v_pk_mul_f32 v[68:69], v[68:69], v[120:121] op_sel_hi:[1,0]
    v_pk_mul_f32 v[70:71], v[70:71], v[120:121] op_sel_hi:[1,0]
    v_cvt_pk_bf16_f32 v60, v64, v65
    v_cvt_pk_bf16_f32 v61, v66, v67
    v_cvt_pk_bf16_f32 v62, v68, v69
    v_cvt_pk_bf16_f32 v63, v70, v71
    v_exp_f32 v72, v72
    v_exp_f32 v73, v73
    v_exp_f32 v74, v74
    v_exp_f32 v75, v75
    v_exp_f32 v76, v76
    v_exp_f32 v77, v77
    ds_write_b128 v8, v[60:63] offset:4096
    v_exp_f32 v78, v78
    v_exp_f32 v79, v79
    v_exp_f32 v80, v80
    v_exp_f32 v81, v81
    v_exp_f32 v82, v82
    v_exp_f32 v83, v83
    v_exp_f32 v84, v84
    v_exp_f32 v85, v85
    v_exp_f32 v86, v86
    v_exp_f32 v87, v87
    v_pk_add_f32 v[124:125], v[72:73], v[74:75]
    v_pk_add_f32 v[112:113], v[76:77], v[78:79]
    v_pk_add_f32 v[124:125], v[124:125], v[80:81]
    v_pk_add_f32 v[112:113], v[112:113], v[82:83]
    v_pk_add_f32 v[124:125], v[124:125], v[84:85]
    v_pk_add_f32 v[112:113], v[112:113], v[86:87]
    v_pk_add_f32 v[124:125], v[124:125], v[112:113]
    v_add_f32 v124, v124, v125
    v_rcp_f32 v124, v124
    s_nop 0
    v_pk_mul_f32 v[72:73], v[72:73], v[124:125] op_sel_hi:[1,0]
    v_pk_mul_f32 v[74:75], v[74:75], v[124:125] op_sel_hi:[1,0]
    v_pk_mul_f32 v[76:77], v[76:77], v[124:125] op_sel_hi:[1,0]
    v_pk_mul_f32 v[78:79], v[78:79], v[124:125] op_sel_hi:[1,0]
    v_cvt_pk_bf16_f32 v72, v72, v73
    v_cvt_pk_bf16_f32 v73, v74, v75
    v_cvt_pk_bf16_f32 v74, v76, v77
    v_cvt_pk_bf16_f32 v75, v78, v79
    ds_write_b128 v126, v[72:75]
    v_pk_mul_f32 v[80:81], v[80:81], v[124:125] op_sel_hi:[1,0]
    v_pk_mul_f32 v[82:83], v[82:83], v[124:125] op_sel_hi:[1,0]
    v_pk_mul_f32 v[84:85], v[84:85], v[124:125] op_sel_hi:[1,0]
    v_pk_mul_f32 v[86:87], v[86:87], v[124:125] op_sel_hi:[1,0]
    v_cvt_pk_bf16_f32 v76, v80, v81
    v_cvt_pk_bf16_f32 v77, v82, v83
    v_cvt_pk_bf16_f32 v78, v84, v85
    v_cvt_pk_bf16_f32 v79, v86, v87
    v_mul_f32 v119, v122, v118
    v_pk_fma_f32 v[88:89], v[40:41], v[118:119], v[118:119] op_sel:[0,0,1] op_sel_hi:[1,0,1] neg_lo:[1,0,0] neg_hi:[1,0,0]
    v_pk_fma_f32 v[90:91], v[42:43], v[118:119], v[118:119] op_sel:[0,0,1] op_sel_hi:[1,0,1] neg_lo:[1,0,0] neg_hi:[1,0,0]
    v_pk_fma_f32 v[92:93], v[44:45], v[118:119], v[118:119] op_sel:[0,0,1] op_sel_hi:[1,0,1] neg_lo:[1,0,0] neg_hi:[1,0,0]
    v_pk_fma_f32 v[94:95], v[46:47], v[118:119], v[118:119] op_sel:[0,0,1] op_sel_hi:[1,0,1] neg_lo:[1,0,0] neg_hi:[1,0,0]
    v_pk_fma_f32 v[96:97], v[48:49], v[118:119], v[118:119] op_sel:[0,0,1] op_sel_hi:[1,0,1] neg_lo:[1,0,0] neg_hi:[1,0,0]
    ds_write_b128 v127, v[76:79]
    v_pk_fma_f32 v[98:99], v[50:51], v[118:119], v[118:119] op_sel:[0,0,1] op_sel_hi:[1,0,1] neg_lo:[1,0,0] neg_hi:[1,0,0]
    v_pk_fma_f32 v[100:101], v[52:53], v[118:119], v[118:119] op_sel:[0,0,1] op_sel_hi:[1,0,1] neg_lo:[1,0,0] neg_hi:[1,0,0]
    v_pk_fma_f32 v[102:103], v[54:55], v[118:119], v[118:119] op_sel:[0,0,1] op_sel_hi:[1,0,1] neg_lo:[1,0,0] neg_hi:[1,0,0]
    v_exp_f32 v88, v88
    v_exp_f32 v89, v89
    v_exp_f32 v90, v90
    v_exp_f32 v91, v91
    v_exp_f32 v92, v92
    v_exp_f32 v93, v93
    v_exp_f32 v94, v94
    v_exp_f32 v95, v95
    v_exp_f32 v96, v96
    v_exp_f32 v97, v97
    v_exp_f32 v98, v98
    v_exp_f32 v99, v99
    v_exp_f32 v100, v100
    v_exp_f32 v101, v101
    v_exp_f32 v102, v102
    v_exp_f32 v103, v103
    v_pk_add_f32 v[124:125], v[88:89], v[90:91]
    v_pk_add_f32 v[112:113], v[92:93], v[94:95]
    v_pk_add_f32 v[124:125], v[124:125], v[96:97]
    v_pk_add_f32 v[112:113], v[112:113], v[98:99]
    v_pk_add_f32 v[124:125], v[124:125], v[100:101]
    v_pk_add_f32 v[112:113], v[112:113], v[102:103]
    v_pk_add_f32 v[124:125], v[124:125], v[112:113]
    v_add_f32 v124, v124, v125
    v_rcp_f32 v124, v124
    s_nop 0
    v_pk_mul_f32 v[88:89], v[88:89], v[124:125] op_sel_hi:[1,0]
    v_pk_mul_f32 v[90:91], v[90:91], v[124:125] op_sel_hi:[1,0]
    v_pk_mul_f32 v[92:93], v[92:93], v[124:125] op_sel_hi:[1,0]
    v_pk_mul_f32 v[94:95], v[94:95], v[124:125] op_sel_hi:[1,0]
    v_cvt_pk_bf16_f32 v88, v88, v89
    v_cvt_pk_bf16_f32 v89, v90, v91
    v_cvt_pk_bf16_f32 v90, v92, v93
    v_cvt_pk_bf16_f32 v91, v94, v95
    ds_write_b128 v126, v[88:91] offset:4096
    v_pk_mul_f32 v[96:97], v[96:97], v[124:125] op_sel_hi:[1,0]
    v_pk_mul_f32 v[98:99], v[98:99], v[124:125] op_sel_hi:[1,0]
    v_pk_mul_f32 v[100:101], v[100:101], v[124:125] op_sel_hi:[1,0]
    v_pk_mul_f32 v[102:103], v[102:103], v[124:125] op_sel_hi:[1,0]
    v_cvt_pk_bf16_f32 v92, v96, v97
    v_cvt_pk_bf16_f32 v93, v98, v99
    v_cvt_pk_bf16_f32 v94, v100, v101
    v_cvt_pk_bf16_f32 v95, v102, v103
    ds_write_b128 v127, v[92:95] offset:4096
    v_add_u32 v123, 0x10000, v1
    v_mov_b32 v64, 0x3f803f80
    v_mov_b32 v65, 0x3f803f80
    v_mov_b32 v66, 0x3f803f80
    v_mov_b32 v67, 0x3f803f80
    s_waitcnt vmcnt(0) lgkmcnt(0)
    s_barrier
    ds_read_b64_tr_b16 v[72:73], v9 offset:0
    ds_read_b64_tr_b16 v[74:75], v9 offset:512
    ds_read_b64_tr_b16 v[76:77], v10 offset:0
    ds_read_b64_tr_b16 v[78:79], v10 offset:512
    ds_read_b64_tr_b16 v[80:81], v9 offset:1024
    ds_read_b64_tr_b16 v[82:83], v9 offset:1536
    ds_read_b64_tr_b16 v[84:85], v10 offset:1024
    ds_read_b64_tr_b16 v[86:87], v10 offset:1536
    ds_read_b64_tr_b16 v[88:89], v9 offset:2048
    ds_read_b64_tr_b16 v[90:91], v9 offset:2560
    ds_read_b64_tr_b16 v[92:93], v10 offset:2048
    ds_read_b64_tr_b16 v[94:95], v10 offset:2560
    ds_read_b64_tr_b16 v[96:97], v9 offset:3072
    ds_read_b64_tr_b16 v[98:99], v9 offset:3584
    ds_read_b64_tr_b16 v[100:101], v10 offset:3072
    ds_read_b64_tr_b16 v[102:103], v10 offset:3584
    s_waitcnt lgkmcnt(12)
    v_mfma_f32_16x16x32_bf16 v[56:59], v[72:75], v[76:79], 0
    v_mfma_f32_16x16x32_bf16 v[60:63], v[72:75], v[64:67], 0
    s_waitcnt lgkmcnt(8)
    v_mfma_f32_16x16x32_bf16 v[56:59], v[80:83], v[84:87], v[56:59]
    v_mfma_f32_16x16x32_bf16 v[60:63], v[80:83], v[64:67], v[60:63]
    s_waitcnt lgkmcnt(4)
    v_mfma_f32_16x16x32_bf16 v[56:59], v[88:91], v[92:95], v[56:59]
    v_mfma_f32_16x16x32_bf16 v[60:63], v[88:91], v[64:67], v[60:63]
    s_waitcnt lgkmcnt(0)
    v_mfma_f32_16x16x32_bf16 v[56:59], v[96:99], v[100:103], v[56:59]
    v_mfma_f32_16x16x32_bf16 v[60:63], v[96:99], v[64:67], v[60:63]
    v_mov_b32 v40, 3
    s_add_u32 s84, s74, 1671168
    ds_read_b128 v[72:75], v123 offset:24576
    ds_read_b128 v[76:79], v123 offset:25600
    s_nop 0
    v_cvt_pk_bf16_f32 v56, v56, v57
    v_cvt_pk_bf16_f32 v57, v58, v59
    s_nop 0
    v_cvt_pk_bf16_f32 v58, v60, v61
    v_cvt_pk_bf16_f32 v59, v62, v63
    s_nop 0
    v_permlane32_swap_b32 v56, v58
    v_permlane32_swap_b32 v57, v59
    s_mov_b32 exec_hi, 0x00010001
    buffer_store_dwordx4 v[56:59], v11, s[40:43], s84 offen sc1
    s_mov_b64 exec, 1
    buffer_store_dword v40, off, s[40:43], s78 offset:1088 sc1
    s_mov_b64 exec, -1
    ds_read_b128 v[80:83], v123 offset:26624
    ds_read_b128 v[84:87], v123 offset:27648
    ds_read_b128 v[88:91], v123 offset:28672
    ds_read_b128 v[92:95], v123 offset:29696
    s_waitcnt lgkmcnt(5)
    v_mfma_f32_32x32x16_bf16 v[40:55], v[72:75], v[128:131], 0
    ds_read_b128 v[96:99], v123 offset:30720
    s_waitcnt lgkmcnt(5)
    v_mfma_f32_32x32x16_bf16 v[40:55], v[76:79], v[132:135], v[40:55]
    ds_read_b128 v[100:103], v123 offset:31744
    s_waitcnt lgkmcnt(5)
    v_mfma_f32_32x32x16_bf16 v[40:55], v[80:83], v[136:139], v[40:55]
    ds_read_b128 v[72:75], v123 offset:32768
    s_waitcnt lgkmcnt(5)
    v_mfma_f32_32x32x16_bf16 v[40:55], v[84:87], v[140:143], v[40:55]
    ds_read_b128 v[76:79], v123 offset:33792
    s_waitcnt lgkmcnt(5)
    v_mfma_f32_32x32x16_bf16 v[40:55], v[88:91], v[144:147], v[40:55]
    ds_read_b128 v[80:83], v123 offset:34816
    ds_read2st64_b32 v[112:113], v22 offset0:20 offset1:21
    ds_read2st64_b32 v[114:115], v22 offset0:22 offset1:23
    s_waitcnt lgkmcnt(7)
    v_mfma_f32_32x32x16_bf16 v[40:55], v[92:95], v[148:151], v[40:55]
    ds_read_b128 v[84:87], v123 offset:35840
    s_waitcnt lgkmcnt(7)
    v_mfma_f32_32x32x16_bf16 v[40:55], v[96:99], v[152:155], v[40:55]
    ds_read_b128 v[88:91], v123 offset:36864
    s_waitcnt lgkmcnt(7)
    v_mfma_f32_32x32x16_bf16 v[40:55], v[100:103], v[156:159], v[40:55]
    ds_read_b128 v[92:95], v123 offset:37888
    s_waitcnt lgkmcnt(7)
    v_mfma_f32_32x32x16_bf16 v[40:55], v[72:75], v[160:163], v[40:55]
    ds_read_b128 v[96:99], v123 offset:38912
    s_waitcnt lgkmcnt(4)
    v_add_f32 v112, v112, v113
    v_add_f32 v114, v114, v115
    v_add_f32 v114, v112, v114
    v_mfma_f32_32x32x16_bf16 v[40:55], v[76:79], v[164:167], v[40:55]
    ds_read_b128 v[100:103], v123 offset:39936
    v_cvt_pk_bf16_f32 v112, v114, v114
    v_and_b32 v115, 0xffff0000, v112
    v_sub_f32 v115, v114, v115
    v_mfma_f32_32x32x16_bf16 v[40:55], v[80:83], v[168:171], v[40:55]
    ds_read_b128 v[72:75], v123 offset:40960
    v_cvt_pk_bf16_f32 v113, v115, 0
    s_waitcnt lgkmcnt(5)
    v_mfma_f32_32x32x16_bf16 v[40:55], v[84:87], v[172:175], v[40:55]
    ds_read_b128 v[76:79], v123 offset:41984
    s_waitcnt lgkmcnt(5)
    v_mfma_f32_32x32x16_bf16 v[40:55], v[88:91], v[176:179], v[40:55]
    ds_read_b128 v[80:83], v123 offset:43008
    s_waitcnt lgkmcnt(5)
    v_mfma_f32_32x32x16_bf16 v[40:55], v[92:95], v[180:183], v[40:55]
    ds_read_b128 v[84:87], v123 offset:44032
    v_mfma_f32_32x32x8_bf16 v[40:55], v[112:113], v[116:117], v[40:55]
    s_waitcnt lgkmcnt(5)
    v_mfma_f32_32x32x16_bf16 v[40:55], v[96:99], v[184:187], v[40:55]
    ds_read_b128 v[88:91], v123 offset:45056
    s_waitcnt lgkmcnt(5)
    v_mfma_f32_32x32x16_bf16 v[40:55], v[100:103], v[188:191], v[40:55]
    ds_read_b128 v[92:95], v123 offset:46080
    s_waitcnt lgkmcnt(5)
    v_mfma_f32_32x32x16_bf16 v[40:55], v[72:75], v[192:195], v[40:55]
    ds_read_b128 v[96:99], v123 offset:47104
    s_add_u32 s12, s75, 1671168
    s_waitcnt lgkmcnt(5)
    v_mfma_f32_32x32x16_bf16 v[40:55], v[76:79], v[196:199], v[40:55]
    ds_read_b128 v[100:103], v123 offset:48128
    s_add_u32 s13, s75, 1810432
    s_waitcnt lgkmcnt(5)
    v_mfma_f32_32x32x16_bf16 v[40:55], v[80:83], v[200:203], v[40:55]
    ds_read_b128 v[72:75], v123 offset:49152
    s_add_u32 s14, s75, 1949696
    s_waitcnt lgkmcnt(5)
    v_mfma_f32_32x32x16_bf16 v[40:55], v[84:87], v[204:207], v[40:55]
    ds_read_b128 v[76:79], v123 offset:50176
    s_add_u32 s15, s75, 2088960
    s_waitcnt lgkmcnt(5)
    v_mfma_f32_32x32x16_bf16 v[40:55], v[88:91], v[208:211], v[40:55]
    ds_read_b128 v[80:83], v123 offset:51200
    s_mov_b32 s67, 3
    s_waitcnt lgkmcnt(5)
    v_mfma_f32_32x32x16_bf16 v[40:55], v[92:95], v[212:215], v[40:55]
    ds_read_b128 v[84:87], v123 offset:52224
    buffer_load_dwordx4 v[132:135], v13, s[40:43], s12 offen offset:0 sc1
    s_waitcnt lgkmcnt(5)
    v_mfma_f32_32x32x16_bf16 v[40:55], v[96:99], v[216:219], v[40:55]
    ds_read_b128 v[88:91], v123 offset:53248
    buffer_load_dwordx4 v[136:139], v13, s[40:43], s12 offen offset:256 sc1
    s_waitcnt lgkmcnt(5)
    v_mfma_f32_32x32x16_bf16 v[40:55], v[100:103], v[220:223], v[40:55]
    ds_read_b128 v[92:95], v123 offset:54272
    buffer_load_dwordx4 v[140:143], v13, s[40:43], s13 offen offset:0 sc1
    s_waitcnt lgkmcnt(5)
    v_mfma_f32_32x32x16_bf16 v[40:55], v[72:75], v[224:227], v[40:55]
    ds_read_b128 v[96:99], v123 offset:55296
    buffer_load_dwordx4 v[144:147], v13, s[40:43], s13 offen offset:256 sc1
    s_waitcnt lgkmcnt(5)
    v_mfma_f32_32x32x16_bf16 v[40:55], v[76:79], v[228:231], v[40:55]
    ds_read_b128 v[100:103], v123 offset:56320
    buffer_load_dwordx4 v[128:131], v14, s[40:43], s12 offen sc1
    s_waitcnt lgkmcnt(5)
    v_mfma_f32_32x32x16_bf16 v[40:55], v[80:83], v[232:235], v[40:55]
    buffer_load_dwordx4 v[148:151], v13, s[40:43], s14 offen offset:0 sc1
    s_waitcnt lgkmcnt(4)
    v_mfma_f32_32x32x16_bf16 v[40:55], v[84:87], v[236:239], v[40:55]
    buffer_load_dwordx4 v[152:155], v13, s[40:43], s14 offen offset:256 sc1
    s_waitcnt lgkmcnt(3)
    v_mfma_f32_32x32x16_bf16 v[40:55], v[88:91], v[240:243], v[40:55]
    buffer_load_dwordx4 v[156:159], v13, s[40:43], s15 offen offset:0 sc1
    s_waitcnt lgkmcnt(2)
    v_mfma_f32_32x32x16_bf16 v[40:55], v[92:95], v[244:247], v[40:55]
    buffer_load_dwordx4 v[160:163], v13, s[40:43], s15 offen offset:256 sc1
    s_waitcnt lgkmcnt(1)
    v_mfma_f32_32x32x16_bf16 v[40:55], v[96:99], v[248:251], v[40:55]
    s_waitcnt lgkmcnt(0)
    v_mfma_f32_32x32x16_bf16 v[40:55], v[100:103], v[252:255], v[40:55]
    buffer_load_dword v164, v19, s[40:43], 0 offen offset:64 sc1
    ds_read_b128 v[192:195], v2 offset:36864
    ds_read_b128 v[196:199], v2 offset:37888
    s_nop 8
    v_max3_f32 v119, v40, v41, v42
    v_max3_f32 v121, v43, v44, v45
    v_max3_f32 v119, v119, v46, v47
    v_max3_f32 v121, v121, v48, v49
    v_max3_f32 v119, v119, v50, v51
    v_max3_f32 v121, v121, v52, v53
    v_max3_f32 v119, v119, v54, v55
    v_max_f32 v119, v119, v121
    v_mul_f32 v119, -v119, v118
    v_pk_fma_f32 v[72:73], v[40:41], v[118:119], v[118:119] op_sel:[0,0,1] op_sel_hi:[1,0,1]
    v_pk_fma_f32 v[74:75], v[42:43], v[118:119], v[118:119] op_sel:[0,0,1] op_sel_hi:[1,0,1]
    v_pk_fma_f32 v[76:77], v[44:45], v[118:119], v[118:119] op_sel:[0,0,1] op_sel_hi:[1,0,1]
    v_pk_fma_f32 v[78:79], v[46:47], v[118:119], v[118:119] op_sel:[0,0,1] op_sel_hi:[1,0,1]
    v_pk_fma_f32 v[80:81], v[48:49], v[118:119], v[118:119] op_sel:[0,0,1] op_sel_hi:[1,0,1]
    v_pk_fma_f32 v[82:83], v[50:51], v[118:119], v[118:119] op_sel:[0,0,1] op_sel_hi:[1,0,1]
    v_pk_fma_f32 v[84:85], v[52:53], v[118:119], v[118:119] op_sel:[0,0,1] op_sel_hi:[1,0,1]
    v_pk_fma_f32 v[86:87], v[54:55], v[118:119], v[118:119] op_sel:[0,0,1] op_sel_hi:[1,0,1]
    v_exp_f32 v72, v72
    v_exp_f32 v73, v73
    v_exp_f32 v74, v74
    v_exp_f32 v75, v75
    v_exp_f32 v76, v76
    v_exp_f32 v77, v77
    v_exp_f32 v78, v78
    v_exp_f32 v79, v79
    v_exp_f32 v80, v80
    v_exp_f32 v81, v81
    v_exp_f32 v82, v82
    v_exp_f32 v83, v83
    v_exp_f32 v84, v84
    v_exp_f32 v85, v85
    v_exp_f32 v86, v86
    v_exp_f32 v87, v87
    v_pk_add_f32 v[124:125], v[72:73], v[74:75]
    v_pk_add_f32 v[112:113], v[76:77], v[78:79]
    v_pk_add_f32 v[124:125], v[124:125], v[80:81]
    v_pk_add_f32 v[112:113], v[112:113], v[82:83]
    v_pk_add_f32 v[124:125], v[124:125], v[84:85]
    v_pk_add_f32 v[112:113], v[112:113], v[86:87]
    v_pk_add_f32 v[124:125], v[124:125], v[112:113]
    v_add_f32 v124, v124, v125
    v_rcp_f32 v124, v124
    s_nop 0
    v_pk_mul_f32 v[72:73], v[72:73], v[124:125] op_sel_hi:[1,0]
    v_pk_mul_f32 v[74:75], v[74:75], v[124:125] op_sel_hi:[1,0]
    v_pk_mul_f32 v[76:77], v[76:77], v[124:125] op_sel_hi:[1,0]
    v_pk_mul_f32 v[78:79], v[78:79], v[124:125] op_sel_hi:[1,0]
    v_pk_mul_f32 v[80:81], v[80:81], v[124:125] op_sel_hi:[1,0]
    v_pk_mul_f32 v[82:83], v[82:83], v[124:125] op_sel_hi:[1,0]
    v_pk_mul_f32 v[84:85], v[84:85], v[124:125] op_sel_hi:[1,0]
    v_pk_mul_f32 v[86:87], v[86:87], v[124:125] op_sel_hi:[1,0]
    v_cvt_pk_bf16_f32 v72, v72, v73
    v_cvt_pk_bf16_f32 v73, v74, v75
    v_cvt_pk_bf16_f32 v74, v76, v77
    v_cvt_pk_bf16_f32 v75, v78, v79
    v_cvt_pk_bf16_f32 v76, v80, v81
    v_cvt_pk_bf16_f32 v77, v82, v83
    v_cvt_pk_bf16_f32 v78, v84, v85
    v_cvt_pk_bf16_f32 v79, v86, v87
    v_min3_f32 v122, v40, v41, v42
    v_min3_f32 v123, v43, v44, v45
    v_min3_f32 v122, v122, v46, v47
    v_min3_f32 v123, v123, v48, v49
    v_min3_f32 v122, v122, v50, v51
    v_min3_f32 v123, v123, v52, v53
    v_min3_f32 v122, v122, v54, v55
    v_min_f32 v122, v122, v123
    v_mul_f32 v119, v122, v118
    v_pk_fma_f32 v[88:89], v[40:41], v[118:119], v[118:119] op_sel:[0,0,1] op_sel_hi:[1,0,1] neg_lo:[1,0,0] neg_hi:[1,0,0]
    v_pk_fma_f32 v[90:91], v[42:43], v[118:119], v[118:119] op_sel:[0,0,1] op_sel_hi:[1,0,1] neg_lo:[1,0,0] neg_hi:[1,0,0]
    v_pk_fma_f32 v[92:93], v[44:45], v[118:119], v[118:119] op_sel:[0,0,1] op_sel_hi:[1,0,1] neg_lo:[1,0,0] neg_hi:[1,0,0]
    v_pk_fma_f32 v[94:95], v[46:47], v[118:119], v[118:119] op_sel:[0,0,1] op_sel_hi:[1,0,1] neg_lo:[1,0,0] neg_hi:[1,0,0]
    v_pk_fma_f32 v[96:97], v[48:49], v[118:119], v[118:119] op_sel:[0,0,1] op_sel_hi:[1,0,1] neg_lo:[1,0,0] neg_hi:[1,0,0]
    v_pk_fma_f32 v[98:99], v[50:51], v[118:119], v[118:119] op_sel:[0,0,1] op_sel_hi:[1,0,1] neg_lo:[1,0,0] neg_hi:[1,0,0]
    v_pk_fma_f32 v[100:101], v[52:53], v[118:119], v[118:119] op_sel:[0,0,1] op_sel_hi:[1,0,1] neg_lo:[1,0,0] neg_hi:[1,0,0]
    v_pk_fma_f32 v[102:103], v[54:55], v[118:119], v[118:119] op_sel:[0,0,1] op_sel_hi:[1,0,1] neg_lo:[1,0,0] neg_hi:[1,0,0]
    v_exp_f32 v88, v88
    v_exp_f32 v89, v89
    v_exp_f32 v90, v90
    v_exp_f32 v91, v91
    v_exp_f32 v92, v92
    v_exp_f32 v93, v93
    v_exp_f32 v94, v94
    v_exp_f32 v95, v95
    v_exp_f32 v96, v96
    v_exp_f32 v97, v97
    v_exp_f32 v98, v98
    v_exp_f32 v99, v99
    v_exp_f32 v100, v100
    v_exp_f32 v101, v101
    v_exp_f32 v102, v102
    v_exp_f32 v103, v103
    v_pk_add_f32 v[124:125], v[88:89], v[90:91]
    v_pk_add_f32 v[112:113], v[92:93], v[94:95]
    v_pk_add_f32 v[124:125], v[124:125], v[96:97]
    v_pk_add_f32 v[112:113], v[112:113], v[98:99]
    v_pk_add_f32 v[124:125], v[124:125], v[100:101]
    v_pk_add_f32 v[112:113], v[112:113], v[102:103]
    v_pk_add_f32 v[124:125], v[124:125], v[112:113]
    v_add_f32 v124, v124, v125
    v_rcp_f32 v124, v124
    s_nop 0
    v_pk_mul_f32 v[88:89], v[88:89], v[124:125] op_sel_hi:[1,0]
    v_pk_mul_f32 v[90:91], v[90:91], v[124:125] op_sel_hi:[1,0]
    v_pk_mul_f32 v[92:93], v[92:93], v[124:125] op_sel_hi:[1,0]
    v_pk_mul_f32 v[94:95], v[94:95], v[124:125] op_sel_hi:[1,0]
    v_pk_mul_f32 v[96:97], v[96:97], v[124:125] op_sel_hi:[1,0]
    v_pk_mul_f32 v[98:99], v[98:99], v[124:125] op_sel_hi:[1,0]
    v_pk_mul_f32 v[100:101], v[100:101], v[124:125] op_sel_hi:[1,0]
    v_pk_mul_f32 v[102:103], v[102:103], v[124:125] op_sel_hi:[1,0]
    s_waitcnt vmcnt(9) lgkmcnt(0)
    v_mfma_f32_16x16x32_bf16 v[56:59], v[192:195], v[132:135], 0
    v_cvt_pk_bf16_f32 v88, v88, v89
    v_cvt_pk_bf16_f32 v89, v90, v91
    s_waitcnt vmcnt(8)
    v_mfma_f32_16x16x32_bf16 v[56:59], v[196:199], v[136:139], v[56:59]
    v_cvt_pk_bf16_f32 v90, v92, v93
    v_cvt_pk_bf16_f32 v91, v94, v95
    s_waitcnt vmcnt(7)
    v_mfma_f32_16x16x32_bf16 v[56:59], v[192:195], v[140:143], v[56:59]
    v_cvt_pk_bf16_f32 v92, v96, v97
    v_cvt_pk_bf16_f32 v93, v98, v99
    s_waitcnt vmcnt(6)
    v_mfma_f32_16x16x32_bf16 v[56:59], v[196:199], v[144:147], v[56:59]
    v_cvt_pk_bf16_f32 v94, v100, v101
    v_cvt_pk_bf16_f32 v95, v102, v103
    v_permlane32_swap_b32 v72, v88
    v_permlane32_swap_b32 v73, v89
    v_permlane32_swap_b32 v74, v90
    v_permlane32_swap_b32 v75, v91
L_part3_s:
    s_waitcnt vmcnt(5)
    v_mfma_f32_16x16x32_bf16 v[60:63], v[192:195], v[128:131], 0
    s_waitcnt vmcnt(4)
    v_mfma_f32_16x16x32_bf16 v[56:59], v[192:195], v[148:151], v[56:59]
    s_waitcnt vmcnt(3)
    v_mfma_f32_16x16x32_bf16 v[56:59], v[196:199], v[152:155], v[56:59]
    s_waitcnt vmcnt(2)
    v_mfma_f32_16x16x32_bf16 v[56:59], v[192:195], v[156:159], v[56:59]
    v_cvt_pk_bf16_f32 v64, v60, v61
    v_cvt_pk_bf16_f32 v65, v62, v63
    s_waitcnt vmcnt(1)
    v_mfma_f32_16x16x32_bf16 v[56:59], v[196:199], v[160:163], v[56:59]
    s_mov_b64 exec, 0x00ff00ff
    ds_write_b64 v16, v[64:65]
    s_mov_b64 exec, -1
    s_nop 4
    v_cmp_u_f32 vcc, v56, v60
    v_cvt_pk_bf16_f32 v56, v56, v57
    v_cvt_pk_bf16_f32 v57, v58, v59
    ds_write_b64 v15, v[56:57]
    s_cbranch_vccnz L_partre_s
L_partok3_s:
    v_permlane32_swap_b32 v76, v92
    v_permlane32_swap_b32 v77, v93
    v_permlane32_swap_b32 v78, v94
    v_permlane32_swap_b32 v79, v95
    s_waitcnt lgkmcnt(0)
    s_barrier
    ds_read_b128 v[128:131], v17 offset:0
    ds_read_b128 v[132:135], v17 offset:16
    ds_read_b128 v[136:139], v17 offset:1600
    ds_read_b128 v[140:143], v17 offset:1616
    s_waitcnt lgkmcnt(3)
    v_mfma_f32_32x32x16_bf16 v[40:55], v[128:131], v[72:75], 0
    v_mov_b32 v106, 4
    s_waitcnt vmcnt(0)
    v_cmp_gt_u32 vcc, 3, v164
    s_waitcnt lgkmcnt(2)
    v_mfma_f32_32x32x16_bf16 v[40:55], v[132:135], v[76:79], v[40:55]
    s_cbranch_vccnz Lrefa_42_s
Lfc_41_s:
    s_waitcnt lgkmcnt(0)
    v_mfma_f32_32x32x16_bf16 v[56:71], v[136:139], v[88:91], 0
    v_mfma_f32_32x32x16_bf16 v[56:71], v[140:143], v[92:95], v[56:71]
    v_add_f32 v48, v48, v50
    v_add_f32 v49, v49, v51
    v_add_f32 v48, 0x358637bd, v48
    v_add_f32 v48, v48, v49
    v_rcp_f32 v48, v48
    s_nop 0
    v_pk_mul_f32 v[40:41], v[40:41], v[48:49] op_sel_hi:[1,0]
    v_pk_mul_f32 v[42:43], v[42:43], v[48:49] op_sel_hi:[1,0]
    v_pk_mul_f32 v[44:45], v[44:45], v[48:49] op_sel_hi:[1,0]
    v_pk_mul_f32 v[46:47], v[46:47], v[48:49] op_sel_hi:[1,0]
    v_bfi_b32 v40, s60, v40, v4
    v_cvt_pk_bf16_f32 v40, v40, v41
    v_cvt_pk_bf16_f32 v41, v42, v43
    v_cvt_pk_bf16_f32 v42, v44, v45
    v_cvt_pk_bf16_f32 v43, v46, v47
    buffer_store_dwordx4 v[40:43], v1, s[44:47], s71 offen offset:0 sc1
    v_add_f32 v64, v64, v66
    v_add_f32 v65, v65, v67
    v_add_f32 v64, 0x358637bd, v64
    v_add_f32 v64, v64, v65
    v_rcp_f32 v64, v64
    s_nop 0
    v_pk_mul_f32 v[56:57], v[56:57], v[64:65] op_sel_hi:[1,0]
    v_pk_mul_f32 v[58:59], v[58:59], v[64:65] op_sel_hi:[1,0]
    v_pk_mul_f32 v[60:61], v[60:61], v[64:65] op_sel_hi:[1,0]
    v_pk_mul_f32 v[62:63], v[62:63], v[64:65] op_sel_hi:[1,0]
    v_bfi_b32 v56, s60, v56, v4
    v_cvt_pk_bf16_f32 v56, v56, v57
    v_cvt_pk_bf16_f32 v57, v58, v59
    v_cvt_pk_bf16_f32 v58, v60, v61
    v_cvt_pk_bf16_f32 v59, v62, v63
    buffer_store_dwordx4 v[56:59], v1, s[44:47], s71 offen offset:1024 sc1
    s_mov_b64 exec, 1
    s_waitcnt vmcnt(0)
    buffer_store_dword v106, off, s[40:43], s78 offset:0 sc1
    s_mov_b64 exec, -1
    s_and_b32 s84, s8, 0x6000
    v_add_u32 v116, s84, v2
    s_and_b32 s84, s9, 0x6000
    v_add_u32 v117, s84, v2
    s_and_b32 s84, s10, 0x6000
    v_add_u32 v118, s84, v2
    s_and_b32 s84, s11, 0x6000
    v_add_u32 v119, s84, v2
    v_and_or_b32 v141, v20, 60, s61
L_ore3_s:
    s_lshl2_add_u32 m0, s81, 114688
    buffer_load_dword v127, v18, s[40:43], 0 offen sc1
    s_cmp_eq_u32 s66, s0
    s_cbranch_scc0 Lpchk_44_s
    ds_write_b128 v116, v[40:43] offset:0
    ds_write_b128 v116, v[56:59] offset:1024
    s_branch L_oown3_s
L_opoll3_s:
    buffer_load_dword v127, v18, s[40:43], 0 offen sc1
    s_sub_u32 s68, s68, 1
    s_cbranch_scc1 L_end
L_oown3_s:
    s_waitcnt vmcnt(0)
    v_cmp_gt_u32 vcc, 4, v127
    s_cbranch_vccnz L_opoll3_s
    s_branch L_ojoin3_s
Lpoll_43_s:
    buffer_load_dword v127, v18, s[40:43], 0 offen sc1
    s_sub_u32 s68, s68, 1
    s_cbranch_scc1 L_end
Lpchk_44_s:
    s_waitcnt vmcnt(0)
    v_cmp_gt_u32 vcc, 4, v127
    s_cbranch_vccnz Lpoll_43_s
    buffer_load_dwordx4 v1, s[44:47], s72 offen offset:0 sc1 lds
    buffer_load_dwordx4 v1, s[44:47], s72 offen offset:1024 sc1 lds
L_ojoin3_s:
    s_lshl2_add_u32 m0, s81, 116736
    s_xor_b32 s84, s72, 2048
    buffer_load_dwordx4 v1, s[44:47], s84 offen offset:0 sc1 lds
    buffer_load_dwordx4 v1, s[44:47], s84 offen offset:1024 sc1 lds
    s_lshl2_add_u32 m0, s81, 118784
    s_xor_b32 s84, s72, 4096
    buffer_load_dwordx4 v1, s[44:47], s84 offen offset:0 sc1 lds
    buffer_load_dwordx4 v1, s[44:47], s84 offen offset:1024 sc1 lds
    s_lshl2_add_u32 m0, s81, 120832
    s_xor_b32 s84, s72, 6144
    buffer_load_dwordx4 v1, s[44:47], s84 offen offset:0 sc1 lds
    s_barrier
    buffer_load_dwordx4 v1, s[44:47], s84 offen offset:1024 sc1 lds
L_oskip3_s:
    s_waitcnt vmcnt(7)
    ds_read_b128 v[72:75], v116 offset:0
    s_waitcnt vmcnt(6)
    ds_read_b128 v[76:79], v116 offset:1024
    s_waitcnt vmcnt(5)
    ds_read_b128 v[80:83], v116 offset:2048
    s_waitcnt lgkmcnt(2)
    v_mfma_f32_32x32x16_bf16 v[40:55], a[128:131], v[72:75], v[24:39]
    s_waitcnt vmcnt(4)
    ds_read_b128 v[84:87], v116 offset:3072
    s_waitcnt lgkmcnt(2)
    v_mfma_f32_32x32x16_bf16 v[40:55], a[132:135], v[76:79], v[40:55]
    v_bitop3_b32 v12, 1, v72, v76 bitop3:0x80
    s_waitcnt vmcnt(3)
    ds_read_b128 v[88:91], v116 offset:4096
    s_waitcnt lgkmcnt(2)
    v_mfma_f32_32x32x16_bf16 v[40:55], a[136:139], v[80:83], v[40:55]
    s_waitcnt vmcnt(2)
    ds_read_b128 v[92:95], v116 offset:5120
    s_waitcnt lgkmcnt(2)
    v_mfma_f32_32x32x16_bf16 v[40:55], a[140:143], v[84:87], v[40:55]
    v_bitop3_b32 v12, v12, v80, v84 bitop3:0x80
    s_waitcnt vmcnt(1)
    ds_read_b128 v[96:99], v116 offset:6144
    s_waitcnt lgkmcnt(2)
    v_mfma_f32_32x32x16_bf16 v[40:55], a[144:147], v[88:91], v[40:55]
    s_waitcnt vmcnt(0)
    ds_read_b128 v[100:103], v116 offset:7168
    s_barrier
    s_waitcnt lgkmcnt(2)
    v_mfma_f32_32x32x16_bf16 v[40:55], a[148:151], v[92:95], v[40:55]
    v_bitop3_b32 v12, v12, v88, v92 bitop3:0x80
    ds_read_b128 v[72:75], v117 offset:0
    ds_read_b128 v[76:79], v117 offset:1024
    s_waitcnt lgkmcnt(3)
    v_mfma_f32_32x32x16_bf16 v[40:55], a[152:155], v[96:99], v[40:55]
    ds_read_b128 v[80:83], v117 offset:2048
    ds_read_b128 v[84:87], v117 offset:3072
    s_waitcnt lgkmcnt(4)
    v_mfma_f32_32x32x16_bf16 v[40:55], a[156:159], v[100:103], v[40:55]
    v_bitop3_b32 v12, v12, v96, v100 bitop3:0x80
    v_cmp_eq_u32 vcc, 0, v12
    ds_read_b128 v[88:91], v117 offset:4096
    ds_read_b128 v[92:95], v117 offset:5120
    s_waitcnt lgkmcnt(5)
    v_mfma_f32_32x32x16_bf16 v[40:55], a[160:163], v[72:75], v[40:55]
    ds_read_b128 v[96:99], v117 offset:6144
    ds_read_b128 v[100:103], v117 offset:7168
    s_cmp_eq_u64 vcc, 0
    s_cselect_b64 exec, 1, 0
    buffer_store_dword v106, off, s[40:43], s16 offset:64 sc1
    s_mov_b64 exec, -1
    s_cselect_b32 s62, 1, 0
    s_waitcnt lgkmcnt(6)
    v_mfma_f32_32x32x16_bf16 v[40:55], a[164:167], v[76:79], v[40:55]
    v_bitop3_b32 v12, v12, v72, v76 bitop3:0x80
    ds_read_b128 v[72:75], v118 offset:0
    s_waitcnt lgkmcnt(6)
    v_mfma_f32_32x32x16_bf16 v[40:55], a[168:171], v[80:83], v[40:55]
    ds_read_b128 v[76:79], v118 offset:1024
    v_and_b32 v104, 31, v0
    s_waitcnt lgkmcnt(6)
    v_mfma_f32_32x32x16_bf16 v[40:55], a[172:175], v[84:87], v[40:55]
    v_bitop3_b32 v12, v12, v80, v84 bitop3:0x80
    ds_read_b128 v[80:83], v118 offset:2048
    v_lshl_add_u32 v104, v104, 6, s81
    s_waitcnt lgkmcnt(6)
    v_mfma_f32_32x32x16_bf16 v[40:55], a[176:179], v[88:91], v[40:55]
    ds_read_b128 v[84:87], v118 offset:3072
    v_lshrrev_b32 v105, 4, v0
    s_waitcnt lgkmcnt(6)
    v_mfma_f32_32x32x16_bf16 v[40:55], a[180:183], v[92:95], v[40:55]
    v_bitop3_b32 v12, v12, v88, v92 bitop3:0x80
    ds_read_b128 v[88:91], v118 offset:4096
    v_xor_b32 v105, v105, v0
    s_waitcnt lgkmcnt(6)
    v_mfma_f32_32x32x16_bf16 v[40:55], a[120:123], v[96:99], v[40:55]
    ds_read_b128 v[92:95], v118 offset:5120
    v_and_b32 v105, 6, v105
    s_waitcnt lgkmcnt(6)
    v_mfma_f32_32x32x16_bf16 v[40:55], a[124:127], v[100:103], v[40:55]
    v_bitop3_b32 v12, v12, v96, v100 bitop3:0x80
    ds_read_b128 v[96:99], v118 offset:6144
    v_lshl_add_u32 v108, v105, 3, v104
    s_waitcnt lgkmcnt(6)
    v_mfma_f32_32x32x16_bf16 v[40:55], a[184:187], v[72:75], v[40:55]
    ds_read_b128 v[100:103], v118 offset:7168
    v_xor_b32 v109, 32, v108
    s_waitcnt lgkmcnt(6)
    v_mfma_f32_32x32x16_bf16 v[40:55], a[188:191], v[76:79], v[40:55]
    v_bitop3_b32 v12, v12, v72, v76 bitop3:0x80
    ds_read_b128 v[72:75], v119 offset:0
    v_lshrrev_b32 v104, 3, v0
    s_waitcnt lgkmcnt(6)
    v_mfma_f32_32x32x16_bf16 v[40:55], a[192:195], v[80:83], v[40:55]
    ds_read_b128 v[76:79], v119 offset:1024
    v_xor_b32 v104, v104, v0
    s_waitcnt lgkmcnt(6)
    v_mfma_f32_32x32x16_bf16 v[40:55], a[196:199], v[84:87], v[40:55]
    v_bitop3_b32 v12, v12, v80, v84 bitop3:0x80
    ds_read_b128 v[80:83], v119 offset:2048
    buffer_load_dword v140, v141, s[40:43], 0 offen offset:64 sc1
    v_and_b32 v104, 3, v104
    s_waitcnt lgkmcnt(6)
    v_mfma_f32_32x32x16_bf16 v[40:55], a[200:203], v[88:91], v[40:55]
    ds_read_b128 v[84:87], v119 offset:3072
    v_lshlrev_b32 v104, 4, v104
    s_waitcnt lgkmcnt(6)
    v_mfma_f32_32x32x16_bf16 v[40:55], a[204:207], v[92:95], v[40:55]
    v_bitop3_b32 v12, v12, v88, v92 bitop3:0x80
    ds_read_b128 v[88:91], v119 offset:4096
    v_lshrrev_b32 v105, 2, v0
    s_waitcnt lgkmcnt(6)
    v_mfma_f32_32x32x16_bf16 v[40:55], a[208:211], v[96:99], v[40:55]
    ds_read_b128 v[92:95], v119 offset:5120
    v_lshl_add_u32 v110, v105, 10, v104
    s_waitcnt lgkmcnt(6)
    v_mfma_f32_32x32x16_bf16 v[40:55], a[212:215], v[100:103], v[40:55]
    v_bitop3_b32 v12, v12, v96, v100 bitop3:0x80
    ds_read_b128 v[96:99], v119 offset:6144
    s_add_u32 s87, s89, 16384
    s_waitcnt lgkmcnt(6)
    v_mfma_f32_32x32x16_bf16 v[40:55], a[216:219], v[72:75], v[40:55]
    ds_read_b128 v[100:103], v119 offset:7168
    s_waitcnt lgkmcnt(6)
    v_mfma_f32_32x32x16_bf16 v[40:55], a[220:223], v[76:79], v[40:55]
    v_bitop3_b32 v12, v12, v72, v76 bitop3:0x80
    s_waitcnt lgkmcnt(5)
    v_mfma_f32_32x32x16_bf16 v[40:55], a[224:227], v[80:83], v[40:55]
    s_waitcnt lgkmcnt(4)
    v_bitop3_b32 v12, v12, v80, v84 bitop3:0x80
    s_waitcnt lgkmcnt(2)
    v_bitop3_b32 v12, v12, v88, v92 bitop3:0x80
    v_mfma_f32_32x32x16_bf16 v[40:55], a[228:231], v[84:87], v[40:55]
    s_waitcnt lgkmcnt(0)
    v_bitop3_b32 v12, v12, v96, v100 bitop3:0x80
    v_cmp_eq_u32 vcc, 0, v12
    v_mfma_f32_32x32x16_bf16 v[40:55], a[232:235], v[88:91], v[40:55]
    s_cbranch_vccnz L_obad3_s
    v_mfma_f32_32x32x16_bf16 v[40:55], a[236:239], v[92:95], v[40:55]
    s_waitcnt vmcnt(0)
    v_cmp_gt_u32 vcc, 4, v140
    v_mfma_f32_32x32x16_bf16 v[40:55], a[240:243], v[96:99], v[40:55]
    s_cbranch_vccnz Lrefb_46_s
Lfc_45_s:
    v_mfma_f32_32x32x16_bf16 v[24:39], a[244:247], v[100:103], v[40:55]
    s_nop 11
    v_cvt_pk_bf16_f32 v43, v30, v31
    v_cvt_pk_bf16_f32 v42, v28, v29
    v_cvt_pk_bf16_f32 v41, v26, v27
    v_cvt_pk_bf16_f32 v40, v24, v25
    ds_write_b128 v108, v[40:43]
    v_cvt_pk_bf16_f32 v47, v38, v39
    v_cvt_pk_bf16_f32 v46, v36, v37
    v_cvt_pk_bf16_f32 v45, v34, v35
    v_cvt_pk_bf16_f32 v44, v32, v33
    ds_write_b128 v109, v[44:47]
    ds_read_b128 v[56:59], v21 offset:0
    ds_read_b128 v[60:63], v21 offset:1024
    s_waitcnt lgkmcnt(1)
    buffer_store_dwordx4 v[56:59], v110, s[44:47], s89 offen
    s_waitcnt lgkmcnt(0)
    buffer_store_dwordx4 v[60:63], v110, s[44:47], s87 offen
    s_endpgm
L_cold1_s:
    .p2align 6
L_partre_s:
    v_cmp_eq_u32 s[20:21], -1, v132
    v_cmp_eq_u32 s[22:23], -1, v136
    v_cmp_eq_u32 s[24:25], -1, v140
    v_cmp_eq_u32 s[26:27], -1, v144
    v_cmp_eq_u32 s[18:19], -1, v128
    v_cmp_eq_u32 s[28:29], -1, v148
    v_cmp_eq_u32 s[30:31], -1, v152
    v_cmp_eq_u32 s[56:57], -1, v156
    v_cmp_eq_u32 s[58:59], -1, v160
    s_mov_b64 exec, s[20:21]
    buffer_load_dwordx4 v[132:135], v13, s[40:43], s12 offen offset:0 sc1
    s_mov_b64 exec, s[22:23]
    buffer_load_dwordx4 v[136:139], v13, s[40:43], s12 offen offset:256 sc1
    s_mov_b64 exec, s[24:25]
    buffer_load_dwordx4 v[140:143], v13, s[40:43], s13 offen offset:0 sc1
    s_mov_b64 exec, s[26:27]
    buffer_load_dwordx4 v[144:147], v13, s[40:43], s13 offen offset:256 sc1
    s_mov_b64 exec, s[18:19]
    buffer_load_dwordx4 v[128:131], v14, s[40:43], s12 offen sc1
    s_mov_b64 exec, s[28:29]
    buffer_load_dwordx4 v[148:151], v13, s[40:43], s14 offen offset:0 sc1
    s_mov_b64 exec, s[30:31]
    buffer_load_dwordx4 v[152:155], v13, s[40:43], s14 offen offset:256 sc1
    s_mov_b64 exec, s[56:57]
    buffer_load_dwordx4 v[156:159], v13, s[40:43], s15 offen offset:0 sc1
    s_mov_b64 exec, s[58:59]
    buffer_load_dwordx4 v[160:163], v13, s[40:43], s15 offen offset:256 sc1
    s_mov_b64 exec, -1
    s_or_b64 s[18:19], s[18:19], s[20:21]
    s_or_b64 s[18:19], s[18:19], s[22:23]
    s_or_b64 s[18:19], s[18:19], s[24:25]
    s_or_b64 s[18:19], s[18:19], s[26:27]
    s_or_b64 s[18:19], s[18:19], s[28:29]
    s_or_b64 s[18:19], s[18:19], s[30:31]
    s_or_b64 s[18:19], s[18:19], s[56:57]
    s_or_b64 s[18:19], s[18:19], s[58:59]
    s_cbranch_scc0 L_scan_s
L_resum_s:
    s_sub_u32 s68, s68, 1
    s_cbranch_scc1 L_end
    s_cmp_eq_u32 s67, 0
    s_cbranch_scc1 L_part_w0_s
    s_cmp_eq_u32 s67, 1
    s_cbranch_scc1 L_part_w1_s
    s_cmp_eq_u32 s67, 2
    s_cbranch_scc1 L_part_w2_s
L_part_w3_s:
    s_waitcnt vmcnt(0)
    v_mfma_f32_16x16x32_bf16 v[56:59], v[192:195], v[132:135], 0
    v_mfma_f32_16x16x32_bf16 v[56:59], v[196:199], v[136:139], v[56:59]
    v_mfma_f32_16x16x32_bf16 v[56:59], v[192:195], v[140:143], v[56:59]
    v_mfma_f32_16x16x32_bf16 v[56:59], v[196:199], v[144:147], v[56:59]
    s_branch L_part3_s
L_part_w0_s:
    s_waitcnt vmcnt(0)
    s_branch L_part0_s
L_part_w1_s:
    s_waitcnt vmcnt(0)
    s_nop 1
    v_mfma_f32_16x16x32_bf16 v[56:59], v[192:195], v[132:135], 0
    v_mfma_f32_16x16x32_bf16 v[56:59], v[196:199], v[136:139], v[56:59]
    v_mfma_f32_16x16x32_bf16 v[56:59], v[192:195], v[140:143], v[56:59]
    v_mfma_f32_16x16x32_bf16 v[56:59], v[196:199], v[144:147], v[56:59]
    s_branch L_part1_s
L_part_w2_s:
    s_waitcnt vmcnt(0)
    s_nop 3
    v_mfma_f32_16x16x32_bf16 v[56:59], v[192:195], v[132:135], 0
    v_mfma_f32_16x16x32_bf16 v[56:59], v[196:199], v[136:139], v[56:59]
    v_mfma_f32_16x16x32_bf16 v[56:59], v[192:195], v[140:143], v[56:59]
    v_mfma_f32_16x16x32_bf16 v[56:59], v[196:199], v[144:147], v[56:59]
    s_branch L_part2_s
Lrefb_13_s:
    s_sub_u32 s68, s68, 1
    s_cbranch_scc1 L_end
    buffer_load_dword v140, v141, s[40:43], 0 offen offset:64 sc1
    s_waitcnt vmcnt(0)
    v_cmp_gt_u32 vcc, 1, v140
    s_cbranch_vccnz Lrefb_13_s
    s_branch Lfc_12_s
Lrefb_24_s:
    s_sub_u32 s68, s68, 1
    s_cbranch_scc1 L_end
    buffer_load_dword v140, v141, s[40:43], 0 offen offset:64 sc1
    s_waitcnt vmcnt(0)
    v_cmp_gt_u32 vcc, 2, v140
    s_cbranch_vccnz Lrefb_24_s
    s_branch Lfc_23_s
Lrefb_35_s:
    s_sub_u32 s68, s68, 1
    s_cbranch_scc1 L_end
    buffer_load_dword v140, v141, s[40:43], 0 offen offset:64 sc1
    s_waitcnt vmcnt(0)
    v_cmp_gt_u32 vcc, 3, v140
    s_cbranch_vccnz Lrefb_35_s
    s_branch Lfc_34_s
Lrefb_46_s:
    s_sub_u32 s68, s68, 1
    s_cbranch_scc1 L_end
    buffer_load_dword v140, v141, s[40:43], 0 offen offset:64 sc1
    s_waitcnt vmcnt(0)
    v_cmp_gt_u32 vcc, 4, v140
    s_cbranch_vccnz Lrefb_46_s
    s_branch Lfc_45_s
Lstre_17_s:
    s_sub_u32 s68, s68, 1
    s_cbranch_scc1 L_end
    buffer_load_dword v112, v20, s[40:43], s77 offen offset:256 sc1
    buffer_load_dword v113, v20, s[40:43], s77 offen offset:1280 sc1
    buffer_load_dword v114, v20, s[40:43], s77 offen offset:2304 sc1
    buffer_load_dword v115, v20, s[40:43], s77 offen offset:3328 sc1
    s_waitcnt vmcnt(0)
    v_max3_u32 v120, v112, v113, v114
    v_max_u32 v120, v120, v115
    v_cmp_eq_u32 vcc, -1, v120
    s_cbranch_vccnz Lstre_17_s
    s_branch Lstok_18_s
L_xbad1_s:
    s_sub_u32 s68, s68, 1
    s_cbranch_scc1 L_end
    s_waitcnt vmcnt(0) lgkmcnt(0)
    s_nop 7
    s_xor_b32 s96, s70, 0
    buffer_load_dwordx4 v[128:131], v1, s[44:47], s96 offen offset:0 sc1
    buffer_load_dwordx4 v[132:135], v1, s[44:47], s96 offen offset:1024 sc1
    buffer_load_dwordx4 v[136:139], v1, s[44:47], s96 offen offset:2048 sc1
    buffer_load_dwordx4 v[140:143], v1, s[44:47], s96 offen offset:3072 sc1
    s_xor_b32 s96, s70, 4096
    buffer_load_dwordx4 v[144:147], v1, s[44:47], s96 offen offset:0 sc1
    s_waitcnt lgkmcnt(0)
    s_branch L_xre1_s
Lrefa_20_s:
    s_sub_u32 s68, s68, 1
    s_cbranch_scc1 L_end
    buffer_load_dword v164, v19, s[40:43], 0 offen offset:64 sc1
    s_waitcnt vmcnt(0)
    v_cmp_gt_u32 vcc, 1, v164
    s_cbranch_vccnz Lrefa_20_s
    s_branch Lfc_19_s
L_obad1_s:
    s_sub_u32 s68, s68, 1
    s_cbranch_scc1 L_end
    s_waitcnt vmcnt(0) lgkmcnt(0)
    s_barrier
    s_nop 7
    s_cmp_eq_u32 s62, 0
    s_cbranch_scc0 L_okeep1_s
    s_cmp_eq_u32 s66, s0
    s_cbranch_scc1 L_opoll1_s
    s_branch L_ore1_s
L_okeep1_s:
    s_barrier
    s_branch L_oskip1_s
Lstre_28_s:
    s_sub_u32 s68, s68, 1
    s_cbranch_scc1 L_end
    buffer_load_dword v112, v20, s[40:43], s77 offen offset:512 sc1
    buffer_load_dword v113, v20, s[40:43], s77 offen offset:1536 sc1
    buffer_load_dword v114, v20, s[40:43], s77 offen offset:2560 sc1
    buffer_load_dword v115, v20, s[40:43], s77 offen offset:3584 sc1
    s_waitcnt vmcnt(0)
    v_max3_u32 v120, v112, v113, v114
    v_max_u32 v120, v120, v115
    v_cmp_eq_u32 vcc, -1, v120
    s_cbranch_vccnz Lstre_28_s
    s_branch Lstok_29_s
L_xbad2_s:
    s_sub_u32 s68, s68, 1
    s_cbranch_scc1 L_end
    s_waitcnt vmcnt(0) lgkmcnt(0)
    s_nop 7
    ds_read_b64_tr_b16 v[72:73], v3 offset:0
    ds_read_b64_tr_b16 v[74:75], v3 offset:256
    ds_read_b64_tr_b16 v[76:77], v3 offset:32768
    ds_read_b64_tr_b16 v[78:79], v3 offset:33024
    ds_read_b64_tr_b16 v[80:81], v3 offset:1024
    ds_read_b64_tr_b16 v[82:83], v3 offset:1280
    ds_read_b64_tr_b16 v[84:85], v3 offset:33792
    ds_read_b64_tr_b16 v[86:87], v3 offset:34048
    ds_read_b64_tr_b16 v[88:89], v3 offset:2048
    ds_read_b64_tr_b16 v[90:91], v3 offset:2304
    ds_read_b64_tr_b16 v[92:93], v3 offset:34816
    ds_read_b64_tr_b16 v[94:95], v3 offset:35072
    s_xor_b32 s96, s70, 0
    buffer_load_dwordx4 v[128:131], v1, s[44:47], s96 offen offset:0 sc1
    buffer_load_dwordx4 v[132:135], v1, s[44:47], s96 offen offset:1024 sc1
    buffer_load_dwordx4 v[136:139], v1, s[44:47], s96 offen offset:2048 sc1
    buffer_load_dwordx4 v[140:143], v1, s[44:47], s96 offen offset:3072 sc1
    s_waitcnt lgkmcnt(0)
    s_branch L_xre2_s
Lrefa_31_s:
    s_sub_u32 s68, s68, 1
    s_cbranch_scc1 L_end
    buffer_load_dword v164, v19, s[40:43], 0 offen offset:64 sc1
    s_waitcnt vmcnt(0)
    v_cmp_gt_u32 vcc, 2, v164
    s_cbranch_vccnz Lrefa_31_s
    s_branch Lfc_30_s
L_obad2_s:
    s_sub_u32 s68, s68, 1
    s_cbranch_scc1 L_end
    s_waitcnt vmcnt(0) lgkmcnt(0)
    s_barrier
    s_nop 7
    s_cmp_eq_u32 s62, 0
    s_cbranch_scc0 L_okeep2_s
    s_cmp_eq_u32 s66, s0
    s_cbranch_scc1 L_opoll2_s
    s_branch L_ore2_s
L_okeep2_s:
    s_barrier
    s_branch L_oskip2_s
Lstre_39_s:
    s_sub_u32 s68, s68, 1
    s_cbranch_scc1 L_end
    buffer_load_dword v112, v20, s[40:43], s77 offen offset:768 sc1
    buffer_load_dword v113, v20, s[40:43], s77 offen offset:1792 sc1
    buffer_load_dword v114, v20, s[40:43], s77 offen offset:2816 sc1
    buffer_load_dword v115, v20, s[40:43], s77 offen offset:3840 sc1
    s_waitcnt vmcnt(0)
    v_max3_u32 v120, v112, v113, v114
    v_max_u32 v120, v120, v115
    v_cmp_eq_u32 vcc, -1, v120
    s_cbranch_vccnz Lstre_39_s
    s_branch Lstok_40_s
L_xbad3_s:
    s_sub_u32 s68, s68, 1
    s_cbranch_scc1 L_end
    s_waitcnt vmcnt(0) lgkmcnt(0)
    s_nop 7
    ds_read_b128 v[72:75], v1 offset:0
    ds_read_b128 v[76:79], v1 offset:32768
    ds_read_b128 v[80:83], v1 offset:1024
    ds_read_b128 v[84:87], v1 offset:33792
    ds_read_b128 v[88:91], v1 offset:2048
    ds_read_b128 v[92:95], v1 offset:34816
    s_xor_b32 s96, s70, 0
    buffer_load_dwordx4 v[128:131], v1, s[44:47], s96 offen offset:0 sc1
    buffer_load_dwordx4 v[132:135], v1, s[44:47], s96 offen offset:1024 sc1
    buffer_load_dwordx4 v[136:139], v1, s[44:47], s96 offen offset:2048 sc1
    buffer_load_dwordx4 v[140:143], v1, s[44:47], s96 offen offset:3072 sc1
    s_waitcnt lgkmcnt(0)
    s_branch L_xre3_s
L_scan_s:
    v_max3_u32 v104, v128, v129, v130
    v_max3_u32 v104, v104, v131, v132
    v_max3_u32 v104, v104, v133, v134
    v_max3_u32 v104, v104, v135, v136
    v_max3_u32 v104, v104, v137, v138
    v_max3_u32 v104, v104, v139, v140
    v_max3_u32 v104, v104, v141, v142
    v_max3_u32 v104, v104, v143, v144
    v_max3_u32 v104, v104, v145, v146
    v_max3_u32 v104, v104, v147, v148
    v_max3_u32 v104, v104, v149, v150
    v_max3_u32 v104, v104, v151, v152
    v_max3_u32 v104, v104, v153, v154
    v_max3_u32 v104, v104, v155, v156
    v_max3_u32 v104, v104, v157, v158
    v_max3_u32 v104, v104, v159, v160
    v_max3_u32 v104, v104, v161, v162
    v_max_u32 v104, v104, v163
    v_cmp_eq_u32 vcc, -1, v104
    s_cbranch_vccnz L_all_s
    s_cmp_eq_u32 s67, 0
    s_cbranch_scc1 L_partok0_s
    s_cmp_eq_u32 s67, 1
    s_cbranch_scc1 L_partok1_s
    s_cmp_eq_u32 s67, 2
    s_cbranch_scc1 L_partok2_s
    s_branch L_partok3_s
L_all_s:
    buffer_load_dwordx4 v[128:131], v14, s[40:43], s12 offen sc1
    buffer_load_dwordx4 v[132:135], v13, s[40:43], s12 offen offset:0 sc1
    buffer_load_dwordx4 v[136:139], v13, s[40:43], s12 offen offset:256 sc1
    buffer_load_dwordx4 v[140:143], v13, s[40:43], s13 offen offset:0 sc1
    buffer_load_dwordx4 v[144:147], v13, s[40:43], s13 offen offset:256 sc1
    buffer_load_dwordx4 v[148:151], v13, s[40:43], s14 offen offset:0 sc1
    buffer_load_dwordx4 v[152:155], v13, s[40:43], s14 offen offset:256 sc1
    buffer_load_dwordx4 v[156:159], v13, s[40:43], s15 offen offset:0 sc1
    buffer_load_dwordx4 v[160:163], v13, s[40:43], s15 offen offset:256 sc1
    s_branch L_resum_s
Lrefa_42_s:
    s_sub_u32 s68, s68, 1
    s_cbranch_scc1 L_end
    buffer_load_dword v164, v19, s[40:43], 0 offen offset:64 sc1
    s_waitcnt vmcnt(0)
    v_cmp_gt_u32 vcc, 3, v164
    s_cbranch_vccnz Lrefa_42_s
    s_branch Lfc_41_s
L_obad3_s:
    s_sub_u32 s68, s68, 1
    s_cbranch_scc1 L_end
    s_waitcnt vmcnt(0) lgkmcnt(0)
    s_barrier
    s_nop 7
    s_cmp_eq_u32 s62, 0
    s_cbranch_scc0 L_okeep3_s
    s_cmp_eq_u32 s66, s0
    s_cbranch_scc1 L_opoll3_s
    s_branch L_ore3_s
L_okeep3_s:
    s_barrier
    s_branch L_oskip3_s
.section .rodata,"a"
.p2align 6
.amdhsa_kernel interleave_layers__linear_kernel_hedgehog__linear_kernel_hedgehog__prompt_kernel
  .amdhsa_next_free_vgpr 512
  .amdhsa_next_free_sgpr 102
  .amdhsa_accum_offset 256
  .amdhsa_group_segment_fixed_size 0
  .amdhsa_kernarg_size 88
  .amdhsa_user_sgpr_count 2
  .amdhsa_user_sgpr_kernarg_segment_ptr 1
  .amdhsa_system_sgpr_workgroup_id_x 1
  .amdhsa_float_denorm_mode_32 3
.end_amdhsa_kernel
```
